```python
import torch

def _softmax(x, axis=-1):
    return torch.softmax(x, dim=axis)
def _gelu(x):
    return torch.nn.functional.gelu(x, approximate="tanh")
def _silu(x):
    return torch.nn.functional.silu(x)
def _sigmoid(x):
    return torch.sigmoid(x)
def _layernorm(x, axis=-1, eps=1e-5):
    m = x.mean(dim=axis, keepdim=True)
    v = x.var(dim=axis, keepdim=True, unbiased=False)
    return (x - m) / torch.sqrt(v + eps)
def _scatter_add(tgt, idx, src, axis=0):
    return tgt.clone().index_add_(axis, idx, src)
def _segment_sum(src, seg, n):
    out = torch.zeros((n,) + src.shape[1:], dtype=src.dtype)
    return out.index_add_(0, seg, src)
def _pad(x, pw):
    flat = tuple(v for pair in reversed(pw) for v in pair)
    return torch.nn.functional.pad(x, flat)

kernel_name = 'sequential_preLN__ssm_conv_h3__glu_gated_swiglu__prompt'

def setup_inputs():

    _w = (lambda a: (lambda t: t.to(torch.bfloat16) if t.is_floating_point() else t)(torch.as_tensor(a)))
    def _A_setup():
        B, S, D = 1, 2048, 1024
        ks = 4
        return {
            "q": _w((lambda *s: torch.randn(*s, dtype=torch.bfloat16) * 0.05)(B, S, D)),
            "k": _w((lambda *s: torch.randn(*s, dtype=torch.bfloat16) * 0.2)(B, S, D)),
            "v": _w((lambda *s: torch.randn(*s, dtype=torch.bfloat16) * 0.2)(B, S, D)),
            "shift_k": _w((lambda *s: torch.randn(*s, dtype=torch.bfloat16) * 0.2)(D, ks) * 0.5),
            "ssm_k": _w((lambda *s: torch.randn(*s, dtype=torch.bfloat16) * 0.4)(D, S) * (1.0 / S ** 0.5)),
            "ssm_D": _w((lambda *s: torch.randn(*s, dtype=torch.bfloat16) * 0.2)(D)),
        }
    _A_in = _A_setup()

    def _B_setup():
        B, S, D, F = 1, 2048, 1024, 3584
        return {
            "x": _w((lambda *s: torch.randn(*s, dtype=torch.bfloat16) * 0.05)(B, S, D)),
            "w1": _w((lambda *s: torch.randn(*s, dtype=torch.bfloat16) * 0.2)(D, F) * (2.0 / D) ** 0.5),
            "w3": _w((lambda *s: torch.randn(*s, dtype=torch.bfloat16) * 0.2)(D, F) * (2.0 / D) ** 0.5),
            "w2": _w((lambda *s: torch.randn(*s, dtype=torch.bfloat16) * 0.2)(F, D) * (2.0 / F) ** 0.5),
        }
    _B_in = _B_setup()

    return {
        "A_q": _A_in["q"],
        "A_k": _A_in["k"],
        "A_v": _A_in["v"],
        "A_shift_k": _A_in["shift_k"],
        "A_ssm_k": _A_in["ssm_k"],
        "A_ssm_D": _A_in["ssm_D"],
        "B_x": _B_in["x"],
        "B_w1": _B_in["w1"],
        "B_w3": _B_in["w3"],
        "B_w2": _B_in["w2"],
    }

def reference(A_q, A_k, A_v, A_shift_k, A_ssm_k, A_ssm_D, B_x, B_w1, B_w3, B_w2):
    def _A_ref(q, k, v, shift_k, ssm_k, ssm_D):
        B, S, D = q.shape
        ks = shift_k.shape[-1]
        k_pad = _pad(k, ((0, 0), (ks - 1, 0), (0, 0)))
        k_shift = torch.zeros_like(k)
        for t in range(ks):
            k_shift = k_shift + k_pad[:, t:t + S, :] * shift_k[:, ks - 1 - t][None, None, :]
        kv = k_shift * v
        L = 2 * S
        kv_pad = _pad(kv, ((0, 0), (0, S), (0, 0)))
        kf_pad = _pad(ssm_k, ((0, 0), (0, S)))
        kv_f = (lambda x, axes=(-2,-1): torch.fft.rfft2(x.float(), dim=axes))(kv_pad[:, None, :, :], axes=(1, 2))
        kf_f = (lambda x, axes=(-2,-1): torch.fft.rfft2(x.float(), dim=axes))(kf_pad[:, None, :], axes=(1, 2))
        kf_f = (lambda x, *d: x.permute(*d))(kf_f, 1, 2, 0)
        y_f = kv_f * kf_f[None, :, :, :]
        y = (lambda x, s, axes=(-2,-1): torch.fft.irfft2(x, s=s, dim=axes).to(torch.bfloat16))(y_f, (1, L), axes=(1, 2))[:, 0, :S, :]
        y = y + kv * ssm_D[None, None, :]
        return q * y

    def _B_ref(x, w1, w3, w2):
        gate = torch.einsum("bsd,df->bsf", x, w1)
        up = torch.einsum("bsd,df->bsf", x, w3)
        h = _silu(gate) * up
        out = torch.einsum("bsf,fd->bsd", h, w2)
        return out

    x = A_q
    h = x + _A_ref(_layernorm(x, axis=-1), A_k, A_v, A_shift_k, A_ssm_k, A_ssm_D)
    h2 = h + _B_ref(_layernorm(h, axis=-1), B_w1, B_w3, B_w2)
    return h2
```

```asm
; @launch kernel=sequential_preLN__ssm_conv_h3__glu_gated_swiglu__prompt_kernel grid=(256,1,1) block=(256,1,1) lds=160064
.amdgcn_target "amdgcn-amd-amdhsa--gfx950"
.text
.globl sequential_preLN__ssm_conv_h3__glu_gated_swiglu__prompt_kernel
.p2align 8
.type sequential_preLN__ssm_conv_h3__glu_gated_swiglu__prompt_kernel,@function
sequential_preLN__ssm_conv_h3__glu_gated_swiglu__prompt_kernel:
s_cmp_ge_u32 s2, 256
s_cbranch_scc1 L_g12_end
s_load_dwordx8 s[24:31], s[0:1], 0
s_load_dwordx4 s[32:35], s[0:1], 32
s_load_dwordx4 s[36:39], s[0:1], 56
s_load_dwordx4 s[44:47], s[0:1], 88
v_lshrrev_b32 v1, 6, v0
v_and_b32 v0, 63, v0
s_and_b32 s40, s2, 7
v_readfirstlane_b32 s3, v1
s_lshl_b32 s40, s40, 5
s_lshr_b32 s41, s2, 3
s_add_u32 s40, s40, s41
s_lshl_b32 s41, s40, 3
s_xor_b32 s50, s40, 128
s_lshr_b32 s50, s50, 4
s_and_b32 s51, s40, 15
s_lshl_b32 s52, s51, 2
s_add_u32 s52, s52, s3
s_lshl_b32 s52, s52, 16
s_lshl_b32 s53, s50, 7
s_add_u32 s52, s52, s53
v_lshrrev_b32 v5, 4, v0
v_and_b32 v6, 15, v0
v_lshlrev_b32 v2, 14, v5
v_lshl_add_u32 v2, v6, 3, v2
v_add_u32 v2, s52, v2
v_subrev_u32 v3, 6144, v2
v_cmp_gt_u32 vcc, 2048, v2
v_mov_b32 v8, 0x80000000
s_lshl_b32 s53, s50, 9
v_cndmask_b32 v3, v3, v8, vcc
v_lshl_add_u32 v7, v6, 5, s53
v_lshlrev_b32 v4, 4, v0
v_mov_b32 v242, 0
v_mov_b32 v243, 0
v_mov_b32 v244, 0
v_mov_b32 v245, 0
s_mul_i32 s62, s3, 37952
s_mov_b32 s48, 4096
s_mov_b32 s49, 8192
s_mov_b32 s60, 12288
s_lshl_b32 s43, s2, 9
s_lshl_b32 s63, s3, 7
s_add_u32 s43, s43, s63
s_add_u32 s43, s43, 28049408
s_waitcnt lgkmcnt(0)
s_add_u32 s100, s46, 27983872
s_addc_u32 s101, s47, 0
s_load_dword s42, s[100:101], 0
s_mov_b32 s20, s46
s_and_b32 s21, s47, 0xffff
s_mov_b32 s22, 268435456
s_mov_b32 s23, 0x00020000
s_mov_b32 s8, s26
s_and_b32 s9, s27, 0xffff
s_mov_b32 s10, 4194304
s_mov_b32 s11, 0x00020000
s_mov_b64 exec, 0xff
buffer_store_dwordx4 v[242:245], v4, s[20:23], s43 offen sc1
s_mov_b64 exec, -1
buffer_load_dwordx2 v[16:17], v3, s[8:11], 0 offen offset:0
buffer_load_dwordx2 v[18:19], v3, s[8:11], 0 offen offset:2048
buffer_load_dwordx2 v[20:21], v3, s[8:11], s48 offen offset:0
buffer_load_dwordx2 v[22:23], v2, s[8:11], 0 offen offset:0
buffer_load_dwordx2 v[24:25], v2, s[8:11], 0 offen offset:2048
buffer_load_dwordx2 v[26:27], v2, s[8:11], s48 offen offset:0
buffer_load_dwordx2 v[28:29], v2, s[8:11], s48 offen offset:2048
buffer_load_dwordx2 v[30:31], v2, s[8:11], s49 offen offset:0
buffer_load_dwordx2 v[32:33], v2, s[8:11], s49 offen offset:2048
buffer_load_dwordx2 v[34:35], v2, s[8:11], s60 offen offset:0
buffer_load_dwordx2 v[36:37], v2, s[8:11], s60 offen offset:2048
s_mov_b32 s4, s30
s_and_b32 s5, s31, 0xffff
s_mov_b32 s6, 8192
s_mov_b32 s7, 0x00020000
buffer_load_dwordx4 v[162:165], v7, s[4:7], 0 offen offset:0
buffer_load_dwordx4 v[166:169], v7, s[4:7], 0 offen offset:16
s_mov_b32 s12, s28
s_and_b32 s13, s29, 0xffff
s_mov_b32 s14, 4194304
s_mov_b32 s15, 0x00020000
buffer_load_dwordx2 v[38:39], v2, s[12:15], 0 offen offset:0
buffer_load_dwordx2 v[40:41], v2, s[12:15], 0 offen offset:2048
buffer_load_dwordx2 v[42:43], v2, s[12:15], s48 offen offset:0
buffer_load_dwordx2 v[44:45], v2, s[12:15], s48 offen offset:2048
buffer_load_dwordx2 v[46:47], v2, s[12:15], s49 offen offset:0
buffer_load_dwordx2 v[48:49], v2, s[12:15], s49 offen offset:2048
buffer_load_dwordx2 v[50:51], v2, s[12:15], s60 offen offset:0
buffer_load_dwordx2 v[52:53], v2, s[12:15], s60 offen offset:2048
s_mov_b32 s4, s24
s_and_b32 s5, s25, 0xffff
s_mov_b32 s6, 4194304
s_mov_b32 s7, 0x00020000
s_mov_b32 s16, s32
s_and_b32 s17, s33, 0xffff
s_mov_b32 s18, 4194304
s_mov_b32 s19, 0x00020000
s_lshl_b32 s61, s40, 2
s_add_u32 s61, s61, s3
s_lshl_b32 s61, s61, 12
v_add_u32 v6, s61, v4
v_subrev_u32 v7, 16, v6
v_cmp_eq_u32 vcc, 0, v0
s_add_u32 s34, s34, s41
s_addc_u32 s35, s35, 0
v_cndmask_b32 v8, v7, v8, vcc
s_load_dwordx2 s[54:55], s[34:35], 0
buffer_load_dwordx4 v[186:189], v8, s[16:19], 0 offen offset:0
buffer_load_dwordx4 v[190:193], v6, s[16:19], 0 offen offset:0
buffer_load_dwordx4 v[194:197], v7, s[16:19], 0 offen offset:1024
buffer_load_dwordx4 v[198:201], v6, s[16:19], 0 offen offset:1024
buffer_load_dwordx4 v[202:205], v7, s[16:19], 0 offen offset:2048
buffer_load_dwordx4 v[206:209], v6, s[16:19], 0 offen offset:2048
buffer_load_dwordx4 v[210:213], v7, s[16:19], 0 offen offset:3072
buffer_load_dwordx4 v[214:217], v6, s[16:19], 0 offen offset:3072
s_cmp_ge_u32 s2, 24
s_cbranch_scc1 L_k1_nocpf
s_getpc_b64 s[52:53]
L_k1_pc:
s_lshr_b32 s56, s2, 3
s_lshl_b32 s56, s56, 2
s_add_u32 s56, s56, s3
s_lshl_b32 s56, s56, 13
v_lshlrev_b32 v250, 7, v0
v_add_u32 v250, s56, v250
v_min_u32 v250, L_g12_end - L_k1_pc, v250
v_mov_b32 v251, s53
v_add_co_u32 v250, vcc, s52, v250
v_addc_co_u32 v251, vcc, 0, v251, vcc
global_load_dword v255, v[250:251], off
L_k1_nocpf:
v_add_u32 v9, s62, v4
v_mul_u32_u24 v10, 4160, v0
v_add_u32 v10, s62, v10
s_mov_b32 exec_hi, 0
ds_write_b128 v9, v[242:245] offset:37376
s_mov_b32 exec_lo, 0xff
ds_write_b128 v10, v[242:245]
s_lshl_b32 s52, s2, 7
s_add_u32 s52, s52, 27394048
s_cmp_eq_u32 s3, 1
s_cselect_b32 s52, s52, 0x80000000
buffer_store_dwordx4 v[242:245], v4, s[20:23], s52 offen sc1
s_mov_b32 exec_lo, 15
s_lshl_b32 s52, s2, 6
s_add_u32 s52, s52, 27328512
s_cmp_eq_u32 s3, 0
s_cselect_b32 s52, s52, 0x80000000
buffer_store_dwordx4 v[242:245], v4, s[20:23], s52 offen sc1
s_mov_b64 exec, -1
s_mov_b32 s56, s36
s_mov_b32 s57, s37
s_mov_b32 s58, s38
s_mov_b32 s59, s39
s_waitcnt lgkmcnt(0)
s_mul_i32 s44, s42, 0x9E3779B1
s_add_u32 s44, s44, 0x7F4A7C15
s_or_b32 s44, s44, 1
s_add_u32 s45, s42, 1
v_mov_b32 v14, s44
v_mov_b32 v15, 0
s_cmp_ge_u32 s3, 2
s_cselect_b32 s48, s55, s54
s_bitcmp1_b32 s3, 0
s_cselect_b32 s49, 0, 16
s_lshl_b32 s48, s48, s49
s_and_b32 s48, s48, 0xffff0000
v_and_b32 v6, 15, v0
v_lshrrev_b32 v7, 2, v6
v_mul_u32_u24 v8, 37952, v7
v_and_b32 v7, 3, v6
v_lshl_add_u32 v8, v7, 10, v8
s_lshl_b32 s49, s3, 2
s_sub_u32 s49, 15, s49
v_sub_u32 v5, s49, v5
v_xor_b32 v5, v5, v7
v_lshl_add_u32 v8, v5, 4, v8
v_add_u32 v8, 33280, v8
v_lshrrev_b32 v5, 4, v0
v_lshlrev_b32 v7, 8, v5
v_lshl_add_u32 v7, v6, 4, v7
s_add_u32 s49, s62, 33280
v_add_u32 v7, s49, v7
v_lshlrev_b32 v5, 12, v5
v_lshl_add_u32 v5, v6, 4, v5
s_lshl_b32 s49, s50, 2
s_add_u32 s49, s49, s3
s_lshl_b32 s49, s49, 16
s_sub_u32 s53, 15, s51
s_lshl_b32 s53, s53, 8
s_add_u32 s49, s49, s53
s_add_u32 s49, s49, 18874368
s_waitcnt vmcnt(18)
v_lshlrev_b32 v170, 16, v162
v_lshlrev_b32 v171, 16, v164
v_lshlrev_b32 v172, 16, v166
v_lshlrev_b32 v173, 16, v168
v_and_b32 v174, 0xffff0000, v162
v_and_b32 v175, 0xffff0000, v164
v_and_b32 v176, 0xffff0000, v166
v_and_b32 v177, 0xffff0000, v168
v_lshlrev_b32 v178, 16, v163
v_lshlrev_b32 v179, 16, v165
v_lshlrev_b32 v180, 16, v167
v_lshlrev_b32 v181, 16, v169
v_and_b32 v182, 0xffff0000, v163
v_and_b32 v183, 0xffff0000, v165
v_and_b32 v184, 0xffff0000, v167
v_and_b32 v185, 0xffff0000, v169
v_lshlrev_b32 v86, 16, v16
v_and_b32 v87, 0xffff0000, v16
v_lshlrev_b32 v88, 16, v17
v_and_b32 v89, 0xffff0000, v17
v_lshlrev_b32 v90, 16, v18
v_and_b32 v91, 0xffff0000, v18
v_lshlrev_b32 v92, 16, v19
v_and_b32 v93, 0xffff0000, v19
v_lshlrev_b32 v94, 16, v20
v_and_b32 v95, 0xffff0000, v20
v_lshlrev_b32 v96, 16, v21
v_and_b32 v97, 0xffff0000, v21
v_lshlrev_b32 v98, 16, v22
v_and_b32 v99, 0xffff0000, v22
v_lshlrev_b32 v100, 16, v23
v_and_b32 v101, 0xffff0000, v23
v_lshlrev_b32 v102, 16, v24
v_and_b32 v103, 0xffff0000, v24
v_lshlrev_b32 v104, 16, v25
v_and_b32 v105, 0xffff0000, v25
v_lshlrev_b32 v106, 16, v26
v_and_b32 v107, 0xffff0000, v26
v_lshlrev_b32 v108, 16, v27
v_and_b32 v109, 0xffff0000, v27
v_lshlrev_b32 v110, 16, v28
v_and_b32 v111, 0xffff0000, v28
v_lshlrev_b32 v112, 16, v29
v_and_b32 v113, 0xffff0000, v29
v_lshlrev_b32 v114, 16, v30
v_and_b32 v115, 0xffff0000, v30
v_lshlrev_b32 v116, 16, v31
v_and_b32 v117, 0xffff0000, v31
v_lshlrev_b32 v118, 16, v32
v_and_b32 v119, 0xffff0000, v32
v_lshlrev_b32 v120, 16, v33
v_and_b32 v121, 0xffff0000, v33
v_lshlrev_b32 v122, 16, v34
v_and_b32 v123, 0xffff0000, v34
v_lshlrev_b32 v124, 16, v35
v_and_b32 v125, 0xffff0000, v35
v_lshlrev_b32 v126, 16, v36
v_and_b32 v127, 0xffff0000, v36
v_lshlrev_b32 v128, 16, v37
v_and_b32 v129, 0xffff0000, v37
v_pk_mul_f32 v[130:131], v[98:99], v[170:171]
v_pk_mul_f32 v[132:133], v[100:101], v[172:173]
v_pk_fma_f32 v[130:131], v[94:95], v[174:175], v[130:131]
v_pk_fma_f32 v[132:133], v[96:97], v[176:177], v[132:133]
v_pk_fma_f32 v[130:131], v[90:91], v[178:179], v[130:131]
v_pk_fma_f32 v[132:133], v[92:93], v[180:181], v[132:133]
v_pk_fma_f32 v[130:131], v[86:87], v[182:183], v[130:131]
v_pk_fma_f32 v[132:133], v[88:89], v[184:185], v[132:133]
v_pk_mul_f32 v[134:135], v[102:103], v[170:171]
v_pk_mul_f32 v[136:137], v[104:105], v[172:173]
v_pk_fma_f32 v[134:135], v[98:99], v[174:175], v[134:135]
v_pk_fma_f32 v[136:137], v[100:101], v[176:177], v[136:137]
v_pk_fma_f32 v[134:135], v[94:95], v[178:179], v[134:135]
v_pk_fma_f32 v[136:137], v[96:97], v[180:181], v[136:137]
v_pk_fma_f32 v[134:135], v[90:91], v[182:183], v[134:135]
v_pk_fma_f32 v[136:137], v[92:93], v[184:185], v[136:137]
v_pk_mul_f32 v[138:139], v[106:107], v[170:171]
v_pk_mul_f32 v[140:141], v[108:109], v[172:173]
v_pk_fma_f32 v[138:139], v[102:103], v[174:175], v[138:139]
v_pk_fma_f32 v[140:141], v[104:105], v[176:177], v[140:141]
v_pk_fma_f32 v[138:139], v[98:99], v[178:179], v[138:139]
v_pk_fma_f32 v[140:141], v[100:101], v[180:181], v[140:141]
v_pk_fma_f32 v[138:139], v[94:95], v[182:183], v[138:139]
v_pk_fma_f32 v[140:141], v[96:97], v[184:185], v[140:141]
v_pk_mul_f32 v[142:143], v[110:111], v[170:171]
v_pk_mul_f32 v[144:145], v[112:113], v[172:173]
v_pk_fma_f32 v[142:143], v[106:107], v[174:175], v[142:143]
v_pk_fma_f32 v[144:145], v[108:109], v[176:177], v[144:145]
v_pk_fma_f32 v[142:143], v[102:103], v[178:179], v[142:143]
v_pk_fma_f32 v[144:145], v[104:105], v[180:181], v[144:145]
v_pk_fma_f32 v[142:143], v[98:99], v[182:183], v[142:143]
v_pk_fma_f32 v[144:145], v[100:101], v[184:185], v[144:145]
v_pk_mul_f32 v[146:147], v[114:115], v[170:171]
v_pk_mul_f32 v[148:149], v[116:117], v[172:173]
v_pk_fma_f32 v[146:147], v[110:111], v[174:175], v[146:147]
v_pk_fma_f32 v[148:149], v[112:113], v[176:177], v[148:149]
v_pk_fma_f32 v[146:147], v[106:107], v[178:179], v[146:147]
v_pk_fma_f32 v[148:149], v[108:109], v[180:181], v[148:149]
v_pk_fma_f32 v[146:147], v[102:103], v[182:183], v[146:147]
v_pk_fma_f32 v[148:149], v[104:105], v[184:185], v[148:149]
v_pk_mul_f32 v[150:151], v[118:119], v[170:171]
v_pk_mul_f32 v[152:153], v[120:121], v[172:173]
v_pk_fma_f32 v[150:151], v[114:115], v[174:175], v[150:151]
v_pk_fma_f32 v[152:153], v[116:117], v[176:177], v[152:153]
v_pk_fma_f32 v[150:151], v[110:111], v[178:179], v[150:151]
v_pk_fma_f32 v[152:153], v[112:113], v[180:181], v[152:153]
v_pk_fma_f32 v[150:151], v[106:107], v[182:183], v[150:151]
v_pk_fma_f32 v[152:153], v[108:109], v[184:185], v[152:153]
v_pk_mul_f32 v[154:155], v[122:123], v[170:171]
v_pk_mul_f32 v[156:157], v[124:125], v[172:173]
v_pk_fma_f32 v[154:155], v[118:119], v[174:175], v[154:155]
v_pk_fma_f32 v[156:157], v[120:121], v[176:177], v[156:157]
v_pk_fma_f32 v[154:155], v[114:115], v[178:179], v[154:155]
v_pk_fma_f32 v[156:157], v[116:117], v[180:181], v[156:157]
v_pk_fma_f32 v[154:155], v[110:111], v[182:183], v[154:155]
v_pk_fma_f32 v[156:157], v[112:113], v[184:185], v[156:157]
v_pk_mul_f32 v[158:159], v[126:127], v[170:171]
v_pk_mul_f32 v[160:161], v[128:129], v[172:173]
v_pk_fma_f32 v[158:159], v[122:123], v[174:175], v[158:159]
v_pk_fma_f32 v[160:161], v[124:125], v[176:177], v[160:161]
v_pk_fma_f32 v[158:159], v[118:119], v[178:179], v[158:159]
v_pk_fma_f32 v[160:161], v[120:121], v[180:181], v[160:161]
v_pk_fma_f32 v[158:159], v[114:115], v[182:183], v[158:159]
v_pk_fma_f32 v[160:161], v[116:117], v[184:185], v[160:161]
s_waitcnt vmcnt(10)
v_lshlrev_b32 v16, 16, v38
v_and_b32 v17, 0xffff0000, v38
v_pk_mul_f32 v[130:131], v[130:131], v[16:17]
v_lshlrev_b32 v18, 16, v39
v_and_b32 v19, 0xffff0000, v39
v_pk_mul_f32 v[132:133], v[132:133], v[18:19]
v_lshlrev_b32 v20, 16, v40
v_and_b32 v21, 0xffff0000, v40
v_pk_mul_f32 v[134:135], v[134:135], v[20:21]
v_lshlrev_b32 v22, 16, v41
v_and_b32 v23, 0xffff0000, v41
v_pk_mul_f32 v[136:137], v[136:137], v[22:23]
v_lshlrev_b32 v24, 16, v42
v_and_b32 v25, 0xffff0000, v42
v_pk_mul_f32 v[138:139], v[138:139], v[24:25]
v_lshlrev_b32 v26, 16, v43
v_and_b32 v27, 0xffff0000, v43
v_pk_mul_f32 v[140:141], v[140:141], v[26:27]
v_lshlrev_b32 v28, 16, v44
v_and_b32 v29, 0xffff0000, v44
v_pk_mul_f32 v[142:143], v[142:143], v[28:29]
v_lshlrev_b32 v30, 16, v45
v_and_b32 v31, 0xffff0000, v45
v_pk_mul_f32 v[144:145], v[144:145], v[30:31]
v_lshlrev_b32 v16, 16, v46
v_and_b32 v17, 0xffff0000, v46
v_pk_mul_f32 v[146:147], v[146:147], v[16:17]
v_lshlrev_b32 v18, 16, v47
v_and_b32 v19, 0xffff0000, v47
v_pk_mul_f32 v[148:149], v[148:149], v[18:19]
v_lshlrev_b32 v20, 16, v48
v_and_b32 v21, 0xffff0000, v48
v_pk_mul_f32 v[150:151], v[150:151], v[20:21]
v_lshlrev_b32 v22, 16, v49
v_and_b32 v23, 0xffff0000, v49
v_pk_mul_f32 v[152:153], v[152:153], v[22:23]
v_lshlrev_b32 v24, 16, v50
v_and_b32 v25, 0xffff0000, v50
v_pk_mul_f32 v[154:155], v[154:155], v[24:25]
v_lshlrev_b32 v26, 16, v51
v_and_b32 v27, 0xffff0000, v51
v_pk_mul_f32 v[156:157], v[156:157], v[26:27]
v_lshlrev_b32 v28, 16, v52
v_and_b32 v29, 0xffff0000, v52
v_pk_mul_f32 v[158:159], v[158:159], v[28:29]
v_lshlrev_b32 v30, 16, v53
v_and_b32 v31, 0xffff0000, v53
v_pk_mul_f32 v[160:161], v[160:161], v[30:31]
v_cvt_pk_bf16_f32 v38, v158, v154
v_cvt_pk_bf16_f32 v39, v150, v146
v_cvt_pk_bf16_f32 v40, v142, v138
v_cvt_pk_bf16_f32 v41, v134, v130
ds_write_b128 v8, v[38:41] offset:0
v_cvt_pk_bf16_f32 v42, v159, v155
v_cvt_pk_bf16_f32 v43, v151, v147
v_cvt_pk_bf16_f32 v44, v143, v139
v_cvt_pk_bf16_f32 v45, v135, v131
ds_write_b128 v8, v[42:45] offset:256
v_cvt_pk_bf16_f32 v46, v160, v156
v_cvt_pk_bf16_f32 v47, v152, v148
v_cvt_pk_bf16_f32 v48, v144, v140
v_cvt_pk_bf16_f32 v49, v136, v132
ds_write_b128 v8, v[46:49] offset:512
v_cvt_pk_bf16_f32 v50, v161, v157
v_cvt_pk_bf16_f32 v51, v153, v149
v_cvt_pk_bf16_f32 v52, v145, v141
v_cvt_pk_bf16_f32 v53, v137, v133
ds_write_b128 v8, v[50:53] offset:768
v_xor_b32 v11, 16, v7
v_xor_b32 v12, 32, v7
v_xor_b32 v13, 48, v7
s_waitcnt lgkmcnt(0)
s_barrier
ds_read_b128 v[38:41], v7 offset:0
ds_read_b128 v[42:45], v11 offset:1024
ds_read_b128 v[46:49], v12 offset:2048
ds_read_b128 v[50:53], v13 offset:3072
s_waitcnt lgkmcnt(3)
buffer_store_dwordx4 v[38:41], v5, s[20:23], s49 offen sc1
s_add_u32 s49, s49, 16384
s_waitcnt lgkmcnt(2)
buffer_store_dwordx4 v[42:45], v5, s[20:23], s49 offen sc1
s_add_u32 s49, s49, 16384
s_waitcnt lgkmcnt(1)
buffer_store_dwordx4 v[46:49], v5, s[20:23], s49 offen sc1
s_add_u32 s49, s49, 16384
s_waitcnt lgkmcnt(0)
buffer_store_dwordx4 v[50:53], v5, s[20:23], s49 offen sc1
s_lshl_b32 s53, s2, 14
s_lshl_b32 s49, s3, 12
s_add_u32 s53, s53, s49
v_add_u32 v5, s53, v4
buffer_load_dwordx4 v[70:73], v5, s[4:7], 0 offen offset:0
buffer_load_dwordx4 v[74:77], v5, s[4:7], 0 offen offset:1024
buffer_load_dwordx4 v[78:81], v5, s[4:7], 0 offen offset:2048
buffer_load_dwordx4 v[82:85], v5, s[4:7], 0 offen offset:3072
s_waitcnt vmcnt(16)
v_alignbit_b32 v218, v187, v186, 16
v_alignbit_b32 v219, v188, v187, 16
v_alignbit_b32 v220, v189, v188, 16
v_alignbit_b32 v221, v190, v189, 16
ds_write_b128 v9, v[218:221] offset:16
v_mov_b32 v222, v187
v_mov_b32 v223, v188
v_mov_b32 v224, v189
v_mov_b32 v225, v190
ds_write_b128 v9, v[222:225] offset:4176
v_alignbit_b32 v226, v188, v187, 16
v_alignbit_b32 v227, v189, v188, 16
v_alignbit_b32 v228, v190, v189, 16
v_alignbit_b32 v229, v191, v190, 16
s_waitcnt vmcnt(4)
s_mov_b64 exec, 1
buffer_store_dword v14, v15, s[20:23], s43 offen offset:96 sc1
s_mov_b64 exec, -1
v_xor_b32 v3, 15, v0
v_lshlrev_b32 v3, 11, v3
s_lshl_b32 s42, s3, 20
s_add_u32 s42, s42, s41
v_add_u32 v3, s42, v3
s_mov_b32 s42, 0
s_lshl_b32 s63, s2, 2
s_add_u32 s63, s63, s3
s_lshl_b32 s63, s63, 12
s_add_u32 s63, s63, 29360128
v_mov_b32 v242, -1
v_mov_b32 v243, -1
v_mov_b32 v244, -1
v_mov_b32 v245, -1
ds_write_b128 v9, v[226:229] offset:8336
buffer_load_dwordx2 v[54:55], v3, s[4:7], s42 offen
s_add_u32 s42, s42, 131072
ds_write_b128 v9, v[188:191] offset:12496
v_alignbit_b32 v230, v189, v188, 16
v_alignbit_b32 v231, v190, v189, 16
v_alignbit_b32 v232, v191, v190, 16
v_alignbit_b32 v233, v192, v191, 16
ds_write_b128 v9, v[230:233] offset:16656
v_mov_b32 v234, v189
v_mov_b32 v235, v190
v_mov_b32 v236, v191
v_mov_b32 v237, v192
ds_write_b128 v9, v[234:237] offset:20816
v_alignbit_b32 v238, v190, v189, 16
v_alignbit_b32 v239, v191, v190, 16
v_alignbit_b32 v240, v192, v191, 16
v_alignbit_b32 v241, v193, v192, 16
ds_write_b128 v9, v[238:241] offset:24976
ds_write_b128 v9, v[190:193] offset:29136
s_waitcnt vmcnt(16)
v_alignbit_b32 v218, v195, v194, 16
v_alignbit_b32 v219, v196, v195, 16
buffer_load_dwordx2 v[56:57], v3, s[4:7], s42 offen
s_add_u32 s42, s42, 131072
v_alignbit_b32 v220, v197, v196, 16
v_alignbit_b32 v221, v198, v197, 16
ds_write_b128 v9, v[218:221] offset:1040
v_mov_b32 v222, v195
v_mov_b32 v223, v196
v_mov_b32 v224, v197
v_mov_b32 v225, v198
ds_write_b128 v9, v[222:225] offset:5200
v_alignbit_b32 v226, v196, v195, 16
v_alignbit_b32 v227, v197, v196, 16
v_alignbit_b32 v228, v198, v197, 16
v_alignbit_b32 v229, v199, v198, 16
ds_write_b128 v9, v[226:229] offset:9360
ds_write_b128 v9, v[196:199] offset:13520
v_alignbit_b32 v230, v197, v196, 16
v_alignbit_b32 v231, v198, v197, 16
v_alignbit_b32 v232, v199, v198, 16
v_alignbit_b32 v233, v200, v199, 16
ds_write_b128 v9, v[230:233] offset:17680
v_mov_b32 v234, v197
buffer_load_dwordx2 v[58:59], v3, s[4:7], s42 offen
s_add_u32 s42, s42, 131072
v_mov_b32 v235, v198
v_mov_b32 v236, v199
v_mov_b32 v237, v200
ds_write_b128 v9, v[234:237] offset:21840
v_alignbit_b32 v238, v198, v197, 16
v_alignbit_b32 v239, v199, v198, 16
v_alignbit_b32 v240, v200, v199, 16
v_alignbit_b32 v241, v201, v200, 16
ds_write_b128 v9, v[238:241] offset:26000
ds_write_b128 v9, v[198:201] offset:30160
s_waitcnt vmcnt(16)
v_alignbit_b32 v218, v203, v202, 16
v_alignbit_b32 v219, v204, v203, 16
v_alignbit_b32 v220, v205, v204, 16
v_alignbit_b32 v221, v206, v205, 16
ds_write_b128 v9, v[218:221] offset:2064
v_mov_b32 v222, v203
v_mov_b32 v223, v204
v_mov_b32 v224, v205
v_mov_b32 v225, v206
buffer_load_dwordx2 v[60:61], v3, s[4:7], s42 offen
s_add_u32 s42, s42, 131072
ds_write_b128 v9, v[222:225] offset:6224
v_alignbit_b32 v226, v204, v203, 16
v_alignbit_b32 v227, v205, v204, 16
v_alignbit_b32 v228, v206, v205, 16
v_alignbit_b32 v229, v207, v206, 16
ds_write_b128 v9, v[226:229] offset:10384
ds_write_b128 v9, v[204:207] offset:14544
v_alignbit_b32 v230, v205, v204, 16
v_alignbit_b32 v231, v206, v205, 16
v_alignbit_b32 v232, v207, v206, 16
v_alignbit_b32 v233, v208, v207, 16
ds_write_b128 v9, v[230:233] offset:18704
v_mov_b32 v234, v205
v_mov_b32 v235, v206
v_mov_b32 v236, v207
v_mov_b32 v237, v208
ds_write_b128 v9, v[234:237] offset:22864
v_alignbit_b32 v238, v206, v205, 16
v_alignbit_b32 v239, v207, v206, 16
v_alignbit_b32 v240, v208, v207, 16
v_alignbit_b32 v241, v209, v208, 16
ds_write_b128 v9, v[238:241] offset:27024
ds_write_b128 v9, v[206:209] offset:31184
s_waitcnt vmcnt(15)
v_alignbit_b32 v218, v211, v210, 16
v_alignbit_b32 v219, v212, v211, 16
v_alignbit_b32 v220, v213, v212, 16
v_alignbit_b32 v221, v214, v213, 16
ds_write_b128 v9, v[218:221] offset:3088
v_mov_b32 v222, v211
v_mov_b32 v223, v212
v_mov_b32 v224, v213
v_mov_b32 v225, v214
ds_write_b128 v9, v[222:225] offset:7248
v_alignbit_b32 v226, v212, v211, 16
v_alignbit_b32 v227, v213, v212, 16
v_alignbit_b32 v228, v214, v213, 16
v_alignbit_b32 v229, v215, v214, 16
ds_write_b128 v9, v[226:229] offset:11408
ds_write_b128 v9, v[212:215] offset:15568
v_alignbit_b32 v230, v213, v212, 16
v_alignbit_b32 v231, v214, v213, 16
v_alignbit_b32 v232, v215, v214, 16
v_alignbit_b32 v233, v216, v215, 16
ds_write_b128 v9, v[230:233] offset:19728
v_mov_b32 v234, v213
v_mov_b32 v235, v214
v_mov_b32 v236, v215
v_mov_b32 v237, v216
ds_write_b128 v9, v[234:237] offset:23888
v_alignbit_b32 v238, v214, v213, 16
v_alignbit_b32 v239, v215, v214, 16
v_alignbit_b32 v240, v216, v215, 16
v_alignbit_b32 v241, v217, v216, 16
ds_write_b128 v9, v[238:241] offset:28048
ds_write_b128 v9, v[214:217] offset:32208
s_lshl_b32 s53, s50, 4
v_and_b32 v10, 15, v0
v_add_u32 v10, s53, v10
v_and_b32 v11, 31, v10
v_lshrrev_b32 v10, 5, v10
v_lshl_add_u32 v10, v11, 3, v10
v_lshlrev_b32 v10, 9, v10
s_lshr_b32 s53, s51, 2
s_lshl_b32 s53, s53, 7
s_add_u32 s53, s53, 28049504
s_mov_b32 s49, 0
buffer_load_dword v13, v10, s[20:23], s53 offen sc1
s_waitcnt vmcnt(6)
s_mov_b32 s63, 0x3f803f80
v_mov_b32 v242, 0
v_mov_b32 v243, 0
v_mov_b32 v244, 0
v_mov_b32 v245, 0
v_mov_b32 v246, s63
v_dot2_f32_bf16 v242, v70, v246, v242
v_dot2_f32_bf16 v243, v70, v70, v243
v_dot2_f32_bf16 v244, v78, v246, v244
v_dot2_f32_bf16 v245, v78, v78, v245
v_dot2_f32_bf16 v242, v71, v246, v242
v_dot2_f32_bf16 v243, v71, v71, v243
v_dot2_f32_bf16 v244, v79, v246, v244
v_dot2_f32_bf16 v245, v79, v79, v245
v_dot2_f32_bf16 v242, v72, v246, v242
v_dot2_f32_bf16 v243, v72, v72, v243
v_dot2_f32_bf16 v244, v80, v246, v244
v_dot2_f32_bf16 v245, v80, v80, v245
v_dot2_f32_bf16 v242, v73, v246, v242
v_dot2_f32_bf16 v243, v73, v73, v243
v_dot2_f32_bf16 v244, v81, v246, v244
v_dot2_f32_bf16 v245, v81, v81, v245
v_dot2_f32_bf16 v242, v74, v246, v242
v_dot2_f32_bf16 v243, v74, v74, v243
v_dot2_f32_bf16 v244, v82, v246, v244
v_dot2_f32_bf16 v245, v82, v82, v245
v_dot2_f32_bf16 v242, v75, v246, v242
v_dot2_f32_bf16 v243, v75, v75, v243
v_dot2_f32_bf16 v244, v83, v246, v244
v_dot2_f32_bf16 v245, v83, v83, v245
v_dot2_f32_bf16 v242, v76, v246, v242
v_dot2_f32_bf16 v243, v76, v76, v243
v_dot2_f32_bf16 v244, v84, v246, v244
v_dot2_f32_bf16 v245, v84, v84, v245
v_dot2_f32_bf16 v242, v77, v246, v242
v_dot2_f32_bf16 v243, v77, v77, v243
v_dot2_f32_bf16 v244, v85, v246, v244
v_dot2_f32_bf16 v245, v85, v85, v245
s_add_u32 m0, s62, 33280
s_add_u32 s61, s61, 18874368
s_branch L_k1_p2c
L_k1_p2:
buffer_load_dword v13, v10, s[20:23], s53 offen sc1
L_k1_p2c:
s_waitcnt vmcnt(0)
v_cmp_eq_u32 vcc, s44, v13
s_cmp_eq_u64 vcc, -1
s_cbranch_scc1 L_k1_p3
s_add_u32 s49, s49, 1
s_cmp_gt_u32 s49, 20000
s_cbranch_scc0 L_k1_p2
L_k1_p3:
buffer_load_dwordx4 v4, s[20:23], s61 offen offset:0 sc1 lds
buffer_load_dwordx4 v4, s[20:23], s61 offen offset:1024 sc1 lds
buffer_load_dwordx4 v4, s[20:23], s61 offen offset:2048 sc1 lds
buffer_load_dwordx4 v4, s[20:23], s61 offen offset:3072 sc1 lds
v_add_f32_dpp v242, v242, v242 row_shr:1 row_mask:0xf bank_mask:0xf bound_ctrl:0
v_add_f32_dpp v243, v243, v243 row_shr:1 row_mask:0xf bank_mask:0xf bound_ctrl:0
v_add_f32_dpp v244, v244, v244 row_shr:1 row_mask:0xf bank_mask:0xf bound_ctrl:0
v_add_f32_dpp v245, v245, v245 row_shr:1 row_mask:0xf bank_mask:0xf bound_ctrl:0
v_add_f32_dpp v242, v242, v242 row_shr:2 row_mask:0xf bank_mask:0xf bound_ctrl:0
v_add_f32_dpp v243, v243, v243 row_shr:2 row_mask:0xf bank_mask:0xf bound_ctrl:0
v_add_f32_dpp v244, v244, v244 row_shr:2 row_mask:0xf bank_mask:0xf bound_ctrl:0
v_add_f32_dpp v245, v245, v245 row_shr:2 row_mask:0xf bank_mask:0xf bound_ctrl:0
v_add_f32_dpp v242, v242, v242 row_shr:4 row_mask:0xf bank_mask:0xf bound_ctrl:0
v_add_f32_dpp v243, v243, v243 row_shr:4 row_mask:0xf bank_mask:0xf bound_ctrl:0
v_add_f32_dpp v244, v244, v244 row_shr:4 row_mask:0xf bank_mask:0xf bound_ctrl:0
v_add_f32_dpp v245, v245, v245 row_shr:4 row_mask:0xf bank_mask:0xf bound_ctrl:0
v_add_f32_dpp v242, v242, v242 row_shr:8 row_mask:0xf bank_mask:0xf bound_ctrl:0
v_add_f32_dpp v243, v243, v243 row_shr:8 row_mask:0xf bank_mask:0xf bound_ctrl:0
v_add_f32_dpp v244, v244, v244 row_shr:8 row_mask:0xf bank_mask:0xf bound_ctrl:0
v_add_f32_dpp v245, v245, v245 row_shr:8 row_mask:0xf bank_mask:0xf bound_ctrl:0
v_add_f32_dpp v242, v242, v242 row_bcast:15 row_mask:0xa bank_mask:0xf
v_add_f32_dpp v243, v243, v243 row_bcast:15 row_mask:0xa bank_mask:0xf
v_add_f32_dpp v244, v244, v244 row_bcast:15 row_mask:0xa bank_mask:0xf
v_add_f32_dpp v245, v245, v245 row_bcast:15 row_mask:0xa bank_mask:0xf
v_add_f32_dpp v242, v242, v242 row_bcast:31 row_mask:0xc bank_mask:0xf
v_add_f32_dpp v243, v243, v243 row_bcast:31 row_mask:0xc bank_mask:0xf
v_add_f32_dpp v244, v244, v244 row_bcast:31 row_mask:0xc bank_mask:0xf
v_add_f32_dpp v245, v245, v245 row_bcast:31 row_mask:0xc bank_mask:0xf
s_mov_b32 s63, 0x3a800000
v_mul_f32 v242, s63, v242
v_mul_f32 v244, s63, v244
v_mul_f32 v243, s63, v243
v_mul_f32 v245, s63, v245
v_fma_f32 v243, -v242, v242, v243
v_fma_f32 v245, -v244, v244, v245
v_max_f32 v243, 0, v243
v_max_f32 v245, 0, v245
v_add_f32 v243, 0x3727c5ac, v243
v_add_f32 v245, 0x3727c5ac, v245
v_rsq_f32 v243, v243
v_rsq_f32 v245, v245
s_lshl_b32 s63, s2, 7
s_lshl_b32 s49, s3, 5
s_add_u32 s63, s63, s49
s_add_u32 s63, s63, 27262976
v_mov_b32 v246, v244
v_mov_b32 v247, v245
v_mov_b32 v244, s44
v_mov_b32 v248, s44
s_mov_b32 exec_lo, 0
s_mov_b32 exec_hi, 0x80000000
buffer_store_dwordx4 v[242:245], v15, s[20:23], s63 offen sc1
buffer_store_dwordx4 v[246:249], v15, s[20:23], s63 offen offset:16 sc1
s_mov_b64 exec, -1
s_lshr_b32 s49, s2, 3
s_cmp_ge_u32 s49, 16
s_cselect_b32 s16, s58, s56
s_cselect_b32 s17, s59, s57
s_and_b32 s17, s17, 0xffff
s_mov_b32 s18, 7340032
s_mov_b32 s19, 0x00020000
v_cmp_gt_u32 vcc, 56, v0
v_mov_b32 v9, 0x80000000
v_mul_u32_u24 v252, 9363, v0
v_lshrrev_b32 v252, 16, v252
v_mul_u32_u24 v252, 6272, v252
v_lshl_add_u32 v254, v0, 7, v252
v_cndmask_b32 v254, v9, v254, vcc
s_and_b32 s49, s49, 15
s_lshl_b32 s49, s49, 2
s_add_u32 s49, s49, s3
s_and_b32 s52, s49, 0x38
s_add_u32 s49, s49, s52
s_mul_i32 s61, s49, 57344
s_and_b32 s49, s2, 7
s_mul_i32 s49, s49, 896
s_add_u32 s61, s61, s49
v_and_b32 v12, 7, v0
v_mul_u32_u24 v10, 4160, v12
v_bfe_u32 v12, v0, 3, 1
v_lshrrev_b32 v13, 4, v0
v_add_u32 v12, v12, v13
v_lshl_add_u32 v10, v12, 4, v10
v_add_u32 v10, s62, v10
v_and_b32 v12, 15, v0
v_lshlrev_b32 v12, 5, v12
v_lshlrev_b32 v13, 4, v13
v_sub_u32 v11, v13, v12
s_add_u32 s52, s62, 33760
v_add_u32 v11, s52, v11
v_lshrrev_b32 v13, 1, v13
v_add_u32 v12, v12, v13
s_add_u32 s52, s62, 33784
v_sub_u32 v12, s52, v12
s_waitcnt vmcnt(2) lgkmcnt(0)
ds_read_b128 v[130:133], v10 offset:0
ds_read_b128 a[0:3], v11 offset:3584
ds_read_b128 a[32:35], v11 offset:3072
ds_read_b128 a[64:67], v11 offset:2560
ds_read_b128 a[96:99], v11 offset:2048
ds_read_b128 a[128:131], v11 offset:1536
ds_read_b128 a[160:163], v11 offset:1024
ds_read_b128 a[192:195], v11 offset:512
ds_read_b128 a[224:227], v11 offset:0
ds_read_b128 v[134:137], v10 offset:64
s_mov_b32 s49, s42
v_xor_b32 v5, 15, v0
v_lshlrev_b32 v5, 4, v5
s_lshl_b32 s50, s3, 13
s_add_u32 s50, s50, 27262976
s_add_u32 s51, s50, 4096
s_waitcnt lgkmcnt(1)
v_mfma_f32_16x16x32_bf16 v[86:89], v[130:133], a[0:3], 0
ds_read_b128 a[4:7], v11 offset:3648
ds_read_b128 a[36:39], v11 offset:3136
v_mfma_f32_16x16x32_bf16 v[90:93], v[130:133], a[32:35], 0
ds_read_b128 a[68:71], v11 offset:2624
ds_read_b128 a[100:103], v11 offset:2112
v_mfma_f32_16x16x32_bf16 v[94:97], v[130:133], a[64:67], 0
ds_read_b128 a[132:135], v11 offset:1600
ds_read_b128 a[164:167], v11 offset:1088
v_mfma_f32_16x16x32_bf16 v[98:101], v[130:133], a[96:99], 0
ds_read_b128 a[196:199], v11 offset:576
ds_read_b128 a[228:231], v11 offset:64
s_cmp_lg_u32 s3, 0
s_cbranch_scc1 L_k1_x16
buffer_load_dwordx2 v[62:63], v3, s[4:7], s49 offen
L_k1_x16:
v_mfma_f32_16x16x32_bf16 v[102:105], v[130:133], a[128:131], 0
ds_read_b128 v[138:141], v10 offset:128
v_mfma_f32_16x16x32_bf16 v[106:109], v[130:133], a[160:163], 0
v_mfma_f32_16x16x32_bf16 v[110:113], v[130:133], a[192:195], 0
v_mfma_f32_16x16x32_bf16 v[114:117], v[130:133], a[224:227], 0
s_waitcnt lgkmcnt(1)
v_mfma_f32_16x16x32_bf16 v[86:89], v[134:137], a[4:7], v[86:89]
ds_read_b128 a[8:11], v11 offset:3712
ds_read_b128 a[40:43], v11 offset:3200
v_mfma_f32_16x16x32_bf16 v[90:93], v[134:137], a[36:39], v[90:93]
ds_read_b128 a[72:75], v11 offset:2688
ds_read_b128 a[104:107], v11 offset:2176
v_mfma_f32_16x16x32_bf16 v[94:97], v[134:137], a[68:71], v[94:97]
ds_read_b128 a[136:139], v11 offset:1664
ds_read_b128 a[168:171], v11 offset:1152
v_mfma_f32_16x16x32_bf16 v[98:101], v[134:137], a[100:103], v[98:101]
ds_read_b128 a[200:203], v11 offset:640
ds_read_b128 a[232:235], v11 offset:128
v_mfma_f32_16x16x32_bf16 v[102:105], v[134:137], a[132:135], v[102:105]
ds_read_b128 v[142:145], v10 offset:192
v_mfma_f32_16x16x32_bf16 v[106:109], v[134:137], a[164:167], v[106:109]
v_mfma_f32_16x16x32_bf16 v[110:113], v[134:137], a[196:199], v[110:113]
v_mfma_f32_16x16x32_bf16 v[114:117], v[134:137], a[228:231], v[114:117]
s_waitcnt lgkmcnt(1)
v_mfma_f32_16x16x32_bf16 v[86:89], v[138:141], a[8:11], v[86:89]
ds_read_b128 a[12:15], v11 offset:3776
ds_read_b128 a[44:47], v11 offset:3264
v_mfma_f32_16x16x32_bf16 v[90:93], v[138:141], a[40:43], v[90:93]
ds_read_b128 a[76:79], v11 offset:2752
ds_read_b128 a[108:111], v11 offset:2240
s_cmp_lg_u32 s3, 1
s_cbranch_scc1 L_k1_x17
buffer_load_dwordx2 v[62:63], v3, s[4:7], s49 offen
L_k1_x17:
v_mfma_f32_16x16x32_bf16 v[94:97], v[138:141], a[72:75], v[94:97]
ds_read_b128 a[140:143], v11 offset:1728
ds_read_b128 a[172:175], v11 offset:1216
v_mfma_f32_16x16x32_bf16 v[98:101], v[138:141], a[104:107], v[98:101]
ds_read_b128 a[204:207], v11 offset:704
ds_read_b128 a[236:239], v11 offset:192
v_mfma_f32_16x16x32_bf16 v[102:105], v[138:141], a[136:139], v[102:105]
ds_read_b128 v[146:149], v10 offset:256
v_mfma_f32_16x16x32_bf16 v[106:109], v[138:141], a[168:171], v[106:109]
v_mfma_f32_16x16x32_bf16 v[110:113], v[138:141], a[200:203], v[110:113]
v_mfma_f32_16x16x32_bf16 v[114:117], v[138:141], a[232:235], v[114:117]
s_waitcnt lgkmcnt(1)
v_mfma_f32_16x16x32_bf16 v[86:89], v[142:145], a[12:15], v[86:89]
ds_read_b128 a[16:19], v11 offset:3840
ds_read_b128 a[48:51], v11 offset:3328
v_mfma_f32_16x16x32_bf16 v[90:93], v[142:145], a[44:47], v[90:93]
ds_read_b128 a[80:83], v11 offset:2816
ds_read_b128 a[112:115], v11 offset:2304
v_mfma_f32_16x16x32_bf16 v[94:97], v[142:145], a[76:79], v[94:97]
ds_read_b128 a[144:147], v11 offset:1792
ds_read_b128 a[176:179], v11 offset:1280
v_mfma_f32_16x16x32_bf16 v[98:101], v[142:145], a[108:111], v[98:101]
ds_read_b128 a[208:211], v11 offset:768
ds_read_b128 a[240:243], v11 offset:256
v_mfma_f32_16x16x32_bf16 v[102:105], v[142:145], a[140:143], v[102:105]
ds_read_b128 v[150:153], v10 offset:320
v_mfma_f32_16x16x32_bf16 v[106:109], v[142:145], a[172:175], v[106:109]
v_mfma_f32_16x16x32_bf16 v[110:113], v[142:145], a[204:207], v[110:113]
v_mfma_f32_16x16x32_bf16 v[114:117], v[142:145], a[236:239], v[114:117]
s_cmp_lg_u32 s3, 2
s_cbranch_scc1 L_k1_x18
buffer_load_dwordx2 v[62:63], v3, s[4:7], s49 offen
L_k1_x18:
s_waitcnt lgkmcnt(1)
v_mfma_f32_16x16x32_bf16 v[86:89], v[146:149], a[16:19], v[86:89]
ds_read_b128 a[20:23], v11 offset:3904
ds_read_b128 a[52:55], v11 offset:3392
v_mfma_f32_16x16x32_bf16 v[90:93], v[146:149], a[48:51], v[90:93]
ds_read_b128 a[84:87], v11 offset:2880
ds_read_b128 a[116:119], v11 offset:2368
v_mfma_f32_16x16x32_bf16 v[94:97], v[146:149], a[80:83], v[94:97]
ds_read_b128 a[148:151], v11 offset:1856
ds_read_b128 a[180:183], v11 offset:1344
v_mfma_f32_16x16x32_bf16 v[98:101], v[146:149], a[112:115], v[98:101]
ds_read_b128 a[212:215], v11 offset:832
ds_read_b128 a[244:247], v11 offset:320
v_mfma_f32_16x16x32_bf16 v[102:105], v[146:149], a[144:147], v[102:105]
ds_read_b128 v[154:157], v10 offset:384
v_mfma_f32_16x16x32_bf16 v[106:109], v[146:149], a[176:179], v[106:109]
v_mfma_f32_16x16x32_bf16 v[110:113], v[146:149], a[208:211], v[110:113]
v_mfma_f32_16x16x32_bf16 v[114:117], v[146:149], a[240:243], v[114:117]
s_waitcnt lgkmcnt(1)
v_mfma_f32_16x16x32_bf16 v[86:89], v[150:153], a[20:23], v[86:89]
ds_read_b128 a[24:27], v11 offset:3968
ds_read_b128 a[56:59], v11 offset:3456
v_mfma_f32_16x16x32_bf16 v[90:93], v[150:153], a[52:55], v[90:93]
ds_read_b128 a[88:91], v11 offset:2944
ds_read_b128 a[120:123], v11 offset:2432
v_mfma_f32_16x16x32_bf16 v[94:97], v[150:153], a[84:87], v[94:97]
ds_read_b128 a[152:155], v11 offset:1920
ds_read_b128 a[184:187], v11 offset:1408
v_mfma_f32_16x16x32_bf16 v[98:101], v[150:153], a[116:119], v[98:101]
ds_read_b128 a[216:219], v11 offset:896
ds_read_b128 a[248:251], v11 offset:384
v_mfma_f32_16x16x32_bf16 v[102:105], v[150:153], a[148:151], v[102:105]
ds_read_b128 v[158:161], v10 offset:448
v_mfma_f32_16x16x32_bf16 v[106:109], v[150:153], a[180:183], v[106:109]
s_cmp_lg_u32 s3, 3
s_cbranch_scc1 L_k1_x19
buffer_load_dwordx2 v[62:63], v3, s[4:7], s49 offen
L_k1_x19:
s_add_u32 s49, s49, 131072
v_mfma_f32_16x16x32_bf16 v[110:113], v[150:153], a[212:215], v[110:113]
v_mfma_f32_16x16x32_bf16 v[114:117], v[150:153], a[244:247], v[114:117]
s_waitcnt lgkmcnt(1)
v_mfma_f32_16x16x32_bf16 v[86:89], v[154:157], a[24:27], v[86:89]
ds_read_b128 a[28:31], v11 offset:4032
ds_read_b128 a[60:63], v11 offset:3520
v_mfma_f32_16x16x32_bf16 v[90:93], v[154:157], a[56:59], v[90:93]
ds_read_b128 a[92:95], v11 offset:3008
ds_read_b128 a[124:127], v11 offset:2496
v_mfma_f32_16x16x32_bf16 v[94:97], v[154:157], a[88:91], v[94:97]
ds_read_b128 a[156:159], v11 offset:1984
ds_read_b128 a[188:191], v11 offset:1472
v_mfma_f32_16x16x32_bf16 v[98:101], v[154:157], a[120:123], v[98:101]
ds_read_b128 a[220:223], v11 offset:960
ds_read_b128 a[252:255], v11 offset:448
v_mfma_f32_16x16x32_bf16 v[102:105], v[154:157], a[152:155], v[102:105]
ds_read_b128 v[130:133], v10 offset:512
ds_read_b128 v[134:137], v10 offset:576
v_mfma_f32_16x16x32_bf16 v[106:109], v[154:157], a[184:187], v[106:109]
v_mfma_f32_16x16x32_bf16 v[110:113], v[154:157], a[216:219], v[110:113]
v_mfma_f32_16x16x32_bf16 v[114:117], v[154:157], a[248:251], v[114:117]
s_waitcnt lgkmcnt(2)
v_mfma_f32_16x16x32_bf16 v[86:89], v[158:161], a[28:31], v[86:89]
ds_read_b128 v[138:141], v10 offset:640
ds_read_b128 v[142:145], v10 offset:704
v_mfma_f32_16x16x32_bf16 v[90:93], v[158:161], a[60:63], v[90:93]
v_mfma_f32_16x16x32_bf16 v[94:97], v[158:161], a[92:95], v[94:97]
v_mfma_f32_16x16x32_bf16 v[98:101], v[158:161], a[124:127], v[98:101]
s_cmp_lg_u32 s3, 0
s_cbranch_scc1 L_k1_x20
buffer_load_dwordx2 v[64:65], v3, s[4:7], s49 offen
L_k1_x20:
v_mfma_f32_16x16x32_bf16 v[102:105], v[158:161], a[156:159], v[102:105]
v_mfma_f32_16x16x32_bf16 v[106:109], v[158:161], a[188:191], v[106:109]
v_mfma_f32_16x16x32_bf16 v[110:113], v[158:161], a[220:223], v[110:113]
v_mfma_f32_16x16x32_bf16 v[114:117], v[158:161], a[252:255], v[114:117]
s_waitcnt lgkmcnt(3)
v_mfma_f32_16x16x32_bf16 v[90:93], v[130:133], a[0:3], v[90:93]
ds_read_b128 v[146:149], v10 offset:768
v_mfma_f32_16x16x32_bf16 v[94:97], v[130:133], a[32:35], v[94:97]
ds_read_b128 v[150:153], v10 offset:832
v_mfma_f32_16x16x32_bf16 v[98:101], v[130:133], a[64:67], v[98:101]
ds_read_b64 v[16:17], v12 offset:3584
v_mfma_f32_16x16x32_bf16 v[102:105], v[130:133], a[96:99], v[102:105]
v_mfma_f32_16x16x32_bf16 v[106:109], v[130:133], a[128:131], v[106:109]
v_mfma_f32_16x16x32_bf16 v[110:113], v[130:133], a[160:163], v[110:113]
v_mfma_f32_16x16x32_bf16 v[114:117], v[130:133], a[192:195], v[114:117]
s_waitcnt lgkmcnt(5)
v_mfma_f32_16x16x32_bf16 v[90:93], v[134:137], a[4:7], v[90:93]
ds_read_b128 v[154:157], v10 offset:896
v_mfma_f32_16x16x32_bf16 v[94:97], v[134:137], a[36:39], v[94:97]
ds_read_b128 v[158:161], v10 offset:960
v_mfma_f32_16x16x32_bf16 v[98:101], v[134:137], a[68:71], v[98:101]
ds_read_b64 v[18:19], v12 offset:3072
s_cmp_lg_u32 s3, 1
s_cbranch_scc1 L_k1_x21
buffer_load_dwordx2 v[64:65], v3, s[4:7], s49 offen
L_k1_x21:
v_mfma_f32_16x16x32_bf16 v[102:105], v[134:137], a[100:103], v[102:105]
v_mfma_f32_16x16x32_bf16 v[106:109], v[134:137], a[132:135], v[106:109]
v_mfma_f32_16x16x32_bf16 v[110:113], v[134:137], a[164:167], v[110:113]
v_mfma_f32_16x16x32_bf16 v[114:117], v[134:137], a[196:199], v[114:117]
s_waitcnt lgkmcnt(7)
v_mfma_f32_16x16x32_bf16 v[90:93], v[138:141], a[8:11], v[90:93]
ds_read_b128 v[130:133], v10 offset:1024
v_mfma_f32_16x16x32_bf16 v[94:97], v[138:141], a[40:43], v[94:97]
ds_read_b64 v[20:21], v12 offset:2560
v_mfma_f32_16x16x32_bf16 v[98:101], v[138:141], a[72:75], v[98:101]
v_mfma_f32_16x16x32_bf16 v[102:105], v[138:141], a[104:107], v[102:105]
v_mfma_f32_16x16x32_bf16 v[106:109], v[138:141], a[136:139], v[106:109]
v_mfma_f32_16x16x32_bf16 v[110:113], v[138:141], a[168:171], v[110:113]
v_mfma_f32_16x16x32_bf16 v[114:117], v[138:141], a[200:203], v[114:117]
s_waitcnt lgkmcnt(8)
v_mfma_f32_16x16x32_bf16 v[90:93], v[142:145], a[12:15], v[90:93]
ds_read_b128 v[134:137], v10 offset:1088
v_mfma_f32_16x16x32_bf16 v[94:97], v[142:145], a[44:47], v[94:97]
ds_read_b64 v[22:23], v12 offset:2048
v_mfma_f32_16x16x32_bf16 v[98:101], v[142:145], a[76:79], v[98:101]
s_cmp_lg_u32 s3, 2
s_cbranch_scc1 L_k1_x22
buffer_load_dwordx2 v[64:65], v3, s[4:7], s49 offen
L_k1_x22:
v_mfma_f32_16x16x32_bf16 v[102:105], v[142:145], a[108:111], v[102:105]
v_mfma_f32_16x16x32_bf16 v[106:109], v[142:145], a[140:143], v[106:109]
v_mfma_f32_16x16x32_bf16 v[110:113], v[142:145], a[172:175], v[110:113]
v_mfma_f32_16x16x32_bf16 v[114:117], v[142:145], a[204:207], v[114:117]
s_waitcnt lgkmcnt(9)
v_mfma_f32_16x16x32_bf16 v[90:93], v[146:149], a[16:19], v[90:93]
ds_read_b128 v[138:141], v10 offset:1152
v_mfma_f32_16x16x32_bf16 v[94:97], v[146:149], a[48:51], v[94:97]
ds_read_b64 v[24:25], v12 offset:1536
v_mfma_f32_16x16x32_bf16 v[98:101], v[146:149], a[80:83], v[98:101]
v_mfma_f32_16x16x32_bf16 v[102:105], v[146:149], a[112:115], v[102:105]
v_mfma_f32_16x16x32_bf16 v[106:109], v[146:149], a[144:147], v[106:109]
v_mfma_f32_16x16x32_bf16 v[110:113], v[146:149], a[176:179], v[110:113]
v_mfma_f32_16x16x32_bf16 v[114:117], v[146:149], a[208:211], v[114:117]
s_waitcnt lgkmcnt(10)
v_mfma_f32_16x16x32_bf16 v[90:93], v[150:153], a[20:23], v[90:93]
ds_read_b128 v[142:145], v10 offset:1216
buffer_load_dword v255, v254, s[16:19], s61 offen
v_mfma_f32_16x16x32_bf16 v[94:97], v[150:153], a[52:55], v[94:97]
ds_read_b64 v[26:27], v12 offset:1024
v_mfma_f32_16x16x32_bf16 v[98:101], v[150:153], a[84:87], v[98:101]
s_cmp_lg_u32 s3, 3
s_cbranch_scc1 L_k1_x23
buffer_load_dwordx2 v[64:65], v3, s[4:7], s49 offen
L_k1_x23:
s_add_u32 s49, s49, 131072
v_mfma_f32_16x16x32_bf16 v[102:105], v[150:153], a[116:119], v[102:105]
v_mfma_f32_16x16x32_bf16 v[106:109], v[150:153], a[148:151], v[106:109]
v_mfma_f32_16x16x32_bf16 v[110:113], v[150:153], a[180:183], v[110:113]
v_mfma_f32_16x16x32_bf16 v[114:117], v[150:153], a[212:215], v[114:117]
s_waitcnt lgkmcnt(10)
v_mfma_f32_16x16x32_bf16 v[90:93], v[154:157], a[24:27], v[90:93]
ds_read_b128 v[146:149], v10 offset:1280
v_mfma_f32_16x16x32_bf16 v[94:97], v[154:157], a[56:59], v[94:97]
ds_read_b64 v[28:29], v12 offset:512
v_mfma_f32_16x16x32_bf16 v[98:101], v[154:157], a[88:91], v[98:101]
v_mfma_f32_16x16x32_bf16 v[102:105], v[154:157], a[120:123], v[102:105]
v_mfma_f32_16x16x32_bf16 v[106:109], v[154:157], a[152:155], v[106:109]
v_mfma_f32_16x16x32_bf16 v[110:113], v[154:157], a[184:187], v[110:113]
v_mfma_f32_16x16x32_bf16 v[114:117], v[154:157], a[216:219], v[114:117]
s_waitcnt lgkmcnt(11)
v_mfma_f32_16x16x32_bf16 v[90:93], v[158:161], a[28:31], v[90:93]
ds_read_b128 v[150:153], v10 offset:1344
v_mfma_f32_16x16x32_bf16 v[94:97], v[158:161], a[60:63], v[94:97]
ds_read_b64 v[30:31], v12 offset:0
v_mfma_f32_16x16x32_bf16 v[98:101], v[158:161], a[92:95], v[98:101]
s_cmp_lg_u32 s3, 0
s_cbranch_scc1 L_k1_x24
buffer_load_dwordx2 v[66:67], v3, s[4:7], s49 offen
L_k1_x24:
v_mfma_f32_16x16x32_bf16 v[102:105], v[158:161], a[124:127], v[102:105]
v_mfma_f32_16x16x32_bf16 v[106:109], v[158:161], a[156:159], v[106:109]
v_mfma_f32_16x16x32_bf16 v[110:113], v[158:161], a[188:191], v[110:113]
v_mfma_f32_16x16x32_bf16 v[114:117], v[158:161], a[220:223], v[114:117]
s_waitcnt lgkmcnt(11)
v_mfma_f32_16x16x32_bf16 v[94:97], v[130:133], a[0:3], v[94:97]
ds_read_b128 v[154:157], v10 offset:1408
v_mfma_f32_16x16x32_bf16 v[98:101], v[130:133], a[32:35], v[98:101]
v_mfma_f32_16x16x32_bf16 v[102:105], v[130:133], a[64:67], v[102:105]
v_mfma_f32_16x16x32_bf16 v[106:109], v[130:133], a[96:99], v[106:109]
v_mfma_f32_16x16x32_bf16 v[110:113], v[130:133], a[128:131], v[110:113]
v_mfma_f32_16x16x32_bf16 v[114:117], v[130:133], a[160:163], v[114:117]
s_waitcnt lgkmcnt(10)
v_mfma_f32_16x16x32_bf16 v[94:97], v[134:137], a[4:7], v[94:97]
ds_read_b128 v[158:161], v10 offset:1472
v_mfma_f32_16x16x32_bf16 v[98:101], v[134:137], a[36:39], v[98:101]
v_mfma_f32_16x16x32_bf16 v[102:105], v[134:137], a[68:71], v[102:105]
v_mfma_f32_16x16x32_bf16 v[106:109], v[134:137], a[100:103], v[106:109]
s_cmp_lg_u32 s3, 1
s_cbranch_scc1 L_k1_x25
buffer_load_dwordx2 v[66:67], v3, s[4:7], s49 offen
L_k1_x25:
v_mfma_f32_16x16x32_bf16 v[110:113], v[134:137], a[132:135], v[110:113]
v_mfma_f32_16x16x32_bf16 v[114:117], v[134:137], a[164:167], v[114:117]
s_waitcnt lgkmcnt(9)
v_mfma_f32_16x16x32_bf16 v[94:97], v[138:141], a[8:11], v[94:97]
ds_read_b128 v[130:133], v10 offset:1536
v_mfma_f32_16x16x32_bf16 v[98:101], v[138:141], a[40:43], v[98:101]
v_mfma_f32_16x16x32_bf16 v[102:105], v[138:141], a[72:75], v[102:105]
v_mfma_f32_16x16x32_bf16 v[106:109], v[138:141], a[104:107], v[106:109]
v_mfma_f32_16x16x32_bf16 v[110:113], v[138:141], a[136:139], v[110:113]
v_mfma_f32_16x16x32_bf16 v[114:117], v[138:141], a[168:171], v[114:117]
s_waitcnt lgkmcnt(8)
v_mfma_f32_16x16x32_bf16 v[94:97], v[142:145], a[12:15], v[94:97]
ds_read_b128 v[134:137], v10 offset:1600
v_mfma_f32_16x16x32_bf16 v[98:101], v[142:145], a[44:47], v[98:101]
v_mfma_f32_16x16x32_bf16 v[102:105], v[142:145], a[76:79], v[102:105]
v_and_b32 v38, 0xffff0000, v17
v_mfma_f32_16x16x32_bf16 v[106:109], v[142:145], a[108:111], v[106:109]
v_lshlrev_b32 v39, 16, v17
v_mfma_f32_16x16x32_bf16 v[110:113], v[142:145], a[140:143], v[110:113]
v_and_b32 v40, 0xffff0000, v16
v_mfma_f32_16x16x32_bf16 v[114:117], v[142:145], a[172:175], v[114:117]
s_cmp_lg_u32 s3, 2
s_cbranch_scc1 L_k1_x26
buffer_load_dwordx2 v[66:67], v3, s[4:7], s49 offen
L_k1_x26:
v_lshlrev_b32 v41, 16, v16
s_waitcnt lgkmcnt(7)
v_mfma_f32_16x16x32_bf16 v[94:97], v[146:149], a[16:19], v[94:97]
ds_read_b128 v[138:141], v10 offset:1664
v_mfma_f32_16x16x32_bf16 v[98:101], v[146:149], a[48:51], v[98:101]
v_fma_f32 v86, s48, v38, v86
v_mfma_f32_16x16x32_bf16 v[102:105], v[146:149], a[80:83], v[102:105]
v_fma_f32 v87, s48, v39, v87
v_mfma_f32_16x16x32_bf16 v[106:109], v[146:149], a[112:115], v[106:109]
v_fma_f32 v88, s48, v40, v88
v_mfma_f32_16x16x32_bf16 v[110:113], v[146:149], a[144:147], v[110:113]
v_fma_f32 v89, s48, v41, v89
v_mfma_f32_16x16x32_bf16 v[114:117], v[146:149], a[176:179], v[114:117]
v_cvt_pk_bf16_f32 v16, v89, v88
v_cvt_pk_bf16_f32 v17, v87, v86
ds_write_b64 v12, v[16:17] offset:3584
s_waitcnt lgkmcnt(7)
v_mfma_f32_16x16x32_bf16 v[94:97], v[150:153], a[20:23], v[94:97]
ds_read_b128 v[142:145], v10 offset:1728
v_mfma_f32_16x16x32_bf16 v[98:101], v[150:153], a[52:55], v[98:101]
v_mfma_f32_16x16x32_bf16 v[102:105], v[150:153], a[84:87], v[102:105]
v_mfma_f32_16x16x32_bf16 v[106:109], v[150:153], a[116:119], v[106:109]
v_mfma_f32_16x16x32_bf16 v[110:113], v[150:153], a[148:151], v[110:113]
v_mfma_f32_16x16x32_bf16 v[114:117], v[150:153], a[180:183], v[114:117]
s_waitcnt lgkmcnt(6)
v_mfma_f32_16x16x32_bf16 v[94:97], v[154:157], a[24:27], v[94:97]
ds_read_b128 v[146:149], v10 offset:1792
v_mfma_f32_16x16x32_bf16 v[98:101], v[154:157], a[56:59], v[98:101]
s_cmp_lg_u32 s3, 3
s_cbranch_scc1 L_k1_x27
buffer_load_dwordx2 v[66:67], v3, s[4:7], s49 offen
L_k1_x27:
s_add_u32 s49, s49, 131072
v_mfma_f32_16x16x32_bf16 v[102:105], v[154:157], a[88:91], v[102:105]
v_mfma_f32_16x16x32_bf16 v[106:109], v[154:157], a[120:123], v[106:109]
v_mfma_f32_16x16x32_bf16 v[110:113], v[154:157], a[152:155], v[110:113]
v_mfma_f32_16x16x32_bf16 v[114:117], v[154:157], a[184:187], v[114:117]
s_waitcnt lgkmcnt(6)
v_mfma_f32_16x16x32_bf16 v[94:97], v[158:161], a[28:31], v[94:97]
ds_read_b128 v[150:153], v10 offset:1856
v_mfma_f32_16x16x32_bf16 v[98:101], v[158:161], a[60:63], v[98:101]
v_mfma_f32_16x16x32_bf16 v[102:105], v[158:161], a[92:95], v[102:105]
v_mfma_f32_16x16x32_bf16 v[106:109], v[158:161], a[124:127], v[106:109]
v_mfma_f32_16x16x32_bf16 v[110:113], v[158:161], a[156:159], v[110:113]
v_mfma_f32_16x16x32_bf16 v[114:117], v[158:161], a[188:191], v[114:117]
s_waitcnt lgkmcnt(6)
v_mfma_f32_16x16x32_bf16 v[98:101], v[130:133], a[0:3], v[98:101]
ds_read_b128 v[154:157], v10 offset:1920
v_mfma_f32_16x16x32_bf16 v[102:105], v[130:133], a[32:35], v[102:105]
v_mfma_f32_16x16x32_bf16 v[106:109], v[130:133], a[64:67], v[106:109]
v_mfma_f32_16x16x32_bf16 v[110:113], v[130:133], a[96:99], v[110:113]
s_cmp_lg_u32 s3, 0
s_cbranch_scc1 L_k1_x28
buffer_load_dwordx2 v[68:69], v3, s[4:7], s49 offen
L_k1_x28:
v_mfma_f32_16x16x32_bf16 v[114:117], v[130:133], a[128:131], v[114:117]
s_waitcnt lgkmcnt(6)
v_mfma_f32_16x16x32_bf16 v[98:101], v[134:137], a[4:7], v[98:101]
ds_read_b128 v[158:161], v10 offset:1984
v_mfma_f32_16x16x32_bf16 v[102:105], v[134:137], a[36:39], v[102:105]
v_mfma_f32_16x16x32_bf16 v[106:109], v[134:137], a[68:71], v[106:109]
v_mfma_f32_16x16x32_bf16 v[110:113], v[134:137], a[100:103], v[110:113]
v_mfma_f32_16x16x32_bf16 v[114:117], v[134:137], a[132:135], v[114:117]
s_waitcnt lgkmcnt(6)
v_mfma_f32_16x16x32_bf16 v[98:101], v[138:141], a[8:11], v[98:101]
ds_read_b128 v[130:133], v10 offset:2048
v_mfma_f32_16x16x32_bf16 v[102:105], v[138:141], a[40:43], v[102:105]
v_mfma_f32_16x16x32_bf16 v[106:109], v[138:141], a[72:75], v[106:109]
v_mfma_f32_16x16x32_bf16 v[110:113], v[138:141], a[104:107], v[110:113]
v_mfma_f32_16x16x32_bf16 v[114:117], v[138:141], a[136:139], v[114:117]
s_waitcnt lgkmcnt(5)
v_mfma_f32_16x16x32_bf16 v[98:101], v[142:145], a[12:15], v[98:101]
ds_read_b128 v[134:137], v10 offset:2112
v_mfma_f32_16x16x32_bf16 v[102:105], v[142:145], a[44:47], v[102:105]
v_mfma_f32_16x16x32_bf16 v[106:109], v[142:145], a[76:79], v[106:109]
s_cmp_lg_u32 s3, 1
s_cbranch_scc1 L_k1_x29
buffer_load_dwordx2 v[68:69], v3, s[4:7], s49 offen
L_k1_x29:
v_and_b32 v42, 0xffff0000, v19
v_mfma_f32_16x16x32_bf16 v[110:113], v[142:145], a[108:111], v[110:113]
v_lshlrev_b32 v43, 16, v19
v_mfma_f32_16x16x32_bf16 v[114:117], v[142:145], a[140:143], v[114:117]
v_and_b32 v44, 0xffff0000, v18
s_waitcnt lgkmcnt(5)
v_mfma_f32_16x16x32_bf16 v[98:101], v[146:149], a[16:19], v[98:101]
ds_read_b128 v[138:141], v10 offset:2176
v_mfma_f32_16x16x32_bf16 v[102:105], v[146:149], a[48:51], v[102:105]
v_lshlrev_b32 v45, 16, v18
v_mfma_f32_16x16x32_bf16 v[106:109], v[146:149], a[80:83], v[106:109]
v_fma_f32 v90, s48, v42, v90
v_mfma_f32_16x16x32_bf16 v[110:113], v[146:149], a[112:115], v[110:113]
v_fma_f32 v91, s48, v43, v91
v_mfma_f32_16x16x32_bf16 v[114:117], v[146:149], a[144:147], v[114:117]
v_fma_f32 v92, s48, v44, v92
s_waitcnt lgkmcnt(5)
v_mfma_f32_16x16x32_bf16 v[98:101], v[150:153], a[20:23], v[98:101]
ds_read_b128 v[142:145], v10 offset:2240
v_mfma_f32_16x16x32_bf16 v[102:105], v[150:153], a[52:55], v[102:105]
v_fma_f32 v93, s48, v45, v93
v_mfma_f32_16x16x32_bf16 v[106:109], v[150:153], a[84:87], v[106:109]
v_cvt_pk_bf16_f32 v18, v93, v92
v_cvt_pk_bf16_f32 v19, v91, v90
ds_write_b64 v12, v[18:19] offset:3072
v_mfma_f32_16x16x32_bf16 v[110:113], v[150:153], a[116:119], v[110:113]
v_mfma_f32_16x16x32_bf16 v[114:117], v[150:153], a[148:151], v[114:117]
s_waitcnt lgkmcnt(6)
v_mfma_f32_16x16x32_bf16 v[98:101], v[154:157], a[24:27], v[98:101]
ds_read_b128 v[146:149], v10 offset:2304
v_mfma_f32_16x16x32_bf16 v[102:105], v[154:157], a[56:59], v[102:105]
s_cmp_lg_u32 s3, 2
s_cbranch_scc1 L_k1_x30
buffer_load_dwordx2 v[68:69], v3, s[4:7], s49 offen
L_k1_x30:
v_mfma_f32_16x16x32_bf16 v[106:109], v[154:157], a[88:91], v[106:109]
v_mfma_f32_16x16x32_bf16 v[110:113], v[154:157], a[120:123], v[110:113]
v_mfma_f32_16x16x32_bf16 v[114:117], v[154:157], a[152:155], v[114:117]
s_waitcnt lgkmcnt(6)
v_mfma_f32_16x16x32_bf16 v[98:101], v[158:161], a[28:31], v[98:101]
ds_read_b128 v[150:153], v10 offset:2368
v_mfma_f32_16x16x32_bf16 v[102:105], v[158:161], a[60:63], v[102:105]
v_mfma_f32_16x16x32_bf16 v[106:109], v[158:161], a[92:95], v[106:109]
v_mfma_f32_16x16x32_bf16 v[110:113], v[158:161], a[124:127], v[110:113]
v_mfma_f32_16x16x32_bf16 v[114:117], v[158:161], a[156:159], v[114:117]
s_waitcnt lgkmcnt(6)
v_mfma_f32_16x16x32_bf16 v[102:105], v[130:133], a[0:3], v[102:105]
ds_read_b128 v[154:157], v10 offset:2432
v_mfma_f32_16x16x32_bf16 v[106:109], v[130:133], a[32:35], v[106:109]
v_mfma_f32_16x16x32_bf16 v[110:113], v[130:133], a[64:67], v[110:113]
v_mfma_f32_16x16x32_bf16 v[114:117], v[130:133], a[96:99], v[114:117]
s_waitcnt lgkmcnt(6)
v_mfma_f32_16x16x32_bf16 v[102:105], v[134:137], a[4:7], v[102:105]
ds_read_b128 v[158:161], v10 offset:2496
v_mfma_f32_16x16x32_bf16 v[106:109], v[134:137], a[36:39], v[106:109]
s_cmp_lg_u32 s3, 3
s_cbranch_scc1 L_k1_x31
buffer_load_dwordx2 v[68:69], v3, s[4:7], s49 offen
L_k1_x31:
s_add_u32 s49, s49, 131072
v_mfma_f32_16x16x32_bf16 v[110:113], v[134:137], a[68:71], v[110:113]
v_mfma_f32_16x16x32_bf16 v[114:117], v[134:137], a[100:103], v[114:117]
s_waitcnt lgkmcnt(6)
v_mfma_f32_16x16x32_bf16 v[102:105], v[138:141], a[8:11], v[102:105]
ds_read_b128 v[130:133], v10 offset:2560
v_mfma_f32_16x16x32_bf16 v[106:109], v[138:141], a[40:43], v[106:109]
v_mfma_f32_16x16x32_bf16 v[110:113], v[138:141], a[72:75], v[110:113]
v_mfma_f32_16x16x32_bf16 v[114:117], v[138:141], a[104:107], v[114:117]
s_waitcnt lgkmcnt(6)
v_mfma_f32_16x16x32_bf16 v[102:105], v[142:145], a[12:15], v[102:105]
ds_read_b128 v[134:137], v10 offset:2624
v_mfma_f32_16x16x32_bf16 v[106:109], v[142:145], a[44:47], v[106:109]
v_mfma_f32_16x16x32_bf16 v[110:113], v[142:145], a[76:79], v[110:113]
v_and_b32 v46, 0xffff0000, v21
v_mfma_f32_16x16x32_bf16 v[114:117], v[142:145], a[108:111], v[114:117]
v_lshlrev_b32 v47, 16, v21
s_waitcnt lgkmcnt(5)
v_mfma_f32_16x16x32_bf16 v[102:105], v[146:149], a[16:19], v[102:105]
ds_read_b128 v[138:141], v10 offset:2688
v_mfma_f32_16x16x32_bf16 v[106:109], v[146:149], a[48:51], v[106:109]
v_and_b32 v48, 0xffff0000, v20
v_mfma_f32_16x16x32_bf16 v[110:113], v[146:149], a[80:83], v[110:113]
v_lshlrev_b32 v49, 16, v20
v_mfma_f32_16x16x32_bf16 v[114:117], v[146:149], a[112:115], v[114:117]
v_fma_f32 v94, s48, v46, v94
s_waitcnt lgkmcnt(5)
v_mfma_f32_16x16x32_bf16 v[102:105], v[150:153], a[20:23], v[102:105]
ds_read_b128 v[142:145], v10 offset:2752
v_mfma_f32_16x16x32_bf16 v[106:109], v[150:153], a[52:55], v[106:109]
v_fma_f32 v95, s48, v47, v95
v_mfma_f32_16x16x32_bf16 v[110:113], v[150:153], a[84:87], v[110:113]
v_fma_f32 v96, s48, v48, v96
v_mfma_f32_16x16x32_bf16 v[114:117], v[150:153], a[116:119], v[114:117]
v_fma_f32 v97, s48, v49, v97
s_waitcnt lgkmcnt(5)
v_mfma_f32_16x16x32_bf16 v[102:105], v[154:157], a[24:27], v[102:105]
ds_read_b128 v[146:149], v10 offset:2816
v_mfma_f32_16x16x32_bf16 v[106:109], v[154:157], a[56:59], v[106:109]
v_cvt_pk_bf16_f32 v20, v97, v96
v_cvt_pk_bf16_f32 v21, v95, v94
ds_write_b64 v12, v[20:21] offset:2560
v_mfma_f32_16x16x32_bf16 v[110:113], v[154:157], a[88:91], v[110:113]
v_mfma_f32_16x16x32_bf16 v[114:117], v[154:157], a[120:123], v[114:117]
s_waitcnt lgkmcnt(6)
v_mfma_f32_16x16x32_bf16 v[102:105], v[158:161], a[28:31], v[102:105]
ds_read_b128 v[150:153], v10 offset:2880
v_mfma_f32_16x16x32_bf16 v[106:109], v[158:161], a[60:63], v[106:109]
v_mfma_f32_16x16x32_bf16 v[110:113], v[158:161], a[92:95], v[110:113]
v_mfma_f32_16x16x32_bf16 v[114:117], v[158:161], a[124:127], v[114:117]
buffer_load_dwordx3 v[162:164], v5, s[20:23], s50 offen offset:0 sc1
s_waitcnt lgkmcnt(6)
v_mfma_f32_16x16x32_bf16 v[106:109], v[130:133], a[0:3], v[106:109]
ds_read_b128 v[154:157], v10 offset:2944
v_mfma_f32_16x16x32_bf16 v[110:113], v[130:133], a[32:35], v[110:113]
v_mfma_f32_16x16x32_bf16 v[114:117], v[130:133], a[64:67], v[114:117]
buffer_load_dwordx3 v[166:168], v5, s[20:23], s50 offen offset:1024 sc1
s_waitcnt lgkmcnt(6)
v_mfma_f32_16x16x32_bf16 v[106:109], v[134:137], a[4:7], v[106:109]
ds_read_b128 v[158:161], v10 offset:3008
v_mfma_f32_16x16x32_bf16 v[110:113], v[134:137], a[36:39], v[110:113]
v_mfma_f32_16x16x32_bf16 v[114:117], v[134:137], a[68:71], v[114:117]
buffer_load_dwordx3 v[170:172], v5, s[20:23], s50 offen offset:2048 sc1
s_waitcnt lgkmcnt(6)
v_mfma_f32_16x16x32_bf16 v[106:109], v[138:141], a[8:11], v[106:109]
ds_read_b128 v[130:133], v10 offset:3072
v_mfma_f32_16x16x32_bf16 v[110:113], v[138:141], a[40:43], v[110:113]
v_mfma_f32_16x16x32_bf16 v[114:117], v[138:141], a[72:75], v[114:117]
buffer_load_dwordx3 v[174:176], v5, s[20:23], s50 offen offset:3072 sc1
s_waitcnt lgkmcnt(6)
v_mfma_f32_16x16x32_bf16 v[106:109], v[142:145], a[12:15], v[106:109]
ds_read_b128 v[134:137], v10 offset:3136
v_mfma_f32_16x16x32_bf16 v[110:113], v[142:145], a[44:47], v[110:113]
v_mfma_f32_16x16x32_bf16 v[114:117], v[142:145], a[76:79], v[114:117]
buffer_load_dwordx3 v[70:72], v5, s[20:23], s51 offen offset:0 sc1
v_and_b32 v50, 0xffff0000, v23
s_waitcnt lgkmcnt(6)
v_mfma_f32_16x16x32_bf16 v[106:109], v[146:149], a[16:19], v[106:109]
ds_read_b128 v[138:141], v10 offset:3200
v_mfma_f32_16x16x32_bf16 v[110:113], v[146:149], a[48:51], v[110:113]
v_lshlrev_b32 v51, 16, v23
v_mfma_f32_16x16x32_bf16 v[114:117], v[146:149], a[80:83], v[114:117]
buffer_load_dwordx3 v[74:76], v5, s[20:23], s51 offen offset:1024 sc1
v_and_b32 v52, 0xffff0000, v22
s_waitcnt lgkmcnt(5)
v_mfma_f32_16x16x32_bf16 v[106:109], v[150:153], a[20:23], v[106:109]
ds_read_b128 v[142:145], v10 offset:3264
v_mfma_f32_16x16x32_bf16 v[110:113], v[150:153], a[52:55], v[110:113]
v_lshlrev_b32 v53, 16, v22
v_mfma_f32_16x16x32_bf16 v[114:117], v[150:153], a[84:87], v[114:117]
buffer_load_dwordx3 v[78:80], v5, s[20:23], s51 offen offset:2048 sc1
v_fma_f32 v98, s48, v50, v98
s_waitcnt lgkmcnt(5)
v_mfma_f32_16x16x32_bf16 v[106:109], v[154:157], a[24:27], v[106:109]
ds_read_b128 v[146:149], v10 offset:3328
v_mfma_f32_16x16x32_bf16 v[110:113], v[154:157], a[56:59], v[110:113]
v_fma_f32 v99, s48, v51, v99
v_mfma_f32_16x16x32_bf16 v[114:117], v[154:157], a[88:91], v[114:117]
buffer_load_dwordx3 v[82:84], v5, s[20:23], s51 offen offset:3072 sc1
v_fma_f32 v100, s48, v52, v100
s_waitcnt lgkmcnt(5)
v_mfma_f32_16x16x32_bf16 v[106:109], v[158:161], a[28:31], v[106:109]
ds_read_b128 v[150:153], v10 offset:3392
v_mfma_f32_16x16x32_bf16 v[110:113], v[158:161], a[60:63], v[110:113]
v_fma_f32 v101, s48, v53, v101
v_mfma_f32_16x16x32_bf16 v[114:117], v[158:161], a[92:95], v[114:117]
v_cvt_pk_bf16_f32 v22, v101, v100
v_cvt_pk_bf16_f32 v23, v99, v98
ds_write_b64 v12, v[22:23] offset:2048
s_waitcnt lgkmcnt(6)
v_mfma_f32_16x16x32_bf16 v[110:113], v[130:133], a[0:3], v[110:113]
ds_read_b128 v[154:157], v10 offset:3456
v_mfma_f32_16x16x32_bf16 v[114:117], v[130:133], a[32:35], v[114:117]
s_waitcnt lgkmcnt(6)
v_mfma_f32_16x16x32_bf16 v[110:113], v[134:137], a[4:7], v[110:113]
ds_read_b128 v[158:161], v10 offset:3520
v_mfma_f32_16x16x32_bf16 v[114:117], v[134:137], a[36:39], v[114:117]
s_waitcnt lgkmcnt(6)
v_mfma_f32_16x16x32_bf16 v[110:113], v[138:141], a[8:11], v[110:113]
ds_read_b128 v[130:133], v10 offset:3584
v_mfma_f32_16x16x32_bf16 v[114:117], v[138:141], a[40:43], v[114:117]
s_waitcnt lgkmcnt(6)
v_mfma_f32_16x16x32_bf16 v[110:113], v[142:145], a[12:15], v[110:113]
ds_read_b128 v[134:137], v10 offset:3648
v_mfma_f32_16x16x32_bf16 v[114:117], v[142:145], a[44:47], v[114:117]
v_and_b32 v38, 0xffff0000, v25
s_waitcnt lgkmcnt(6)
v_mfma_f32_16x16x32_bf16 v[110:113], v[146:149], a[16:19], v[110:113]
ds_read_b128 v[138:141], v10 offset:3712
v_mfma_f32_16x16x32_bf16 v[114:117], v[146:149], a[48:51], v[114:117]
v_lshlrev_b32 v39, 16, v25
v_and_b32 v40, 0xffff0000, v24
s_waitcnt lgkmcnt(6)
v_mfma_f32_16x16x32_bf16 v[110:113], v[150:153], a[20:23], v[110:113]
ds_read_b128 v[142:145], v10 offset:3776
v_mfma_f32_16x16x32_bf16 v[114:117], v[150:153], a[52:55], v[114:117]
v_lshlrev_b32 v41, 16, v24
v_fma_f32 v102, s48, v38, v102
s_waitcnt lgkmcnt(5)
v_mfma_f32_16x16x32_bf16 v[110:113], v[154:157], a[24:27], v[110:113]
ds_read_b128 v[146:149], v10 offset:3840
v_mfma_f32_16x16x32_bf16 v[114:117], v[154:157], a[56:59], v[114:117]
v_fma_f32 v103, s48, v39, v103
v_fma_f32 v104, s48, v40, v104
s_waitcnt lgkmcnt(5)
v_mfma_f32_16x16x32_bf16 v[110:113], v[158:161], a[28:31], v[110:113]
ds_read_b128 v[150:153], v10 offset:3904
v_mfma_f32_16x16x32_bf16 v[114:117], v[158:161], a[60:63], v[114:117]
v_fma_f32 v105, s48, v41, v105
v_cvt_pk_bf16_f32 v24, v105, v104
v_cvt_pk_bf16_f32 v25, v103, v102
ds_write_b64 v12, v[24:25] offset:1536
s_waitcnt lgkmcnt(6)
v_mfma_f32_16x16x32_bf16 v[114:117], v[130:133], a[0:3], v[114:117]
ds_read_b128 v[154:157], v10 offset:3968
s_waitcnt lgkmcnt(6)
v_mfma_f32_16x16x32_bf16 v[114:117], v[134:137], a[4:7], v[114:117]
ds_read_b128 v[158:161], v10 offset:4032
s_waitcnt lgkmcnt(6)
v_mfma_f32_16x16x32_bf16 v[114:117], v[138:141], a[8:11], v[114:117]
s_waitcnt lgkmcnt(5)
v_mfma_f32_16x16x32_bf16 v[114:117], v[142:145], a[12:15], v[114:117]
v_and_b32 v42, 0xffff0000, v27
s_waitcnt lgkmcnt(4)
v_mfma_f32_16x16x32_bf16 v[114:117], v[146:149], a[16:19], v[114:117]
v_lshlrev_b32 v43, 16, v27
v_and_b32 v44, 0xffff0000, v26
s_waitcnt lgkmcnt(3)
v_mfma_f32_16x16x32_bf16 v[114:117], v[150:153], a[20:23], v[114:117]
v_lshlrev_b32 v45, 16, v26
v_fma_f32 v106, s48, v42, v106
s_waitcnt lgkmcnt(1)
v_mfma_f32_16x16x32_bf16 v[114:117], v[154:157], a[24:27], v[114:117]
v_fma_f32 v107, s48, v43, v107
v_fma_f32 v108, s48, v44, v108
s_waitcnt lgkmcnt(0)
v_mfma_f32_16x16x32_bf16 v[114:117], v[158:161], a[28:31], v[114:117]
v_fma_f32 v109, s48, v45, v109
v_cvt_pk_bf16_f32 v26, v109, v108
v_cvt_pk_bf16_f32 v27, v107, v106
ds_write_b64 v12, v[26:27] offset:1024
v_bfe_u32 v14, v0, 2, 2
v_mul_u32_u24 v14, 37952, v14
v_lshrrev_b32 v15, 4, v0
v_lshlrev_b32 v15, 5, v15
v_sub_u32 v14, v14, v15
v_and_b32 v15, 3, v0
v_lshl_add_u32 v14, v15, 3, v14
s_lshl_b32 s52, s3, 10
s_sub_u32 s52, 36448, s52
v_add_u32 v14, s52, v14
v_lshrrev_b32 v15, 5, v0
v_lshlrev_b32 v15, 16, v15
v_xor_b32 v9, 15, v0
v_and_b32 v9, 31, v9
v_lshl_add_u32 v15, v9, 4, v15
v_and_b32 v46, 0xffff0000, v29
v_lshlrev_b32 v47, 16, v29
v_and_b32 v48, 0xffff0000, v28
v_lshlrev_b32 v49, 16, v28
v_fma_f32 v110, s48, v46, v110
v_fma_f32 v111, s48, v47, v111
v_fma_f32 v112, s48, v48, v112
v_fma_f32 v113, s48, v49, v113
v_cvt_pk_bf16_f32 v28, v113, v112
v_cvt_pk_bf16_f32 v29, v111, v110
ds_write_b64 v12, v[28:29] offset:512
v_and_b32 v50, 0xffff0000, v31
v_lshlrev_b32 v51, 16, v31
v_and_b32 v52, 0xffff0000, v30
v_lshlrev_b32 v53, 16, v30
v_fma_f32 v114, s48, v50, v114
v_fma_f32 v115, s48, v51, v115
v_fma_f32 v116, s48, v52, v116
v_fma_f32 v117, s48, v53, v117
v_cvt_pk_bf16_f32 v30, v117, v116
v_cvt_pk_bf16_f32 v31, v115, v114
ds_write_b64 v12, v[30:31] offset:0
s_lshl_b32 s52, s3, 20
s_lshr_b32 s53, s40, 2
s_lshl_b32 s53, s53, 10
s_add_u32 s52, s52, s53
s_and_b32 s53, s40, 1
s_lshl_b32 s53, s53, 9
s_add_u32 s52, s52, s53
s_and_b32 s53, s40, 2
s_lshl_b32 s53, s53, 2
s_add_u32 s52, s52, s53
s_lshl_b32 s52, s40, 8
s_lshl_b32 s53, s3, 20
s_add_u32 s52, s52, s53
v_xor_b32 v15, 15, v0
v_and_b32 v15, 15, v15
v_lshlrev_b32 v15, 4, v15
v_bfe_u32 v9, v0, 4, 1
v_lshl_add_u32 v15, v9, 17, v15
v_lshrrev_b32 v9, 5, v0
v_lshl_add_u32 v15, v9, 16, v15
s_lshl_b32 s53, s3, 9
v_lshlrev_b32 v9, 3, v0
v_add_u32 v9, s53, v9
v_add_u32 v8, 151808, v9
s_waitcnt lgkmcnt(0)
s_barrier
ds_read_b64_tr_b16 v[16:17], v14 offset:896
ds_read_b64_tr_b16 v[18:19], v14 offset:768
ds_read_b64_tr_b16 v[20:21], v14 offset:640
ds_read_b64_tr_b16 v[22:23], v14 offset:512
ds_read_b64_tr_b16 v[24:25], v14 offset:384
ds_read_b64_tr_b16 v[26:27], v14 offset:256
ds_read_b64_tr_b16 v[28:29], v14 offset:128
ds_read_b64_tr_b16 v[30:31], v14 offset:0
s_mov_b32 s53, 0
L_k1_stc:
s_waitcnt vmcnt(0)
v_xor_b32 v13, s44, v164
v_xor_b32 v12, s44, v168
v_or_b32 v13, v13, v12
v_xor_b32 v12, s44, v172
v_or_b32 v13, v13, v12
v_xor_b32 v12, s44, v176
v_or_b32 v13, v13, v12
v_xor_b32 v12, s44, v72
v_or_b32 v13, v13, v12
v_xor_b32 v12, s44, v76
v_or_b32 v13, v13, v12
v_xor_b32 v12, s44, v80
v_or_b32 v13, v13, v12
v_xor_b32 v12, s44, v84
v_or_b32 v13, v13, v12
v_cmp_eq_u32 vcc, 0, v13
s_cmp_eq_u64 vcc, -1
s_cbranch_scc1 L_k1_stok
s_add_u32 s53, s53, 1
s_cmp_gt_u32 s53, 20000
s_cbranch_scc1 L_k1_stok
buffer_load_dwordx3 v[162:164], v5, s[20:23], s50 offen offset:0 sc1
buffer_load_dwordx3 v[166:168], v5, s[20:23], s50 offen offset:1024 sc1
buffer_load_dwordx3 v[170:172], v5, s[20:23], s50 offen offset:2048 sc1
buffer_load_dwordx3 v[174:176], v5, s[20:23], s50 offen offset:3072 sc1
buffer_load_dwordx3 v[70:72], v5, s[20:23], s51 offen offset:0 sc1
buffer_load_dwordx3 v[74:76], v5, s[20:23], s51 offen offset:1024 sc1
buffer_load_dwordx3 v[78:80], v5, s[20:23], s51 offen offset:2048 sc1
buffer_load_dwordx3 v[82:84], v5, s[20:23], s51 offen offset:3072 sc1
s_branch L_k1_stc
L_k1_stok:
s_waitcnt lgkmcnt(0)
s_barrier
v_lshlrev_b32 v86, 16, v54
v_and_b32 v87, 0xffff0000, v54
v_lshlrev_b32 v88, 16, v55
v_and_b32 v89, 0xffff0000, v55
v_mul_f32 v162, v162, v163
v_lshlrev_b32 v90, 16, v16
v_and_b32 v91, 0xffff0000, v16
v_lshlrev_b32 v92, 16, v17
v_and_b32 v93, 0xffff0000, v17
v_pk_fma_f32 v[94:95], v[86:87], v[162:163], v[162:163] op_sel:[0,1,0] op_sel_hi:[1,1,0] neg_lo:[0,0,1] neg_hi:[0,0,1]
v_pk_fma_f32 v[96:97], v[88:89], v[162:163], v[162:163] op_sel:[0,1,0] op_sel_hi:[1,1,0] neg_lo:[0,0,1] neg_hi:[0,0,1]
v_pk_fma_f32 v[86:87], v[94:95], v[90:91], v[86:87]
v_pk_fma_f32 v[88:89], v[96:97], v[92:93], v[88:89]
v_cvt_pk_bf16_f32 v54, v86, v87
v_cvt_pk_bf16_f32 v55, v88, v89
v_lshlrev_b32 v98, 16, v56
v_and_b32 v99, 0xffff0000, v56
v_lshlrev_b32 v100, 16, v57
v_and_b32 v101, 0xffff0000, v57
v_mul_f32 v166, v166, v167
v_lshlrev_b32 v102, 16, v18
v_and_b32 v103, 0xffff0000, v18
v_lshlrev_b32 v104, 16, v19
v_and_b32 v105, 0xffff0000, v19
v_pk_fma_f32 v[106:107], v[98:99], v[166:167], v[166:167] op_sel:[0,1,0] op_sel_hi:[1,1,0] neg_lo:[0,0,1] neg_hi:[0,0,1]
v_pk_fma_f32 v[108:109], v[100:101], v[166:167], v[166:167] op_sel:[0,1,0] op_sel_hi:[1,1,0] neg_lo:[0,0,1] neg_hi:[0,0,1]
v_pk_fma_f32 v[98:99], v[106:107], v[102:103], v[98:99]
v_pk_fma_f32 v[100:101], v[108:109], v[104:105], v[100:101]
v_cvt_pk_bf16_f32 v56, v98, v99
v_cvt_pk_bf16_f32 v57, v100, v101
s_nop 1
v_permlane16_swap_b32 v54, v56
v_permlane16_swap_b32 v55, v57
buffer_store_dwordx4 v[54:57], v15, s[20:23], s52 offen sc1
s_add_u32 s52, s52, 0x40000
v_lshlrev_b32 v86, 16, v58
v_and_b32 v87, 0xffff0000, v58
v_lshlrev_b32 v88, 16, v59
v_and_b32 v89, 0xffff0000, v59
v_mul_f32 v170, v170, v171
v_lshlrev_b32 v90, 16, v20
v_and_b32 v91, 0xffff0000, v20
v_lshlrev_b32 v92, 16, v21
v_and_b32 v93, 0xffff0000, v21
v_pk_fma_f32 v[94:95], v[86:87], v[170:171], v[170:171] op_sel:[0,1,0] op_sel_hi:[1,1,0] neg_lo:[0,0,1] neg_hi:[0,0,1]
v_pk_fma_f32 v[96:97], v[88:89], v[170:171], v[170:171] op_sel:[0,1,0] op_sel_hi:[1,1,0] neg_lo:[0,0,1] neg_hi:[0,0,1]
v_pk_fma_f32 v[86:87], v[94:95], v[90:91], v[86:87]
v_pk_fma_f32 v[88:89], v[96:97], v[92:93], v[88:89]
v_cvt_pk_bf16_f32 v58, v86, v87
v_cvt_pk_bf16_f32 v59, v88, v89
v_lshlrev_b32 v98, 16, v60
v_and_b32 v99, 0xffff0000, v60
v_lshlrev_b32 v100, 16, v61
v_and_b32 v101, 0xffff0000, v61
v_mul_f32 v174, v174, v175
v_lshlrev_b32 v102, 16, v22
v_and_b32 v103, 0xffff0000, v22
v_lshlrev_b32 v104, 16, v23
v_and_b32 v105, 0xffff0000, v23
v_pk_fma_f32 v[106:107], v[98:99], v[174:175], v[174:175] op_sel:[0,1,0] op_sel_hi:[1,1,0] neg_lo:[0,0,1] neg_hi:[0,0,1]
v_pk_fma_f32 v[108:109], v[100:101], v[174:175], v[174:175] op_sel:[0,1,0] op_sel_hi:[1,1,0] neg_lo:[0,0,1] neg_hi:[0,0,1]
v_pk_fma_f32 v[98:99], v[106:107], v[102:103], v[98:99]
v_pk_fma_f32 v[100:101], v[108:109], v[104:105], v[100:101]
v_cvt_pk_bf16_f32 v60, v98, v99
v_cvt_pk_bf16_f32 v61, v100, v101
s_nop 1
v_permlane16_swap_b32 v58, v60
v_permlane16_swap_b32 v59, v61
buffer_store_dwordx4 v[58:61], v15, s[20:23], s52 offen sc1
s_add_u32 s52, s52, 0x40000
v_lshlrev_b32 v86, 16, v62
v_and_b32 v87, 0xffff0000, v62
v_lshlrev_b32 v88, 16, v63
v_and_b32 v89, 0xffff0000, v63
v_mul_f32 v70, v70, v71
v_lshlrev_b32 v90, 16, v24
v_and_b32 v91, 0xffff0000, v24
v_lshlrev_b32 v92, 16, v25
v_and_b32 v93, 0xffff0000, v25
v_pk_fma_f32 v[94:95], v[86:87], v[70:71], v[70:71] op_sel:[0,1,0] op_sel_hi:[1,1,0] neg_lo:[0,0,1] neg_hi:[0,0,1]
v_pk_fma_f32 v[96:97], v[88:89], v[70:71], v[70:71] op_sel:[0,1,0] op_sel_hi:[1,1,0] neg_lo:[0,0,1] neg_hi:[0,0,1]
v_pk_fma_f32 v[86:87], v[94:95], v[90:91], v[86:87]
v_pk_fma_f32 v[88:89], v[96:97], v[92:93], v[88:89]
v_cvt_pk_bf16_f32 v62, v86, v87
v_cvt_pk_bf16_f32 v63, v88, v89
v_lshlrev_b32 v98, 16, v64
v_and_b32 v99, 0xffff0000, v64
v_lshlrev_b32 v100, 16, v65
v_and_b32 v101, 0xffff0000, v65
v_mul_f32 v74, v74, v75
v_lshlrev_b32 v102, 16, v26
v_and_b32 v103, 0xffff0000, v26
v_lshlrev_b32 v104, 16, v27
v_and_b32 v105, 0xffff0000, v27
v_pk_fma_f32 v[106:107], v[98:99], v[74:75], v[74:75] op_sel:[0,1,0] op_sel_hi:[1,1,0] neg_lo:[0,0,1] neg_hi:[0,0,1]
v_pk_fma_f32 v[108:109], v[100:101], v[74:75], v[74:75] op_sel:[0,1,0] op_sel_hi:[1,1,0] neg_lo:[0,0,1] neg_hi:[0,0,1]
v_pk_fma_f32 v[98:99], v[106:107], v[102:103], v[98:99]
v_pk_fma_f32 v[100:101], v[108:109], v[104:105], v[100:101]
v_cvt_pk_bf16_f32 v64, v98, v99
v_cvt_pk_bf16_f32 v65, v100, v101
s_nop 1
v_permlane16_swap_b32 v62, v64
v_permlane16_swap_b32 v63, v65
buffer_store_dwordx4 v[62:65], v15, s[20:23], s52 offen sc1
s_add_u32 s52, s52, 0x40000
v_lshlrev_b32 v86, 16, v66
v_and_b32 v87, 0xffff0000, v66
v_lshlrev_b32 v88, 16, v67
v_and_b32 v89, 0xffff0000, v67
v_mul_f32 v78, v78, v79
v_lshlrev_b32 v90, 16, v28
v_and_b32 v91, 0xffff0000, v28
v_lshlrev_b32 v92, 16, v29
v_and_b32 v93, 0xffff0000, v29
v_pk_fma_f32 v[94:95], v[86:87], v[78:79], v[78:79] op_sel:[0,1,0] op_sel_hi:[1,1,0] neg_lo:[0,0,1] neg_hi:[0,0,1]
v_pk_fma_f32 v[96:97], v[88:89], v[78:79], v[78:79] op_sel:[0,1,0] op_sel_hi:[1,1,0] neg_lo:[0,0,1] neg_hi:[0,0,1]
v_pk_fma_f32 v[86:87], v[94:95], v[90:91], v[86:87]
v_pk_fma_f32 v[88:89], v[96:97], v[92:93], v[88:89]
v_cvt_pk_bf16_f32 v66, v86, v87
v_cvt_pk_bf16_f32 v67, v88, v89
v_lshlrev_b32 v98, 16, v68
v_and_b32 v99, 0xffff0000, v68
v_lshlrev_b32 v100, 16, v69
v_and_b32 v101, 0xffff0000, v69
v_mul_f32 v82, v82, v83
v_lshlrev_b32 v102, 16, v30
v_and_b32 v103, 0xffff0000, v30
v_lshlrev_b32 v104, 16, v31
v_and_b32 v105, 0xffff0000, v31
v_pk_fma_f32 v[106:107], v[98:99], v[82:83], v[82:83] op_sel:[0,1,0] op_sel_hi:[1,1,0] neg_lo:[0,0,1] neg_hi:[0,0,1]
v_pk_fma_f32 v[108:109], v[100:101], v[82:83], v[82:83] op_sel:[0,1,0] op_sel_hi:[1,1,0] neg_lo:[0,0,1] neg_hi:[0,0,1]
v_pk_fma_f32 v[98:99], v[106:107], v[102:103], v[98:99]
v_pk_fma_f32 v[100:101], v[108:109], v[104:105], v[100:101]
v_cvt_pk_bf16_f32 v68, v98, v99
v_cvt_pk_bf16_f32 v69, v100, v101
s_nop 1
v_permlane16_swap_b32 v66, v68
v_permlane16_swap_b32 v67, v69
buffer_store_dwordx4 v[66:69], v15, s[20:23], s52 offen sc1
s_add_u32 s52, s52, 0x40000
s_cmp_lg_u32 s2, 0
s_cbranch_scc1 L_k1_nobump
s_cmp_lg_u32 s3, 0
s_cbranch_scc1 L_k1_nobump
v_mov_b32 v12, s45
v_mov_b32 v13, 27983872
s_mov_b64 exec, 1
buffer_store_dword v12, v13, s[20:23], 0 offen sc1
s_mov_b64 exec, -1
L_k1_nobump:
s_mov_b32 s59, s44
s_load_dwordx4 s[44:47], s[0:1], 88
s_load_dwordx4 s[28:31], s[0:1], 56
s_load_dwordx4 s[92:95], s[0:1], 72
s_and_b32 s32, s2, 7
s_lshr_b32 s33, s2, 3
s_and_b32 s34, s33, 7
s_lshl_b32 s35, s32, 2
s_lshr_b32 s36, s33, 3
s_add_u32 s35, s35, s36
s_lshl_b32 s36, s34, 3
s_lshl_b32 s37, s3, 1
s_add_u32 s36, s36, s37
s_lshl_b32 s37, s36, 16
s_and_b32 s38, s3, 1
s_mul_i32 s38, s38, 229376
s_mul_i32 s39, s35, 224
s_add_u32 s38, s38, s39
v_add_u32 v11, 0, v0
v_mul_u32_u24 v12, 4682, v11
v_lshrrev_b32 v12, 16, v12
v_mul_u32_u24 v13, 6944, v12
v_lshl_add_u32 v13, v11, 4, v13
v_add_u32 v4, s38, v13
v_add_u32 v11, 64, v0
v_mul_u32_u24 v12, 4682, v11
v_lshrrev_b32 v12, 16, v12
v_mul_u32_u24 v13, 6944, v12
v_lshl_add_u32 v13, v11, 4, v13
s_sub_u32 s39, s38, 1024
v_add_u32 v5, s39, v13
v_add_u32 v11, 128, v0
v_mul_u32_u24 v12, 4682, v11
v_lshrrev_b32 v12, 16, v12
v_mul_u32_u24 v13, 6944, v12
v_lshl_add_u32 v13, v11, 4, v13
s_sub_u32 s39, s38, 2048
v_add_u32 v6, s39, v13
v_add_u32 v11, 192, v0
v_mul_u32_u24 v12, 4682, v11
v_lshrrev_b32 v12, 16, v12
v_mul_u32_u24 v13, 6944, v12
v_lshl_add_u32 v13, v11, 4, v13
s_sub_u32 s39, s38, 3072
v_add_u32 v7, s39, v13
v_add_u32 v11, 256, v0
v_mul_u32_u24 v12, 4682, v11
v_lshrrev_b32 v12, 16, v12
v_mul_u32_u24 v13, 6944, v12
v_lshl_add_u32 v13, v11, 4, v13
v_add_u32 v8, s38, v13
v_add_u32 v11, 320, v0
v_mul_u32_u24 v12, 4682, v11
v_lshrrev_b32 v12, 16, v12
v_mul_u32_u24 v13, 6944, v12
v_lshl_add_u32 v13, v11, 4, v13
s_sub_u32 s39, s38, 1024
v_add_u32 v9, s39, v13
v_add_u32 v11, 384, v0
v_mul_u32_u24 v12, 4682, v11
v_lshrrev_b32 v12, 16, v12
v_mul_u32_u24 v13, 6944, v12
v_lshl_add_u32 v13, v11, 4, v13
s_sub_u32 s39, s38, 2048
v_add_u32 v10, s39, v13
v_lshrrev_b32 v13, 5, v0
v_lshlrev_b32 v2, 10, v13
v_bfe_u32 v14, v0, 4, 1
v_lshlrev_b32 v14, 8, v14
v_and_b32 v15, 15, v0
v_lshlrev_b32 v15, 4, v15
v_add3_u32 v2, v2, v14, v15
v_add_u32 v2, s37, v2
v_add_u32 v3, 0x10000, v2
s_lshr_b32 s40, s3, 1
s_mul_i32 s40, s40, 14336
s_and_b32 s41, s3, 1
s_mul_i32 s41, s41, 7168
s_add_u32 s40, s40, s41
s_lshl_b32 s22, s34, 1
s_mul_i32 s21, s22, 458752
s_lshl_b32 s20, s22, 12
s_lshl_b32 s27, s35, 11
v_lshlrev_b32 v13, 4, v13
v_bfe_u32 v14, v0, 2, 3
v_add_u32 v13, v13, v14
v_mul_u32_u24 v13, 224, v13
v_and_b32 v14, 3, v0
v_lshlrev_b32 v14, 3, v14
v_add_u32 v11, v13, v14
v_add_u32 v12, 57344, v11
v_lshlrev_b32 v1, 4, v0
s_cmp_ge_u32 s3, 2
s_waitcnt lgkmcnt(0)
s_cselect_b32 s8, s30, s28
s_cselect_b32 s9, s31, s29
s_and_b32 s9, s9, 0xffff
s_mov_b32 s10, 7340032
s_mov_b32 s11, 0x00020000
s_add_u32 m0, s40, 0
s_nop 0
buffer_load_dwordx4 v4, s[8:11], s21 offen offset:0 lds
buffer_load_dwordx4 v5, s[8:11], s21 offen offset:1024 lds
buffer_load_dwordx4 v6, s[8:11], s21 offen offset:2048 lds
buffer_load_dwordx4 v7, s[8:11], s21 offen offset:3072 lds
s_add_u32 m0, s40, 4096
s_nop 0
buffer_load_dwordx4 v8, s[8:11], s21 offen offset:0 lds
buffer_load_dwordx4 v9, s[8:11], s21 offen offset:1024 lds
buffer_load_dwordx4 v10, s[8:11], s21 offen offset:2048 lds
s_add_u32 s22, s22, 1
s_and_b32 s22, s22, 15
s_mul_i32 s21, s22, 458752
s_mov_b32 s4, s46
s_and_b32 s5, s47, 0xffff
s_mov_b32 s6, 4194304
s_mov_b32 s7, 0x00020000
s_mov_b32 s16, s46
s_and_b32 s17, s47, 0xffff
s_mov_b32 s18, 268435456
s_mov_b32 s19, 0x00020000
s_lshl_b32 s56, s3, 13
s_lshl_b32 s57, s2, 5
s_add_u32 s56, s56, s57
s_add_u32 s56, s56, 28835840
v_mov_b32 v14, s59
v_mov_b32 v15, 0
s_add_u32 s12, s46, 4194304
s_addc_u32 s13, s47, 0
s_and_b32 s13, s13, 0xffff
s_mov_b32 s14, 14680064
s_mov_b32 s15, 0x00020000
s_mov_b32 s52, s92
s_and_b32 s53, s93, 0xffff
s_mov_b32 s54, 7340032
s_mov_b32 s55, 0x00020000
s_mov_b32 s88, s94
s_and_b32 s89, s95, 0xffff
s_mov_b32 s90, 4194304
s_mov_b32 s91, 0x00020000
v_bfe_u32 v13, v0, 2, 2
v_lshrrev_b32 v14, 4, v0
v_cmp_eq_u32 vcc, v13, v14
v_and_b32 v13, 1, v0
v_lshlrev_b32 v13, 4, v13
v_mov_b32 v14, 0x3f80
v_lshlrev_b32 v13, v13, v14
v_cndmask_b32 v13, 0, v13, vcc
v_and_b32 v14, 2, v0
v_cmp_eq_u32 vcc, 0, v14
v_accvgpr_write_b32 a250, 0
v_accvgpr_write_b32 a251, 0
v_cndmask_b32 v14, 0, v13, vcc
v_cndmask_b32 v15, v13, 0, vcc
v_accvgpr_write_b32 a252, 0
v_accvgpr_write_b32 a253, 0
v_accvgpr_write_b32 a248, v14
v_accvgpr_write_b32 a249, v15
v_accvgpr_write_b32 a254, v14
v_accvgpr_write_b32 a255, v15
v_add_u32 v29, s40, v1
v_lshlrev_b32 v13, 2, v0
s_lshl_b32 s41, s36, 7
s_add_u32 s41, s41, 27328512
s_add_u32 s42, s41, 8192
s_lshl_b32 s58, s2, 2
s_add_u32 s58, s58, s3
s_mul_i32 s58, s58, 7168
s_lshl_b32 s26, s3, 11
s_add_u32 s57, s26, 131072
v_lshl_add_u32 v26, v0, 5, s57
v_lshl_add_u32 v27, v0, 2, s57
s_lshr_b32 s25, s3, 1
s_mul_i32 s25, s25, 14336
s_mul_i32 s57, s35, 448
s_add_u32 s25, s25, s57
s_add_u32 s25, s25, 27394048
v_cmp_gt_u32 vcc, 28, v0
v_mov_b32 v28, 27407936
v_mov_b32 v23, 27394048
s_lshl_b32 s43, s34, 7
v_cndmask_b32 v28, v28, v23, vcc
v_add3_u32 v28, v28, v1, s57
s_add_u32 s43, s43, s35
s_lshl_b32 s43, s43, 7
s_add_u32 s43, s43, 28049440
s_lshl_b32 s57, s34, 7
v_add_u32 v22, s57, v0
v_and_b32 v23, 7, v0
v_lshlrev_b32 v23, 7, v23
v_add_u32 v23, s35, v23
v_cmp_gt_u32 vcc, 32, v0
v_mov_b32 v24, 0
v_mov_b32 v25, 1
v_cndmask_b32 v22, v23, v22, vcc
v_lshlrev_b32 v22, 7, v22
v_add_u32 v22, 28049440, v22
s_lshr_b32 s96, s32, 2
s_xor_b32 s96, s96, 1
s_and_b32 s97, s32, 1
s_lshl_b32 s98, s34, 1
s_add_u32 s97, s97, s98
s_and_b32 s98, s32, 2
s_lshl_b32 s98, s98, 1
s_lshr_b32 s99, s33, 3
s_add_u32 s98, s98, s99
s_lshl_b32 s99, s97, 2
s_add_u32 s99, s99, s3
v_lshrrev_b32 v31, 4, v0
v_lshlrev_b32 v14, 1, v31
v_and_b32 v15, 15, v0
v_xor_b32 v15, v14, v15
v_lshlrev_b32 v15, 4, v15
v_lshlrev_b32 v31, 11, v31
s_and_b32 s100, s3, 1
s_lshl_b32 s100, s100, 14
s_lshl_b32 s101, s98, 8
s_add_u32 s100, s100, s101
v_add3_u32 v30, v31, v15, s100
v_xor_b32 v31, 0x80, v30
v_add_u32 v31, 7168, v31
s_lshr_b32 s101, s3, 1
s_mul_i32 s101, s101, 7
s_mul_i32 s100, s96, 112
s_add_u32 s100, s100, s101
s_lshl_b32 s100, s100, 15
s_lshl_b32 s39, s34, 2
s_add_u32 s39, s39, s3
s_lshl_b32 s39, s39, 5
s_add_u32 s39, s39, s35
s_lshl_b32 s39, s39, 7
s_add_u32 s39, s39, 28049408
v_mov_b32 v14, s59
v_mov_b32 v15, 0
s_waitcnt vmcnt(7)
s_mov_b64 exec, 1
buffer_store_dword v14, v15, s[16:19], s56 offen sc1
s_mov_b64 exec, -1
s_add_u32 m0, s40, 28672
s_nop 0
buffer_load_dwordx4 v4, s[8:11], s21 offen offset:0 lds
buffer_load_dwordx4 v5, s[8:11], s21 offen offset:1024 lds
buffer_load_dwordx4 v6, s[8:11], s21 offen offset:2048 lds
buffer_load_dwordx4 v7, s[8:11], s21 offen offset:3072 lds
s_add_u32 m0, s40, 32768
s_nop 0
buffer_load_dwordx4 v8, s[8:11], s21 offen offset:0 lds
buffer_load_dwordx4 v9, s[8:11], s21 offen offset:1024 lds
buffer_load_dwordx4 v10, s[8:11], s21 offen offset:2048 lds
s_add_u32 s22, s22, 1
s_and_b32 s22, s22, 15
s_mul_i32 s21, s22, 458752
s_waitcnt vmcnt(0)
s_barrier
ds_read_b128 a[208:211], v29 offset:0
ds_read_b128 a[212:215], v29 offset:896
ds_read_b128 a[216:219], v29 offset:1792
ds_read_b128 a[220:223], v29 offset:2688
ds_read_b128 a[224:227], v29 offset:3584
ds_read_b128 a[228:231], v29 offset:4480
ds_read_b128 a[232:235], v29 offset:5376
ds_read_b128 a[236:239], v29 offset:6272
s_waitcnt lgkmcnt(0)
v_mfma_f32_16x16x32_bf16 a[240:243], a[248:251], a[208:211], 0
v_mfma_f32_16x16x32_bf16 a[244:247], a[252:255], a[208:211], 0
v_mfma_f32_16x16x32_bf16 a[240:243], a[248:251], a[212:215], a[240:243]
v_mfma_f32_16x16x32_bf16 a[244:247], a[252:255], a[212:215], a[244:247]
v_mfma_f32_16x16x32_bf16 a[240:243], a[248:251], a[216:219], a[240:243]
v_mfma_f32_16x16x32_bf16 a[244:247], a[252:255], a[216:219], a[244:247]
v_mfma_f32_16x16x32_bf16 a[240:243], a[248:251], a[220:223], a[240:243]
v_mfma_f32_16x16x32_bf16 a[244:247], a[252:255], a[220:223], a[244:247]
v_mfma_f32_16x16x32_bf16 a[240:243], a[248:251], a[224:227], a[240:243]
v_mfma_f32_16x16x32_bf16 a[244:247], a[252:255], a[224:227], a[244:247]
v_mfma_f32_16x16x32_bf16 a[240:243], a[248:251], a[228:231], a[240:243]
v_mfma_f32_16x16x32_bf16 a[244:247], a[252:255], a[228:231], a[244:247]
v_mfma_f32_16x16x32_bf16 a[240:243], a[248:251], a[232:235], a[240:243]
v_mfma_f32_16x16x32_bf16 a[244:247], a[252:255], a[232:235], a[244:247]
v_mfma_f32_16x16x32_bf16 a[240:243], a[248:251], a[236:239], a[240:243]
v_mfma_f32_16x16x32_bf16 a[244:247], a[252:255], a[236:239], a[244:247]
ds_read_b128 a[208:211], v29 offset:28672
ds_read_b128 a[212:215], v29 offset:29568
ds_read_b128 a[216:219], v29 offset:30464
ds_read_b128 a[220:223], v29 offset:31360
ds_read_b128 a[224:227], v29 offset:32256
ds_read_b128 a[228:231], v29 offset:33152
ds_read_b128 a[232:235], v29 offset:34048
ds_read_b128 a[236:239], v29 offset:34944
s_waitcnt lgkmcnt(0)
v_mfma_f32_16x16x32_bf16 a[240:243], a[248:251], a[208:211], a[240:243]
v_mfma_f32_16x16x32_bf16 a[244:247], a[252:255], a[208:211], a[244:247]
v_mfma_f32_16x16x32_bf16 a[240:243], a[248:251], a[212:215], a[240:243]
v_mfma_f32_16x16x32_bf16 a[244:247], a[252:255], a[212:215], a[244:247]
v_mfma_f32_16x16x32_bf16 a[240:243], a[248:251], a[216:219], a[240:243]
v_mfma_f32_16x16x32_bf16 a[244:247], a[252:255], a[216:219], a[244:247]
v_mfma_f32_16x16x32_bf16 a[240:243], a[248:251], a[220:223], a[240:243]
v_mfma_f32_16x16x32_bf16 a[244:247], a[252:255], a[220:223], a[244:247]
v_mfma_f32_16x16x32_bf16 a[240:243], a[248:251], a[224:227], a[240:243]
v_mfma_f32_16x16x32_bf16 a[244:247], a[252:255], a[224:227], a[244:247]
v_mfma_f32_16x16x32_bf16 a[240:243], a[248:251], a[228:231], a[240:243]
v_mfma_f32_16x16x32_bf16 a[244:247], a[252:255], a[228:231], a[244:247]
v_mfma_f32_16x16x32_bf16 a[240:243], a[248:251], a[232:235], a[240:243]
v_mfma_f32_16x16x32_bf16 a[244:247], a[252:255], a[232:235], a[244:247]
v_mfma_f32_16x16x32_bf16 a[240:243], a[248:251], a[236:239], a[240:243]
v_mfma_f32_16x16x32_bf16 a[244:247], a[252:255], a[236:239], a[244:247]
s_nop 7
s_nop 1
ds_write_b128 v26, a[240:243]
ds_write_b128 v26, a[244:247] offset:16
ds_read_b32 v64, v27 offset:0
ds_read_b32 v65, v27 offset:224
ds_read_b32 v66, v27 offset:448
ds_read_b32 v67, v27 offset:672
ds_read_b32 v68, v27 offset:896
ds_read_b32 v69, v27 offset:1120
ds_read_b32 v70, v27 offset:1344
ds_read_b32 v71, v27 offset:1568
s_waitcnt lgkmcnt(0)
v_add_f32 v64, v64, v66
v_add_f32 v65, v65, v67
v_add_f32 v68, v68, v70
v_add_f32 v69, v69, v71
v_add_f32 v14, v64, v68
v_add_f32 v15, v65, v69
ds_read_b64_tr_b16 a[0:1], v11 offset:0
ds_read_b64_tr_b16 a[2:3], v11 offset:1792
ds_read_b64_tr_b16 a[4:5], v11 offset:14336
ds_read_b64_tr_b16 a[6:7], v11 offset:16128
ds_read_b64_tr_b16 a[8:9], v11 offset:32
ds_read_b64_tr_b16 a[10:11], v11 offset:1824
ds_read_b64_tr_b16 a[12:13], v11 offset:14368
ds_read_b64_tr_b16 a[14:15], v11 offset:16160
ds_read_b64_tr_b16 a[16:17], v11 offset:64
ds_read_b64_tr_b16 a[18:19], v11 offset:1856
ds_read_b64_tr_b16 a[20:21], v11 offset:14400
ds_read_b64_tr_b16 a[22:23], v11 offset:16192
ds_read_b64_tr_b16 a[24:25], v11 offset:96
ds_read_b64_tr_b16 a[26:27], v11 offset:1888
ds_read_b64_tr_b16 a[28:29], v11 offset:14432
ds_read_b64_tr_b16 a[30:31], v11 offset:16224
ds_read_b64_tr_b16 a[32:33], v11 offset:128
ds_read_b64_tr_b16 a[34:35], v11 offset:1920
ds_read_b64_tr_b16 a[36:37], v11 offset:14464
ds_read_b64_tr_b16 a[38:39], v11 offset:16256
ds_read_b64_tr_b16 a[40:41], v11 offset:160
ds_read_b64_tr_b16 a[42:43], v11 offset:1952
ds_read_b64_tr_b16 a[44:45], v11 offset:14496
ds_read_b64_tr_b16 a[46:47], v11 offset:16288
ds_read_b64_tr_b16 a[48:49], v11 offset:192
ds_read_b64_tr_b16 a[50:51], v11 offset:1984
ds_read_b64_tr_b16 a[52:53], v11 offset:14528
ds_read_b64_tr_b16 a[54:55], v11 offset:16320
s_lshr_b32 s56, s34, 1
s_lshl_b32 s56, s56, 2
s_add_u32 s56, s56, s3
s_lshl_b32 s56, s56, 11
s_add_u32 s56, s56, 28835840
v_lshlrev_b32 v33, 5, v0
s_mov_b32 s57, 0
L_f_p:
buffer_load_dword v32, v33, s[16:19], s56 offen sc1
s_waitcnt vmcnt(0)
v_cmp_eq_u32 vcc, s59, v32
s_cmp_eq_u64 vcc, -1
s_cbranch_scc1 L_f_p2
s_sleep 2
s_add_u32 s57, s57, 1
s_cmp_gt_u32 s57, 20000
s_cbranch_scc0 L_f_p
L_f_p2:
s_barrier
buffer_load_dwordx4 v[176:179], v2, s[4:7], s20 offen offset:0 sc1
buffer_load_dwordx4 v[180:183], v2, s[4:7], s20 offen offset:512 sc1
buffer_load_dwordx4 v[184:187], v3, s[4:7], s20 offen offset:0 sc1
buffer_load_dwordx4 v[188:191], v3, s[4:7], s20 offen offset:512 sc1
buffer_load_dwordx4 v[32:35], v2, s[4:7], s27 offen offset:0 sc1
buffer_load_dwordx4 v[36:39], v2, s[4:7], s27 offen offset:512 sc1
buffer_load_dwordx4 v[40:43], v3, s[4:7], s27 offen offset:0 sc1
buffer_load_dwordx4 v[44:47], v3, s[4:7], s27 offen offset:512 sc1
buffer_load_dwordx4 v[192:195], v2, s[4:7], s20 offen offset:2048 sc1
buffer_load_dwordx4 v[196:199], v2, s[4:7], s20 offen offset:2560 sc1
buffer_load_dwordx4 v[200:203], v3, s[4:7], s20 offen offset:2048 sc1
buffer_load_dwordx4 v[204:207], v3, s[4:7], s20 offen offset:2560 sc1
s_add_u32 s20, s20, 4096
s_and_b32 s20, s20, 0xffff
v_mov_b32 v56, 0x3f803f80
s_waitcnt vmcnt(4)
v_dot2_f32_bf16 v48, v32, v56, 0
v_dot2_f32_bf16 v52, v32, v32, 0
v_dot2_f32_bf16 v49, v34, v56, 0
v_dot2_f32_bf16 v53, v34, v34, 0
v_dot2_f32_bf16 v50, v40, v56, 0
v_dot2_f32_bf16 v54, v40, v40, 0
v_dot2_f32_bf16 v51, v42, v56, 0
v_dot2_f32_bf16 v55, v42, v42, 0
v_dot2_f32_bf16 v48, v33, v56, v48
v_dot2_f32_bf16 v52, v33, v33, v52
v_dot2_f32_bf16 v49, v35, v56, v49
v_dot2_f32_bf16 v53, v35, v35, v53
v_dot2_f32_bf16 v50, v41, v56, v50
v_dot2_f32_bf16 v54, v41, v41, v54
v_dot2_f32_bf16 v51, v43, v56, v51
v_dot2_f32_bf16 v55, v43, v43, v55
v_dot2_f32_bf16 v48, v36, v56, v48
v_dot2_f32_bf16 v52, v36, v36, v52
v_dot2_f32_bf16 v49, v38, v56, v49
v_dot2_f32_bf16 v53, v38, v38, v53
v_dot2_f32_bf16 v50, v44, v56, v50
v_dot2_f32_bf16 v54, v44, v44, v54
v_dot2_f32_bf16 v51, v46, v56, v51
v_dot2_f32_bf16 v55, v46, v46, v55
v_dot2_f32_bf16 v48, v37, v56, v48
v_dot2_f32_bf16 v52, v37, v37, v52
v_dot2_f32_bf16 v49, v39, v56, v49
v_dot2_f32_bf16 v53, v39, v39, v53
v_dot2_f32_bf16 v50, v45, v56, v50
v_dot2_f32_bf16 v54, v45, v45, v54
v_dot2_f32_bf16 v51, v47, v56, v51
v_dot2_f32_bf16 v55, v47, v47, v55
s_nop 2
v_permlane32_swap_b32 v48, v50
v_permlane32_swap_b32 v49, v51
v_permlane32_swap_b32 v52, v54
v_permlane32_swap_b32 v53, v55
v_add_f32 v48, v48, v50
v_add_f32 v49, v49, v51
v_add_f32 v52, v52, v54
v_add_f32 v53, v53, v55
s_nop 0
v_permlane16_swap_b32 v48, v49
v_permlane16_swap_b32 v52, v53
s_nop 0
v_add_f32 v18, v48, v49
v_add_f32 v19, v52, v53
s_waitcnt vmcnt(8)
v_swap_b32 v178, v180
v_swap_b32 v179, v181
v_swap_b32 v186, v188
v_swap_b32 v187, v189
s_waitcnt lgkmcnt(0)
v_mfma_f32_16x16x32_bf16 v[32:35], a[0:3], v[176:179], 0
v_mfma_f32_16x16x32_bf16 v[36:39], a[0:3], v[180:183], 0
v_mfma_f32_16x16x32_bf16 v[48:51], a[4:7], v[176:179], 0
v_mfma_f32_16x16x32_bf16 v[52:55], a[4:7], v[180:183], 0
ds_read_b64_tr_b16 a[56:57], v11 offset:7168
v_mfma_f32_16x16x32_bf16 v[64:67], a[8:11], v[176:179], 0
ds_read_b64_tr_b16 a[58:59], v11 offset:8960
v_mfma_f32_16x16x32_bf16 v[68:71], a[8:11], v[180:183], 0
buffer_load_dwordx4 v[208:211], v2, s[4:7], s20 offen offset:0 sc1
v_mfma_f32_16x16x32_bf16 v[80:83], a[12:15], v[176:179], 0
ds_read_b64_tr_b16 a[60:61], v11 offset:21504
v_mfma_f32_16x16x32_bf16 v[84:87], a[12:15], v[180:183], 0
ds_read_b64_tr_b16 a[62:63], v11 offset:23296
v_mfma_f32_16x16x32_bf16 v[96:99], a[16:19], v[176:179], 0
v_mfma_f32_16x16x32_bf16 v[100:103], a[16:19], v[180:183], 0
ds_read_b64_tr_b16 a[64:65], v11 offset:7200
v_mfma_f32_16x16x32_bf16 v[112:115], a[20:23], v[176:179], 0
ds_read_b64_tr_b16 a[66:67], v11 offset:8992
v_mfma_f32_16x16x32_bf16 v[116:119], a[20:23], v[180:183], 0
buffer_load_dwordx4 v[212:215], v2, s[4:7], s20 offen offset:512 sc1
v_mfma_f32_16x16x32_bf16 v[128:131], a[24:27], v[176:179], 0
ds_read_b64_tr_b16 a[68:69], v11 offset:21536
v_mfma_f32_16x16x32_bf16 v[132:135], a[24:27], v[180:183], 0
ds_read_b64_tr_b16 a[70:71], v11 offset:23328
v_mfma_f32_16x16x32_bf16 v[144:147], a[28:31], v[176:179], 0
buffer_load_dwordx4 v[216:219], v3, s[4:7], s20 offen offset:0 sc1
v_mfma_f32_16x16x32_bf16 v[148:151], a[28:31], v[180:183], 0
ds_read_b64_tr_b16 a[72:73], v11 offset:7232
v_mfma_f32_16x16x32_bf16 v[160:163], a[32:35], v[176:179], 0
ds_read_b64_tr_b16 a[74:75], v11 offset:9024
v_mfma_f32_16x16x32_bf16 v[164:167], a[32:35], v[180:183], 0
v_mfma_f32_16x16x32_bf16 a[112:115], a[36:39], v[176:179], 0
ds_read_b64_tr_b16 a[76:77], v11 offset:21568
v_mfma_f32_16x16x32_bf16 a[116:119], a[36:39], v[180:183], 0
ds_read_b64_tr_b16 a[78:79], v11 offset:23360
v_mfma_f32_16x16x32_bf16 a[128:131], a[40:43], v[176:179], 0
buffer_load_dwordx4 v[220:223], v3, s[4:7], s20 offen offset:512 sc1
v_mfma_f32_16x16x32_bf16 a[132:135], a[40:43], v[180:183], 0
ds_read_b64_tr_b16 a[80:81], v11 offset:7264
v_mfma_f32_16x16x32_bf16 a[144:147], a[44:47], v[176:179], 0
ds_read_b64_tr_b16 a[82:83], v11 offset:9056
v_mfma_f32_16x16x32_bf16 a[148:151], a[44:47], v[180:183], 0
v_mfma_f32_16x16x32_bf16 a[160:163], a[48:51], v[176:179], 0
ds_read_b64_tr_b16 a[84:85], v11 offset:21600
v_mfma_f32_16x16x32_bf16 a[164:167], a[48:51], v[180:183], 0
ds_read_b64_tr_b16 a[86:87], v11 offset:23392
v_mfma_f32_16x16x32_bf16 a[176:179], a[52:55], v[176:179], 0
buffer_load_dwordx4 v[224:227], v2, s[4:7], s20 offen offset:2048 sc1
v_mfma_f32_16x16x32_bf16 a[180:183], a[52:55], v[180:183], 0
ds_read_b64_tr_b16 a[88:89], v11 offset:7296
v_mfma_f32_16x16x32_bf16 v[40:43], a[0:3], v[184:187], 0
ds_read_b64_tr_b16 a[90:91], v11 offset:9088
v_mfma_f32_16x16x32_bf16 v[44:47], a[0:3], v[188:191], 0
buffer_load_dwordx4 v[228:231], v2, s[4:7], s20 offen offset:2560 sc1
v_mfma_f32_16x16x32_bf16 v[56:59], a[4:7], v[184:187], 0
ds_read_b64_tr_b16 a[92:93], v11 offset:21632
v_mfma_f32_16x16x32_bf16 v[60:63], a[4:7], v[188:191], 0
ds_read_b64_tr_b16 a[94:95], v11 offset:23424
v_mfma_f32_16x16x32_bf16 v[72:75], a[8:11], v[184:187], 0
v_mfma_f32_16x16x32_bf16 v[76:79], a[8:11], v[188:191], 0
ds_read_b64_tr_b16 a[96:97], v11 offset:7328
v_mfma_f32_16x16x32_bf16 v[88:91], a[12:15], v[184:187], 0
ds_read_b64_tr_b16 a[98:99], v11 offset:9120
v_mfma_f32_16x16x32_bf16 v[92:95], a[12:15], v[188:191], 0
buffer_load_dwordx4 v[232:235], v3, s[4:7], s20 offen offset:2048 sc1
v_mfma_f32_16x16x32_bf16 v[104:107], a[16:19], v[184:187], 0
ds_read_b64_tr_b16 a[100:101], v11 offset:21664
v_mfma_f32_16x16x32_bf16 v[108:111], a[16:19], v[188:191], 0
ds_read_b64_tr_b16 a[102:103], v11 offset:23456
v_mfma_f32_16x16x32_bf16 v[120:123], a[20:23], v[184:187], 0
v_mfma_f32_16x16x32_bf16 v[124:127], a[20:23], v[188:191], 0
ds_read_b64_tr_b16 a[104:105], v11 offset:7360
v_mfma_f32_16x16x32_bf16 v[136:139], a[24:27], v[184:187], 0
ds_read_b64_tr_b16 a[106:107], v11 offset:9152
v_mfma_f32_16x16x32_bf16 v[140:143], a[24:27], v[188:191], 0
buffer_load_dwordx4 v[236:239], v3, s[4:7], s20 offen offset:2560 sc1
s_add_u32 s20, s20, 4096
s_and_b32 s20, s20, 0xffff
v_mfma_f32_16x16x32_bf16 v[152:155], a[28:31], v[184:187], 0
ds_read_b64_tr_b16 a[108:109], v11 offset:21696
v_mfma_f32_16x16x32_bf16 v[156:159], a[28:31], v[188:191], 0
ds_read_b64_tr_b16 a[110:111], v11 offset:23488
v_mfma_f32_16x16x32_bf16 v[168:171], a[32:35], v[184:187], 0
s_add_u32 m0, s40, 57344
s_nop 0
buffer_load_dwordx4 v4, s[8:11], s21 offen offset:0 lds
v_mfma_f32_16x16x32_bf16 v[172:175], a[32:35], v[188:191], 0
v_mfma_f32_16x16x32_bf16 a[120:123], a[36:39], v[184:187], 0
v_mfma_f32_16x16x32_bf16 a[124:127], a[36:39], v[188:191], 0
v_mfma_f32_16x16x32_bf16 a[136:139], a[40:43], v[184:187], 0
v_mfma_f32_16x16x32_bf16 a[140:143], a[40:43], v[188:191], 0
buffer_load_dwordx4 v5, s[8:11], s21 offen offset:1024 lds
v_mfma_f32_16x16x32_bf16 a[152:155], a[44:47], v[184:187], 0
s_waitcnt vmcnt(10)
v_swap_b32 v194, v196
v_mfma_f32_16x16x32_bf16 a[156:159], a[44:47], v[188:191], 0
v_swap_b32 v195, v197
v_mfma_f32_16x16x32_bf16 a[168:171], a[48:51], v[184:187], 0
v_swap_b32 v202, v204
v_mfma_f32_16x16x32_bf16 a[172:175], a[48:51], v[188:191], 0
v_swap_b32 v203, v205
v_mfma_f32_16x16x32_bf16 a[184:187], a[52:55], v[184:187], 0
v_mfma_f32_16x16x32_bf16 a[188:191], a[52:55], v[188:191], 0
s_waitcnt lgkmcnt(0)
v_mfma_f32_16x16x32_bf16 v[32:35], a[56:59], v[192:195], v[32:35]
v_mfma_f32_16x16x32_bf16 v[36:39], a[56:59], v[196:199], v[36:39]
v_mfma_f32_16x16x32_bf16 v[48:51], a[60:63], v[192:195], v[48:51]
s_waitcnt vmcnt(22) lgkmcnt(0)
s_barrier
v_mfma_f32_16x16x32_bf16 v[52:55], a[60:63], v[196:199], v[52:55]
ds_read_b64_tr_b16 a[0:1], v11 offset:28672
v_mfma_f32_16x16x32_bf16 v[64:67], a[64:67], v[192:195], v[64:67]
ds_read_b64_tr_b16 a[2:3], v11 offset:30464
v_mfma_f32_16x16x32_bf16 v[68:71], a[64:67], v[196:199], v[68:71]
buffer_load_dwordx4 v6, s[8:11], s21 offen offset:2048 lds
v_mfma_f32_16x16x32_bf16 v[80:83], a[68:71], v[192:195], v[80:83]
ds_read_b64_tr_b16 a[4:5], v11 offset:43008
v_mfma_f32_16x16x32_bf16 v[84:87], a[68:71], v[196:199], v[84:87]
ds_read_b64_tr_b16 a[6:7], v11 offset:44800
v_mfma_f32_16x16x32_bf16 v[96:99], a[72:75], v[192:195], v[96:99]
v_mfma_f32_16x16x32_bf16 v[100:103], a[72:75], v[196:199], v[100:103]
ds_read_b64_tr_b16 a[8:9], v11 offset:28704
v_mfma_f32_16x16x32_bf16 v[112:115], a[76:79], v[192:195], v[112:115]
ds_read_b64_tr_b16 a[10:11], v11 offset:30496
v_mfma_f32_16x16x32_bf16 v[116:119], a[76:79], v[196:199], v[116:119]
buffer_load_dwordx4 v7, s[8:11], s21 offen offset:3072 lds
v_mfma_f32_16x16x32_bf16 v[128:131], a[80:83], v[192:195], v[128:131]
ds_read_b64_tr_b16 a[12:13], v11 offset:43040
v_mfma_f32_16x16x32_bf16 v[132:135], a[80:83], v[196:199], v[132:135]
ds_read_b64_tr_b16 a[14:15], v11 offset:44832
v_mfma_f32_16x16x32_bf16 v[144:147], a[84:87], v[192:195], v[144:147]
s_add_u32 m0, s40, 61440
s_nop 0
buffer_load_dwordx4 v8, s[8:11], s21 offen offset:0 lds
v_mfma_f32_16x16x32_bf16 v[148:151], a[84:87], v[196:199], v[148:151]
ds_read_b64_tr_b16 a[16:17], v11 offset:28736
v_mfma_f32_16x16x32_bf16 v[160:163], a[88:91], v[192:195], v[160:163]
ds_read_b64_tr_b16 a[18:19], v11 offset:30528
v_mfma_f32_16x16x32_bf16 v[164:167], a[88:91], v[196:199], v[164:167]
v_mfma_f32_16x16x32_bf16 a[112:115], a[92:95], v[192:195], a[112:115]
ds_read_b64_tr_b16 a[20:21], v11 offset:43072
v_mfma_f32_16x16x32_bf16 a[116:119], a[92:95], v[196:199], a[116:119]
ds_read_b64_tr_b16 a[22:23], v11 offset:44864
v_mfma_f32_16x16x32_bf16 a[128:131], a[96:99], v[192:195], a[128:131]
buffer_load_dwordx4 v9, s[8:11], s21 offen offset:1024 lds
v_mfma_f32_16x16x32_bf16 a[132:135], a[96:99], v[196:199], a[132:135]
ds_read_b64_tr_b16 a[24:25], v11 offset:28768
v_mfma_f32_16x16x32_bf16 a[144:147], a[100:103], v[192:195], a[144:147]
ds_read_b64_tr_b16 a[26:27], v11 offset:30560
v_mfma_f32_16x16x32_bf16 a[148:151], a[100:103], v[196:199], a[148:151]
v_mfma_f32_16x16x32_bf16 a[160:163], a[104:107], v[192:195], a[160:163]
ds_read_b64_tr_b16 a[28:29], v11 offset:43104
v_mfma_f32_16x16x32_bf16 a[164:167], a[104:107], v[196:199], a[164:167]
ds_read_b64_tr_b16 a[30:31], v11 offset:44896
v_mfma_f32_16x16x32_bf16 a[176:179], a[108:111], v[192:195], a[176:179]
buffer_load_dwordx4 v10, s[8:11], s21 offen offset:2048 lds
s_add_u32 s22, s22, 1
s_and_b32 s22, s22, 15
s_mul_i32 s21, s22, 458752
v_mfma_f32_16x16x32_bf16 a[180:183], a[108:111], v[196:199], a[180:183]
ds_read_b64_tr_b16 a[32:33], v11 offset:28800
v_mfma_f32_16x16x32_bf16 v[40:43], a[56:59], v[200:203], v[40:43]
ds_read_b64_tr_b16 a[34:35], v11 offset:30592
v_mfma_f32_16x16x32_bf16 v[44:47], a[56:59], v[204:207], v[44:47]
s_add_u32 m0, s40, 86016
s_nop 0
buffer_load_dwordx4 v4, s[8:11], s21 offen offset:0 lds
v_mfma_f32_16x16x32_bf16 v[56:59], a[60:63], v[200:203], v[56:59]
ds_read_b64_tr_b16 a[36:37], v11 offset:43136
v_mfma_f32_16x16x32_bf16 v[60:63], a[60:63], v[204:207], v[60:63]
ds_read_b64_tr_b16 a[38:39], v11 offset:44928
v_mfma_f32_16x16x32_bf16 v[72:75], a[64:67], v[200:203], v[72:75]
v_mfma_f32_16x16x32_bf16 v[76:79], a[64:67], v[204:207], v[76:79]
ds_read_b64_tr_b16 a[40:41], v11 offset:28832
v_mfma_f32_16x16x32_bf16 v[88:91], a[68:71], v[200:203], v[88:91]
ds_read_b64_tr_b16 a[42:43], v11 offset:30624
v_mfma_f32_16x16x32_bf16 v[92:95], a[68:71], v[204:207], v[92:95]
buffer_load_dwordx4 v5, s[8:11], s21 offen offset:1024 lds
v_mfma_f32_16x16x32_bf16 v[104:107], a[72:75], v[200:203], v[104:107]
ds_read_b64_tr_b16 a[44:45], v11 offset:43168
v_mfma_f32_16x16x32_bf16 v[108:111], a[72:75], v[204:207], v[108:111]
ds_read_b64_tr_b16 a[46:47], v11 offset:44960
v_mfma_f32_16x16x32_bf16 v[120:123], a[76:79], v[200:203], v[120:123]
v_mfma_f32_16x16x32_bf16 v[124:127], a[76:79], v[204:207], v[124:127]
ds_read_b64_tr_b16 a[48:49], v11 offset:28864
v_mfma_f32_16x16x32_bf16 v[136:139], a[80:83], v[200:203], v[136:139]
ds_read_b64_tr_b16 a[50:51], v11 offset:30656
v_mfma_f32_16x16x32_bf16 v[140:143], a[80:83], v[204:207], v[140:143]
buffer_load_dwordx4 v6, s[8:11], s21 offen offset:2048 lds
v_mfma_f32_16x16x32_bf16 v[152:155], a[84:87], v[200:203], v[152:155]
ds_read_b64_tr_b16 a[52:53], v11 offset:43200
v_mfma_f32_16x16x32_bf16 v[156:159], a[84:87], v[204:207], v[156:159]
ds_read_b64_tr_b16 a[54:55], v11 offset:44992
v_mfma_f32_16x16x32_bf16 v[168:171], a[88:91], v[200:203], v[168:171]
buffer_load_dwordx4 v7, s[8:11], s21 offen offset:3072 lds
v_mfma_f32_16x16x32_bf16 v[172:175], a[88:91], v[204:207], v[172:175]
v_mfma_f32_16x16x32_bf16 a[120:123], a[92:95], v[200:203], a[120:123]
v_mfma_f32_16x16x32_bf16 a[124:127], a[92:95], v[204:207], a[124:127]
v_mfma_f32_16x16x32_bf16 a[136:139], a[96:99], v[200:203], a[136:139]
v_mfma_f32_16x16x32_bf16 a[140:143], a[96:99], v[204:207], a[140:143]
s_add_u32 m0, s40, 90112
s_nop 0
buffer_load_dwordx4 v8, s[8:11], s21 offen offset:0 lds
v_mfma_f32_16x16x32_bf16 a[152:155], a[100:103], v[200:203], a[152:155]
s_waitcnt vmcnt(16)
v_swap_b32 v210, v212
v_mfma_f32_16x16x32_bf16 a[156:159], a[100:103], v[204:207], a[156:159]
v_swap_b32 v211, v213
v_mfma_f32_16x16x32_bf16 a[168:171], a[104:107], v[200:203], a[168:171]
v_swap_b32 v218, v220
v_mfma_f32_16x16x32_bf16 a[172:175], a[104:107], v[204:207], a[172:175]
v_swap_b32 v219, v221
v_mfma_f32_16x16x32_bf16 a[184:187], a[108:111], v[200:203], a[184:187]
v_mfma_f32_16x16x32_bf16 a[188:191], a[108:111], v[204:207], a[188:191]
s_waitcnt lgkmcnt(0)
v_mfma_f32_16x16x32_bf16 v[32:35], a[0:3], v[208:211], v[32:35]
v_mfma_f32_16x16x32_bf16 v[36:39], a[0:3], v[212:215], v[36:39]
v_mfma_f32_16x16x32_bf16 v[48:51], a[4:7], v[208:211], v[48:51]
v_mfma_f32_16x16x32_bf16 v[52:55], a[4:7], v[212:215], v[52:55]
ds_read_b64_tr_b16 a[56:57], v11 offset:35840
v_mfma_f32_16x16x32_bf16 v[64:67], a[8:11], v[208:211], v[64:67]
ds_read_b64_tr_b16 a[58:59], v11 offset:37632
v_mfma_f32_16x16x32_bf16 v[68:71], a[8:11], v[212:215], v[68:71]
buffer_load_dwordx4 v9, s[8:11], s21 offen offset:1024 lds
v_mfma_f32_16x16x32_bf16 v[80:83], a[12:15], v[208:211], v[80:83]
ds_read_b64_tr_b16 a[60:61], v11 offset:50176
v_mfma_f32_16x16x32_bf16 v[84:87], a[12:15], v[212:215], v[84:87]
ds_read_b64_tr_b16 a[62:63], v11 offset:51968
v_mfma_f32_16x16x32_bf16 v[96:99], a[16:19], v[208:211], v[96:99]
v_mfma_f32_16x16x32_bf16 v[100:103], a[16:19], v[212:215], v[100:103]
ds_read_b64_tr_b16 a[64:65], v11 offset:35872
v_mfma_f32_16x16x32_bf16 v[112:115], a[20:23], v[208:211], v[112:115]
ds_read_b64_tr_b16 a[66:67], v11 offset:37664
v_mfma_f32_16x16x32_bf16 v[116:119], a[20:23], v[212:215], v[116:119]
buffer_load_dwordx4 v10, s[8:11], s21 offen offset:2048 lds
s_add_u32 s22, s22, 1
s_and_b32 s22, s22, 15
s_mul_i32 s21, s22, 458752
v_mfma_f32_16x16x32_bf16 v[128:131], a[24:27], v[208:211], v[128:131]
ds_read_b64_tr_b16 a[68:69], v11 offset:50208
v_mfma_f32_16x16x32_bf16 v[132:135], a[24:27], v[212:215], v[132:135]
ds_read_b64_tr_b16 a[70:71], v11 offset:52000
v_mfma_f32_16x16x32_bf16 v[144:147], a[28:31], v[208:211], v[144:147]
buffer_load_dwordx4 v[240:243], v2, s[4:7], s20 offen offset:0 sc1
v_mfma_f32_16x16x32_bf16 v[148:151], a[28:31], v[212:215], v[148:151]
ds_read_b64_tr_b16 a[72:73], v11 offset:35904
v_mfma_f32_16x16x32_bf16 v[160:163], a[32:35], v[208:211], v[160:163]
ds_read_b64_tr_b16 a[74:75], v11 offset:37696
v_mfma_f32_16x16x32_bf16 v[164:167], a[32:35], v[212:215], v[164:167]
v_mfma_f32_16x16x32_bf16 a[112:115], a[36:39], v[208:211], a[112:115]
ds_read_b64_tr_b16 a[76:77], v11 offset:50240
v_mfma_f32_16x16x32_bf16 a[116:119], a[36:39], v[212:215], a[116:119]
ds_read_b64_tr_b16 a[78:79], v11 offset:52032
v_mfma_f32_16x16x32_bf16 a[128:131], a[40:43], v[208:211], a[128:131]
buffer_load_dwordx4 v[244:247], v2, s[4:7], s20 offen offset:512 sc1
v_mfma_f32_16x16x32_bf16 a[132:135], a[40:43], v[212:215], a[132:135]
ds_read_b64_tr_b16 a[80:81], v11 offset:35936
v_mfma_f32_16x16x32_bf16 a[144:147], a[44:47], v[208:211], a[144:147]
ds_read_b64_tr_b16 a[82:83], v11 offset:37728
v_mfma_f32_16x16x32_bf16 a[148:151], a[44:47], v[212:215], a[148:151]
v_mfma_f32_16x16x32_bf16 a[160:163], a[48:51], v[208:211], a[160:163]
ds_read_b64_tr_b16 a[84:85], v11 offset:50272
v_mfma_f32_16x16x32_bf16 a[164:167], a[48:51], v[212:215], a[164:167]
ds_read_b64_tr_b16 a[86:87], v11 offset:52064
v_mfma_f32_16x16x32_bf16 a[176:179], a[52:55], v[208:211], a[176:179]
buffer_load_dwordx4 v[248:251], v3, s[4:7], s20 offen offset:0 sc1
v_mfma_f32_16x16x32_bf16 a[180:183], a[52:55], v[212:215], a[180:183]
ds_read_b64_tr_b16 a[88:89], v11 offset:35968
v_mfma_f32_16x16x32_bf16 v[40:43], a[0:3], v[216:219], v[40:43]
ds_read_b64_tr_b16 a[90:91], v11 offset:37760
v_mfma_f32_16x16x32_bf16 v[44:47], a[0:3], v[220:223], v[44:47]
buffer_load_dwordx4 v[252:255], v3, s[4:7], s20 offen offset:512 sc1
v_mfma_f32_16x16x32_bf16 v[56:59], a[4:7], v[216:219], v[56:59]
ds_read_b64_tr_b16 a[92:93], v11 offset:50304
v_mfma_f32_16x16x32_bf16 v[60:63], a[4:7], v[220:223], v[60:63]
ds_read_b64_tr_b16 a[94:95], v11 offset:52096
v_mfma_f32_16x16x32_bf16 v[72:75], a[8:11], v[216:219], v[72:75]
v_mfma_f32_16x16x32_bf16 v[76:79], a[8:11], v[220:223], v[76:79]
ds_read_b64_tr_b16 a[96:97], v11 offset:36000
v_mfma_f32_16x16x32_bf16 v[88:91], a[12:15], v[216:219], v[88:91]
ds_read_b64_tr_b16 a[98:99], v11 offset:37792
v_mfma_f32_16x16x32_bf16 v[92:95], a[12:15], v[220:223], v[92:95]
buffer_load_dwordx4 v[176:179], v2, s[4:7], s20 offen offset:2048 sc1
v_mfma_f32_16x16x32_bf16 v[104:107], a[16:19], v[216:219], v[104:107]
ds_read_b64_tr_b16 a[100:101], v11 offset:50336
v_mfma_f32_16x16x32_bf16 v[108:111], a[16:19], v[220:223], v[108:111]
ds_read_b64_tr_b16 a[102:103], v11 offset:52128
v_mfma_f32_16x16x32_bf16 v[120:123], a[20:23], v[216:219], v[120:123]
v_mfma_f32_16x16x32_bf16 v[124:127], a[20:23], v[220:223], v[124:127]
ds_read_b64_tr_b16 a[104:105], v11 offset:36032
v_mfma_f32_16x16x32_bf16 v[136:139], a[24:27], v[216:219], v[136:139]
ds_read_b64_tr_b16 a[106:107], v11 offset:37824
v_mfma_f32_16x16x32_bf16 v[140:143], a[24:27], v[220:223], v[140:143]
buffer_load_dwordx4 v[180:183], v2, s[4:7], s20 offen offset:2560 sc1
v_mfma_f32_16x16x32_bf16 v[152:155], a[28:31], v[216:219], v[152:155]
ds_read_b64_tr_b16 a[108:109], v11 offset:50368
v_mfma_f32_16x16x32_bf16 v[156:159], a[28:31], v[220:223], v[156:159]
ds_read_b64_tr_b16 a[110:111], v11 offset:52160
v_mfma_f32_16x16x32_bf16 v[168:171], a[32:35], v[216:219], v[168:171]
buffer_load_dwordx4 v[184:187], v3, s[4:7], s20 offen offset:2048 sc1
v_mfma_f32_16x16x32_bf16 v[172:175], a[32:35], v[220:223], v[172:175]
v_mfma_f32_16x16x32_bf16 a[120:123], a[36:39], v[216:219], a[120:123]
v_mfma_f32_16x16x32_bf16 a[124:127], a[36:39], v[220:223], a[124:127]
v_mfma_f32_16x16x32_bf16 a[136:139], a[40:43], v[216:219], a[136:139]
v_mfma_f32_16x16x32_bf16 a[140:143], a[40:43], v[220:223], a[140:143]
buffer_load_dwordx4 v[188:191], v3, s[4:7], s20 offen offset:2560 sc1
s_add_u32 s20, s20, 4096
s_and_b32 s20, s20, 0xffff
v_mfma_f32_16x16x32_bf16 a[152:155], a[44:47], v[216:219], a[152:155]
s_waitcnt vmcnt(22)
v_swap_b32 v226, v228
v_mfma_f32_16x16x32_bf16 a[156:159], a[44:47], v[220:223], a[156:159]
v_swap_b32 v227, v229
v_mfma_f32_16x16x32_bf16 a[168:171], a[48:51], v[216:219], a[168:171]
v_swap_b32 v234, v236
v_mfma_f32_16x16x32_bf16 a[172:175], a[48:51], v[220:223], a[172:175]
v_swap_b32 v235, v237
v_mfma_f32_16x16x32_bf16 a[184:187], a[52:55], v[216:219], a[184:187]
v_mfma_f32_16x16x32_bf16 a[188:191], a[52:55], v[220:223], a[188:191]
s_waitcnt lgkmcnt(0)
v_mfma_f32_16x16x32_bf16 v[32:35], a[56:59], v[224:227], v[32:35]
v_mfma_f32_16x16x32_bf16 v[36:39], a[56:59], v[228:231], v[36:39]
v_mfma_f32_16x16x32_bf16 v[48:51], a[60:63], v[224:227], v[48:51]
s_waitcnt vmcnt(15) lgkmcnt(0)
s_barrier
v_mfma_f32_16x16x32_bf16 v[52:55], a[60:63], v[228:231], v[52:55]
ds_read_b64_tr_b16 a[0:1], v12 offset:0
v_mfma_f32_16x16x32_bf16 v[64:67], a[64:67], v[224:227], v[64:67]
ds_read_b64_tr_b16 a[2:3], v12 offset:1792
v_mfma_f32_16x16x32_bf16 v[68:71], a[64:67], v[228:231], v[68:71]
s_add_u32 m0, s40, 0
s_nop 0
buffer_load_dwordx4 v4, s[8:11], s21 offen offset:0 lds
v_mfma_f32_16x16x32_bf16 v[80:83], a[68:71], v[224:227], v[80:83]
ds_read_b64_tr_b16 a[4:5], v12 offset:14336
v_mfma_f32_16x16x32_bf16 v[84:87], a[68:71], v[228:231], v[84:87]
ds_read_b64_tr_b16 a[6:7], v12 offset:16128
v_mfma_f32_16x16x32_bf16 v[96:99], a[72:75], v[224:227], v[96:99]
buffer_atomic_add_f32 v18, v13, s[16:19], s41 offen
v_mfma_f32_16x16x32_bf16 v[100:103], a[72:75], v[228:231], v[100:103]
ds_read_b64_tr_b16 a[8:9], v12 offset:32
v_mfma_f32_16x16x32_bf16 v[112:115], a[76:79], v[224:227], v[112:115]
ds_read_b64_tr_b16 a[10:11], v12 offset:1824
v_mfma_f32_16x16x32_bf16 v[116:119], a[76:79], v[228:231], v[116:119]
buffer_load_dwordx4 v5, s[8:11], s21 offen offset:1024 lds
v_mfma_f32_16x16x32_bf16 v[128:131], a[80:83], v[224:227], v[128:131]
ds_read_b64_tr_b16 a[12:13], v12 offset:14368
v_mfma_f32_16x16x32_bf16 v[132:135], a[80:83], v[228:231], v[132:135]
ds_read_b64_tr_b16 a[14:15], v12 offset:16160
v_mfma_f32_16x16x32_bf16 v[144:147], a[84:87], v[224:227], v[144:147]
buffer_load_dwordx4 v6, s[8:11], s21 offen offset:2048 lds
v_mfma_f32_16x16x32_bf16 v[148:151], a[84:87], v[228:231], v[148:151]
ds_read_b64_tr_b16 a[16:17], v12 offset:64
v_mfma_f32_16x16x32_bf16 v[160:163], a[88:91], v[224:227], v[160:163]
ds_read_b64_tr_b16 a[18:19], v12 offset:1856
v_mfma_f32_16x16x32_bf16 v[164:167], a[88:91], v[228:231], v[164:167]
buffer_atomic_add_f32 v19, v13, s[16:19], s42 offen
v_mfma_f32_16x16x32_bf16 a[112:115], a[92:95], v[224:227], a[112:115]
ds_read_b64_tr_b16 a[20:21], v12 offset:14400
v_mfma_f32_16x16x32_bf16 a[116:119], a[92:95], v[228:231], a[116:119]
ds_read_b64_tr_b16 a[22:23], v12 offset:16192
v_mfma_f32_16x16x32_bf16 a[128:131], a[96:99], v[224:227], a[128:131]
buffer_load_dwordx4 v7, s[8:11], s21 offen offset:3072 lds
v_mfma_f32_16x16x32_bf16 a[132:135], a[96:99], v[228:231], a[132:135]
ds_read_b64_tr_b16 a[24:25], v12 offset:96
v_mfma_f32_16x16x32_bf16 a[144:147], a[100:103], v[224:227], a[144:147]
ds_read_b64_tr_b16 a[26:27], v12 offset:1888
v_mfma_f32_16x16x32_bf16 a[148:151], a[100:103], v[228:231], a[148:151]
s_mov_b32 exec_hi, 0xffffff
buffer_atomic_add_f32 v14, v13, s[16:19], s25 offen offset:0
s_mov_b32 exec_hi, -1
v_mfma_f32_16x16x32_bf16 a[160:163], a[104:107], v[224:227], a[160:163]
ds_read_b64_tr_b16 a[28:29], v12 offset:14432
v_mfma_f32_16x16x32_bf16 a[164:167], a[104:107], v[228:231], a[164:167]
ds_read_b64_tr_b16 a[30:31], v12 offset:16224
v_mfma_f32_16x16x32_bf16 a[176:179], a[108:111], v[224:227], a[176:179]
s_add_u32 m0, s40, 4096
s_nop 0
buffer_load_dwordx4 v8, s[8:11], s21 offen offset:0 lds
v_mfma_f32_16x16x32_bf16 a[180:183], a[108:111], v[228:231], a[180:183]
ds_read_b64_tr_b16 a[32:33], v12 offset:128
v_mfma_f32_16x16x32_bf16 v[40:43], a[56:59], v[232:235], v[40:43]
ds_read_b64_tr_b16 a[34:35], v12 offset:1920
v_mfma_f32_16x16x32_bf16 v[44:47], a[56:59], v[236:239], v[44:47]
buffer_load_dwordx4 v9, s[8:11], s21 offen offset:1024 lds
v_mfma_f32_16x16x32_bf16 v[56:59], a[60:63], v[232:235], v[56:59]
ds_read_b64_tr_b16 a[36:37], v12 offset:14464
v_mfma_f32_16x16x32_bf16 v[60:63], a[60:63], v[236:239], v[60:63]
ds_read_b64_tr_b16 a[38:39], v12 offset:16256
v_mfma_f32_16x16x32_bf16 v[72:75], a[64:67], v[232:235], v[72:75]
s_mov_b32 exec_hi, 0xffffff
buffer_atomic_add_f32 v15, v13, s[16:19], s25 offen offset:224
s_mov_b32 exec_hi, -1
v_mfma_f32_16x16x32_bf16 v[76:79], a[64:67], v[236:239], v[76:79]
ds_read_b64_tr_b16 a[40:41], v12 offset:160
v_mfma_f32_16x16x32_bf16 v[88:91], a[68:71], v[232:235], v[88:91]
ds_read_b64_tr_b16 a[42:43], v12 offset:1952
v_mfma_f32_16x16x32_bf16 v[92:95], a[68:71], v[236:239], v[92:95]
buffer_load_dwordx4 v10, s[8:11], s21 offen offset:2048 lds
s_add_u32 s22, s22, 1
s_and_b32 s22, s22, 15
s_mul_i32 s21, s22, 458752
v_mfma_f32_16x16x32_bf16 v[104:107], a[72:75], v[232:235], v[104:107]
ds_read_b64_tr_b16 a[44:45], v12 offset:14496
v_mfma_f32_16x16x32_bf16 v[108:111], a[72:75], v[236:239], v[108:111]
ds_read_b64_tr_b16 a[46:47], v12 offset:16288
v_mfma_f32_16x16x32_bf16 v[120:123], a[76:79], v[232:235], v[120:123]
v_and_b32 v13, 60, v13
v_mfma_f32_16x16x32_bf16 v[124:127], a[76:79], v[236:239], v[124:127]
ds_read_b64_tr_b16 a[48:49], v12 offset:192
v_mfma_f32_16x16x32_bf16 v[136:139], a[80:83], v[232:235], v[136:139]
ds_read_b64_tr_b16 a[50:51], v12 offset:1984
v_mfma_f32_16x16x32_bf16 v[140:143], a[80:83], v[236:239], v[140:143]
buffer_load_dwordx4 v[192:195], v2, s[4:7], s20 offen offset:0 sc1
v_mfma_f32_16x16x32_bf16 v[152:155], a[84:87], v[232:235], v[152:155]
ds_read_b64_tr_b16 a[52:53], v12 offset:14528
v_mfma_f32_16x16x32_bf16 v[156:159], a[84:87], v[236:239], v[156:159]
ds_read_b64_tr_b16 a[54:55], v12 offset:16320
v_mfma_f32_16x16x32_bf16 v[168:171], a[88:91], v[232:235], v[168:171]
buffer_load_dwordx4 v[196:199], v2, s[4:7], s20 offen offset:512 sc1
v_mfma_f32_16x16x32_bf16 v[172:175], a[88:91], v[236:239], v[172:175]
v_mfma_f32_16x16x32_bf16 a[120:123], a[92:95], v[232:235], a[120:123]
v_mfma_f32_16x16x32_bf16 a[124:127], a[92:95], v[236:239], a[124:127]
v_mfma_f32_16x16x32_bf16 a[136:139], a[96:99], v[232:235], a[136:139]
v_mfma_f32_16x16x32_bf16 a[140:143], a[96:99], v[236:239], a[140:143]
buffer_load_dwordx4 v[200:203], v3, s[4:7], s20 offen offset:0 sc1
v_mfma_f32_16x16x32_bf16 a[152:155], a[100:103], v[232:235], a[152:155]
s_waitcnt vmcnt(18)
v_swap_b32 v242, v244
v_mfma_f32_16x16x32_bf16 a[156:159], a[100:103], v[236:239], a[156:159]
v_swap_b32 v243, v245
v_mfma_f32_16x16x32_bf16 a[168:171], a[104:107], v[232:235], a[168:171]
v_swap_b32 v250, v252
v_mfma_f32_16x16x32_bf16 a[172:175], a[104:107], v[236:239], a[172:175]
v_swap_b32 v251, v253
v_mfma_f32_16x16x32_bf16 a[184:187], a[108:111], v[232:235], a[184:187]
v_mfma_f32_16x16x32_bf16 a[188:191], a[108:111], v[236:239], a[188:191]
s_waitcnt lgkmcnt(0)
v_mfma_f32_16x16x32_bf16 v[32:35], a[0:3], v[240:243], v[32:35]
v_mfma_f32_16x16x32_bf16 v[36:39], a[0:3], v[244:247], v[36:39]
v_mfma_f32_16x16x32_bf16 v[48:51], a[4:7], v[240:243], v[48:51]
v_mfma_f32_16x16x32_bf16 v[52:55], a[4:7], v[244:247], v[52:55]
ds_read_b64_tr_b16 a[56:57], v12 offset:7168
v_mfma_f32_16x16x32_bf16 v[64:67], a[8:11], v[240:243], v[64:67]
ds_read_b64_tr_b16 a[58:59], v12 offset:8960
v_mfma_f32_16x16x32_bf16 v[68:71], a[8:11], v[244:247], v[68:71]
buffer_load_dwordx4 v[204:207], v3, s[4:7], s20 offen offset:512 sc1
v_mfma_f32_16x16x32_bf16 v[80:83], a[12:15], v[240:243], v[80:83]
ds_read_b64_tr_b16 a[60:61], v12 offset:21504
v_mfma_f32_16x16x32_bf16 v[84:87], a[12:15], v[244:247], v[84:87]
ds_read_b64_tr_b16 a[62:63], v12 offset:23296
v_mfma_f32_16x16x32_bf16 v[96:99], a[16:19], v[240:243], v[96:99]
v_mfma_f32_16x16x32_bf16 v[100:103], a[16:19], v[244:247], v[100:103]
ds_read_b64_tr_b16 a[64:65], v12 offset:7200
v_mfma_f32_16x16x32_bf16 v[112:115], a[20:23], v[240:243], v[112:115]
ds_read_b64_tr_b16 a[66:67], v12 offset:8992
v_mfma_f32_16x16x32_bf16 v[116:119], a[20:23], v[244:247], v[116:119]
buffer_load_dwordx4 v[208:211], v2, s[4:7], s20 offen offset:2048 sc1
v_mfma_f32_16x16x32_bf16 v[128:131], a[24:27], v[240:243], v[128:131]
ds_read_b64_tr_b16 a[68:69], v12 offset:21536
v_mfma_f32_16x16x32_bf16 v[132:135], a[24:27], v[244:247], v[132:135]
ds_read_b64_tr_b16 a[70:71], v12 offset:23328
v_mfma_f32_16x16x32_bf16 v[144:147], a[28:31], v[240:243], v[144:147]
buffer_load_dwordx4 v[212:215], v2, s[4:7], s20 offen offset:2560 sc1
v_mfma_f32_16x16x32_bf16 v[148:151], a[28:31], v[244:247], v[148:151]
ds_read_b64_tr_b16 a[72:73], v12 offset:7232
v_mfma_f32_16x16x32_bf16 v[160:163], a[32:35], v[240:243], v[160:163]
ds_read_b64_tr_b16 a[74:75], v12 offset:9024
v_mfma_f32_16x16x32_bf16 v[164:167], a[32:35], v[244:247], v[164:167]
v_mfma_f32_16x16x32_bf16 a[112:115], a[36:39], v[240:243], a[112:115]
ds_read_b64_tr_b16 a[76:77], v12 offset:21568
v_mfma_f32_16x16x32_bf16 a[116:119], a[36:39], v[244:247], a[116:119]
ds_read_b64_tr_b16 a[78:79], v12 offset:23360
v_mfma_f32_16x16x32_bf16 a[128:131], a[40:43], v[240:243], a[128:131]
buffer_load_dwordx4 v[216:219], v3, s[4:7], s20 offen offset:2048 sc1
v_mfma_f32_16x16x32_bf16 a[132:135], a[40:43], v[244:247], a[132:135]
ds_read_b64_tr_b16 a[80:81], v12 offset:7264
v_mfma_f32_16x16x32_bf16 a[144:147], a[44:47], v[240:243], a[144:147]
ds_read_b64_tr_b16 a[82:83], v12 offset:9056
v_mfma_f32_16x16x32_bf16 a[148:151], a[44:47], v[244:247], a[148:151]
v_mfma_f32_16x16x32_bf16 a[160:163], a[48:51], v[240:243], a[160:163]
ds_read_b64_tr_b16 a[84:85], v12 offset:21600
v_mfma_f32_16x16x32_bf16 a[164:167], a[48:51], v[244:247], a[164:167]
ds_read_b64_tr_b16 a[86:87], v12 offset:23392
v_mfma_f32_16x16x32_bf16 a[176:179], a[52:55], v[240:243], a[176:179]
buffer_load_dwordx4 v[220:223], v3, s[4:7], s20 offen offset:2560 sc1
s_add_u32 s20, s20, 4096
s_and_b32 s20, s20, 0xffff
v_mfma_f32_16x16x32_bf16 a[180:183], a[52:55], v[244:247], a[180:183]
ds_read_b64_tr_b16 a[88:89], v12 offset:7296
v_mfma_f32_16x16x32_bf16 v[40:43], a[0:3], v[248:251], v[40:43]
ds_read_b64_tr_b16 a[90:91], v12 offset:9088
v_mfma_f32_16x16x32_bf16 v[44:47], a[0:3], v[252:255], v[44:47]
s_add_u32 m0, s40, 28672
s_nop 0
buffer_load_dwordx4 v4, s[8:11], s21 offen offset:0 lds
v_mfma_f32_16x16x32_bf16 v[56:59], a[4:7], v[248:251], v[56:59]
ds_read_b64_tr_b16 a[92:93], v12 offset:21632
v_mfma_f32_16x16x32_bf16 v[60:63], a[4:7], v[252:255], v[60:63]
ds_read_b64_tr_b16 a[94:95], v12 offset:23424
v_mfma_f32_16x16x32_bf16 v[72:75], a[8:11], v[248:251], v[72:75]
v_mfma_f32_16x16x32_bf16 v[76:79], a[8:11], v[252:255], v[76:79]
ds_read_b64_tr_b16 a[96:97], v12 offset:7328
v_mfma_f32_16x16x32_bf16 v[88:91], a[12:15], v[248:251], v[88:91]
ds_read_b64_tr_b16 a[98:99], v12 offset:9120
v_mfma_f32_16x16x32_bf16 v[92:95], a[12:15], v[252:255], v[92:95]
buffer_load_dwordx4 v5, s[8:11], s21 offen offset:1024 lds
v_mfma_f32_16x16x32_bf16 v[104:107], a[16:19], v[248:251], v[104:107]
ds_read_b64_tr_b16 a[100:101], v12 offset:21664
v_mfma_f32_16x16x32_bf16 v[108:111], a[16:19], v[252:255], v[108:111]
ds_read_b64_tr_b16 a[102:103], v12 offset:23456
v_mfma_f32_16x16x32_bf16 v[120:123], a[20:23], v[248:251], v[120:123]
v_mfma_f32_16x16x32_bf16 v[124:127], a[20:23], v[252:255], v[124:127]
ds_read_b64_tr_b16 a[104:105], v12 offset:7360
v_mfma_f32_16x16x32_bf16 v[136:139], a[24:27], v[248:251], v[136:139]
ds_read_b64_tr_b16 a[106:107], v12 offset:9152
v_mfma_f32_16x16x32_bf16 v[140:143], a[24:27], v[252:255], v[140:143]
buffer_load_dwordx4 v6, s[8:11], s21 offen offset:2048 lds
v_mfma_f32_16x16x32_bf16 v[152:155], a[28:31], v[248:251], v[152:155]
ds_read_b64_tr_b16 a[108:109], v12 offset:21696
v_mfma_f32_16x16x32_bf16 v[156:159], a[28:31], v[252:255], v[156:159]
ds_read_b64_tr_b16 a[110:111], v12 offset:23488
v_mfma_f32_16x16x32_bf16 v[168:171], a[32:35], v[248:251], v[168:171]
buffer_load_dwordx4 v7, s[8:11], s21 offen offset:3072 lds
v_mfma_f32_16x16x32_bf16 v[172:175], a[32:35], v[252:255], v[172:175]
v_mfma_f32_16x16x32_bf16 a[120:123], a[36:39], v[248:251], a[120:123]
v_mfma_f32_16x16x32_bf16 a[124:127], a[36:39], v[252:255], a[124:127]
v_mfma_f32_16x16x32_bf16 a[136:139], a[40:43], v[248:251], a[136:139]
v_mfma_f32_16x16x32_bf16 a[140:143], a[40:43], v[252:255], a[140:143]
s_add_u32 m0, s40, 32768
s_nop 0
buffer_load_dwordx4 v8, s[8:11], s21 offen offset:0 lds
v_mfma_f32_16x16x32_bf16 a[152:155], a[44:47], v[248:251], a[152:155]
s_waitcnt vmcnt(24)
v_swap_b32 v178, v180
v_mfma_f32_16x16x32_bf16 a[156:159], a[44:47], v[252:255], a[156:159]
v_swap_b32 v179, v181
v_mfma_f32_16x16x32_bf16 a[168:171], a[48:51], v[248:251], a[168:171]
v_swap_b32 v186, v188
v_mfma_f32_16x16x32_bf16 a[172:175], a[48:51], v[252:255], a[172:175]
v_swap_b32 v187, v189
v_mfma_f32_16x16x32_bf16 a[184:187], a[52:55], v[248:251], a[184:187]
v_mfma_f32_16x16x32_bf16 a[188:191], a[52:55], v[252:255], a[188:191]
s_waitcnt lgkmcnt(0)
v_mfma_f32_16x16x32_bf16 v[32:35], a[56:59], v[176:179], v[32:35]
v_mfma_f32_16x16x32_bf16 v[36:39], a[56:59], v[180:183], v[36:39]
v_mfma_f32_16x16x32_bf16 v[48:51], a[60:63], v[176:179], v[48:51]
s_waitcnt vmcnt(32) lgkmcnt(0)
s_barrier
v_mfma_f32_16x16x32_bf16 v[52:55], a[60:63], v[180:183], v[52:55]
ds_read_b64_tr_b16 a[0:1], v12 offset:28672
v_mfma_f32_16x16x32_bf16 v[64:67], a[64:67], v[176:179], v[64:67]
ds_read_b64_tr_b16 a[2:3], v12 offset:30464
v_mfma_f32_16x16x32_bf16 v[68:71], a[64:67], v[180:183], v[68:71]
buffer_load_dwordx4 v9, s[8:11], s21 offen offset:1024 lds
v_mfma_f32_16x16x32_bf16 v[80:83], a[68:71], v[176:179], v[80:83]
ds_read_b64_tr_b16 a[4:5], v12 offset:43008
v_mfma_f32_16x16x32_bf16 v[84:87], a[68:71], v[180:183], v[84:87]
ds_read_b64_tr_b16 a[6:7], v12 offset:44800
v_mfma_f32_16x16x32_bf16 v[96:99], a[72:75], v[176:179], v[96:99]
v_mfma_f32_16x16x32_bf16 v[100:103], a[72:75], v[180:183], v[100:103]
ds_read_b64_tr_b16 a[8:9], v12 offset:28704
v_mfma_f32_16x16x32_bf16 v[112:115], a[76:79], v[176:179], v[112:115]
ds_read_b64_tr_b16 a[10:11], v12 offset:30496
v_mfma_f32_16x16x32_bf16 v[116:119], a[76:79], v[180:183], v[116:119]
buffer_load_dwordx4 v10, s[8:11], s21 offen offset:2048 lds
s_add_u32 s22, s22, 1
s_and_b32 s22, s22, 15
s_mul_i32 s21, s22, 458752
v_mfma_f32_16x16x32_bf16 v[128:131], a[80:83], v[176:179], v[128:131]
ds_read_b64_tr_b16 a[12:13], v12 offset:43040
v_mfma_f32_16x16x32_bf16 v[132:135], a[80:83], v[180:183], v[132:135]
ds_read_b64_tr_b16 a[14:15], v12 offset:44832
v_mfma_f32_16x16x32_bf16 v[144:147], a[84:87], v[176:179], v[144:147]
buffer_load_dwordx4 v[224:227], v2, s[4:7], s20 offen offset:0 sc1
v_mfma_f32_16x16x32_bf16 v[148:151], a[84:87], v[180:183], v[148:151]
ds_read_b64_tr_b16 a[16:17], v12 offset:28736
v_mfma_f32_16x16x32_bf16 v[160:163], a[88:91], v[176:179], v[160:163]
ds_read_b64_tr_b16 a[18:19], v12 offset:30528
v_mfma_f32_16x16x32_bf16 v[164:167], a[88:91], v[180:183], v[164:167]
v_mfma_f32_16x16x32_bf16 a[112:115], a[92:95], v[176:179], a[112:115]
ds_read_b64_tr_b16 a[20:21], v12 offset:43072
v_mfma_f32_16x16x32_bf16 a[116:119], a[92:95], v[180:183], a[116:119]
ds_read_b64_tr_b16 a[22:23], v12 offset:44864
v_mfma_f32_16x16x32_bf16 a[128:131], a[96:99], v[176:179], a[128:131]
buffer_load_dwordx4 v[228:231], v2, s[4:7], s20 offen offset:512 sc1
v_mfma_f32_16x16x32_bf16 a[132:135], a[96:99], v[180:183], a[132:135]
ds_read_b64_tr_b16 a[24:25], v12 offset:28768
v_mfma_f32_16x16x32_bf16 a[144:147], a[100:103], v[176:179], a[144:147]
ds_read_b64_tr_b16 a[26:27], v12 offset:30560
v_mfma_f32_16x16x32_bf16 a[148:151], a[100:103], v[180:183], a[148:151]
v_mfma_f32_16x16x32_bf16 a[160:163], a[104:107], v[176:179], a[160:163]
ds_read_b64_tr_b16 a[28:29], v12 offset:43104
v_mfma_f32_16x16x32_bf16 a[164:167], a[104:107], v[180:183], a[164:167]
ds_read_b64_tr_b16 a[30:31], v12 offset:44896
v_mfma_f32_16x16x32_bf16 a[176:179], a[108:111], v[176:179], a[176:179]
buffer_load_dwordx4 v[232:235], v3, s[4:7], s20 offen offset:0 sc1
v_mfma_f32_16x16x32_bf16 a[180:183], a[108:111], v[180:183], a[180:183]
ds_read_b64_tr_b16 a[32:33], v12 offset:28800
v_mfma_f32_16x16x32_bf16 v[40:43], a[56:59], v[184:187], v[40:43]
ds_read_b64_tr_b16 a[34:35], v12 offset:30592
v_mfma_f32_16x16x32_bf16 v[44:47], a[56:59], v[188:191], v[44:47]
buffer_load_dwordx4 v[236:239], v3, s[4:7], s20 offen offset:512 sc1
v_mfma_f32_16x16x32_bf16 v[56:59], a[60:63], v[184:187], v[56:59]
ds_read_b64_tr_b16 a[36:37], v12 offset:43136
v_mfma_f32_16x16x32_bf16 v[60:63], a[60:63], v[188:191], v[60:63]
ds_read_b64_tr_b16 a[38:39], v12 offset:44928
v_mfma_f32_16x16x32_bf16 v[72:75], a[64:67], v[184:187], v[72:75]
v_mfma_f32_16x16x32_bf16 v[76:79], a[64:67], v[188:191], v[76:79]
ds_read_b64_tr_b16 a[40:41], v12 offset:28832
v_mfma_f32_16x16x32_bf16 v[88:91], a[68:71], v[184:187], v[88:91]
ds_read_b64_tr_b16 a[42:43], v12 offset:30624
v_mfma_f32_16x16x32_bf16 v[92:95], a[68:71], v[188:191], v[92:95]
buffer_load_dwordx4 v[240:243], v2, s[4:7], s20 offen offset:2048 sc1
v_mfma_f32_16x16x32_bf16 v[104:107], a[72:75], v[184:187], v[104:107]
ds_read_b64_tr_b16 a[44:45], v12 offset:43168
v_mfma_f32_16x16x32_bf16 v[108:111], a[72:75], v[188:191], v[108:111]
ds_read_b64_tr_b16 a[46:47], v12 offset:44960
v_mfma_f32_16x16x32_bf16 v[120:123], a[76:79], v[184:187], v[120:123]
v_mfma_f32_16x16x32_bf16 v[124:127], a[76:79], v[188:191], v[124:127]
ds_read_b64_tr_b16 a[48:49], v12 offset:28864
v_mfma_f32_16x16x32_bf16 v[136:139], a[80:83], v[184:187], v[136:139]
ds_read_b64_tr_b16 a[50:51], v12 offset:30656
v_mfma_f32_16x16x32_bf16 v[140:143], a[80:83], v[188:191], v[140:143]
buffer_load_dwordx4 v[244:247], v2, s[4:7], s20 offen offset:2560 sc1
v_mfma_f32_16x16x32_bf16 v[152:155], a[84:87], v[184:187], v[152:155]
ds_read_b64_tr_b16 a[52:53], v12 offset:43200
v_mfma_f32_16x16x32_bf16 v[156:159], a[84:87], v[188:191], v[156:159]
ds_read_b64_tr_b16 a[54:55], v12 offset:44992
v_mfma_f32_16x16x32_bf16 v[168:171], a[88:91], v[184:187], v[168:171]
buffer_load_dwordx4 v[248:251], v3, s[4:7], s20 offen offset:2048 sc1
v_mfma_f32_16x16x32_bf16 v[172:175], a[88:91], v[188:191], v[172:175]
v_mfma_f32_16x16x32_bf16 a[120:123], a[92:95], v[184:187], a[120:123]
v_mfma_f32_16x16x32_bf16 a[124:127], a[92:95], v[188:191], a[124:127]
v_mfma_f32_16x16x32_bf16 a[136:139], a[96:99], v[184:187], a[136:139]
v_mfma_f32_16x16x32_bf16 a[140:143], a[96:99], v[188:191], a[140:143]
buffer_load_dwordx4 v[252:255], v3, s[4:7], s20 offen offset:2560 sc1
s_add_u32 s20, s20, 4096
s_and_b32 s20, s20, 0xffff
v_mfma_f32_16x16x32_bf16 a[152:155], a[100:103], v[184:187], a[152:155]
s_waitcnt vmcnt(19)
v_swap_b32 v194, v196
v_mfma_f32_16x16x32_bf16 a[156:159], a[100:103], v[188:191], a[156:159]
v_swap_b32 v195, v197
v_mfma_f32_16x16x32_bf16 a[168:171], a[104:107], v[184:187], a[168:171]
v_swap_b32 v202, v204
v_mfma_f32_16x16x32_bf16 a[172:175], a[104:107], v[188:191], a[172:175]
v_swap_b32 v203, v205
v_mfma_f32_16x16x32_bf16 a[184:187], a[108:111], v[184:187], a[184:187]
v_mfma_f32_16x16x32_bf16 a[188:191], a[108:111], v[188:191], a[188:191]
s_waitcnt lgkmcnt(0)
v_mfma_f32_16x16x32_bf16 v[32:35], a[0:3], v[192:195], v[32:35]
v_mfma_f32_16x16x32_bf16 v[36:39], a[0:3], v[196:199], v[36:39]
v_mfma_f32_16x16x32_bf16 v[48:51], a[4:7], v[192:195], v[48:51]
v_mfma_f32_16x16x32_bf16 v[52:55], a[4:7], v[196:199], v[52:55]
ds_read_b64_tr_b16 a[56:57], v12 offset:35840
v_mfma_f32_16x16x32_bf16 v[64:67], a[8:11], v[192:195], v[64:67]
ds_read_b64_tr_b16 a[58:59], v12 offset:37632
s_add_u32 m0, s40, 57344
v_mfma_f32_16x16x32_bf16 v[68:71], a[8:11], v[196:199], v[68:71]
buffer_load_dwordx4 v4, s[8:11], s21 offen offset:0 lds
v_mfma_f32_16x16x32_bf16 v[80:83], a[12:15], v[192:195], v[80:83]
ds_read_b64_tr_b16 a[60:61], v12 offset:50176
v_mfma_f32_16x16x32_bf16 v[84:87], a[12:15], v[196:199], v[84:87]
ds_read_b64_tr_b16 a[62:63], v12 offset:51968
v_mfma_f32_16x16x32_bf16 v[96:99], a[16:19], v[192:195], v[96:99]
v_mfma_f32_16x16x32_bf16 v[100:103], a[16:19], v[196:199], v[100:103]
ds_read_b64_tr_b16 a[64:65], v12 offset:35872
v_mfma_f32_16x16x32_bf16 v[112:115], a[20:23], v[192:195], v[112:115]
ds_read_b64_tr_b16 a[66:67], v12 offset:37664
v_mfma_f32_16x16x32_bf16 v[116:119], a[20:23], v[196:199], v[116:119]
buffer_load_dwordx4 v5, s[8:11], s21 offen offset:1024 lds
v_mfma_f32_16x16x32_bf16 v[128:131], a[24:27], v[192:195], v[128:131]
ds_read_b64_tr_b16 a[68:69], v12 offset:50208
v_mfma_f32_16x16x32_bf16 v[132:135], a[24:27], v[196:199], v[132:135]
ds_read_b64_tr_b16 a[70:71], v12 offset:52000
v_mfma_f32_16x16x32_bf16 v[144:147], a[28:31], v[192:195], v[144:147]
v_mfma_f32_16x16x32_bf16 v[148:151], a[28:31], v[196:199], v[148:151]
ds_read_b64_tr_b16 a[72:73], v12 offset:35904
v_mfma_f32_16x16x32_bf16 v[160:163], a[32:35], v[192:195], v[160:163]
ds_read_b64_tr_b16 a[74:75], v12 offset:37696
v_mfma_f32_16x16x32_bf16 v[164:167], a[32:35], v[196:199], v[164:167]
buffer_load_dwordx4 v6, s[8:11], s21 offen offset:2048 lds
v_mfma_f32_16x16x32_bf16 a[112:115], a[36:39], v[192:195], a[112:115]
ds_read_b64_tr_b16 a[76:77], v12 offset:50240
v_mfma_f32_16x16x32_bf16 a[116:119], a[36:39], v[196:199], a[116:119]
ds_read_b64_tr_b16 a[78:79], v12 offset:52032
v_mfma_f32_16x16x32_bf16 a[128:131], a[40:43], v[192:195], a[128:131]
v_mfma_f32_16x16x32_bf16 a[132:135], a[40:43], v[196:199], a[132:135]
ds_read_b64_tr_b16 a[80:81], v12 offset:35936
v_mfma_f32_16x16x32_bf16 a[144:147], a[44:47], v[192:195], a[144:147]
ds_read_b64_tr_b16 a[82:83], v12 offset:37728
v_mfma_f32_16x16x32_bf16 a[148:151], a[44:47], v[196:199], a[148:151]
buffer_load_dwordx4 v7, s[8:11], s21 offen offset:3072 lds
v_mfma_f32_16x16x32_bf16 a[160:163], a[48:51], v[192:195], a[160:163]
ds_read_b64_tr_b16 a[84:85], v12 offset:50272
v_mfma_f32_16x16x32_bf16 a[164:167], a[48:51], v[196:199], a[164:167]
ds_read_b64_tr_b16 a[86:87], v12 offset:52064
v_mfma_f32_16x16x32_bf16 a[176:179], a[52:55], v[192:195], a[176:179]
v_mfma_f32_16x16x32_bf16 a[180:183], a[52:55], v[196:199], a[180:183]
ds_read_b64_tr_b16 a[88:89], v12 offset:35968
v_mfma_f32_16x16x32_bf16 v[40:43], a[0:3], v[200:203], v[40:43]
ds_read_b64_tr_b16 a[90:91], v12 offset:37760
s_add_u32 m0, s40, 61440
v_mfma_f32_16x16x32_bf16 v[44:47], a[0:3], v[204:207], v[44:47]
buffer_load_dwordx4 v8, s[8:11], s21 offen offset:0 lds
v_mfma_f32_16x16x32_bf16 v[56:59], a[4:7], v[200:203], v[56:59]
ds_read_b64_tr_b16 a[92:93], v12 offset:50304
v_mfma_f32_16x16x32_bf16 v[60:63], a[4:7], v[204:207], v[60:63]
ds_read_b64_tr_b16 a[94:95], v12 offset:52096
v_mfma_f32_16x16x32_bf16 v[72:75], a[8:11], v[200:203], v[72:75]
v_mfma_f32_16x16x32_bf16 v[76:79], a[8:11], v[204:207], v[76:79]
ds_read_b64_tr_b16 a[96:97], v12 offset:36000
v_mfma_f32_16x16x32_bf16 v[88:91], a[12:15], v[200:203], v[88:91]
ds_read_b64_tr_b16 a[98:99], v12 offset:37792
v_mfma_f32_16x16x32_bf16 v[92:95], a[12:15], v[204:207], v[92:95]
buffer_load_dwordx4 v9, s[8:11], s21 offen offset:1024 lds
v_mfma_f32_16x16x32_bf16 v[104:107], a[16:19], v[200:203], v[104:107]
ds_read_b64_tr_b16 a[100:101], v12 offset:50336
v_mfma_f32_16x16x32_bf16 v[108:111], a[16:19], v[204:207], v[108:111]
ds_read_b64_tr_b16 a[102:103], v12 offset:52128
v_mfma_f32_16x16x32_bf16 v[120:123], a[20:23], v[200:203], v[120:123]
v_mfma_f32_16x16x32_bf16 v[124:127], a[20:23], v[204:207], v[124:127]
ds_read_b64_tr_b16 a[104:105], v12 offset:36032
v_mfma_f32_16x16x32_bf16 v[136:139], a[24:27], v[200:203], v[136:139]
ds_read_b64_tr_b16 a[106:107], v12 offset:37824
v_mfma_f32_16x16x32_bf16 v[140:143], a[24:27], v[204:207], v[140:143]
buffer_load_dwordx4 v10, s[8:11], s21 offen offset:2048 lds
v_mfma_f32_16x16x32_bf16 v[152:155], a[28:31], v[200:203], v[152:155]
ds_read_b64_tr_b16 a[108:109], v12 offset:50368
s_add_u32 s22, s22, 1
v_mfma_f32_16x16x32_bf16 v[156:159], a[28:31], v[204:207], v[156:159]
ds_read_b64_tr_b16 a[110:111], v12 offset:52160
s_and_b32 s22, s22, 15
v_mfma_f32_16x16x32_bf16 v[168:171], a[32:35], v[200:203], v[168:171]
s_mul_i32 s21, s22, 458752
v_mfma_f32_16x16x32_bf16 v[172:175], a[32:35], v[204:207], v[172:175]
v_mfma_f32_16x16x32_bf16 a[120:123], a[36:39], v[200:203], a[120:123]
buffer_load_dwordx4 v[176:179], v2, s[4:7], s20 offen offset:0 sc1
v_mfma_f32_16x16x32_bf16 a[124:127], a[36:39], v[204:207], a[124:127]
v_mfma_f32_16x16x32_bf16 a[136:139], a[40:43], v[200:203], a[136:139]
v_mfma_f32_16x16x32_bf16 a[140:143], a[40:43], v[204:207], a[140:143]
v_mfma_f32_16x16x32_bf16 a[152:155], a[44:47], v[200:203], a[152:155]
s_waitcnt vmcnt(23)
v_swap_b32 v210, v212
v_mfma_f32_16x16x32_bf16 a[156:159], a[44:47], v[204:207], a[156:159]
v_swap_b32 v211, v213
v_mfma_f32_16x16x32_bf16 a[168:171], a[48:51], v[200:203], a[168:171]
v_swap_b32 v218, v220
v_mfma_f32_16x16x32_bf16 a[172:175], a[48:51], v[204:207], a[172:175]
v_swap_b32 v219, v221
v_mfma_f32_16x16x32_bf16 a[184:187], a[52:55], v[200:203], a[184:187]
v_mfma_f32_16x16x32_bf16 a[188:191], a[52:55], v[204:207], a[188:191]
s_waitcnt lgkmcnt(0)
v_mfma_f32_16x16x32_bf16 v[32:35], a[56:59], v[208:211], v[32:35]
v_mfma_f32_16x16x32_bf16 v[36:39], a[56:59], v[212:215], v[36:39]
v_mfma_f32_16x16x32_bf16 v[48:51], a[60:63], v[208:211], v[48:51]
s_waitcnt vmcnt(31) lgkmcnt(0)
s_barrier
v_mfma_f32_16x16x32_bf16 v[52:55], a[60:63], v[212:215], v[52:55]
ds_read_b64_tr_b16 a[0:1], v11 offset:0
v_mfma_f32_16x16x32_bf16 v[64:67], a[64:67], v[208:211], v[64:67]
ds_read_b64_tr_b16 a[2:3], v11 offset:1792
v_mfma_f32_16x16x32_bf16 v[68:71], a[64:67], v[212:215], v[68:71]
buffer_load_dwordx4 v[180:183], v2, s[4:7], s20 offen offset:512 sc1
v_mfma_f32_16x16x32_bf16 v[80:83], a[68:71], v[208:211], v[80:83]
ds_read_b64_tr_b16 a[4:5], v11 offset:14336
v_mfma_f32_16x16x32_bf16 v[84:87], a[68:71], v[212:215], v[84:87]
ds_read_b64_tr_b16 a[6:7], v11 offset:16128
v_mfma_f32_16x16x32_bf16 v[96:99], a[72:75], v[208:211], v[96:99]
v_mfma_f32_16x16x32_bf16 v[100:103], a[72:75], v[212:215], v[100:103]
ds_read_b64_tr_b16 a[8:9], v11 offset:32
v_mfma_f32_16x16x32_bf16 v[112:115], a[76:79], v[208:211], v[112:115]
ds_read_b64_tr_b16 a[10:11], v11 offset:1824
v_mfma_f32_16x16x32_bf16 v[116:119], a[76:79], v[212:215], v[116:119]
buffer_load_dwordx4 v[184:187], v3, s[4:7], s20 offen offset:0 sc1
v_mfma_f32_16x16x32_bf16 v[128:131], a[80:83], v[208:211], v[128:131]
ds_read_b64_tr_b16 a[12:13], v11 offset:14368
v_mfma_f32_16x16x32_bf16 v[132:135], a[80:83], v[212:215], v[132:135]
ds_read_b64_tr_b16 a[14:15], v11 offset:16160
v_mfma_f32_16x16x32_bf16 v[144:147], a[84:87], v[208:211], v[144:147]
buffer_load_dwordx4 v[188:191], v3, s[4:7], s20 offen offset:512 sc1
v_mfma_f32_16x16x32_bf16 v[148:151], a[84:87], v[212:215], v[148:151]
ds_read_b64_tr_b16 a[16:17], v11 offset:64
v_mfma_f32_16x16x32_bf16 v[160:163], a[88:91], v[208:211], v[160:163]
ds_read_b64_tr_b16 a[18:19], v11 offset:1856
v_mfma_f32_16x16x32_bf16 v[164:167], a[88:91], v[212:215], v[164:167]
v_mfma_f32_16x16x32_bf16 a[112:115], a[92:95], v[208:211], a[112:115]
ds_read_b64_tr_b16 a[20:21], v11 offset:14400
v_mfma_f32_16x16x32_bf16 a[116:119], a[92:95], v[212:215], a[116:119]
ds_read_b64_tr_b16 a[22:23], v11 offset:16192
v_mfma_f32_16x16x32_bf16 a[128:131], a[96:99], v[208:211], a[128:131]
buffer_load_dwordx4 v[192:195], v2, s[4:7], s20 offen offset:2048 sc1
v_mfma_f32_16x16x32_bf16 a[132:135], a[96:99], v[212:215], a[132:135]
ds_read_b64_tr_b16 a[24:25], v11 offset:96
v_mfma_f32_16x16x32_bf16 a[144:147], a[100:103], v[208:211], a[144:147]
ds_read_b64_tr_b16 a[26:27], v11 offset:1888
v_mfma_f32_16x16x32_bf16 a[148:151], a[100:103], v[212:215], a[148:151]
v_mfma_f32_16x16x32_bf16 a[160:163], a[104:107], v[208:211], a[160:163]
ds_read_b64_tr_b16 a[28:29], v11 offset:14432
v_mfma_f32_16x16x32_bf16 a[164:167], a[104:107], v[212:215], a[164:167]
ds_read_b64_tr_b16 a[30:31], v11 offset:16224
v_mfma_f32_16x16x32_bf16 a[176:179], a[108:111], v[208:211], a[176:179]
buffer_load_dwordx4 v[196:199], v2, s[4:7], s20 offen offset:2560 sc1
v_mfma_f32_16x16x32_bf16 a[180:183], a[108:111], v[212:215], a[180:183]
ds_read_b64_tr_b16 a[32:33], v11 offset:128
v_mfma_f32_16x16x32_bf16 v[40:43], a[56:59], v[216:219], v[40:43]
ds_read_b64_tr_b16 a[34:35], v11 offset:1920
v_mfma_f32_16x16x32_bf16 v[44:47], a[56:59], v[220:223], v[44:47]
buffer_load_dwordx4 v[200:203], v3, s[4:7], s20 offen offset:2048 sc1
v_mfma_f32_16x16x32_bf16 v[56:59], a[60:63], v[216:219], v[56:59]
ds_read_b64_tr_b16 a[36:37], v11 offset:14464
v_mfma_f32_16x16x32_bf16 v[60:63], a[60:63], v[220:223], v[60:63]
ds_read_b64_tr_b16 a[38:39], v11 offset:16256
v_mfma_f32_16x16x32_bf16 v[72:75], a[64:67], v[216:219], v[72:75]
v_mfma_f32_16x16x32_bf16 v[76:79], a[64:67], v[220:223], v[76:79]
ds_read_b64_tr_b16 a[40:41], v11 offset:160
v_mfma_f32_16x16x32_bf16 v[88:91], a[68:71], v[216:219], v[88:91]
ds_read_b64_tr_b16 a[42:43], v11 offset:1952
v_mfma_f32_16x16x32_bf16 v[92:95], a[68:71], v[220:223], v[92:95]
buffer_load_dwordx4 v[204:207], v3, s[4:7], s20 offen offset:2560 sc1
v_mfma_f32_16x16x32_bf16 v[104:107], a[72:75], v[216:219], v[104:107]
ds_read_b64_tr_b16 a[44:45], v11 offset:14496
s_add_u32 s20, s20, 4096
v_mfma_f32_16x16x32_bf16 v[108:111], a[72:75], v[220:223], v[108:111]
ds_read_b64_tr_b16 a[46:47], v11 offset:16288
s_and_b32 s20, s20, 0xffff
v_mfma_f32_16x16x32_bf16 v[120:123], a[76:79], v[216:219], v[120:123]
v_mfma_f32_16x16x32_bf16 v[124:127], a[76:79], v[220:223], v[124:127]
ds_read_b64_tr_b16 a[48:49], v11 offset:192
v_mfma_f32_16x16x32_bf16 v[136:139], a[80:83], v[216:219], v[136:139]
ds_read_b64_tr_b16 a[50:51], v11 offset:1984
s_add_u32 m0, s40, 86016
v_mfma_f32_16x16x32_bf16 v[140:143], a[80:83], v[220:223], v[140:143]
buffer_load_dwordx4 v4, s[8:11], s21 offen offset:0 lds
v_mfma_f32_16x16x32_bf16 v[152:155], a[84:87], v[216:219], v[152:155]
ds_read_b64_tr_b16 a[52:53], v11 offset:14528
v_mfma_f32_16x16x32_bf16 v[156:159], a[84:87], v[220:223], v[156:159]
ds_read_b64_tr_b16 a[54:55], v11 offset:16320
v_mfma_f32_16x16x32_bf16 v[168:171], a[88:91], v[216:219], v[168:171]
buffer_load_dwordx4 v5, s[8:11], s21 offen offset:1024 lds
v_mfma_f32_16x16x32_bf16 v[172:175], a[88:91], v[220:223], v[172:175]
v_mfma_f32_16x16x32_bf16 a[120:123], a[92:95], v[216:219], a[120:123]
v_mfma_f32_16x16x32_bf16 a[124:127], a[92:95], v[220:223], a[124:127]
v_mfma_f32_16x16x32_bf16 a[136:139], a[96:99], v[216:219], a[136:139]
v_mfma_f32_16x16x32_bf16 a[140:143], a[96:99], v[220:223], a[140:143]
buffer_load_dwordx4 v6, s[8:11], s21 offen offset:2048 lds
v_mfma_f32_16x16x32_bf16 a[152:155], a[100:103], v[216:219], a[152:155]
s_waitcnt vmcnt(22)
v_swap_b32 v226, v228
v_mfma_f32_16x16x32_bf16 a[156:159], a[100:103], v[220:223], a[156:159]
v_swap_b32 v227, v229
v_mfma_f32_16x16x32_bf16 a[168:171], a[104:107], v[216:219], a[168:171]
v_swap_b32 v234, v236
v_mfma_f32_16x16x32_bf16 a[172:175], a[104:107], v[220:223], a[172:175]
v_swap_b32 v235, v237
v_mfma_f32_16x16x32_bf16 a[184:187], a[108:111], v[216:219], a[184:187]
v_mfma_f32_16x16x32_bf16 a[188:191], a[108:111], v[220:223], a[188:191]
s_waitcnt lgkmcnt(0)
v_mfma_f32_16x16x32_bf16 v[32:35], a[0:3], v[224:227], v[32:35]
v_mfma_f32_16x16x32_bf16 v[36:39], a[0:3], v[228:231], v[36:39]
v_mfma_f32_16x16x32_bf16 v[48:51], a[4:7], v[224:227], v[48:51]
v_mfma_f32_16x16x32_bf16 v[52:55], a[4:7], v[228:231], v[52:55]
ds_read_b64_tr_b16 a[56:57], v11 offset:7168
v_mfma_f32_16x16x32_bf16 v[64:67], a[8:11], v[224:227], v[64:67]
ds_read_b64_tr_b16 a[58:59], v11 offset:8960
v_mfma_f32_16x16x32_bf16 v[68:71], a[8:11], v[228:231], v[68:71]
buffer_load_dwordx4 v7, s[8:11], s21 offen offset:3072 lds
v_mfma_f32_16x16x32_bf16 v[80:83], a[12:15], v[224:227], v[80:83]
ds_read_b64_tr_b16 a[60:61], v11 offset:21504
v_mfma_f32_16x16x32_bf16 v[84:87], a[12:15], v[228:231], v[84:87]
ds_read_b64_tr_b16 a[62:63], v11 offset:23296
v_mfma_f32_16x16x32_bf16 v[96:99], a[16:19], v[224:227], v[96:99]
v_mfma_f32_16x16x32_bf16 v[100:103], a[16:19], v[228:231], v[100:103]
ds_read_b64_tr_b16 a[64:65], v11 offset:7200
v_mfma_f32_16x16x32_bf16 v[112:115], a[20:23], v[224:227], v[112:115]
ds_read_b64_tr_b16 a[66:67], v11 offset:8992
s_add_u32 m0, s40, 90112
v_mfma_f32_16x16x32_bf16 v[116:119], a[20:23], v[228:231], v[116:119]
buffer_load_dwordx4 v8, s[8:11], s21 offen offset:0 lds
v_mfma_f32_16x16x32_bf16 v[128:131], a[24:27], v[224:227], v[128:131]
ds_read_b64_tr_b16 a[68:69], v11 offset:21536
v_mfma_f32_16x16x32_bf16 v[132:135], a[24:27], v[228:231], v[132:135]
ds_read_b64_tr_b16 a[70:71], v11 offset:23328
v_mfma_f32_16x16x32_bf16 v[144:147], a[28:31], v[224:227], v[144:147]
v_mfma_f32_16x16x32_bf16 v[148:151], a[28:31], v[228:231], v[148:151]
ds_read_b64_tr_b16 a[72:73], v11 offset:7232
v_mfma_f32_16x16x32_bf16 v[160:163], a[32:35], v[224:227], v[160:163]
ds_read_b64_tr_b16 a[74:75], v11 offset:9024
v_mfma_f32_16x16x32_bf16 v[164:167], a[32:35], v[228:231], v[164:167]
buffer_load_dwordx4 v9, s[8:11], s21 offen offset:1024 lds
v_mfma_f32_16x16x32_bf16 a[112:115], a[36:39], v[224:227], a[112:115]
ds_read_b64_tr_b16 a[76:77], v11 offset:21568
v_mfma_f32_16x16x32_bf16 a[116:119], a[36:39], v[228:231], a[116:119]
ds_read_b64_tr_b16 a[78:79], v11 offset:23360
v_mfma_f32_16x16x32_bf16 a[128:131], a[40:43], v[224:227], a[128:131]
v_mfma_f32_16x16x32_bf16 a[132:135], a[40:43], v[228:231], a[132:135]
ds_read_b64_tr_b16 a[80:81], v11 offset:7264
v_mfma_f32_16x16x32_bf16 a[144:147], a[44:47], v[224:227], a[144:147]
ds_read_b64_tr_b16 a[82:83], v11 offset:9056
v_mfma_f32_16x16x32_bf16 a[148:151], a[44:47], v[228:231], a[148:151]
buffer_load_dwordx4 v10, s[8:11], s21 offen offset:2048 lds
v_mfma_f32_16x16x32_bf16 a[160:163], a[48:51], v[224:227], a[160:163]
ds_read_b64_tr_b16 a[84:85], v11 offset:21600
s_add_u32 s22, s22, 1
v_mfma_f32_16x16x32_bf16 a[164:167], a[48:51], v[228:231], a[164:167]
ds_read_b64_tr_b16 a[86:87], v11 offset:23392
s_and_b32 s22, s22, 15
v_mfma_f32_16x16x32_bf16 a[176:179], a[52:55], v[224:227], a[176:179]
s_mul_i32 s21, s22, 458752
v_mfma_f32_16x16x32_bf16 a[180:183], a[52:55], v[228:231], a[180:183]
ds_read_b64_tr_b16 a[88:89], v11 offset:7296
v_mfma_f32_16x16x32_bf16 v[40:43], a[0:3], v[232:235], v[40:43]
ds_read_b64_tr_b16 a[90:91], v11 offset:9088
v_mfma_f32_16x16x32_bf16 v[44:47], a[0:3], v[236:239], v[44:47]
buffer_load_dwordx4 v[208:211], v2, s[4:7], s20 offen offset:0 sc1
v_mfma_f32_16x16x32_bf16 v[56:59], a[4:7], v[232:235], v[56:59]
ds_read_b64_tr_b16 a[92:93], v11 offset:21632
v_mfma_f32_16x16x32_bf16 v[60:63], a[4:7], v[236:239], v[60:63]
ds_read_b64_tr_b16 a[94:95], v11 offset:23424
v_mfma_f32_16x16x32_bf16 v[72:75], a[8:11], v[232:235], v[72:75]
v_mfma_f32_16x16x32_bf16 v[76:79], a[8:11], v[236:239], v[76:79]
ds_read_b64_tr_b16 a[96:97], v11 offset:7328
v_mfma_f32_16x16x32_bf16 v[88:91], a[12:15], v[232:235], v[88:91]
ds_read_b64_tr_b16 a[98:99], v11 offset:9120
v_mfma_f32_16x16x32_bf16 v[92:95], a[12:15], v[236:239], v[92:95]
buffer_load_dwordx4 v[212:215], v2, s[4:7], s20 offen offset:512 sc1
v_mfma_f32_16x16x32_bf16 v[104:107], a[16:19], v[232:235], v[104:107]
ds_read_b64_tr_b16 a[100:101], v11 offset:21664
v_mfma_f32_16x16x32_bf16 v[108:111], a[16:19], v[236:239], v[108:111]
ds_read_b64_tr_b16 a[102:103], v11 offset:23456
v_mfma_f32_16x16x32_bf16 v[120:123], a[20:23], v[232:235], v[120:123]
v_mfma_f32_16x16x32_bf16 v[124:127], a[20:23], v[236:239], v[124:127]
ds_read_b64_tr_b16 a[104:105], v11 offset:7360
v_mfma_f32_16x16x32_bf16 v[136:139], a[24:27], v[232:235], v[136:139]
ds_read_b64_tr_b16 a[106:107], v11 offset:9152
v_mfma_f32_16x16x32_bf16 v[140:143], a[24:27], v[236:239], v[140:143]
buffer_load_dwordx4 v[216:219], v3, s[4:7], s20 offen offset:0 sc1
v_mfma_f32_16x16x32_bf16 v[152:155], a[28:31], v[232:235], v[152:155]
ds_read_b64_tr_b16 a[108:109], v11 offset:21696
v_mfma_f32_16x16x32_bf16 v[156:159], a[28:31], v[236:239], v[156:159]
ds_read_b64_tr_b16 a[110:111], v11 offset:23488
v_mfma_f32_16x16x32_bf16 v[168:171], a[32:35], v[232:235], v[168:171]
v_mfma_f32_16x16x32_bf16 v[172:175], a[32:35], v[236:239], v[172:175]
v_mfma_f32_16x16x32_bf16 a[120:123], a[36:39], v[232:235], a[120:123]
buffer_load_dwordx4 v[220:223], v3, s[4:7], s20 offen offset:512 sc1
v_mfma_f32_16x16x32_bf16 a[124:127], a[36:39], v[236:239], a[124:127]
v_mfma_f32_16x16x32_bf16 a[136:139], a[40:43], v[232:235], a[136:139]
v_mfma_f32_16x16x32_bf16 a[140:143], a[40:43], v[236:239], a[140:143]
v_mfma_f32_16x16x32_bf16 a[152:155], a[44:47], v[232:235], a[152:155]
s_waitcnt vmcnt(26)
v_swap_b32 v242, v244
v_mfma_f32_16x16x32_bf16 a[156:159], a[44:47], v[236:239], a[156:159]
v_swap_b32 v243, v245
v_mfma_f32_16x16x32_bf16 a[168:171], a[48:51], v[232:235], a[168:171]
v_swap_b32 v250, v252
v_mfma_f32_16x16x32_bf16 a[172:175], a[48:51], v[236:239], a[172:175]
v_swap_b32 v251, v253
v_mfma_f32_16x16x32_bf16 a[184:187], a[52:55], v[232:235], a[184:187]
v_mfma_f32_16x16x32_bf16 a[188:191], a[52:55], v[236:239], a[188:191]
s_waitcnt lgkmcnt(0)
v_mfma_f32_16x16x32_bf16 v[32:35], a[56:59], v[240:243], v[32:35]
v_mfma_f32_16x16x32_bf16 v[36:39], a[56:59], v[244:247], v[36:39]
v_mfma_f32_16x16x32_bf16 v[48:51], a[60:63], v[240:243], v[48:51]
s_waitcnt vmcnt(34) lgkmcnt(0)
s_barrier
v_mfma_f32_16x16x32_bf16 v[52:55], a[60:63], v[244:247], v[52:55]
ds_read_b64_tr_b16 a[0:1], v11 offset:28672
v_mfma_f32_16x16x32_bf16 v[64:67], a[64:67], v[240:243], v[64:67]
ds_read_b64_tr_b16 a[2:3], v11 offset:30464
v_mfma_f32_16x16x32_bf16 v[68:71], a[64:67], v[244:247], v[68:71]
buffer_load_dwordx4 v[224:227], v2, s[4:7], s20 offen offset:2048 sc1
v_mfma_f32_16x16x32_bf16 v[80:83], a[68:71], v[240:243], v[80:83]
ds_read_b64_tr_b16 a[4:5], v11 offset:43008
v_mfma_f32_16x16x32_bf16 v[84:87], a[68:71], v[244:247], v[84:87]
ds_read_b64_tr_b16 a[6:7], v11 offset:44800
v_mfma_f32_16x16x32_bf16 v[96:99], a[72:75], v[240:243], v[96:99]
v_mfma_f32_16x16x32_bf16 v[100:103], a[72:75], v[244:247], v[100:103]
ds_read_b64_tr_b16 a[8:9], v11 offset:28704
v_mfma_f32_16x16x32_bf16 v[112:115], a[76:79], v[240:243], v[112:115]
ds_read_b64_tr_b16 a[10:11], v11 offset:30496
v_mfma_f32_16x16x32_bf16 v[116:119], a[76:79], v[244:247], v[116:119]
buffer_load_dwordx4 v[228:231], v2, s[4:7], s20 offen offset:2560 sc1
v_mfma_f32_16x16x32_bf16 v[128:131], a[80:83], v[240:243], v[128:131]
ds_read_b64_tr_b16 a[12:13], v11 offset:43040
v_mfma_f32_16x16x32_bf16 v[132:135], a[80:83], v[244:247], v[132:135]
ds_read_b64_tr_b16 a[14:15], v11 offset:44832
v_mfma_f32_16x16x32_bf16 v[144:147], a[84:87], v[240:243], v[144:147]
v_mfma_f32_16x16x32_bf16 v[148:151], a[84:87], v[244:247], v[148:151]
ds_read_b64_tr_b16 a[16:17], v11 offset:28736
v_mfma_f32_16x16x32_bf16 v[160:163], a[88:91], v[240:243], v[160:163]
ds_read_b64_tr_b16 a[18:19], v11 offset:30528
v_mfma_f32_16x16x32_bf16 v[164:167], a[88:91], v[244:247], v[164:167]
buffer_load_dwordx4 v[232:235], v3, s[4:7], s20 offen offset:2048 sc1
v_mfma_f32_16x16x32_bf16 a[112:115], a[92:95], v[240:243], a[112:115]
ds_read_b64_tr_b16 a[20:21], v11 offset:43072
v_mfma_f32_16x16x32_bf16 a[116:119], a[92:95], v[244:247], a[116:119]
ds_read_b64_tr_b16 a[22:23], v11 offset:44864
v_mfma_f32_16x16x32_bf16 a[128:131], a[96:99], v[240:243], a[128:131]
v_mfma_f32_16x16x32_bf16 a[132:135], a[96:99], v[244:247], a[132:135]
ds_read_b64_tr_b16 a[24:25], v11 offset:28768
v_mfma_f32_16x16x32_bf16 a[144:147], a[100:103], v[240:243], a[144:147]
ds_read_b64_tr_b16 a[26:27], v11 offset:30560
v_mfma_f32_16x16x32_bf16 a[148:151], a[100:103], v[244:247], a[148:151]
buffer_load_dwordx4 v[236:239], v3, s[4:7], s20 offen offset:2560 sc1
v_mfma_f32_16x16x32_bf16 a[160:163], a[104:107], v[240:243], a[160:163]
ds_read_b64_tr_b16 a[28:29], v11 offset:43104
s_add_u32 s20, s20, 4096
v_mfma_f32_16x16x32_bf16 a[164:167], a[104:107], v[244:247], a[164:167]
ds_read_b64_tr_b16 a[30:31], v11 offset:44896
s_and_b32 s20, s20, 0xffff
v_mfma_f32_16x16x32_bf16 a[176:179], a[108:111], v[240:243], a[176:179]
v_mfma_f32_16x16x32_bf16 a[180:183], a[108:111], v[244:247], a[180:183]
ds_read_b64_tr_b16 a[32:33], v11 offset:28800
v_mfma_f32_16x16x32_bf16 v[40:43], a[56:59], v[248:251], v[40:43]
ds_read_b64_tr_b16 a[34:35], v11 offset:30592
s_add_u32 m0, s40, 0
v_mfma_f32_16x16x32_bf16 v[44:47], a[56:59], v[252:255], v[44:47]
buffer_load_dwordx4 v4, s[8:11], s21 offen offset:0 lds
v_mfma_f32_16x16x32_bf16 v[56:59], a[60:63], v[248:251], v[56:59]
ds_read_b64_tr_b16 a[36:37], v11 offset:43136
v_mfma_f32_16x16x32_bf16 v[60:63], a[60:63], v[252:255], v[60:63]
ds_read_b64_tr_b16 a[38:39], v11 offset:44928
v_mfma_f32_16x16x32_bf16 v[72:75], a[64:67], v[248:251], v[72:75]
v_mfma_f32_16x16x32_bf16 v[76:79], a[64:67], v[252:255], v[76:79]
ds_read_b64_tr_b16 a[40:41], v11 offset:28832
v_mfma_f32_16x16x32_bf16 v[88:91], a[68:71], v[248:251], v[88:91]
ds_read_b64_tr_b16 a[42:43], v11 offset:30624
v_mfma_f32_16x16x32_bf16 v[92:95], a[68:71], v[252:255], v[92:95]
buffer_load_dwordx4 v5, s[8:11], s21 offen offset:1024 lds
v_mfma_f32_16x16x32_bf16 v[104:107], a[72:75], v[248:251], v[104:107]
ds_read_b64_tr_b16 a[44:45], v11 offset:43168
v_mfma_f32_16x16x32_bf16 v[108:111], a[72:75], v[252:255], v[108:111]
ds_read_b64_tr_b16 a[46:47], v11 offset:44960
v_mfma_f32_16x16x32_bf16 v[120:123], a[76:79], v[248:251], v[120:123]
v_mfma_f32_16x16x32_bf16 v[124:127], a[76:79], v[252:255], v[124:127]
ds_read_b64_tr_b16 a[48:49], v11 offset:28864
v_mfma_f32_16x16x32_bf16 v[136:139], a[80:83], v[248:251], v[136:139]
ds_read_b64_tr_b16 a[50:51], v11 offset:30656
v_mfma_f32_16x16x32_bf16 v[140:143], a[80:83], v[252:255], v[140:143]
buffer_load_dwordx4 v6, s[8:11], s21 offen offset:2048 lds
v_mfma_f32_16x16x32_bf16 v[152:155], a[84:87], v[248:251], v[152:155]
ds_read_b64_tr_b16 a[52:53], v11 offset:43200
v_mfma_f32_16x16x32_bf16 v[156:159], a[84:87], v[252:255], v[156:159]
ds_read_b64_tr_b16 a[54:55], v11 offset:44992
v_mfma_f32_16x16x32_bf16 v[168:171], a[88:91], v[248:251], v[168:171]
v_mfma_f32_16x16x32_bf16 v[172:175], a[88:91], v[252:255], v[172:175]
v_mfma_f32_16x16x32_bf16 a[120:123], a[92:95], v[248:251], a[120:123]
buffer_load_dwordx4 v7, s[8:11], s21 offen offset:3072 lds
v_mfma_f32_16x16x32_bf16 a[124:127], a[92:95], v[252:255], a[124:127]
v_mfma_f32_16x16x32_bf16 a[136:139], a[96:99], v[248:251], a[136:139]
v_mfma_f32_16x16x32_bf16 a[140:143], a[96:99], v[252:255], a[140:143]
v_mfma_f32_16x16x32_bf16 a[152:155], a[100:103], v[248:251], a[152:155]
s_waitcnt vmcnt(23)
v_swap_b32 v178, v180
v_mfma_f32_16x16x32_bf16 a[156:159], a[100:103], v[252:255], a[156:159]
v_swap_b32 v179, v181
v_mfma_f32_16x16x32_bf16 a[168:171], a[104:107], v[248:251], a[168:171]
v_swap_b32 v186, v188
v_mfma_f32_16x16x32_bf16 a[172:175], a[104:107], v[252:255], a[172:175]
v_swap_b32 v187, v189
v_mfma_f32_16x16x32_bf16 a[184:187], a[108:111], v[248:251], a[184:187]
v_mfma_f32_16x16x32_bf16 a[188:191], a[108:111], v[252:255], a[188:191]
s_waitcnt lgkmcnt(0)
v_mfma_f32_16x16x32_bf16 v[32:35], a[0:3], v[176:179], v[32:35]
v_mfma_f32_16x16x32_bf16 v[36:39], a[0:3], v[180:183], v[36:39]
v_mfma_f32_16x16x32_bf16 v[48:51], a[4:7], v[176:179], v[48:51]
v_mfma_f32_16x16x32_bf16 v[52:55], a[4:7], v[180:183], v[52:55]
ds_read_b64_tr_b16 a[56:57], v11 offset:35840
v_mfma_f32_16x16x32_bf16 v[64:67], a[8:11], v[176:179], v[64:67]
ds_read_b64_tr_b16 a[58:59], v11 offset:37632
s_add_u32 m0, s40, 4096
v_mfma_f32_16x16x32_bf16 v[68:71], a[8:11], v[180:183], v[68:71]
buffer_load_dwordx4 v8, s[8:11], s21 offen offset:0 lds
v_mfma_f32_16x16x32_bf16 v[80:83], a[12:15], v[176:179], v[80:83]
ds_read_b64_tr_b16 a[60:61], v11 offset:50176
v_mfma_f32_16x16x32_bf16 v[84:87], a[12:15], v[180:183], v[84:87]
ds_read_b64_tr_b16 a[62:63], v11 offset:51968
v_mfma_f32_16x16x32_bf16 v[96:99], a[16:19], v[176:179], v[96:99]
v_accvgpr_write_b32 a208, -1
v_accvgpr_write_b32 a209, -1
v_mfma_f32_16x16x32_bf16 v[100:103], a[16:19], v[180:183], v[100:103]
ds_read_b64_tr_b16 a[64:65], v11 offset:35872
v_mfma_f32_16x16x32_bf16 v[112:115], a[20:23], v[176:179], v[112:115]
ds_read_b64_tr_b16 a[66:67], v11 offset:37664
v_mfma_f32_16x16x32_bf16 v[116:119], a[20:23], v[180:183], v[116:119]
buffer_load_dwordx4 v9, s[8:11], s21 offen offset:1024 lds
v_mfma_f32_16x16x32_bf16 v[128:131], a[24:27], v[176:179], v[128:131]
ds_read_b64_tr_b16 a[68:69], v11 offset:50208
v_mfma_f32_16x16x32_bf16 v[132:135], a[24:27], v[180:183], v[132:135]
ds_read_b64_tr_b16 a[70:71], v11 offset:52000
v_mfma_f32_16x16x32_bf16 v[144:147], a[28:31], v[176:179], v[144:147]
v_accvgpr_write_b32 a210, -1
v_accvgpr_write_b32 a211, -1
v_mfma_f32_16x16x32_bf16 v[148:151], a[28:31], v[180:183], v[148:151]
ds_read_b64_tr_b16 a[72:73], v11 offset:35904
v_mfma_f32_16x16x32_bf16 v[160:163], a[32:35], v[176:179], v[160:163]
ds_read_b64_tr_b16 a[74:75], v11 offset:37696
v_mfma_f32_16x16x32_bf16 v[164:167], a[32:35], v[180:183], v[164:167]
buffer_load_dwordx4 v10, s[8:11], s21 offen offset:2048 lds
v_mfma_f32_16x16x32_bf16 a[112:115], a[36:39], v[176:179], a[112:115]
ds_read_b64_tr_b16 a[76:77], v11 offset:50240
s_add_u32 s22, s22, 1
v_mfma_f32_16x16x32_bf16 a[116:119], a[36:39], v[180:183], a[116:119]
ds_read_b64_tr_b16 a[78:79], v11 offset:52032
s_and_b32 s22, s22, 15
v_mfma_f32_16x16x32_bf16 a[128:131], a[40:43], v[176:179], a[128:131]
s_mul_i32 s21, s22, 458752
v_mfma_f32_16x16x32_bf16 a[132:135], a[40:43], v[180:183], a[132:135]
ds_read_b64_tr_b16 a[80:81], v11 offset:35936
v_mfma_f32_16x16x32_bf16 a[144:147], a[44:47], v[176:179], a[144:147]
ds_read_b64_tr_b16 a[82:83], v11 offset:37728
v_mfma_f32_16x16x32_bf16 a[148:151], a[44:47], v[180:183], a[148:151]
buffer_load_dwordx4 v[240:243], v2, s[4:7], s20 offen offset:0 sc1
v_mfma_f32_16x16x32_bf16 a[160:163], a[48:51], v[176:179], a[160:163]
ds_read_b64_tr_b16 a[84:85], v11 offset:50272
v_mfma_f32_16x16x32_bf16 a[164:167], a[48:51], v[180:183], a[164:167]
ds_read_b64_tr_b16 a[86:87], v11 offset:52064
v_mfma_f32_16x16x32_bf16 a[176:179], a[52:55], v[176:179], a[176:179]
s_lshl_b32 s48, s2, 2
s_add_u32 s48, s48, s3
v_mfma_f32_16x16x32_bf16 a[180:183], a[52:55], v[180:183], a[180:183]
ds_read_b64_tr_b16 a[88:89], v11 offset:35968
v_mfma_f32_16x16x32_bf16 v[40:43], a[0:3], v[184:187], v[40:43]
ds_read_b64_tr_b16 a[90:91], v11 offset:37760
v_mfma_f32_16x16x32_bf16 v[44:47], a[0:3], v[188:191], v[44:47]
buffer_load_dwordx4 v[244:247], v2, s[4:7], s20 offen offset:512 sc1
v_mfma_f32_16x16x32_bf16 v[56:59], a[4:7], v[184:187], v[56:59]
ds_read_b64_tr_b16 a[92:93], v11 offset:50304
v_mfma_f32_16x16x32_bf16 v[60:63], a[4:7], v[188:191], v[60:63]
ds_read_b64_tr_b16 a[94:95], v11 offset:52096
v_mfma_f32_16x16x32_bf16 v[72:75], a[8:11], v[184:187], v[72:75]
s_lshl_b32 s48, s48, 12
s_add_u32 s48, s48, 29360128
v_mfma_f32_16x16x32_bf16 v[76:79], a[8:11], v[188:191], v[76:79]
ds_read_b64_tr_b16 a[96:97], v11 offset:36000
v_mfma_f32_16x16x32_bf16 v[88:91], a[12:15], v[184:187], v[88:91]
ds_read_b64_tr_b16 a[98:99], v11 offset:37792
v_mfma_f32_16x16x32_bf16 v[92:95], a[12:15], v[188:191], v[92:95]
buffer_load_dwordx4 v[248:251], v3, s[4:7], s20 offen offset:0 sc1
v_mfma_f32_16x16x32_bf16 v[104:107], a[16:19], v[184:187], v[104:107]
ds_read_b64_tr_b16 a[100:101], v11 offset:50336
v_mfma_f32_16x16x32_bf16 v[108:111], a[16:19], v[188:191], v[108:111]
ds_read_b64_tr_b16 a[102:103], v11 offset:52128
v_mfma_f32_16x16x32_bf16 v[120:123], a[20:23], v[184:187], v[120:123]
v_mfma_f32_16x16x32_bf16 v[124:127], a[20:23], v[188:191], v[124:127]
ds_read_b64_tr_b16 a[104:105], v11 offset:36032
v_mfma_f32_16x16x32_bf16 v[136:139], a[24:27], v[184:187], v[136:139]
ds_read_b64_tr_b16 a[106:107], v11 offset:37824
v_mfma_f32_16x16x32_bf16 v[140:143], a[24:27], v[188:191], v[140:143]
buffer_load_dwordx4 v[252:255], v3, s[4:7], s20 offen offset:512 sc1
v_mfma_f32_16x16x32_bf16 v[152:155], a[28:31], v[184:187], v[152:155]
ds_read_b64_tr_b16 a[108:109], v11 offset:50368
v_mfma_f32_16x16x32_bf16 v[156:159], a[28:31], v[188:191], v[156:159]
ds_read_b64_tr_b16 a[110:111], v11 offset:52160
v_mfma_f32_16x16x32_bf16 v[168:171], a[32:35], v[184:187], v[168:171]
v_mfma_f32_16x16x32_bf16 v[172:175], a[32:35], v[188:191], v[172:175]
v_mfma_f32_16x16x32_bf16 a[120:123], a[36:39], v[184:187], a[120:123]
v_mfma_f32_16x16x32_bf16 a[124:127], a[36:39], v[188:191], a[124:127]
v_mfma_f32_16x16x32_bf16 a[136:139], a[40:43], v[184:187], a[136:139]
v_mfma_f32_16x16x32_bf16 a[140:143], a[40:43], v[188:191], a[140:143]
v_mfma_f32_16x16x32_bf16 a[152:155], a[44:47], v[184:187], a[152:155]
s_waitcnt vmcnt(26)
v_swap_b32 v194, v196
v_mfma_f32_16x16x32_bf16 a[156:159], a[44:47], v[188:191], a[156:159]
v_swap_b32 v195, v197
v_mfma_f32_16x16x32_bf16 a[168:171], a[48:51], v[184:187], a[168:171]
v_swap_b32 v202, v204
v_mfma_f32_16x16x32_bf16 a[172:175], a[48:51], v[188:191], a[172:175]
v_swap_b32 v203, v205
v_mfma_f32_16x16x32_bf16 a[184:187], a[52:55], v[184:187], a[184:187]
v_mfma_f32_16x16x32_bf16 a[188:191], a[52:55], v[188:191], a[188:191]
s_waitcnt lgkmcnt(0)
v_mfma_f32_16x16x32_bf16 v[32:35], a[56:59], v[192:195], v[32:35]
v_mfma_f32_16x16x32_bf16 v[36:39], a[56:59], v[196:199], v[36:39]
v_mfma_f32_16x16x32_bf16 v[48:51], a[60:63], v[192:195], v[48:51]
s_waitcnt vmcnt(34) lgkmcnt(0)
s_barrier
s_cmp_eq_u32 s3, 0
s_cselect_b32 s56, s43, 0x80000000
s_mov_b64 exec, 1
buffer_store_dword v25, v24, s[16:19], s56 offen sc1
s_mov_b64 exec, -1
v_mfma_f32_16x16x32_bf16 v[52:55], a[60:63], v[196:199], v[52:55]
ds_read_b64_tr_b16 a[0:1], v12 offset:0
v_mfma_f32_16x16x32_bf16 v[64:67], a[64:67], v[192:195], v[64:67]
ds_read_b64_tr_b16 a[2:3], v12 offset:1792
v_mfma_f32_16x16x32_bf16 v[68:71], a[64:67], v[196:199], v[68:71]
buffer_load_dwordx4 v[176:179], v2, s[4:7], s20 offen offset:2048 sc1
v_mfma_f32_16x16x32_bf16 v[80:83], a[68:71], v[192:195], v[80:83]
ds_read_b64_tr_b16 a[4:5], v12 offset:14336
v_mfma_f32_16x16x32_bf16 v[84:87], a[68:71], v[196:199], v[84:87]
ds_read_b64_tr_b16 a[6:7], v12 offset:16128
v_mfma_f32_16x16x32_bf16 v[96:99], a[72:75], v[192:195], v[96:99]
buffer_store_dwordx4 a[208:211], v1, s[16:19], s48 offen offset:0 sc1
v_mfma_f32_16x16x32_bf16 v[100:103], a[72:75], v[196:199], v[100:103]
ds_read_b64_tr_b16 a[8:9], v12 offset:32
v_mfma_f32_16x16x32_bf16 v[112:115], a[76:79], v[192:195], v[112:115]
ds_read_b64_tr_b16 a[10:11], v12 offset:1824
v_mfma_f32_16x16x32_bf16 v[116:119], a[76:79], v[196:199], v[116:119]
buffer_load_dwordx4 v[180:183], v2, s[4:7], s20 offen offset:2560 sc1
v_mfma_f32_16x16x32_bf16 v[128:131], a[80:83], v[192:195], v[128:131]
ds_read_b64_tr_b16 a[12:13], v12 offset:14368
v_mfma_f32_16x16x32_bf16 v[132:135], a[80:83], v[196:199], v[132:135]
ds_read_b64_tr_b16 a[14:15], v12 offset:16160
v_mfma_f32_16x16x32_bf16 v[144:147], a[84:87], v[192:195], v[144:147]
v_mfma_f32_16x16x32_bf16 v[148:151], a[84:87], v[196:199], v[148:151]
ds_read_b64_tr_b16 a[16:17], v12 offset:64
v_mfma_f32_16x16x32_bf16 v[160:163], a[88:91], v[192:195], v[160:163]
ds_read_b64_tr_b16 a[18:19], v12 offset:1856
v_mfma_f32_16x16x32_bf16 v[164:167], a[88:91], v[196:199], v[164:167]
buffer_load_dwordx4 v[184:187], v3, s[4:7], s20 offen offset:2048 sc1
v_mfma_f32_16x16x32_bf16 a[112:115], a[92:95], v[192:195], a[112:115]
ds_read_b64_tr_b16 a[20:21], v12 offset:14400
v_mfma_f32_16x16x32_bf16 a[116:119], a[92:95], v[196:199], a[116:119]
ds_read_b64_tr_b16 a[22:23], v12 offset:16192
v_mfma_f32_16x16x32_bf16 a[128:131], a[96:99], v[192:195], a[128:131]
v_mfma_f32_16x16x32_bf16 a[132:135], a[96:99], v[196:199], a[132:135]
ds_read_b64_tr_b16 a[24:25], v12 offset:96
v_mfma_f32_16x16x32_bf16 a[144:147], a[100:103], v[192:195], a[144:147]
ds_read_b64_tr_b16 a[26:27], v12 offset:1888
v_mfma_f32_16x16x32_bf16 a[148:151], a[100:103], v[196:199], a[148:151]
buffer_load_dwordx4 v[188:191], v3, s[4:7], s20 offen offset:2560 sc1
v_mfma_f32_16x16x32_bf16 a[160:163], a[104:107], v[192:195], a[160:163]
ds_read_b64_tr_b16 a[28:29], v12 offset:14432
s_add_u32 s20, s20, 4096
v_mfma_f32_16x16x32_bf16 a[164:167], a[104:107], v[196:199], a[164:167]
ds_read_b64_tr_b16 a[30:31], v12 offset:16224
s_and_b32 s20, s20, 0xffff
v_mfma_f32_16x16x32_bf16 a[176:179], a[108:111], v[192:195], a[176:179]
v_mfma_f32_16x16x32_bf16 a[180:183], a[108:111], v[196:199], a[180:183]
ds_read_b64_tr_b16 a[32:33], v12 offset:128
v_mfma_f32_16x16x32_bf16 v[40:43], a[56:59], v[200:203], v[40:43]
ds_read_b64_tr_b16 a[34:35], v12 offset:1920
s_add_u32 m0, s40, 28672
v_mfma_f32_16x16x32_bf16 v[44:47], a[56:59], v[204:207], v[44:47]
buffer_load_dwordx4 v4, s[8:11], s21 offen offset:0 lds
v_mfma_f32_16x16x32_bf16 v[56:59], a[60:63], v[200:203], v[56:59]
ds_read_b64_tr_b16 a[36:37], v12 offset:14464
v_mfma_f32_16x16x32_bf16 v[60:63], a[60:63], v[204:207], v[60:63]
ds_read_b64_tr_b16 a[38:39], v12 offset:16256
v_mfma_f32_16x16x32_bf16 v[72:75], a[64:67], v[200:203], v[72:75]
v_mfma_f32_16x16x32_bf16 v[76:79], a[64:67], v[204:207], v[76:79]
ds_read_b64_tr_b16 a[40:41], v12 offset:160
v_mfma_f32_16x16x32_bf16 v[88:91], a[68:71], v[200:203], v[88:91]
ds_read_b64_tr_b16 a[42:43], v12 offset:1952
v_mfma_f32_16x16x32_bf16 v[92:95], a[68:71], v[204:207], v[92:95]
buffer_load_dwordx4 v5, s[8:11], s21 offen offset:1024 lds
v_mfma_f32_16x16x32_bf16 v[104:107], a[72:75], v[200:203], v[104:107]
ds_read_b64_tr_b16 a[44:45], v12 offset:14496
v_mfma_f32_16x16x32_bf16 v[108:111], a[72:75], v[204:207], v[108:111]
ds_read_b64_tr_b16 a[46:47], v12 offset:16288
v_mfma_f32_16x16x32_bf16 v[120:123], a[76:79], v[200:203], v[120:123]
v_mfma_f32_16x16x32_bf16 v[124:127], a[76:79], v[204:207], v[124:127]
ds_read_b64_tr_b16 a[48:49], v12 offset:192
v_mfma_f32_16x16x32_bf16 v[136:139], a[80:83], v[200:203], v[136:139]
ds_read_b64_tr_b16 a[50:51], v12 offset:1984
v_mfma_f32_16x16x32_bf16 v[140:143], a[80:83], v[204:207], v[140:143]
buffer_load_dwordx4 v6, s[8:11], s21 offen offset:2048 lds
v_mfma_f32_16x16x32_bf16 v[152:155], a[84:87], v[200:203], v[152:155]
ds_read_b64_tr_b16 a[52:53], v12 offset:14528
v_mfma_f32_16x16x32_bf16 v[156:159], a[84:87], v[204:207], v[156:159]
ds_read_b64_tr_b16 a[54:55], v12 offset:16320
v_mfma_f32_16x16x32_bf16 v[168:171], a[88:91], v[200:203], v[168:171]
v_mfma_f32_16x16x32_bf16 v[172:175], a[88:91], v[204:207], v[172:175]
v_mfma_f32_16x16x32_bf16 a[120:123], a[92:95], v[200:203], a[120:123]
buffer_load_dwordx4 v7, s[8:11], s21 offen offset:3072 lds
v_mfma_f32_16x16x32_bf16 a[124:127], a[92:95], v[204:207], a[124:127]
v_mfma_f32_16x16x32_bf16 a[136:139], a[96:99], v[200:203], a[136:139]
v_mfma_f32_16x16x32_bf16 a[140:143], a[96:99], v[204:207], a[140:143]
v_mfma_f32_16x16x32_bf16 a[152:155], a[100:103], v[200:203], a[152:155]
s_waitcnt vmcnt(25)
v_swap_b32 v210, v212
v_mfma_f32_16x16x32_bf16 a[156:159], a[100:103], v[204:207], a[156:159]
v_swap_b32 v211, v213
v_mfma_f32_16x16x32_bf16 a[168:171], a[104:107], v[200:203], a[168:171]
v_swap_b32 v218, v220
v_mfma_f32_16x16x32_bf16 a[172:175], a[104:107], v[204:207], a[172:175]
v_swap_b32 v219, v221
v_mfma_f32_16x16x32_bf16 a[184:187], a[108:111], v[200:203], a[184:187]
v_mfma_f32_16x16x32_bf16 a[188:191], a[108:111], v[204:207], a[188:191]
s_waitcnt lgkmcnt(0)
v_mfma_f32_16x16x32_bf16 v[32:35], a[0:3], v[208:211], v[32:35]
v_mfma_f32_16x16x32_bf16 v[36:39], a[0:3], v[212:215], v[36:39]
v_mfma_f32_16x16x32_bf16 v[48:51], a[4:7], v[208:211], v[48:51]
v_mfma_f32_16x16x32_bf16 v[52:55], a[4:7], v[212:215], v[52:55]
ds_read_b64_tr_b16 a[56:57], v12 offset:7168
v_mfma_f32_16x16x32_bf16 v[64:67], a[8:11], v[208:211], v[64:67]
ds_read_b64_tr_b16 a[58:59], v12 offset:8960
s_add_u32 m0, s40, 32768
v_mfma_f32_16x16x32_bf16 v[68:71], a[8:11], v[212:215], v[68:71]
buffer_load_dwordx4 v8, s[8:11], s21 offen offset:0 lds
v_mfma_f32_16x16x32_bf16 v[80:83], a[12:15], v[208:211], v[80:83]
ds_read_b64_tr_b16 a[60:61], v12 offset:21504
v_mfma_f32_16x16x32_bf16 v[84:87], a[12:15], v[212:215], v[84:87]
ds_read_b64_tr_b16 a[62:63], v12 offset:23296
v_mfma_f32_16x16x32_bf16 v[96:99], a[16:19], v[208:211], v[96:99]
v_mfma_f32_16x16x32_bf16 v[100:103], a[16:19], v[212:215], v[100:103]
ds_read_b64_tr_b16 a[64:65], v12 offset:7200
v_mfma_f32_16x16x32_bf16 v[112:115], a[20:23], v[208:211], v[112:115]
ds_read_b64_tr_b16 a[66:67], v12 offset:8992
v_mfma_f32_16x16x32_bf16 v[116:119], a[20:23], v[212:215], v[116:119]
buffer_load_dwordx4 v9, s[8:11], s21 offen offset:1024 lds
v_mfma_f32_16x16x32_bf16 v[128:131], a[24:27], v[208:211], v[128:131]
ds_read_b64_tr_b16 a[68:69], v12 offset:21536
v_mfma_f32_16x16x32_bf16 v[132:135], a[24:27], v[212:215], v[132:135]
ds_read_b64_tr_b16 a[70:71], v12 offset:23328
v_mfma_f32_16x16x32_bf16 v[144:147], a[28:31], v[208:211], v[144:147]
v_mfma_f32_16x16x32_bf16 v[148:151], a[28:31], v[212:215], v[148:151]
ds_read_b64_tr_b16 a[72:73], v12 offset:7232
v_mfma_f32_16x16x32_bf16 v[160:163], a[32:35], v[208:211], v[160:163]
ds_read_b64_tr_b16 a[74:75], v12 offset:9024
v_mfma_f32_16x16x32_bf16 v[164:167], a[32:35], v[212:215], v[164:167]
buffer_load_dwordx4 v10, s[8:11], s21 offen offset:2048 lds
v_mfma_f32_16x16x32_bf16 a[112:115], a[36:39], v[208:211], a[112:115]
ds_read_b64_tr_b16 a[76:77], v12 offset:21568
s_add_u32 s22, s22, 1
v_mfma_f32_16x16x32_bf16 a[116:119], a[36:39], v[212:215], a[116:119]
ds_read_b64_tr_b16 a[78:79], v12 offset:23360
s_and_b32 s22, s22, 15
v_mfma_f32_16x16x32_bf16 a[128:131], a[40:43], v[208:211], a[128:131]
s_mul_i32 s21, s22, 458752
v_mfma_f32_16x16x32_bf16 a[132:135], a[40:43], v[212:215], a[132:135]
ds_read_b64_tr_b16 a[80:81], v12 offset:7264
v_mfma_f32_16x16x32_bf16 a[144:147], a[44:47], v[208:211], a[144:147]
ds_read_b64_tr_b16 a[82:83], v12 offset:9056
v_mfma_f32_16x16x32_bf16 a[148:151], a[44:47], v[212:215], a[148:151]
buffer_load_dwordx4 v[192:195], v2, s[4:7], s20 offen offset:0 sc1
v_mfma_f32_16x16x32_bf16 a[160:163], a[48:51], v[208:211], a[160:163]
ds_read_b64_tr_b16 a[84:85], v12 offset:21600
v_mfma_f32_16x16x32_bf16 a[164:167], a[48:51], v[212:215], a[164:167]
ds_read_b64_tr_b16 a[86:87], v12 offset:23392
v_mfma_f32_16x16x32_bf16 a[176:179], a[52:55], v[208:211], a[176:179]
v_mfma_f32_16x16x32_bf16 a[180:183], a[52:55], v[212:215], a[180:183]
ds_read_b64_tr_b16 a[88:89], v12 offset:7296
v_mfma_f32_16x16x32_bf16 v[40:43], a[0:3], v[216:219], v[40:43]
ds_read_b64_tr_b16 a[90:91], v12 offset:9088
v_mfma_f32_16x16x32_bf16 v[44:47], a[0:3], v[220:223], v[44:47]
buffer_load_dwordx4 v[196:199], v2, s[4:7], s20 offen offset:512 sc1
v_mfma_f32_16x16x32_bf16 v[56:59], a[4:7], v[216:219], v[56:59]
ds_read_b64_tr_b16 a[92:93], v12 offset:21632
v_mfma_f32_16x16x32_bf16 v[60:63], a[4:7], v[220:223], v[60:63]
ds_read_b64_tr_b16 a[94:95], v12 offset:23424
v_mfma_f32_16x16x32_bf16 v[72:75], a[8:11], v[216:219], v[72:75]
v_mfma_f32_16x16x32_bf16 v[76:79], a[8:11], v[220:223], v[76:79]
ds_read_b64_tr_b16 a[96:97], v12 offset:7328
v_mfma_f32_16x16x32_bf16 v[88:91], a[12:15], v[216:219], v[88:91]
ds_read_b64_tr_b16 a[98:99], v12 offset:9120
v_mfma_f32_16x16x32_bf16 v[92:95], a[12:15], v[220:223], v[92:95]
buffer_load_dwordx4 v[200:203], v3, s[4:7], s20 offen offset:0 sc1
v_mfma_f32_16x16x32_bf16 v[104:107], a[16:19], v[216:219], v[104:107]
ds_read_b64_tr_b16 a[100:101], v12 offset:21664
v_mfma_f32_16x16x32_bf16 v[108:111], a[16:19], v[220:223], v[108:111]
ds_read_b64_tr_b16 a[102:103], v12 offset:23456
v_mfma_f32_16x16x32_bf16 v[120:123], a[20:23], v[216:219], v[120:123]
v_mfma_f32_16x16x32_bf16 v[124:127], a[20:23], v[220:223], v[124:127]
ds_read_b64_tr_b16 a[104:105], v12 offset:7360
v_mfma_f32_16x16x32_bf16 v[136:139], a[24:27], v[216:219], v[136:139]
ds_read_b64_tr_b16 a[106:107], v12 offset:9152
v_mfma_f32_16x16x32_bf16 v[140:143], a[24:27], v[220:223], v[140:143]
buffer_load_dwordx4 v[204:207], v3, s[4:7], s20 offen offset:512 sc1
v_mfma_f32_16x16x32_bf16 v[152:155], a[28:31], v[216:219], v[152:155]
ds_read_b64_tr_b16 a[108:109], v12 offset:21696
v_mfma_f32_16x16x32_bf16 v[156:159], a[28:31], v[220:223], v[156:159]
ds_read_b64_tr_b16 a[110:111], v12 offset:23488
v_mfma_f32_16x16x32_bf16 v[168:171], a[32:35], v[216:219], v[168:171]
v_mfma_f32_16x16x32_bf16 v[172:175], a[32:35], v[220:223], v[172:175]
v_mfma_f32_16x16x32_bf16 a[120:123], a[36:39], v[216:219], a[120:123]
v_mfma_f32_16x16x32_bf16 a[124:127], a[36:39], v[220:223], a[124:127]
v_mfma_f32_16x16x32_bf16 a[136:139], a[40:43], v[216:219], a[136:139]
v_mfma_f32_16x16x32_bf16 a[140:143], a[40:43], v[220:223], a[140:143]
v_mfma_f32_16x16x32_bf16 a[152:155], a[44:47], v[216:219], a[152:155]
s_waitcnt vmcnt(28)
v_swap_b32 v226, v228
v_mfma_f32_16x16x32_bf16 a[156:159], a[44:47], v[220:223], a[156:159]
v_swap_b32 v227, v229
v_mfma_f32_16x16x32_bf16 a[168:171], a[48:51], v[216:219], a[168:171]
v_swap_b32 v234, v236
v_mfma_f32_16x16x32_bf16 a[172:175], a[48:51], v[220:223], a[172:175]
v_swap_b32 v235, v237
v_mfma_f32_16x16x32_bf16 a[184:187], a[52:55], v[216:219], a[184:187]
v_mfma_f32_16x16x32_bf16 a[188:191], a[52:55], v[220:223], a[188:191]
s_waitcnt lgkmcnt(0)
v_mfma_f32_16x16x32_bf16 v[32:35], a[56:59], v[224:227], v[32:35]
v_mfma_f32_16x16x32_bf16 v[36:39], a[56:59], v[228:231], v[36:39]
v_mfma_f32_16x16x32_bf16 v[48:51], a[60:63], v[224:227], v[48:51]
s_waitcnt vmcnt(36) lgkmcnt(0)
s_barrier
v_mfma_f32_16x16x32_bf16 v[52:55], a[60:63], v[228:231], v[52:55]
ds_read_b64_tr_b16 a[0:1], v12 offset:28672
v_mfma_f32_16x16x32_bf16 v[64:67], a[64:67], v[224:227], v[64:67]
ds_read_b64_tr_b16 a[2:3], v12 offset:30464
v_mfma_f32_16x16x32_bf16 v[68:71], a[64:67], v[228:231], v[68:71]
buffer_load_dwordx4 v[208:211], v2, s[4:7], s20 offen offset:2048 sc1
v_mfma_f32_16x16x32_bf16 v[80:83], a[68:71], v[224:227], v[80:83]
ds_read_b64_tr_b16 a[4:5], v12 offset:43008
v_mfma_f32_16x16x32_bf16 v[84:87], a[68:71], v[228:231], v[84:87]
ds_read_b64_tr_b16 a[6:7], v12 offset:44800
v_mfma_f32_16x16x32_bf16 v[96:99], a[72:75], v[224:227], v[96:99]
buffer_store_dwordx4 a[208:211], v1, s[16:19], s48 offen offset:1024 sc1
v_mfma_f32_16x16x32_bf16 v[100:103], a[72:75], v[228:231], v[100:103]
ds_read_b64_tr_b16 a[8:9], v12 offset:28704
v_mfma_f32_16x16x32_bf16 v[112:115], a[76:79], v[224:227], v[112:115]
ds_read_b64_tr_b16 a[10:11], v12 offset:30496
v_mfma_f32_16x16x32_bf16 v[116:119], a[76:79], v[228:231], v[116:119]
buffer_load_dwordx4 v[212:215], v2, s[4:7], s20 offen offset:2560 sc1
v_mfma_f32_16x16x32_bf16 v[128:131], a[80:83], v[224:227], v[128:131]
ds_read_b64_tr_b16 a[12:13], v12 offset:43040
v_mfma_f32_16x16x32_bf16 v[132:135], a[80:83], v[228:231], v[132:135]
ds_read_b64_tr_b16 a[14:15], v12 offset:44832
v_mfma_f32_16x16x32_bf16 v[144:147], a[84:87], v[224:227], v[144:147]
v_mfma_f32_16x16x32_bf16 v[148:151], a[84:87], v[228:231], v[148:151]
ds_read_b64_tr_b16 a[16:17], v12 offset:28736
v_mfma_f32_16x16x32_bf16 v[160:163], a[88:91], v[224:227], v[160:163]
ds_read_b64_tr_b16 a[18:19], v12 offset:30528
v_mfma_f32_16x16x32_bf16 v[164:167], a[88:91], v[228:231], v[164:167]
buffer_load_dwordx4 v[216:219], v3, s[4:7], s20 offen offset:2048 sc1
v_mfma_f32_16x16x32_bf16 a[112:115], a[92:95], v[224:227], a[112:115]
ds_read_b64_tr_b16 a[20:21], v12 offset:43072
v_mfma_f32_16x16x32_bf16 a[116:119], a[92:95], v[228:231], a[116:119]
ds_read_b64_tr_b16 a[22:23], v12 offset:44864
v_mfma_f32_16x16x32_bf16 a[128:131], a[96:99], v[224:227], a[128:131]
v_mfma_f32_16x16x32_bf16 a[132:135], a[96:99], v[228:231], a[132:135]
ds_read_b64_tr_b16 a[24:25], v12 offset:28768
v_mfma_f32_16x16x32_bf16 a[144:147], a[100:103], v[224:227], a[144:147]
ds_read_b64_tr_b16 a[26:27], v12 offset:30560
v_mfma_f32_16x16x32_bf16 a[148:151], a[100:103], v[228:231], a[148:151]
buffer_load_dwordx4 v[220:223], v3, s[4:7], s20 offen offset:2560 sc1
v_mfma_f32_16x16x32_bf16 a[160:163], a[104:107], v[224:227], a[160:163]
ds_read_b64_tr_b16 a[28:29], v12 offset:43104
s_add_u32 s20, s20, 4096
v_mfma_f32_16x16x32_bf16 a[164:167], a[104:107], v[228:231], a[164:167]
ds_read_b64_tr_b16 a[30:31], v12 offset:44896
s_and_b32 s20, s20, 0xffff
v_mfma_f32_16x16x32_bf16 a[176:179], a[108:111], v[224:227], a[176:179]
v_mfma_f32_16x16x32_bf16 a[180:183], a[108:111], v[228:231], a[180:183]
ds_read_b64_tr_b16 a[32:33], v12 offset:28800
v_mfma_f32_16x16x32_bf16 v[40:43], a[56:59], v[232:235], v[40:43]
ds_read_b64_tr_b16 a[34:35], v12 offset:30592
s_add_u32 m0, s40, 57344
v_mfma_f32_16x16x32_bf16 v[44:47], a[56:59], v[236:239], v[44:47]
buffer_load_dwordx4 v4, s[8:11], s21 offen offset:0 lds
v_mfma_f32_16x16x32_bf16 v[56:59], a[60:63], v[232:235], v[56:59]
ds_read_b64_tr_b16 a[36:37], v12 offset:43136
v_mfma_f32_16x16x32_bf16 v[60:63], a[60:63], v[236:239], v[60:63]
ds_read_b64_tr_b16 a[38:39], v12 offset:44928
v_mfma_f32_16x16x32_bf16 v[72:75], a[64:67], v[232:235], v[72:75]
v_mfma_f32_16x16x32_bf16 v[76:79], a[64:67], v[236:239], v[76:79]
ds_read_b64_tr_b16 a[40:41], v12 offset:28832
v_mfma_f32_16x16x32_bf16 v[88:91], a[68:71], v[232:235], v[88:91]
ds_read_b64_tr_b16 a[42:43], v12 offset:30624
v_mfma_f32_16x16x32_bf16 v[92:95], a[68:71], v[236:239], v[92:95]
buffer_load_dwordx4 v5, s[8:11], s21 offen offset:1024 lds
v_mfma_f32_16x16x32_bf16 v[104:107], a[72:75], v[232:235], v[104:107]
ds_read_b64_tr_b16 a[44:45], v12 offset:43168
v_mfma_f32_16x16x32_bf16 v[108:111], a[72:75], v[236:239], v[108:111]
ds_read_b64_tr_b16 a[46:47], v12 offset:44960
v_mfma_f32_16x16x32_bf16 v[120:123], a[76:79], v[232:235], v[120:123]
v_mfma_f32_16x16x32_bf16 v[124:127], a[76:79], v[236:239], v[124:127]
ds_read_b64_tr_b16 a[48:49], v12 offset:28864
v_mfma_f32_16x16x32_bf16 v[136:139], a[80:83], v[232:235], v[136:139]
ds_read_b64_tr_b16 a[50:51], v12 offset:30656
v_mfma_f32_16x16x32_bf16 v[140:143], a[80:83], v[236:239], v[140:143]
buffer_load_dwordx4 v6, s[8:11], s21 offen offset:2048 lds
v_mfma_f32_16x16x32_bf16 v[152:155], a[84:87], v[232:235], v[152:155]
ds_read_b64_tr_b16 a[52:53], v12 offset:43200
v_mfma_f32_16x16x32_bf16 v[156:159], a[84:87], v[236:239], v[156:159]
ds_read_b64_tr_b16 a[54:55], v12 offset:44992
v_mfma_f32_16x16x32_bf16 v[168:171], a[88:91], v[232:235], v[168:171]
v_mfma_f32_16x16x32_bf16 v[172:175], a[88:91], v[236:239], v[172:175]
v_mfma_f32_16x16x32_bf16 a[120:123], a[92:95], v[232:235], a[120:123]
buffer_load_dwordx4 v7, s[8:11], s21 offen offset:3072 lds
v_mfma_f32_16x16x32_bf16 a[124:127], a[92:95], v[236:239], a[124:127]
v_mfma_f32_16x16x32_bf16 a[136:139], a[96:99], v[232:235], a[136:139]
v_mfma_f32_16x16x32_bf16 a[140:143], a[96:99], v[236:239], a[140:143]
v_mfma_f32_16x16x32_bf16 a[152:155], a[100:103], v[232:235], a[152:155]
s_waitcnt vmcnt(26)
v_swap_b32 v242, v244
v_mfma_f32_16x16x32_bf16 a[156:159], a[100:103], v[236:239], a[156:159]
v_swap_b32 v243, v245
v_mfma_f32_16x16x32_bf16 a[168:171], a[104:107], v[232:235], a[168:171]
v_swap_b32 v250, v252
v_mfma_f32_16x16x32_bf16 a[172:175], a[104:107], v[236:239], a[172:175]
v_swap_b32 v251, v253
v_mfma_f32_16x16x32_bf16 a[184:187], a[108:111], v[232:235], a[184:187]
v_mfma_f32_16x16x32_bf16 a[188:191], a[108:111], v[236:239], a[188:191]
s_waitcnt lgkmcnt(0)
v_mfma_f32_16x16x32_bf16 v[32:35], a[0:3], v[240:243], v[32:35]
v_mfma_f32_16x16x32_bf16 v[36:39], a[0:3], v[244:247], v[36:39]
v_mfma_f32_16x16x32_bf16 v[48:51], a[4:7], v[240:243], v[48:51]
v_mfma_f32_16x16x32_bf16 v[52:55], a[4:7], v[244:247], v[52:55]
ds_read_b64_tr_b16 a[56:57], v12 offset:35840
v_mfma_f32_16x16x32_bf16 v[64:67], a[8:11], v[240:243], v[64:67]
ds_read_b64_tr_b16 a[58:59], v12 offset:37632
s_add_u32 m0, s40, 61440
v_mfma_f32_16x16x32_bf16 v[68:71], a[8:11], v[244:247], v[68:71]
buffer_load_dwordx4 v8, s[8:11], s21 offen offset:0 lds
v_mfma_f32_16x16x32_bf16 v[80:83], a[12:15], v[240:243], v[80:83]
ds_read_b64_tr_b16 a[60:61], v12 offset:50176
v_mfma_f32_16x16x32_bf16 v[84:87], a[12:15], v[244:247], v[84:87]
ds_read_b64_tr_b16 a[62:63], v12 offset:51968
v_mfma_f32_16x16x32_bf16 v[96:99], a[16:19], v[240:243], v[96:99]
v_mfma_f32_16x16x32_bf16 v[100:103], a[16:19], v[244:247], v[100:103]
ds_read_b64_tr_b16 a[64:65], v12 offset:35872
v_mfma_f32_16x16x32_bf16 v[112:115], a[20:23], v[240:243], v[112:115]
ds_read_b64_tr_b16 a[66:67], v12 offset:37664
v_mfma_f32_16x16x32_bf16 v[116:119], a[20:23], v[244:247], v[116:119]
buffer_load_dwordx4 v9, s[8:11], s21 offen offset:1024 lds
v_mfma_f32_16x16x32_bf16 v[128:131], a[24:27], v[240:243], v[128:131]
ds_read_b64_tr_b16 a[68:69], v12 offset:50208
v_mfma_f32_16x16x32_bf16 v[132:135], a[24:27], v[244:247], v[132:135]
ds_read_b64_tr_b16 a[70:71], v12 offset:52000
v_mfma_f32_16x16x32_bf16 v[144:147], a[28:31], v[240:243], v[144:147]
v_mfma_f32_16x16x32_bf16 v[148:151], a[28:31], v[244:247], v[148:151]
ds_read_b64_tr_b16 a[72:73], v12 offset:35904
v_mfma_f32_16x16x32_bf16 v[160:163], a[32:35], v[240:243], v[160:163]
ds_read_b64_tr_b16 a[74:75], v12 offset:37696
v_mfma_f32_16x16x32_bf16 v[164:167], a[32:35], v[244:247], v[164:167]
buffer_load_dwordx4 v10, s[8:11], s21 offen offset:2048 lds
v_mfma_f32_16x16x32_bf16 a[112:115], a[36:39], v[240:243], a[112:115]
ds_read_b64_tr_b16 a[76:77], v12 offset:50240
s_add_u32 s22, s22, 1
v_mfma_f32_16x16x32_bf16 a[116:119], a[36:39], v[244:247], a[116:119]
ds_read_b64_tr_b16 a[78:79], v12 offset:52032
s_and_b32 s22, s22, 15
v_mfma_f32_16x16x32_bf16 a[128:131], a[40:43], v[240:243], a[128:131]
s_mul_i32 s21, s22, 458752
v_mfma_f32_16x16x32_bf16 a[132:135], a[40:43], v[244:247], a[132:135]
ds_read_b64_tr_b16 a[80:81], v12 offset:35936
v_mfma_f32_16x16x32_bf16 a[144:147], a[44:47], v[240:243], a[144:147]
ds_read_b64_tr_b16 a[82:83], v12 offset:37728
v_mfma_f32_16x16x32_bf16 a[148:151], a[44:47], v[244:247], a[148:151]
buffer_load_dwordx4 v[224:227], v2, s[4:7], s20 offen offset:0 sc1
v_mfma_f32_16x16x32_bf16 a[160:163], a[48:51], v[240:243], a[160:163]
ds_read_b64_tr_b16 a[84:85], v12 offset:50272
v_mfma_f32_16x16x32_bf16 a[164:167], a[48:51], v[244:247], a[164:167]
ds_read_b64_tr_b16 a[86:87], v12 offset:52064
v_mfma_f32_16x16x32_bf16 a[176:179], a[52:55], v[240:243], a[176:179]
v_mfma_f32_16x16x32_bf16 a[180:183], a[52:55], v[244:247], a[180:183]
ds_read_b64_tr_b16 a[88:89], v12 offset:35968
v_mfma_f32_16x16x32_bf16 v[40:43], a[0:3], v[248:251], v[40:43]
ds_read_b64_tr_b16 a[90:91], v12 offset:37760
v_mfma_f32_16x16x32_bf16 v[44:47], a[0:3], v[252:255], v[44:47]
buffer_load_dwordx4 v[228:231], v2, s[4:7], s20 offen offset:512 sc1
v_mfma_f32_16x16x32_bf16 v[56:59], a[4:7], v[248:251], v[56:59]
ds_read_b64_tr_b16 a[92:93], v12 offset:50304
v_mfma_f32_16x16x32_bf16 v[60:63], a[4:7], v[252:255], v[60:63]
ds_read_b64_tr_b16 a[94:95], v12 offset:52096
v_mfma_f32_16x16x32_bf16 v[72:75], a[8:11], v[248:251], v[72:75]
v_mfma_f32_16x16x32_bf16 v[76:79], a[8:11], v[252:255], v[76:79]
ds_read_b64_tr_b16 a[96:97], v12 offset:36000
v_mfma_f32_16x16x32_bf16 v[88:91], a[12:15], v[248:251], v[88:91]
ds_read_b64_tr_b16 a[98:99], v12 offset:37792
v_mfma_f32_16x16x32_bf16 v[92:95], a[12:15], v[252:255], v[92:95]
buffer_load_dwordx4 v[232:235], v3, s[4:7], s20 offen offset:0 sc1
v_mfma_f32_16x16x32_bf16 v[104:107], a[16:19], v[248:251], v[104:107]
ds_read_b64_tr_b16 a[100:101], v12 offset:50336
v_mfma_f32_16x16x32_bf16 v[108:111], a[16:19], v[252:255], v[108:111]
ds_read_b64_tr_b16 a[102:103], v12 offset:52128
v_mfma_f32_16x16x32_bf16 v[120:123], a[20:23], v[248:251], v[120:123]
v_mfma_f32_16x16x32_bf16 v[124:127], a[20:23], v[252:255], v[124:127]
ds_read_b64_tr_b16 a[104:105], v12 offset:36032
v_mfma_f32_16x16x32_bf16 v[136:139], a[24:27], v[248:251], v[136:139]
ds_read_b64_tr_b16 a[106:107], v12 offset:37824
v_mfma_f32_16x16x32_bf16 v[140:143], a[24:27], v[252:255], v[140:143]
buffer_load_dwordx4 v[236:239], v3, s[4:7], s20 offen offset:512 sc1
v_mfma_f32_16x16x32_bf16 v[152:155], a[28:31], v[248:251], v[152:155]
ds_read_b64_tr_b16 a[108:109], v12 offset:50368
v_mfma_f32_16x16x32_bf16 v[156:159], a[28:31], v[252:255], v[156:159]
ds_read_b64_tr_b16 a[110:111], v12 offset:52160
v_mfma_f32_16x16x32_bf16 v[168:171], a[32:35], v[248:251], v[168:171]
v_mfma_f32_16x16x32_bf16 v[172:175], a[32:35], v[252:255], v[172:175]
v_mfma_f32_16x16x32_bf16 a[120:123], a[36:39], v[248:251], a[120:123]
v_mfma_f32_16x16x32_bf16 a[124:127], a[36:39], v[252:255], a[124:127]
v_mfma_f32_16x16x32_bf16 a[136:139], a[40:43], v[248:251], a[136:139]
v_mfma_f32_16x16x32_bf16 a[140:143], a[40:43], v[252:255], a[140:143]
v_mfma_f32_16x16x32_bf16 a[152:155], a[44:47], v[248:251], a[152:155]
s_waitcnt vmcnt(27)
v_swap_b32 v178, v180
v_mfma_f32_16x16x32_bf16 a[156:159], a[44:47], v[252:255], a[156:159]
v_swap_b32 v179, v181
v_mfma_f32_16x16x32_bf16 a[168:171], a[48:51], v[248:251], a[168:171]
v_swap_b32 v186, v188
v_mfma_f32_16x16x32_bf16 a[172:175], a[48:51], v[252:255], a[172:175]
v_swap_b32 v187, v189
v_mfma_f32_16x16x32_bf16 a[184:187], a[52:55], v[248:251], a[184:187]
v_mfma_f32_16x16x32_bf16 a[188:191], a[52:55], v[252:255], a[188:191]
s_waitcnt lgkmcnt(0)
v_mfma_f32_16x16x32_bf16 v[32:35], a[56:59], v[176:179], v[32:35]
v_mfma_f32_16x16x32_bf16 v[36:39], a[56:59], v[180:183], v[36:39]
v_mfma_f32_16x16x32_bf16 v[48:51], a[60:63], v[176:179], v[48:51]
s_waitcnt vmcnt(37) lgkmcnt(0)
s_barrier
v_mfma_f32_16x16x32_bf16 v[52:55], a[60:63], v[180:183], v[52:55]
ds_read_b64_tr_b16 a[0:1], v11 offset:0
v_mfma_f32_16x16x32_bf16 v[64:67], a[64:67], v[176:179], v[64:67]
ds_read_b64_tr_b16 a[2:3], v11 offset:1792
v_mfma_f32_16x16x32_bf16 v[68:71], a[64:67], v[180:183], v[68:71]
buffer_load_dwordx4 v[240:243], v2, s[4:7], s20 offen offset:2048 sc1
v_mfma_f32_16x16x32_bf16 v[80:83], a[68:71], v[176:179], v[80:83]
ds_read_b64_tr_b16 a[4:5], v11 offset:14336
v_mfma_f32_16x16x32_bf16 v[84:87], a[68:71], v[180:183], v[84:87]
ds_read_b64_tr_b16 a[6:7], v11 offset:16128
v_mfma_f32_16x16x32_bf16 v[96:99], a[72:75], v[176:179], v[96:99]
buffer_store_dwordx4 a[208:211], v1, s[16:19], s48 offen offset:2048 sc1
v_mfma_f32_16x16x32_bf16 v[100:103], a[72:75], v[180:183], v[100:103]
ds_read_b64_tr_b16 a[8:9], v11 offset:32
v_mfma_f32_16x16x32_bf16 v[112:115], a[76:79], v[176:179], v[112:115]
ds_read_b64_tr_b16 a[10:11], v11 offset:1824
v_mfma_f32_16x16x32_bf16 v[116:119], a[76:79], v[180:183], v[116:119]
buffer_load_dwordx4 v[244:247], v2, s[4:7], s20 offen offset:2560 sc1
v_mfma_f32_16x16x32_bf16 v[128:131], a[80:83], v[176:179], v[128:131]
ds_read_b64_tr_b16 a[12:13], v11 offset:14368
v_mfma_f32_16x16x32_bf16 v[132:135], a[80:83], v[180:183], v[132:135]
ds_read_b64_tr_b16 a[14:15], v11 offset:16160
v_mfma_f32_16x16x32_bf16 v[144:147], a[84:87], v[176:179], v[144:147]
v_mfma_f32_16x16x32_bf16 v[148:151], a[84:87], v[180:183], v[148:151]
ds_read_b64_tr_b16 a[16:17], v11 offset:64
v_mfma_f32_16x16x32_bf16 v[160:163], a[88:91], v[176:179], v[160:163]
ds_read_b64_tr_b16 a[18:19], v11 offset:1856
v_mfma_f32_16x16x32_bf16 v[164:167], a[88:91], v[180:183], v[164:167]
buffer_load_dwordx4 v[248:251], v3, s[4:7], s20 offen offset:2048 sc1
v_mfma_f32_16x16x32_bf16 a[112:115], a[92:95], v[176:179], a[112:115]
ds_read_b64_tr_b16 a[20:21], v11 offset:14400
v_mfma_f32_16x16x32_bf16 a[116:119], a[92:95], v[180:183], a[116:119]
ds_read_b64_tr_b16 a[22:23], v11 offset:16192
v_mfma_f32_16x16x32_bf16 a[128:131], a[96:99], v[176:179], a[128:131]
v_mfma_f32_16x16x32_bf16 a[132:135], a[96:99], v[180:183], a[132:135]
ds_read_b64_tr_b16 a[24:25], v11 offset:96
v_mfma_f32_16x16x32_bf16 a[144:147], a[100:103], v[176:179], a[144:147]
ds_read_b64_tr_b16 a[26:27], v11 offset:1888
v_mfma_f32_16x16x32_bf16 a[148:151], a[100:103], v[180:183], a[148:151]
buffer_load_dwordx4 v[252:255], v3, s[4:7], s20 offen offset:2560 sc1
v_mfma_f32_16x16x32_bf16 a[160:163], a[104:107], v[176:179], a[160:163]
ds_read_b64_tr_b16 a[28:29], v11 offset:14432
s_add_u32 s20, s20, 4096
v_mfma_f32_16x16x32_bf16 a[164:167], a[104:107], v[180:183], a[164:167]
ds_read_b64_tr_b16 a[30:31], v11 offset:16224
s_and_b32 s20, s20, 0xffff
v_mfma_f32_16x16x32_bf16 a[176:179], a[108:111], v[176:179], a[176:179]
v_mfma_f32_16x16x32_bf16 a[180:183], a[108:111], v[180:183], a[180:183]
ds_read_b64_tr_b16 a[32:33], v11 offset:128
v_mfma_f32_16x16x32_bf16 v[40:43], a[56:59], v[184:187], v[40:43]
ds_read_b64_tr_b16 a[34:35], v11 offset:1920
s_add_u32 m0, s40, 86016
v_mfma_f32_16x16x32_bf16 v[44:47], a[56:59], v[188:191], v[44:47]
buffer_load_dwordx4 v4, s[8:11], s21 offen offset:0 lds
v_mfma_f32_16x16x32_bf16 v[56:59], a[60:63], v[184:187], v[56:59]
ds_read_b64_tr_b16 a[36:37], v11 offset:14464
v_mfma_f32_16x16x32_bf16 v[60:63], a[60:63], v[188:191], v[60:63]
ds_read_b64_tr_b16 a[38:39], v11 offset:16256
v_mfma_f32_16x16x32_bf16 v[72:75], a[64:67], v[184:187], v[72:75]
v_mfma_f32_16x16x32_bf16 v[76:79], a[64:67], v[188:191], v[76:79]
ds_read_b64_tr_b16 a[40:41], v11 offset:160
v_mfma_f32_16x16x32_bf16 v[88:91], a[68:71], v[184:187], v[88:91]
ds_read_b64_tr_b16 a[42:43], v11 offset:1952
v_mfma_f32_16x16x32_bf16 v[92:95], a[68:71], v[188:191], v[92:95]
buffer_load_dwordx4 v5, s[8:11], s21 offen offset:1024 lds
v_mfma_f32_16x16x32_bf16 v[104:107], a[72:75], v[184:187], v[104:107]
ds_read_b64_tr_b16 a[44:45], v11 offset:14496
v_mfma_f32_16x16x32_bf16 v[108:111], a[72:75], v[188:191], v[108:111]
ds_read_b64_tr_b16 a[46:47], v11 offset:16288
v_mfma_f32_16x16x32_bf16 v[120:123], a[76:79], v[184:187], v[120:123]
v_mfma_f32_16x16x32_bf16 v[124:127], a[76:79], v[188:191], v[124:127]
ds_read_b64_tr_b16 a[48:49], v11 offset:192
v_mfma_f32_16x16x32_bf16 v[136:139], a[80:83], v[184:187], v[136:139]
ds_read_b64_tr_b16 a[50:51], v11 offset:1984
v_mfma_f32_16x16x32_bf16 v[140:143], a[80:83], v[188:191], v[140:143]
buffer_load_dwordx4 v6, s[8:11], s21 offen offset:2048 lds
v_mfma_f32_16x16x32_bf16 v[152:155], a[84:87], v[184:187], v[152:155]
ds_read_b64_tr_b16 a[52:53], v11 offset:14528
v_mfma_f32_16x16x32_bf16 v[156:159], a[84:87], v[188:191], v[156:159]
ds_read_b64_tr_b16 a[54:55], v11 offset:16320
v_mfma_f32_16x16x32_bf16 v[168:171], a[88:91], v[184:187], v[168:171]
v_mfma_f32_16x16x32_bf16 v[172:175], a[88:91], v[188:191], v[172:175]
v_mfma_f32_16x16x32_bf16 a[120:123], a[92:95], v[184:187], a[120:123]
buffer_load_dwordx4 v7, s[8:11], s21 offen offset:3072 lds
v_mfma_f32_16x16x32_bf16 a[124:127], a[92:95], v[188:191], a[124:127]
v_mfma_f32_16x16x32_bf16 a[136:139], a[96:99], v[184:187], a[136:139]
v_mfma_f32_16x16x32_bf16 a[140:143], a[96:99], v[188:191], a[140:143]
v_mfma_f32_16x16x32_bf16 a[152:155], a[100:103], v[184:187], a[152:155]
s_waitcnt vmcnt(25)
v_swap_b32 v194, v196
v_mfma_f32_16x16x32_bf16 a[156:159], a[100:103], v[188:191], a[156:159]
v_swap_b32 v195, v197
v_mfma_f32_16x16x32_bf16 a[168:171], a[104:107], v[184:187], a[168:171]
v_swap_b32 v202, v204
v_mfma_f32_16x16x32_bf16 a[172:175], a[104:107], v[188:191], a[172:175]
v_swap_b32 v203, v205
v_mfma_f32_16x16x32_bf16 a[184:187], a[108:111], v[184:187], a[184:187]
v_mfma_f32_16x16x32_bf16 a[188:191], a[108:111], v[188:191], a[188:191]
s_waitcnt lgkmcnt(0)
v_mfma_f32_16x16x32_bf16 v[32:35], a[0:3], v[192:195], v[32:35]
v_mfma_f32_16x16x32_bf16 v[36:39], a[0:3], v[196:199], v[36:39]
v_mfma_f32_16x16x32_bf16 v[48:51], a[4:7], v[192:195], v[48:51]
v_mfma_f32_16x16x32_bf16 v[52:55], a[4:7], v[196:199], v[52:55]
ds_read_b64_tr_b16 a[56:57], v11 offset:7168
v_mfma_f32_16x16x32_bf16 v[64:67], a[8:11], v[192:195], v[64:67]
ds_read_b64_tr_b16 a[58:59], v11 offset:8960
s_add_u32 m0, s40, 90112
v_mfma_f32_16x16x32_bf16 v[68:71], a[8:11], v[196:199], v[68:71]
buffer_load_dwordx4 v8, s[8:11], s21 offen offset:0 lds
v_mfma_f32_16x16x32_bf16 v[80:83], a[12:15], v[192:195], v[80:83]
ds_read_b64_tr_b16 a[60:61], v11 offset:21504
v_mfma_f32_16x16x32_bf16 v[84:87], a[12:15], v[196:199], v[84:87]
ds_read_b64_tr_b16 a[62:63], v11 offset:23296
v_mfma_f32_16x16x32_bf16 v[96:99], a[16:19], v[192:195], v[96:99]
v_mfma_f32_16x16x32_bf16 v[100:103], a[16:19], v[196:199], v[100:103]
ds_read_b64_tr_b16 a[64:65], v11 offset:7200
v_mfma_f32_16x16x32_bf16 v[112:115], a[20:23], v[192:195], v[112:115]
ds_read_b64_tr_b16 a[66:67], v11 offset:8992
v_mfma_f32_16x16x32_bf16 v[116:119], a[20:23], v[196:199], v[116:119]
buffer_load_dwordx4 v9, s[8:11], s21 offen offset:1024 lds
v_mfma_f32_16x16x32_bf16 v[128:131], a[24:27], v[192:195], v[128:131]
ds_read_b64_tr_b16 a[68:69], v11 offset:21536
v_mfma_f32_16x16x32_bf16 v[132:135], a[24:27], v[196:199], v[132:135]
ds_read_b64_tr_b16 a[70:71], v11 offset:23328
v_mfma_f32_16x16x32_bf16 v[144:147], a[28:31], v[192:195], v[144:147]
v_mfma_f32_16x16x32_bf16 v[148:151], a[28:31], v[196:199], v[148:151]
ds_read_b64_tr_b16 a[72:73], v11 offset:7232
v_mfma_f32_16x16x32_bf16 v[160:163], a[32:35], v[192:195], v[160:163]
ds_read_b64_tr_b16 a[74:75], v11 offset:9024
v_mfma_f32_16x16x32_bf16 v[164:167], a[32:35], v[196:199], v[164:167]
buffer_load_dwordx4 v10, s[8:11], s21 offen offset:2048 lds
v_mfma_f32_16x16x32_bf16 a[112:115], a[36:39], v[192:195], a[112:115]
ds_read_b64_tr_b16 a[76:77], v11 offset:21568
s_add_u32 s22, s22, 1
v_mfma_f32_16x16x32_bf16 a[116:119], a[36:39], v[196:199], a[116:119]
ds_read_b64_tr_b16 a[78:79], v11 offset:23360
s_and_b32 s22, s22, 15
v_mfma_f32_16x16x32_bf16 a[128:131], a[40:43], v[192:195], a[128:131]
s_mul_i32 s21, s22, 458752
v_mfma_f32_16x16x32_bf16 a[132:135], a[40:43], v[196:199], a[132:135]
ds_read_b64_tr_b16 a[80:81], v11 offset:7264
v_mfma_f32_16x16x32_bf16 a[144:147], a[44:47], v[192:195], a[144:147]
ds_read_b64_tr_b16 a[82:83], v11 offset:9056
v_mfma_f32_16x16x32_bf16 a[148:151], a[44:47], v[196:199], a[148:151]
buffer_load_dwordx4 v[176:179], v2, s[4:7], s20 offen offset:0 sc1
v_mfma_f32_16x16x32_bf16 a[160:163], a[48:51], v[192:195], a[160:163]
ds_read_b64_tr_b16 a[84:85], v11 offset:21600
v_mfma_f32_16x16x32_bf16 a[164:167], a[48:51], v[196:199], a[164:167]
ds_read_b64_tr_b16 a[86:87], v11 offset:23392
v_mfma_f32_16x16x32_bf16 a[176:179], a[52:55], v[192:195], a[176:179]
v_mfma_f32_16x16x32_bf16 a[180:183], a[52:55], v[196:199], a[180:183]
ds_read_b64_tr_b16 a[88:89], v11 offset:7296
v_mfma_f32_16x16x32_bf16 v[40:43], a[0:3], v[200:203], v[40:43]
ds_read_b64_tr_b16 a[90:91], v11 offset:9088
v_mfma_f32_16x16x32_bf16 v[44:47], a[0:3], v[204:207], v[44:47]
buffer_load_dwordx4 v[180:183], v2, s[4:7], s20 offen offset:512 sc1
v_mfma_f32_16x16x32_bf16 v[56:59], a[4:7], v[200:203], v[56:59]
ds_read_b64_tr_b16 a[92:93], v11 offset:21632
v_mfma_f32_16x16x32_bf16 v[60:63], a[4:7], v[204:207], v[60:63]
ds_read_b64_tr_b16 a[94:95], v11 offset:23424
v_mfma_f32_16x16x32_bf16 v[72:75], a[8:11], v[200:203], v[72:75]
v_mfma_f32_16x16x32_bf16 v[76:79], a[8:11], v[204:207], v[76:79]
ds_read_b64_tr_b16 a[96:97], v11 offset:7328
v_mfma_f32_16x16x32_bf16 v[88:91], a[12:15], v[200:203], v[88:91]
ds_read_b64_tr_b16 a[98:99], v11 offset:9120
v_mfma_f32_16x16x32_bf16 v[92:95], a[12:15], v[204:207], v[92:95]
buffer_load_dwordx4 v[184:187], v3, s[4:7], s20 offen offset:0 sc1
v_mfma_f32_16x16x32_bf16 v[104:107], a[16:19], v[200:203], v[104:107]
ds_read_b64_tr_b16 a[100:101], v11 offset:21664
v_mfma_f32_16x16x32_bf16 v[108:111], a[16:19], v[204:207], v[108:111]
ds_read_b64_tr_b16 a[102:103], v11 offset:23456
v_mfma_f32_16x16x32_bf16 v[120:123], a[20:23], v[200:203], v[120:123]
v_mfma_f32_16x16x32_bf16 v[124:127], a[20:23], v[204:207], v[124:127]
ds_read_b64_tr_b16 a[104:105], v11 offset:7360
v_mfma_f32_16x16x32_bf16 v[136:139], a[24:27], v[200:203], v[136:139]
ds_read_b64_tr_b16 a[106:107], v11 offset:9152
v_mfma_f32_16x16x32_bf16 v[140:143], a[24:27], v[204:207], v[140:143]
buffer_load_dwordx4 v[188:191], v3, s[4:7], s20 offen offset:512 sc1
v_mfma_f32_16x16x32_bf16 v[152:155], a[28:31], v[200:203], v[152:155]
ds_read_b64_tr_b16 a[108:109], v11 offset:21696
v_mfma_f32_16x16x32_bf16 v[156:159], a[28:31], v[204:207], v[156:159]
ds_read_b64_tr_b16 a[110:111], v11 offset:23488
v_mfma_f32_16x16x32_bf16 v[168:171], a[32:35], v[200:203], v[168:171]
v_mfma_f32_16x16x32_bf16 v[172:175], a[32:35], v[204:207], v[172:175]
v_mfma_f32_16x16x32_bf16 a[120:123], a[36:39], v[200:203], a[120:123]
v_mfma_f32_16x16x32_bf16 a[124:127], a[36:39], v[204:207], a[124:127]
v_mfma_f32_16x16x32_bf16 a[136:139], a[40:43], v[200:203], a[136:139]
v_mfma_f32_16x16x32_bf16 a[140:143], a[40:43], v[204:207], a[140:143]
v_mfma_f32_16x16x32_bf16 a[152:155], a[44:47], v[200:203], a[152:155]
s_waitcnt vmcnt(27)
v_swap_b32 v210, v212
v_mfma_f32_16x16x32_bf16 a[156:159], a[44:47], v[204:207], a[156:159]
v_swap_b32 v211, v213
v_mfma_f32_16x16x32_bf16 a[168:171], a[48:51], v[200:203], a[168:171]
v_swap_b32 v218, v220
v_mfma_f32_16x16x32_bf16 a[172:175], a[48:51], v[204:207], a[172:175]
v_swap_b32 v219, v221
v_mfma_f32_16x16x32_bf16 a[184:187], a[52:55], v[200:203], a[184:187]
v_mfma_f32_16x16x32_bf16 a[188:191], a[52:55], v[204:207], a[188:191]
s_waitcnt lgkmcnt(0)
v_mfma_f32_16x16x32_bf16 v[32:35], a[56:59], v[208:211], v[32:35]
v_mfma_f32_16x16x32_bf16 v[36:39], a[56:59], v[212:215], v[36:39]
v_mfma_f32_16x16x32_bf16 v[48:51], a[60:63], v[208:211], v[48:51]
s_waitcnt vmcnt(36) lgkmcnt(0)
s_barrier
v_mfma_f32_16x16x32_bf16 v[52:55], a[60:63], v[212:215], v[52:55]
ds_read_b64_tr_b16 a[0:1], v11 offset:28672
v_mfma_f32_16x16x32_bf16 v[64:67], a[64:67], v[208:211], v[64:67]
ds_read_b64_tr_b16 a[2:3], v11 offset:30464
v_mfma_f32_16x16x32_bf16 v[68:71], a[64:67], v[212:215], v[68:71]
buffer_load_dwordx4 v[192:195], v2, s[4:7], s20 offen offset:2048 sc1
v_mfma_f32_16x16x32_bf16 v[80:83], a[68:71], v[208:211], v[80:83]
ds_read_b64_tr_b16 a[4:5], v11 offset:43008
v_mfma_f32_16x16x32_bf16 v[84:87], a[68:71], v[212:215], v[84:87]
ds_read_b64_tr_b16 a[6:7], v11 offset:44800
v_mfma_f32_16x16x32_bf16 v[96:99], a[72:75], v[208:211], v[96:99]
buffer_store_dwordx4 a[208:211], v1, s[16:19], s48 offen offset:3072 sc1
v_mfma_f32_16x16x32_bf16 v[100:103], a[72:75], v[212:215], v[100:103]
ds_read_b64_tr_b16 a[8:9], v11 offset:28704
v_mfma_f32_16x16x32_bf16 v[112:115], a[76:79], v[208:211], v[112:115]
ds_read_b64_tr_b16 a[10:11], v11 offset:30496
v_mfma_f32_16x16x32_bf16 v[116:119], a[76:79], v[212:215], v[116:119]
buffer_load_dwordx4 v[196:199], v2, s[4:7], s20 offen offset:2560 sc1
v_mfma_f32_16x16x32_bf16 v[128:131], a[80:83], v[208:211], v[128:131]
ds_read_b64_tr_b16 a[12:13], v11 offset:43040
v_mfma_f32_16x16x32_bf16 v[132:135], a[80:83], v[212:215], v[132:135]
ds_read_b64_tr_b16 a[14:15], v11 offset:44832
v_mfma_f32_16x16x32_bf16 v[144:147], a[84:87], v[208:211], v[144:147]
v_mfma_f32_16x16x32_bf16 v[148:151], a[84:87], v[212:215], v[148:151]
ds_read_b64_tr_b16 a[16:17], v11 offset:28736
v_mfma_f32_16x16x32_bf16 v[160:163], a[88:91], v[208:211], v[160:163]
ds_read_b64_tr_b16 a[18:19], v11 offset:30528
v_mfma_f32_16x16x32_bf16 v[164:167], a[88:91], v[212:215], v[164:167]
buffer_load_dwordx4 v[200:203], v3, s[4:7], s20 offen offset:2048 sc1
v_mfma_f32_16x16x32_bf16 a[112:115], a[92:95], v[208:211], a[112:115]
ds_read_b64_tr_b16 a[20:21], v11 offset:43072
v_mfma_f32_16x16x32_bf16 a[116:119], a[92:95], v[212:215], a[116:119]
ds_read_b64_tr_b16 a[22:23], v11 offset:44864
v_mfma_f32_16x16x32_bf16 a[128:131], a[96:99], v[208:211], a[128:131]
v_mfma_f32_16x16x32_bf16 a[132:135], a[96:99], v[212:215], a[132:135]
ds_read_b64_tr_b16 a[24:25], v11 offset:28768
v_mfma_f32_16x16x32_bf16 a[144:147], a[100:103], v[208:211], a[144:147]
ds_read_b64_tr_b16 a[26:27], v11 offset:30560
v_mfma_f32_16x16x32_bf16 a[148:151], a[100:103], v[212:215], a[148:151]
buffer_load_dwordx4 v[204:207], v3, s[4:7], s20 offen offset:2560 sc1
v_mfma_f32_16x16x32_bf16 a[160:163], a[104:107], v[208:211], a[160:163]
ds_read_b64_tr_b16 a[28:29], v11 offset:43104
s_add_u32 s20, s20, 4096
v_mfma_f32_16x16x32_bf16 a[164:167], a[104:107], v[212:215], a[164:167]
ds_read_b64_tr_b16 a[30:31], v11 offset:44896
s_and_b32 s20, s20, 0xffff
v_mfma_f32_16x16x32_bf16 a[176:179], a[108:111], v[208:211], a[176:179]
v_mfma_f32_16x16x32_bf16 a[180:183], a[108:111], v[212:215], a[180:183]
ds_read_b64_tr_b16 a[32:33], v11 offset:28800
v_mfma_f32_16x16x32_bf16 v[40:43], a[56:59], v[216:219], v[40:43]
ds_read_b64_tr_b16 a[34:35], v11 offset:30592
s_add_u32 m0, s40, 0
v_mfma_f32_16x16x32_bf16 v[44:47], a[56:59], v[220:223], v[44:47]
buffer_load_dwordx4 v4, s[8:11], s21 offen offset:0 lds
v_mfma_f32_16x16x32_bf16 v[56:59], a[60:63], v[216:219], v[56:59]
ds_read_b64_tr_b16 a[36:37], v11 offset:43136
v_mfma_f32_16x16x32_bf16 v[60:63], a[60:63], v[220:223], v[60:63]
ds_read_b64_tr_b16 a[38:39], v11 offset:44928
v_mfma_f32_16x16x32_bf16 v[72:75], a[64:67], v[216:219], v[72:75]
v_mfma_f32_16x16x32_bf16 v[76:79], a[64:67], v[220:223], v[76:79]
ds_read_b64_tr_b16 a[40:41], v11 offset:28832
v_mfma_f32_16x16x32_bf16 v[88:91], a[68:71], v[216:219], v[88:91]
ds_read_b64_tr_b16 a[42:43], v11 offset:30624
v_mfma_f32_16x16x32_bf16 v[92:95], a[68:71], v[220:223], v[92:95]
buffer_load_dwordx4 v5, s[8:11], s21 offen offset:1024 lds
v_mfma_f32_16x16x32_bf16 v[104:107], a[72:75], v[216:219], v[104:107]
ds_read_b64_tr_b16 a[44:45], v11 offset:43168
v_mfma_f32_16x16x32_bf16 v[108:111], a[72:75], v[220:223], v[108:111]
ds_read_b64_tr_b16 a[46:47], v11 offset:44960
v_mfma_f32_16x16x32_bf16 v[120:123], a[76:79], v[216:219], v[120:123]
v_mfma_f32_16x16x32_bf16 v[124:127], a[76:79], v[220:223], v[124:127]
ds_read_b64_tr_b16 a[48:49], v11 offset:28864
v_mfma_f32_16x16x32_bf16 v[136:139], a[80:83], v[216:219], v[136:139]
ds_read_b64_tr_b16 a[50:51], v11 offset:30656
v_mfma_f32_16x16x32_bf16 v[140:143], a[80:83], v[220:223], v[140:143]
buffer_load_dwordx4 v6, s[8:11], s21 offen offset:2048 lds
v_mfma_f32_16x16x32_bf16 v[152:155], a[84:87], v[216:219], v[152:155]
ds_read_b64_tr_b16 a[52:53], v11 offset:43200
v_mfma_f32_16x16x32_bf16 v[156:159], a[84:87], v[220:223], v[156:159]
ds_read_b64_tr_b16 a[54:55], v11 offset:44992
v_mfma_f32_16x16x32_bf16 v[168:171], a[88:91], v[216:219], v[168:171]
v_mfma_f32_16x16x32_bf16 v[172:175], a[88:91], v[220:223], v[172:175]
v_mfma_f32_16x16x32_bf16 a[120:123], a[92:95], v[216:219], a[120:123]
buffer_load_dwordx4 v7, s[8:11], s21 offen offset:3072 lds
v_mfma_f32_16x16x32_bf16 a[124:127], a[92:95], v[220:223], a[124:127]
v_mfma_f32_16x16x32_bf16 a[136:139], a[96:99], v[216:219], a[136:139]
v_mfma_f32_16x16x32_bf16 a[140:143], a[96:99], v[220:223], a[140:143]
v_mfma_f32_16x16x32_bf16 a[152:155], a[100:103], v[216:219], a[152:155]
s_waitcnt vmcnt(25)
v_swap_b32 v226, v228
v_mfma_f32_16x16x32_bf16 a[156:159], a[100:103], v[220:223], a[156:159]
v_swap_b32 v227, v229
v_mfma_f32_16x16x32_bf16 a[168:171], a[104:107], v[216:219], a[168:171]
v_swap_b32 v234, v236
v_mfma_f32_16x16x32_bf16 a[172:175], a[104:107], v[220:223], a[172:175]
v_swap_b32 v235, v237
v_mfma_f32_16x16x32_bf16 a[184:187], a[108:111], v[216:219], a[184:187]
v_mfma_f32_16x16x32_bf16 a[188:191], a[108:111], v[220:223], a[188:191]
s_waitcnt lgkmcnt(0)
v_mfma_f32_16x16x32_bf16 v[32:35], a[0:3], v[224:227], v[32:35]
v_mfma_f32_16x16x32_bf16 v[36:39], a[0:3], v[228:231], v[36:39]
v_mfma_f32_16x16x32_bf16 v[48:51], a[4:7], v[224:227], v[48:51]
v_mfma_f32_16x16x32_bf16 v[52:55], a[4:7], v[228:231], v[52:55]
ds_read_b64_tr_b16 a[56:57], v11 offset:35840
v_mfma_f32_16x16x32_bf16 v[64:67], a[8:11], v[224:227], v[64:67]
ds_read_b64_tr_b16 a[58:59], v11 offset:37632
s_add_u32 m0, s40, 4096
v_mfma_f32_16x16x32_bf16 v[68:71], a[8:11], v[228:231], v[68:71]
buffer_load_dwordx4 v8, s[8:11], s21 offen offset:0 lds
v_mfma_f32_16x16x32_bf16 v[80:83], a[12:15], v[224:227], v[80:83]
ds_read_b64_tr_b16 a[60:61], v11 offset:50176
v_mfma_f32_16x16x32_bf16 v[84:87], a[12:15], v[228:231], v[84:87]
ds_read_b64_tr_b16 a[62:63], v11 offset:51968
v_mfma_f32_16x16x32_bf16 v[96:99], a[16:19], v[224:227], v[96:99]
v_mfma_f32_16x16x32_bf16 v[100:103], a[16:19], v[228:231], v[100:103]
ds_read_b64_tr_b16 a[64:65], v11 offset:35872
v_mfma_f32_16x16x32_bf16 v[112:115], a[20:23], v[224:227], v[112:115]
ds_read_b64_tr_b16 a[66:67], v11 offset:37664
v_mfma_f32_16x16x32_bf16 v[116:119], a[20:23], v[228:231], v[116:119]
buffer_load_dwordx4 v9, s[8:11], s21 offen offset:1024 lds
v_mfma_f32_16x16x32_bf16 v[128:131], a[24:27], v[224:227], v[128:131]
ds_read_b64_tr_b16 a[68:69], v11 offset:50208
v_mfma_f32_16x16x32_bf16 v[132:135], a[24:27], v[228:231], v[132:135]
ds_read_b64_tr_b16 a[70:71], v11 offset:52000
v_mfma_f32_16x16x32_bf16 v[144:147], a[28:31], v[224:227], v[144:147]
v_mfma_f32_16x16x32_bf16 v[148:151], a[28:31], v[228:231], v[148:151]
ds_read_b64_tr_b16 a[72:73], v11 offset:35904
v_mfma_f32_16x16x32_bf16 v[160:163], a[32:35], v[224:227], v[160:163]
ds_read_b64_tr_b16 a[74:75], v11 offset:37696
v_mfma_f32_16x16x32_bf16 v[164:167], a[32:35], v[228:231], v[164:167]
buffer_load_dwordx4 v10, s[8:11], s21 offen offset:2048 lds
v_mfma_f32_16x16x32_bf16 a[112:115], a[36:39], v[224:227], a[112:115]
ds_read_b64_tr_b16 a[76:77], v11 offset:50240
s_add_u32 s22, s22, 1
v_mfma_f32_16x16x32_bf16 a[116:119], a[36:39], v[228:231], a[116:119]
ds_read_b64_tr_b16 a[78:79], v11 offset:52032
s_and_b32 s22, s22, 15
v_mfma_f32_16x16x32_bf16 a[128:131], a[40:43], v[224:227], a[128:131]
s_mul_i32 s21, s22, 458752
v_mfma_f32_16x16x32_bf16 a[132:135], a[40:43], v[228:231], a[132:135]
ds_read_b64_tr_b16 a[80:81], v11 offset:35936
v_mfma_f32_16x16x32_bf16 a[144:147], a[44:47], v[224:227], a[144:147]
ds_read_b64_tr_b16 a[82:83], v11 offset:37728
v_mfma_f32_16x16x32_bf16 a[148:151], a[44:47], v[228:231], a[148:151]
buffer_load_dwordx4 v[208:211], v2, s[4:7], s20 offen offset:0 sc1
v_mfma_f32_16x16x32_bf16 a[160:163], a[48:51], v[224:227], a[160:163]
ds_read_b64_tr_b16 a[84:85], v11 offset:50272
v_mfma_f32_16x16x32_bf16 a[164:167], a[48:51], v[228:231], a[164:167]
ds_read_b64_tr_b16 a[86:87], v11 offset:52064
v_mfma_f32_16x16x32_bf16 a[176:179], a[52:55], v[224:227], a[176:179]
v_mfma_f32_16x16x32_bf16 a[180:183], a[52:55], v[228:231], a[180:183]
ds_read_b64_tr_b16 a[88:89], v11 offset:35968
v_mfma_f32_16x16x32_bf16 v[40:43], a[0:3], v[232:235], v[40:43]
ds_read_b64_tr_b16 a[90:91], v11 offset:37760
v_mfma_f32_16x16x32_bf16 v[44:47], a[0:3], v[236:239], v[44:47]
buffer_load_dwordx4 v[212:215], v2, s[4:7], s20 offen offset:512 sc1
v_mfma_f32_16x16x32_bf16 v[56:59], a[4:7], v[232:235], v[56:59]
ds_read_b64_tr_b16 a[92:93], v11 offset:50304
v_mfma_f32_16x16x32_bf16 v[60:63], a[4:7], v[236:239], v[60:63]
ds_read_b64_tr_b16 a[94:95], v11 offset:52096
v_mfma_f32_16x16x32_bf16 v[72:75], a[8:11], v[232:235], v[72:75]
v_mfma_f32_16x16x32_bf16 v[76:79], a[8:11], v[236:239], v[76:79]
ds_read_b64_tr_b16 a[96:97], v11 offset:36000
v_mfma_f32_16x16x32_bf16 v[88:91], a[12:15], v[232:235], v[88:91]
ds_read_b64_tr_b16 a[98:99], v11 offset:37792
v_mfma_f32_16x16x32_bf16 v[92:95], a[12:15], v[236:239], v[92:95]
buffer_load_dwordx4 v[216:219], v3, s[4:7], s20 offen offset:0 sc1
v_mfma_f32_16x16x32_bf16 v[104:107], a[16:19], v[232:235], v[104:107]
ds_read_b64_tr_b16 a[100:101], v11 offset:50336
v_mfma_f32_16x16x32_bf16 v[108:111], a[16:19], v[236:239], v[108:111]
ds_read_b64_tr_b16 a[102:103], v11 offset:52128
v_mfma_f32_16x16x32_bf16 v[120:123], a[20:23], v[232:235], v[120:123]
v_mfma_f32_16x16x32_bf16 v[124:127], a[20:23], v[236:239], v[124:127]
ds_read_b64_tr_b16 a[104:105], v11 offset:36032
v_mfma_f32_16x16x32_bf16 v[136:139], a[24:27], v[232:235], v[136:139]
ds_read_b64_tr_b16 a[106:107], v11 offset:37824
v_mfma_f32_16x16x32_bf16 v[140:143], a[24:27], v[236:239], v[140:143]
buffer_load_dwordx4 v[220:223], v3, s[4:7], s20 offen offset:512 sc1
v_mfma_f32_16x16x32_bf16 v[152:155], a[28:31], v[232:235], v[152:155]
ds_read_b64_tr_b16 a[108:109], v11 offset:50368
v_mfma_f32_16x16x32_bf16 v[156:159], a[28:31], v[236:239], v[156:159]
ds_read_b64_tr_b16 a[110:111], v11 offset:52160
v_mfma_f32_16x16x32_bf16 v[168:171], a[32:35], v[232:235], v[168:171]
v_mfma_f32_16x16x32_bf16 v[172:175], a[32:35], v[236:239], v[172:175]
v_mfma_f32_16x16x32_bf16 a[120:123], a[36:39], v[232:235], a[120:123]
v_mfma_f32_16x16x32_bf16 a[124:127], a[36:39], v[236:239], a[124:127]
v_mfma_f32_16x16x32_bf16 a[136:139], a[40:43], v[232:235], a[136:139]
v_mfma_f32_16x16x32_bf16 a[140:143], a[40:43], v[236:239], a[140:143]
v_mfma_f32_16x16x32_bf16 a[152:155], a[44:47], v[232:235], a[152:155]
s_waitcnt vmcnt(27)
v_swap_b32 v242, v244
v_mfma_f32_16x16x32_bf16 a[156:159], a[44:47], v[236:239], a[156:159]
v_swap_b32 v243, v245
v_mfma_f32_16x16x32_bf16 a[168:171], a[48:51], v[232:235], a[168:171]
v_swap_b32 v250, v252
v_mfma_f32_16x16x32_bf16 a[172:175], a[48:51], v[236:239], a[172:175]
v_swap_b32 v251, v253
v_mfma_f32_16x16x32_bf16 a[184:187], a[52:55], v[232:235], a[184:187]
v_mfma_f32_16x16x32_bf16 a[188:191], a[52:55], v[236:239], a[188:191]
s_waitcnt lgkmcnt(0)
v_mfma_f32_16x16x32_bf16 v[32:35], a[56:59], v[240:243], v[32:35]
v_mfma_f32_16x16x32_bf16 v[36:39], a[56:59], v[244:247], v[36:39]
v_mfma_f32_16x16x32_bf16 v[48:51], a[60:63], v[240:243], v[48:51]
s_waitcnt vmcnt(36) lgkmcnt(0)
s_barrier
v_mfma_f32_16x16x32_bf16 v[52:55], a[60:63], v[244:247], v[52:55]
ds_read_b64_tr_b16 a[0:1], v12 offset:0
v_mfma_f32_16x16x32_bf16 v[64:67], a[64:67], v[240:243], v[64:67]
ds_read_b64_tr_b16 a[2:3], v12 offset:1792
v_mfma_f32_16x16x32_bf16 v[68:71], a[64:67], v[244:247], v[68:71]
buffer_load_dwordx4 v[224:227], v2, s[4:7], s20 offen offset:2048 sc1
v_mfma_f32_16x16x32_bf16 v[80:83], a[68:71], v[240:243], v[80:83]
ds_read_b64_tr_b16 a[4:5], v12 offset:14336
v_mfma_f32_16x16x32_bf16 v[84:87], a[68:71], v[244:247], v[84:87]
ds_read_b64_tr_b16 a[6:7], v12 offset:16128
v_mfma_f32_16x16x32_bf16 v[96:99], a[72:75], v[240:243], v[96:99]
v_mfma_f32_16x16x32_bf16 v[100:103], a[72:75], v[244:247], v[100:103]
ds_read_b64_tr_b16 a[8:9], v12 offset:32
v_mfma_f32_16x16x32_bf16 v[112:115], a[76:79], v[240:243], v[112:115]
ds_read_b64_tr_b16 a[10:11], v12 offset:1824
v_mfma_f32_16x16x32_bf16 v[116:119], a[76:79], v[244:247], v[116:119]
buffer_load_dwordx4 v[228:231], v2, s[4:7], s20 offen offset:2560 sc1
v_mfma_f32_16x16x32_bf16 v[128:131], a[80:83], v[240:243], v[128:131]
ds_read_b64_tr_b16 a[12:13], v12 offset:14368
v_mfma_f32_16x16x32_bf16 v[132:135], a[80:83], v[244:247], v[132:135]
ds_read_b64_tr_b16 a[14:15], v12 offset:16160
v_mfma_f32_16x16x32_bf16 v[144:147], a[84:87], v[240:243], v[144:147]
v_mfma_f32_16x16x32_bf16 v[148:151], a[84:87], v[244:247], v[148:151]
ds_read_b64_tr_b16 a[16:17], v12 offset:64
v_mfma_f32_16x16x32_bf16 v[160:163], a[88:91], v[240:243], v[160:163]
ds_read_b64_tr_b16 a[18:19], v12 offset:1856
v_mfma_f32_16x16x32_bf16 v[164:167], a[88:91], v[244:247], v[164:167]
buffer_load_dwordx4 v[232:235], v3, s[4:7], s20 offen offset:2048 sc1
v_mfma_f32_16x16x32_bf16 a[112:115], a[92:95], v[240:243], a[112:115]
ds_read_b64_tr_b16 a[20:21], v12 offset:14400
v_mfma_f32_16x16x32_bf16 a[116:119], a[92:95], v[244:247], a[116:119]
ds_read_b64_tr_b16 a[22:23], v12 offset:16192
v_mfma_f32_16x16x32_bf16 a[128:131], a[96:99], v[240:243], a[128:131]
v_mfma_f32_16x16x32_bf16 a[132:135], a[96:99], v[244:247], a[132:135]
ds_read_b64_tr_b16 a[24:25], v12 offset:96
v_mfma_f32_16x16x32_bf16 a[144:147], a[100:103], v[240:243], a[144:147]
ds_read_b64_tr_b16 a[26:27], v12 offset:1888
v_mfma_f32_16x16x32_bf16 a[148:151], a[100:103], v[244:247], a[148:151]
buffer_load_dwordx4 v[236:239], v3, s[4:7], s20 offen offset:2560 sc1
v_mfma_f32_16x16x32_bf16 a[160:163], a[104:107], v[240:243], a[160:163]
ds_read_b64_tr_b16 a[28:29], v12 offset:14432
s_add_u32 s20, s20, 4096
v_mfma_f32_16x16x32_bf16 a[164:167], a[104:107], v[244:247], a[164:167]
ds_read_b64_tr_b16 a[30:31], v12 offset:16224
s_and_b32 s20, s20, 0xffff
v_mfma_f32_16x16x32_bf16 a[176:179], a[108:111], v[240:243], a[176:179]
v_mfma_f32_16x16x32_bf16 a[180:183], a[108:111], v[244:247], a[180:183]
ds_read_b64_tr_b16 a[32:33], v12 offset:128
v_mfma_f32_16x16x32_bf16 v[40:43], a[56:59], v[248:251], v[40:43]
ds_read_b64_tr_b16 a[34:35], v12 offset:1920
s_add_u32 m0, s40, 28672
v_mfma_f32_16x16x32_bf16 v[44:47], a[56:59], v[252:255], v[44:47]
buffer_load_dwordx4 v4, s[8:11], s21 offen offset:0 lds
v_mfma_f32_16x16x32_bf16 v[56:59], a[60:63], v[248:251], v[56:59]
ds_read_b64_tr_b16 a[36:37], v12 offset:14464
v_mfma_f32_16x16x32_bf16 v[60:63], a[60:63], v[252:255], v[60:63]
ds_read_b64_tr_b16 a[38:39], v12 offset:16256
v_mfma_f32_16x16x32_bf16 v[72:75], a[64:67], v[248:251], v[72:75]
v_mfma_f32_16x16x32_bf16 v[76:79], a[64:67], v[252:255], v[76:79]
ds_read_b64_tr_b16 a[40:41], v12 offset:160
v_mfma_f32_16x16x32_bf16 v[88:91], a[68:71], v[248:251], v[88:91]
ds_read_b64_tr_b16 a[42:43], v12 offset:1952
v_mfma_f32_16x16x32_bf16 v[92:95], a[68:71], v[252:255], v[92:95]
buffer_load_dwordx4 v5, s[8:11], s21 offen offset:1024 lds
v_mfma_f32_16x16x32_bf16 v[104:107], a[72:75], v[248:251], v[104:107]
ds_read_b64_tr_b16 a[44:45], v12 offset:14496
v_mfma_f32_16x16x32_bf16 v[108:111], a[72:75], v[252:255], v[108:111]
ds_read_b64_tr_b16 a[46:47], v12 offset:16288
v_mfma_f32_16x16x32_bf16 v[120:123], a[76:79], v[248:251], v[120:123]
v_mfma_f32_16x16x32_bf16 v[124:127], a[76:79], v[252:255], v[124:127]
ds_read_b64_tr_b16 a[48:49], v12 offset:192
v_mfma_f32_16x16x32_bf16 v[136:139], a[80:83], v[248:251], v[136:139]
ds_read_b64_tr_b16 a[50:51], v12 offset:1984
v_mfma_f32_16x16x32_bf16 v[140:143], a[80:83], v[252:255], v[140:143]
buffer_load_dwordx4 v6, s[8:11], s21 offen offset:2048 lds
v_mfma_f32_16x16x32_bf16 v[152:155], a[84:87], v[248:251], v[152:155]
ds_read_b64_tr_b16 a[52:53], v12 offset:14528
v_mfma_f32_16x16x32_bf16 v[156:159], a[84:87], v[252:255], v[156:159]
ds_read_b64_tr_b16 a[54:55], v12 offset:16320
v_mfma_f32_16x16x32_bf16 v[168:171], a[88:91], v[248:251], v[168:171]
v_mfma_f32_16x16x32_bf16 v[172:175], a[88:91], v[252:255], v[172:175]
v_mfma_f32_16x16x32_bf16 a[120:123], a[92:95], v[248:251], a[120:123]
buffer_load_dwordx4 v7, s[8:11], s21 offen offset:3072 lds
v_mfma_f32_16x16x32_bf16 a[124:127], a[92:95], v[252:255], a[124:127]
v_mfma_f32_16x16x32_bf16 a[136:139], a[96:99], v[248:251], a[136:139]
v_mfma_f32_16x16x32_bf16 a[140:143], a[96:99], v[252:255], a[140:143]
v_mfma_f32_16x16x32_bf16 a[152:155], a[100:103], v[248:251], a[152:155]
s_waitcnt vmcnt(24)
v_swap_b32 v178, v180
v_mfma_f32_16x16x32_bf16 a[156:159], a[100:103], v[252:255], a[156:159]
v_swap_b32 v179, v181
v_mfma_f32_16x16x32_bf16 a[168:171], a[104:107], v[248:251], a[168:171]
v_swap_b32 v186, v188
v_mfma_f32_16x16x32_bf16 a[172:175], a[104:107], v[252:255], a[172:175]
v_swap_b32 v187, v189
v_mfma_f32_16x16x32_bf16 a[184:187], a[108:111], v[248:251], a[184:187]
v_mfma_f32_16x16x32_bf16 a[188:191], a[108:111], v[252:255], a[188:191]
s_waitcnt lgkmcnt(0)
v_mfma_f32_16x16x32_bf16 v[32:35], a[0:3], v[176:179], v[32:35]
v_mfma_f32_16x16x32_bf16 v[36:39], a[0:3], v[180:183], v[36:39]
v_mfma_f32_16x16x32_bf16 v[48:51], a[4:7], v[176:179], v[48:51]
v_mfma_f32_16x16x32_bf16 v[52:55], a[4:7], v[180:183], v[52:55]
ds_read_b64_tr_b16 a[56:57], v12 offset:7168
v_mfma_f32_16x16x32_bf16 v[64:67], a[8:11], v[176:179], v[64:67]
ds_read_b64_tr_b16 a[58:59], v12 offset:8960
s_add_u32 m0, s40, 32768
v_mfma_f32_16x16x32_bf16 v[68:71], a[8:11], v[180:183], v[68:71]
buffer_load_dwordx4 v8, s[8:11], s21 offen offset:0 lds
v_mfma_f32_16x16x32_bf16 v[80:83], a[12:15], v[176:179], v[80:83]
ds_read_b64_tr_b16 a[60:61], v12 offset:21504
v_mfma_f32_16x16x32_bf16 v[84:87], a[12:15], v[180:183], v[84:87]
ds_read_b64_tr_b16 a[62:63], v12 offset:23296
v_mfma_f32_16x16x32_bf16 v[96:99], a[16:19], v[176:179], v[96:99]
buffer_load_dword v23, v22, s[16:19], 0 offen sc1
v_mfma_f32_16x16x32_bf16 v[100:103], a[16:19], v[180:183], v[100:103]
ds_read_b64_tr_b16 a[64:65], v12 offset:7200
v_mfma_f32_16x16x32_bf16 v[112:115], a[20:23], v[176:179], v[112:115]
ds_read_b64_tr_b16 a[66:67], v12 offset:8992
v_mfma_f32_16x16x32_bf16 v[116:119], a[20:23], v[180:183], v[116:119]
buffer_load_dwordx4 v9, s[8:11], s21 offen offset:1024 lds
v_mfma_f32_16x16x32_bf16 v[128:131], a[24:27], v[176:179], v[128:131]
ds_read_b64_tr_b16 a[68:69], v12 offset:21536
v_mfma_f32_16x16x32_bf16 v[132:135], a[24:27], v[180:183], v[132:135]
ds_read_b64_tr_b16 a[70:71], v12 offset:23328
v_mfma_f32_16x16x32_bf16 v[144:147], a[28:31], v[176:179], v[144:147]
v_mfma_f32_16x16x32_bf16 v[148:151], a[28:31], v[180:183], v[148:151]
ds_read_b64_tr_b16 a[72:73], v12 offset:7232
v_mfma_f32_16x16x32_bf16 v[160:163], a[32:35], v[176:179], v[160:163]
ds_read_b64_tr_b16 a[74:75], v12 offset:9024
v_mfma_f32_16x16x32_bf16 v[164:167], a[32:35], v[180:183], v[164:167]
buffer_load_dwordx4 v10, s[8:11], s21 offen offset:2048 lds
v_mfma_f32_16x16x32_bf16 a[112:115], a[36:39], v[176:179], a[112:115]
ds_read_b64_tr_b16 a[76:77], v12 offset:21568
s_add_u32 s22, s22, 1
v_mfma_f32_16x16x32_bf16 a[116:119], a[36:39], v[180:183], a[116:119]
ds_read_b64_tr_b16 a[78:79], v12 offset:23360
s_and_b32 s22, s22, 15
v_mfma_f32_16x16x32_bf16 a[128:131], a[40:43], v[176:179], a[128:131]
s_mul_i32 s21, s22, 458752
v_mfma_f32_16x16x32_bf16 a[132:135], a[40:43], v[180:183], a[132:135]
ds_read_b64_tr_b16 a[80:81], v12 offset:7264
v_mfma_f32_16x16x32_bf16 a[144:147], a[44:47], v[176:179], a[144:147]
ds_read_b64_tr_b16 a[82:83], v12 offset:9056
v_mfma_f32_16x16x32_bf16 a[148:151], a[44:47], v[180:183], a[148:151]
buffer_load_dwordx4 v[240:243], v2, s[4:7], s20 offen offset:0 sc1
v_mfma_f32_16x16x32_bf16 a[160:163], a[48:51], v[176:179], a[160:163]
ds_read_b64_tr_b16 a[84:85], v12 offset:21600
v_mfma_f32_16x16x32_bf16 a[164:167], a[48:51], v[180:183], a[164:167]
ds_read_b64_tr_b16 a[86:87], v12 offset:23392
v_mfma_f32_16x16x32_bf16 a[176:179], a[52:55], v[176:179], a[176:179]
v_mfma_f32_16x16x32_bf16 a[180:183], a[52:55], v[180:183], a[180:183]
ds_read_b64_tr_b16 a[88:89], v12 offset:7296
v_mfma_f32_16x16x32_bf16 v[40:43], a[0:3], v[184:187], v[40:43]
ds_read_b64_tr_b16 a[90:91], v12 offset:9088
v_mfma_f32_16x16x32_bf16 v[44:47], a[0:3], v[188:191], v[44:47]
buffer_load_dwordx4 v[244:247], v2, s[4:7], s20 offen offset:512 sc1
v_mfma_f32_16x16x32_bf16 v[56:59], a[4:7], v[184:187], v[56:59]
ds_read_b64_tr_b16 a[92:93], v12 offset:21632
v_mfma_f32_16x16x32_bf16 v[60:63], a[4:7], v[188:191], v[60:63]
ds_read_b64_tr_b16 a[94:95], v12 offset:23424
v_mfma_f32_16x16x32_bf16 v[72:75], a[8:11], v[184:187], v[72:75]
v_mfma_f32_16x16x32_bf16 v[76:79], a[8:11], v[188:191], v[76:79]
ds_read_b64_tr_b16 a[96:97], v12 offset:7328
v_mfma_f32_16x16x32_bf16 v[88:91], a[12:15], v[184:187], v[88:91]
ds_read_b64_tr_b16 a[98:99], v12 offset:9120
v_mfma_f32_16x16x32_bf16 v[92:95], a[12:15], v[188:191], v[92:95]
buffer_load_dwordx4 v[248:251], v3, s[4:7], s20 offen offset:0 sc1
v_mfma_f32_16x16x32_bf16 v[104:107], a[16:19], v[184:187], v[104:107]
ds_read_b64_tr_b16 a[100:101], v12 offset:21664
v_mfma_f32_16x16x32_bf16 v[108:111], a[16:19], v[188:191], v[108:111]
ds_read_b64_tr_b16 a[102:103], v12 offset:23456
v_mfma_f32_16x16x32_bf16 v[120:123], a[20:23], v[184:187], v[120:123]
v_mfma_f32_16x16x32_bf16 v[124:127], a[20:23], v[188:191], v[124:127]
ds_read_b64_tr_b16 a[104:105], v12 offset:7360
v_mfma_f32_16x16x32_bf16 v[136:139], a[24:27], v[184:187], v[136:139]
ds_read_b64_tr_b16 a[106:107], v12 offset:9152
v_mfma_f32_16x16x32_bf16 v[140:143], a[24:27], v[188:191], v[140:143]
buffer_load_dwordx4 v[252:255], v3, s[4:7], s20 offen offset:512 sc1
v_mfma_f32_16x16x32_bf16 v[152:155], a[28:31], v[184:187], v[152:155]
ds_read_b64_tr_b16 a[108:109], v12 offset:21696
v_mfma_f32_16x16x32_bf16 v[156:159], a[28:31], v[188:191], v[156:159]
ds_read_b64_tr_b16 a[110:111], v12 offset:23488
v_mfma_f32_16x16x32_bf16 v[168:171], a[32:35], v[184:187], v[168:171]
v_mfma_f32_16x16x32_bf16 v[172:175], a[32:35], v[188:191], v[172:175]
v_mfma_f32_16x16x32_bf16 a[120:123], a[36:39], v[184:187], a[120:123]
v_mfma_f32_16x16x32_bf16 a[124:127], a[36:39], v[188:191], a[124:127]
v_mfma_f32_16x16x32_bf16 a[136:139], a[40:43], v[184:187], a[136:139]
v_mfma_f32_16x16x32_bf16 a[140:143], a[40:43], v[188:191], a[140:143]
v_mfma_f32_16x16x32_bf16 a[152:155], a[44:47], v[184:187], a[152:155]
s_waitcnt vmcnt(27)
v_swap_b32 v194, v196
v_mfma_f32_16x16x32_bf16 a[156:159], a[44:47], v[188:191], a[156:159]
v_swap_b32 v195, v197
v_mfma_f32_16x16x32_bf16 a[168:171], a[48:51], v[184:187], a[168:171]
v_swap_b32 v202, v204
v_mfma_f32_16x16x32_bf16 a[172:175], a[48:51], v[188:191], a[172:175]
v_swap_b32 v203, v205
v_mfma_f32_16x16x32_bf16 a[184:187], a[52:55], v[184:187], a[184:187]
v_mfma_f32_16x16x32_bf16 a[188:191], a[52:55], v[188:191], a[188:191]
s_waitcnt lgkmcnt(0)
v_mfma_f32_16x16x32_bf16 v[32:35], a[56:59], v[192:195], v[32:35]
v_mfma_f32_16x16x32_bf16 v[36:39], a[56:59], v[196:199], v[36:39]
v_mfma_f32_16x16x32_bf16 v[48:51], a[60:63], v[192:195], v[48:51]
s_waitcnt vmcnt(36) lgkmcnt(0)
s_barrier
v_mfma_f32_16x16x32_bf16 v[52:55], a[60:63], v[196:199], v[52:55]
ds_read_b64_tr_b16 a[0:1], v12 offset:28672
v_mfma_f32_16x16x32_bf16 v[64:67], a[64:67], v[192:195], v[64:67]
ds_read_b64_tr_b16 a[2:3], v12 offset:30464
v_mfma_f32_16x16x32_bf16 v[68:71], a[64:67], v[196:199], v[68:71]
buffer_load_dwordx4 v[176:179], v2, s[4:7], s20 offen offset:2048 sc1
v_mfma_f32_16x16x32_bf16 v[80:83], a[68:71], v[192:195], v[80:83]
ds_read_b64_tr_b16 a[4:5], v12 offset:43008
v_mfma_f32_16x16x32_bf16 v[84:87], a[68:71], v[196:199], v[84:87]
ds_read_b64_tr_b16 a[6:7], v12 offset:44800
v_mfma_f32_16x16x32_bf16 v[96:99], a[72:75], v[192:195], v[96:99]
v_mfma_f32_16x16x32_bf16 v[100:103], a[72:75], v[196:199], v[100:103]
ds_read_b64_tr_b16 a[8:9], v12 offset:28704
v_mfma_f32_16x16x32_bf16 v[112:115], a[76:79], v[192:195], v[112:115]
ds_read_b64_tr_b16 a[10:11], v12 offset:30496
v_mfma_f32_16x16x32_bf16 v[116:119], a[76:79], v[196:199], v[116:119]
buffer_load_dwordx4 v[180:183], v2, s[4:7], s20 offen offset:2560 sc1
v_mfma_f32_16x16x32_bf16 v[128:131], a[80:83], v[192:195], v[128:131]
ds_read_b64_tr_b16 a[12:13], v12 offset:43040
v_mfma_f32_16x16x32_bf16 v[132:135], a[80:83], v[196:199], v[132:135]
ds_read_b64_tr_b16 a[14:15], v12 offset:44832
v_mfma_f32_16x16x32_bf16 v[144:147], a[84:87], v[192:195], v[144:147]
v_mfma_f32_16x16x32_bf16 v[148:151], a[84:87], v[196:199], v[148:151]
ds_read_b64_tr_b16 a[16:17], v12 offset:28736
v_mfma_f32_16x16x32_bf16 v[160:163], a[88:91], v[192:195], v[160:163]
ds_read_b64_tr_b16 a[18:19], v12 offset:30528
v_mfma_f32_16x16x32_bf16 v[164:167], a[88:91], v[196:199], v[164:167]
buffer_load_dwordx4 v[184:187], v3, s[4:7], s20 offen offset:2048 sc1
v_mfma_f32_16x16x32_bf16 a[112:115], a[92:95], v[192:195], a[112:115]
ds_read_b64_tr_b16 a[20:21], v12 offset:43072
v_mfma_f32_16x16x32_bf16 a[116:119], a[92:95], v[196:199], a[116:119]
ds_read_b64_tr_b16 a[22:23], v12 offset:44864
v_mfma_f32_16x16x32_bf16 a[128:131], a[96:99], v[192:195], a[128:131]
v_mfma_f32_16x16x32_bf16 a[132:135], a[96:99], v[196:199], a[132:135]
ds_read_b64_tr_b16 a[24:25], v12 offset:28768
v_mfma_f32_16x16x32_bf16 a[144:147], a[100:103], v[192:195], a[144:147]
ds_read_b64_tr_b16 a[26:27], v12 offset:30560
v_mfma_f32_16x16x32_bf16 a[148:151], a[100:103], v[196:199], a[148:151]
buffer_load_dwordx4 v[188:191], v3, s[4:7], s20 offen offset:2560 sc1
v_mfma_f32_16x16x32_bf16 a[160:163], a[104:107], v[192:195], a[160:163]
ds_read_b64_tr_b16 a[28:29], v12 offset:43104
s_add_u32 s20, s20, 4096
v_mfma_f32_16x16x32_bf16 a[164:167], a[104:107], v[196:199], a[164:167]
ds_read_b64_tr_b16 a[30:31], v12 offset:44896
s_and_b32 s20, s20, 0xffff
v_mfma_f32_16x16x32_bf16 a[176:179], a[108:111], v[192:195], a[176:179]
v_mfma_f32_16x16x32_bf16 a[180:183], a[108:111], v[196:199], a[180:183]
ds_read_b64_tr_b16 a[32:33], v12 offset:28800
v_mfma_f32_16x16x32_bf16 v[40:43], a[56:59], v[200:203], v[40:43]
ds_read_b64_tr_b16 a[34:35], v12 offset:30592
s_add_u32 m0, s40, 57344
v_mfma_f32_16x16x32_bf16 v[44:47], a[56:59], v[204:207], v[44:47]
buffer_load_dwordx4 v4, s[8:11], s21 offen offset:0 lds
v_mfma_f32_16x16x32_bf16 v[56:59], a[60:63], v[200:203], v[56:59]
ds_read_b64_tr_b16 a[36:37], v12 offset:43136
v_mfma_f32_16x16x32_bf16 v[60:63], a[60:63], v[204:207], v[60:63]
ds_read_b64_tr_b16 a[38:39], v12 offset:44928
v_mfma_f32_16x16x32_bf16 v[72:75], a[64:67], v[200:203], v[72:75]
v_mfma_f32_16x16x32_bf16 v[76:79], a[64:67], v[204:207], v[76:79]
ds_read_b64_tr_b16 a[40:41], v12 offset:28832
v_mfma_f32_16x16x32_bf16 v[88:91], a[68:71], v[200:203], v[88:91]
ds_read_b64_tr_b16 a[42:43], v12 offset:30624
v_mfma_f32_16x16x32_bf16 v[92:95], a[68:71], v[204:207], v[92:95]
buffer_load_dwordx4 v5, s[8:11], s21 offen offset:1024 lds
v_mfma_f32_16x16x32_bf16 v[104:107], a[72:75], v[200:203], v[104:107]
ds_read_b64_tr_b16 a[44:45], v12 offset:43168
v_mfma_f32_16x16x32_bf16 v[108:111], a[72:75], v[204:207], v[108:111]
ds_read_b64_tr_b16 a[46:47], v12 offset:44960
v_mfma_f32_16x16x32_bf16 v[120:123], a[76:79], v[200:203], v[120:123]
v_mfma_f32_16x16x32_bf16 v[124:127], a[76:79], v[204:207], v[124:127]
ds_read_b64_tr_b16 a[48:49], v12 offset:28864
v_mfma_f32_16x16x32_bf16 v[136:139], a[80:83], v[200:203], v[136:139]
ds_read_b64_tr_b16 a[50:51], v12 offset:30656
v_mfma_f32_16x16x32_bf16 v[140:143], a[80:83], v[204:207], v[140:143]
buffer_load_dwordx4 v6, s[8:11], s21 offen offset:2048 lds
v_mfma_f32_16x16x32_bf16 v[152:155], a[84:87], v[200:203], v[152:155]
ds_read_b64_tr_b16 a[52:53], v12 offset:43200
v_mfma_f32_16x16x32_bf16 v[156:159], a[84:87], v[204:207], v[156:159]
ds_read_b64_tr_b16 a[54:55], v12 offset:44992
v_mfma_f32_16x16x32_bf16 v[168:171], a[88:91], v[200:203], v[168:171]
v_mfma_f32_16x16x32_bf16 v[172:175], a[88:91], v[204:207], v[172:175]
v_mfma_f32_16x16x32_bf16 a[120:123], a[92:95], v[200:203], a[120:123]
buffer_load_dwordx4 v7, s[8:11], s21 offen offset:3072 lds
v_mfma_f32_16x16x32_bf16 a[124:127], a[92:95], v[204:207], a[124:127]
buffer_load_dword a192, v1, s[52:55], s58 offen
s_add_u32 s58, s58, 1024
v_mfma_f32_16x16x32_bf16 a[136:139], a[96:99], v[200:203], a[136:139]
v_mfma_f32_16x16x32_bf16 a[140:143], a[96:99], v[204:207], a[140:143]
v_mfma_f32_16x16x32_bf16 a[152:155], a[100:103], v[200:203], a[152:155]
s_waitcnt vmcnt(25)
v_swap_b32 v210, v212
v_mfma_f32_16x16x32_bf16 a[156:159], a[100:103], v[204:207], a[156:159]
v_swap_b32 v211, v213
v_mfma_f32_16x16x32_bf16 a[168:171], a[104:107], v[200:203], a[168:171]
v_swap_b32 v218, v220
v_mfma_f32_16x16x32_bf16 a[172:175], a[104:107], v[204:207], a[172:175]
v_swap_b32 v219, v221
v_mfma_f32_16x16x32_bf16 a[184:187], a[108:111], v[200:203], a[184:187]
v_mfma_f32_16x16x32_bf16 a[188:191], a[108:111], v[204:207], a[188:191]
s_waitcnt lgkmcnt(0)
v_mfma_f32_16x16x32_bf16 v[32:35], a[0:3], v[208:211], v[32:35]
v_mfma_f32_16x16x32_bf16 v[36:39], a[0:3], v[212:215], v[36:39]
v_mfma_f32_16x16x32_bf16 v[48:51], a[4:7], v[208:211], v[48:51]
v_mfma_f32_16x16x32_bf16 v[52:55], a[4:7], v[212:215], v[52:55]
ds_read_b64_tr_b16 a[56:57], v12 offset:35840
v_mfma_f32_16x16x32_bf16 v[64:67], a[8:11], v[208:211], v[64:67]
ds_read_b64_tr_b16 a[58:59], v12 offset:37632
s_add_u32 m0, s40, 61440
v_mfma_f32_16x16x32_bf16 v[68:71], a[8:11], v[212:215], v[68:71]
buffer_load_dwordx4 v8, s[8:11], s21 offen offset:0 lds
v_mfma_f32_16x16x32_bf16 v[80:83], a[12:15], v[208:211], v[80:83]
ds_read_b64_tr_b16 a[60:61], v12 offset:50176
v_mfma_f32_16x16x32_bf16 v[84:87], a[12:15], v[212:215], v[84:87]
ds_read_b64_tr_b16 a[62:63], v12 offset:51968
v_mfma_f32_16x16x32_bf16 v[96:99], a[16:19], v[208:211], v[96:99]
v_mfma_f32_16x16x32_bf16 v[100:103], a[16:19], v[212:215], v[100:103]
ds_read_b64_tr_b16 a[64:65], v12 offset:35872
v_mfma_f32_16x16x32_bf16 v[112:115], a[20:23], v[208:211], v[112:115]
ds_read_b64_tr_b16 a[66:67], v12 offset:37664
v_mfma_f32_16x16x32_bf16 v[116:119], a[20:23], v[212:215], v[116:119]
buffer_load_dwordx4 v9, s[8:11], s21 offen offset:1024 lds
v_mfma_f32_16x16x32_bf16 v[128:131], a[24:27], v[208:211], v[128:131]
ds_read_b64_tr_b16 a[68:69], v12 offset:50208
v_mfma_f32_16x16x32_bf16 v[132:135], a[24:27], v[212:215], v[132:135]
ds_read_b64_tr_b16 a[70:71], v12 offset:52000
v_mfma_f32_16x16x32_bf16 v[144:147], a[28:31], v[208:211], v[144:147]
v_mfma_f32_16x16x32_bf16 v[148:151], a[28:31], v[212:215], v[148:151]
ds_read_b64_tr_b16 a[72:73], v12 offset:35904
v_mfma_f32_16x16x32_bf16 v[160:163], a[32:35], v[208:211], v[160:163]
ds_read_b64_tr_b16 a[74:75], v12 offset:37696
v_mfma_f32_16x16x32_bf16 v[164:167], a[32:35], v[212:215], v[164:167]
buffer_load_dwordx4 v10, s[8:11], s21 offen offset:2048 lds
v_mfma_f32_16x16x32_bf16 a[112:115], a[36:39], v[208:211], a[112:115]
ds_read_b64_tr_b16 a[76:77], v12 offset:50240
s_add_u32 s22, s22, 1
v_mfma_f32_16x16x32_bf16 a[116:119], a[36:39], v[212:215], a[116:119]
ds_read_b64_tr_b16 a[78:79], v12 offset:52032
s_and_b32 s22, s22, 15
v_mfma_f32_16x16x32_bf16 a[128:131], a[40:43], v[208:211], a[128:131]
s_mul_i32 s21, s22, 458752
v_mfma_f32_16x16x32_bf16 a[132:135], a[40:43], v[212:215], a[132:135]
ds_read_b64_tr_b16 a[80:81], v12 offset:35936
v_mfma_f32_16x16x32_bf16 a[144:147], a[44:47], v[208:211], a[144:147]
ds_read_b64_tr_b16 a[82:83], v12 offset:37728
v_mfma_f32_16x16x32_bf16 a[148:151], a[44:47], v[212:215], a[148:151]
buffer_load_dwordx4 v[192:195], v2, s[4:7], s20 offen offset:0 sc1
v_mfma_f32_16x16x32_bf16 a[160:163], a[48:51], v[208:211], a[160:163]
ds_read_b64_tr_b16 a[84:85], v12 offset:50272
v_mfma_f32_16x16x32_bf16 a[164:167], a[48:51], v[212:215], a[164:167]
ds_read_b64_tr_b16 a[86:87], v12 offset:52064
v_mfma_f32_16x16x32_bf16 a[176:179], a[52:55], v[208:211], a[176:179]
v_mfma_f32_16x16x32_bf16 a[180:183], a[52:55], v[212:215], a[180:183]
ds_read_b64_tr_b16 a[88:89], v12 offset:35968
v_mfma_f32_16x16x32_bf16 v[40:43], a[0:3], v[216:219], v[40:43]
ds_read_b64_tr_b16 a[90:91], v12 offset:37760
v_mfma_f32_16x16x32_bf16 v[44:47], a[0:3], v[220:223], v[44:47]
buffer_load_dwordx4 v[196:199], v2, s[4:7], s20 offen offset:512 sc1
v_mfma_f32_16x16x32_bf16 v[56:59], a[4:7], v[216:219], v[56:59]
ds_read_b64_tr_b16 a[92:93], v12 offset:50304
v_mfma_f32_16x16x32_bf16 v[60:63], a[4:7], v[220:223], v[60:63]
ds_read_b64_tr_b16 a[94:95], v12 offset:52096
v_mfma_f32_16x16x32_bf16 v[72:75], a[8:11], v[216:219], v[72:75]
v_mfma_f32_16x16x32_bf16 v[76:79], a[8:11], v[220:223], v[76:79]
ds_read_b64_tr_b16 a[96:97], v12 offset:36000
v_mfma_f32_16x16x32_bf16 v[88:91], a[12:15], v[216:219], v[88:91]
ds_read_b64_tr_b16 a[98:99], v12 offset:37792
v_mfma_f32_16x16x32_bf16 v[92:95], a[12:15], v[220:223], v[92:95]
buffer_load_dwordx4 v[200:203], v3, s[4:7], s20 offen offset:0 sc1
v_mfma_f32_16x16x32_bf16 v[104:107], a[16:19], v[216:219], v[104:107]
ds_read_b64_tr_b16 a[100:101], v12 offset:50336
v_mfma_f32_16x16x32_bf16 v[108:111], a[16:19], v[220:223], v[108:111]
ds_read_b64_tr_b16 a[102:103], v12 offset:52128
v_mfma_f32_16x16x32_bf16 v[120:123], a[20:23], v[216:219], v[120:123]
v_mfma_f32_16x16x32_bf16 v[124:127], a[20:23], v[220:223], v[124:127]
ds_read_b64_tr_b16 a[104:105], v12 offset:36032
v_mfma_f32_16x16x32_bf16 v[136:139], a[24:27], v[216:219], v[136:139]
ds_read_b64_tr_b16 a[106:107], v12 offset:37824
v_mfma_f32_16x16x32_bf16 v[140:143], a[24:27], v[220:223], v[140:143]
buffer_load_dwordx4 v[204:207], v3, s[4:7], s20 offen offset:512 sc1
v_mfma_f32_16x16x32_bf16 v[152:155], a[28:31], v[216:219], v[152:155]
ds_read_b64_tr_b16 a[108:109], v12 offset:50368
v_mfma_f32_16x16x32_bf16 v[156:159], a[28:31], v[220:223], v[156:159]
ds_read_b64_tr_b16 a[110:111], v12 offset:52160
v_mfma_f32_16x16x32_bf16 v[168:171], a[32:35], v[216:219], v[168:171]
v_mfma_f32_16x16x32_bf16 v[172:175], a[32:35], v[220:223], v[172:175]
v_mfma_f32_16x16x32_bf16 a[120:123], a[36:39], v[216:219], a[120:123]
v_mfma_f32_16x16x32_bf16 a[124:127], a[36:39], v[220:223], a[124:127]
buffer_load_dword a192, v1, s[52:55], s58 offen
s_add_u32 s58, s58, 1024
v_mfma_f32_16x16x32_bf16 a[136:139], a[40:43], v[216:219], a[136:139]
v_mfma_f32_16x16x32_bf16 a[140:143], a[40:43], v[220:223], a[140:143]
v_mfma_f32_16x16x32_bf16 a[152:155], a[44:47], v[216:219], a[152:155]
s_waitcnt vmcnt(29)
v_swap_b32 v226, v228
v_mfma_f32_16x16x32_bf16 a[156:159], a[44:47], v[220:223], a[156:159]
v_swap_b32 v227, v229
v_mfma_f32_16x16x32_bf16 a[168:171], a[48:51], v[216:219], a[168:171]
v_swap_b32 v234, v236
v_mfma_f32_16x16x32_bf16 a[172:175], a[48:51], v[220:223], a[172:175]
v_swap_b32 v235, v237
v_mfma_f32_16x16x32_bf16 a[184:187], a[52:55], v[216:219], a[184:187]
v_mfma_f32_16x16x32_bf16 a[188:191], a[52:55], v[220:223], a[188:191]
s_waitcnt lgkmcnt(0)
v_mfma_f32_16x16x32_bf16 v[32:35], a[56:59], v[224:227], v[32:35]
v_mfma_f32_16x16x32_bf16 v[36:39], a[56:59], v[228:231], v[36:39]
v_mfma_f32_16x16x32_bf16 v[48:51], a[60:63], v[224:227], v[48:51]
s_waitcnt vmcnt(37) lgkmcnt(0)
s_barrier
v_mfma_f32_16x16x32_bf16 v[52:55], a[60:63], v[228:231], v[52:55]
ds_read_b64_tr_b16 a[0:1], v11 offset:0
v_mfma_f32_16x16x32_bf16 v[64:67], a[64:67], v[224:227], v[64:67]
ds_read_b64_tr_b16 a[2:3], v11 offset:1792
v_mfma_f32_16x16x32_bf16 v[68:71], a[64:67], v[228:231], v[68:71]
buffer_load_dwordx4 v[208:211], v2, s[4:7], s20 offen offset:2048 sc1
v_mfma_f32_16x16x32_bf16 v[80:83], a[68:71], v[224:227], v[80:83]
ds_read_b64_tr_b16 a[4:5], v11 offset:14336
v_mfma_f32_16x16x32_bf16 v[84:87], a[68:71], v[228:231], v[84:87]
ds_read_b64_tr_b16 a[6:7], v11 offset:16128
v_mfma_f32_16x16x32_bf16 v[96:99], a[72:75], v[224:227], v[96:99]
v_mfma_f32_16x16x32_bf16 v[100:103], a[72:75], v[228:231], v[100:103]
ds_read_b64_tr_b16 a[8:9], v11 offset:32
v_mfma_f32_16x16x32_bf16 v[112:115], a[76:79], v[224:227], v[112:115]
ds_read_b64_tr_b16 a[10:11], v11 offset:1824
v_mfma_f32_16x16x32_bf16 v[116:119], a[76:79], v[228:231], v[116:119]
buffer_load_dwordx4 v[212:215], v2, s[4:7], s20 offen offset:2560 sc1
v_mfma_f32_16x16x32_bf16 v[128:131], a[80:83], v[224:227], v[128:131]
ds_read_b64_tr_b16 a[12:13], v11 offset:14368
v_mfma_f32_16x16x32_bf16 v[132:135], a[80:83], v[228:231], v[132:135]
ds_read_b64_tr_b16 a[14:15], v11 offset:16160
v_mfma_f32_16x16x32_bf16 v[144:147], a[84:87], v[224:227], v[144:147]
v_mfma_f32_16x16x32_bf16 v[148:151], a[84:87], v[228:231], v[148:151]
ds_read_b64_tr_b16 a[16:17], v11 offset:64
v_mfma_f32_16x16x32_bf16 v[160:163], a[88:91], v[224:227], v[160:163]
ds_read_b64_tr_b16 a[18:19], v11 offset:1856
v_mfma_f32_16x16x32_bf16 v[164:167], a[88:91], v[228:231], v[164:167]
buffer_load_dwordx4 v[216:219], v3, s[4:7], s20 offen offset:2048 sc1
v_mfma_f32_16x16x32_bf16 a[112:115], a[92:95], v[224:227], a[112:115]
ds_read_b64_tr_b16 a[20:21], v11 offset:14400
v_mfma_f32_16x16x32_bf16 a[116:119], a[92:95], v[228:231], a[116:119]
ds_read_b64_tr_b16 a[22:23], v11 offset:16192
v_mfma_f32_16x16x32_bf16 a[128:131], a[96:99], v[224:227], a[128:131]
v_mfma_f32_16x16x32_bf16 a[132:135], a[96:99], v[228:231], a[132:135]
ds_read_b64_tr_b16 a[24:25], v11 offset:96
v_mfma_f32_16x16x32_bf16 a[144:147], a[100:103], v[224:227], a[144:147]
ds_read_b64_tr_b16 a[26:27], v11 offset:1888
v_mfma_f32_16x16x32_bf16 a[148:151], a[100:103], v[228:231], a[148:151]
buffer_load_dwordx4 v[220:223], v3, s[4:7], s20 offen offset:2560 sc1
v_mfma_f32_16x16x32_bf16 a[160:163], a[104:107], v[224:227], a[160:163]
ds_read_b64_tr_b16 a[28:29], v11 offset:14432
s_add_u32 s20, s20, 4096
v_mfma_f32_16x16x32_bf16 a[164:167], a[104:107], v[228:231], a[164:167]
ds_read_b64_tr_b16 a[30:31], v11 offset:16224
s_and_b32 s20, s20, 0xffff
v_mfma_f32_16x16x32_bf16 a[176:179], a[108:111], v[224:227], a[176:179]
v_mfma_f32_16x16x32_bf16 a[180:183], a[108:111], v[228:231], a[180:183]
ds_read_b64_tr_b16 a[32:33], v11 offset:128
v_mfma_f32_16x16x32_bf16 v[40:43], a[56:59], v[232:235], v[40:43]
ds_read_b64_tr_b16 a[34:35], v11 offset:1920
s_add_u32 m0, s40, 86016
v_mfma_f32_16x16x32_bf16 v[44:47], a[56:59], v[236:239], v[44:47]
buffer_load_dwordx4 v4, s[8:11], s21 offen offset:0 lds
v_mfma_f32_16x16x32_bf16 v[56:59], a[60:63], v[232:235], v[56:59]
ds_read_b64_tr_b16 a[36:37], v11 offset:14464
v_mfma_f32_16x16x32_bf16 v[60:63], a[60:63], v[236:239], v[60:63]
ds_read_b64_tr_b16 a[38:39], v11 offset:16256
v_mfma_f32_16x16x32_bf16 v[72:75], a[64:67], v[232:235], v[72:75]
v_mfma_f32_16x16x32_bf16 v[76:79], a[64:67], v[236:239], v[76:79]
ds_read_b64_tr_b16 a[40:41], v11 offset:160
v_mfma_f32_16x16x32_bf16 v[88:91], a[68:71], v[232:235], v[88:91]
ds_read_b64_tr_b16 a[42:43], v11 offset:1952
v_mfma_f32_16x16x32_bf16 v[92:95], a[68:71], v[236:239], v[92:95]
buffer_load_dwordx4 v5, s[8:11], s21 offen offset:1024 lds
v_mfma_f32_16x16x32_bf16 v[104:107], a[72:75], v[232:235], v[104:107]
ds_read_b64_tr_b16 a[44:45], v11 offset:14496
v_mfma_f32_16x16x32_bf16 v[108:111], a[72:75], v[236:239], v[108:111]
ds_read_b64_tr_b16 a[46:47], v11 offset:16288
v_mfma_f32_16x16x32_bf16 v[120:123], a[76:79], v[232:235], v[120:123]
v_mfma_f32_16x16x32_bf16 v[124:127], a[76:79], v[236:239], v[124:127]
ds_read_b64_tr_b16 a[48:49], v11 offset:192
v_mfma_f32_16x16x32_bf16 v[136:139], a[80:83], v[232:235], v[136:139]
ds_read_b64_tr_b16 a[50:51], v11 offset:1984
v_mfma_f32_16x16x32_bf16 v[140:143], a[80:83], v[236:239], v[140:143]
buffer_load_dwordx4 v6, s[8:11], s21 offen offset:2048 lds
v_mfma_f32_16x16x32_bf16 v[152:155], a[84:87], v[232:235], v[152:155]
ds_read_b64_tr_b16 a[52:53], v11 offset:14528
v_mfma_f32_16x16x32_bf16 v[156:159], a[84:87], v[236:239], v[156:159]
ds_read_b64_tr_b16 a[54:55], v11 offset:16320
v_mfma_f32_16x16x32_bf16 v[168:171], a[88:91], v[232:235], v[168:171]
v_mfma_f32_16x16x32_bf16 v[172:175], a[88:91], v[236:239], v[172:175]
v_mfma_f32_16x16x32_bf16 a[120:123], a[92:95], v[232:235], a[120:123]
buffer_load_dwordx4 v7, s[8:11], s21 offen offset:3072 lds
v_mfma_f32_16x16x32_bf16 a[124:127], a[92:95], v[236:239], a[124:127]
buffer_load_dword a192, v1, s[52:55], s58 offen
s_add_u32 s58, s58, 1024
v_mfma_f32_16x16x32_bf16 a[136:139], a[96:99], v[232:235], a[136:139]
v_mfma_f32_16x16x32_bf16 a[140:143], a[96:99], v[236:239], a[140:143]
v_mfma_f32_16x16x32_bf16 a[152:155], a[100:103], v[232:235], a[152:155]
s_waitcnt vmcnt(26)
v_swap_b32 v242, v244
v_mfma_f32_16x16x32_bf16 a[156:159], a[100:103], v[236:239], a[156:159]
v_swap_b32 v243, v245
v_mfma_f32_16x16x32_bf16 a[168:171], a[104:107], v[232:235], a[168:171]
v_swap_b32 v250, v252
v_mfma_f32_16x16x32_bf16 a[172:175], a[104:107], v[236:239], a[172:175]
v_swap_b32 v251, v253
v_mfma_f32_16x16x32_bf16 a[184:187], a[108:111], v[232:235], a[184:187]
v_mfma_f32_16x16x32_bf16 a[188:191], a[108:111], v[236:239], a[188:191]
s_waitcnt lgkmcnt(0)
v_mfma_f32_16x16x32_bf16 v[32:35], a[0:3], v[240:243], v[32:35]
v_mfma_f32_16x16x32_bf16 v[36:39], a[0:3], v[244:247], v[36:39]
v_mfma_f32_16x16x32_bf16 v[48:51], a[4:7], v[240:243], v[48:51]
v_mfma_f32_16x16x32_bf16 v[52:55], a[4:7], v[244:247], v[52:55]
ds_read_b64_tr_b16 a[56:57], v11 offset:7168
v_mfma_f32_16x16x32_bf16 v[64:67], a[8:11], v[240:243], v[64:67]
ds_read_b64_tr_b16 a[58:59], v11 offset:8960
s_add_u32 m0, s40, 90112
v_mfma_f32_16x16x32_bf16 v[68:71], a[8:11], v[244:247], v[68:71]
buffer_load_dwordx4 v8, s[8:11], s21 offen offset:0 lds
v_mfma_f32_16x16x32_bf16 v[80:83], a[12:15], v[240:243], v[80:83]
ds_read_b64_tr_b16 a[60:61], v11 offset:21504
v_mfma_f32_16x16x32_bf16 v[84:87], a[12:15], v[244:247], v[84:87]
ds_read_b64_tr_b16 a[62:63], v11 offset:23296
v_mfma_f32_16x16x32_bf16 v[96:99], a[16:19], v[240:243], v[96:99]
v_mfma_f32_16x16x32_bf16 v[100:103], a[16:19], v[244:247], v[100:103]
ds_read_b64_tr_b16 a[64:65], v11 offset:7200
v_mfma_f32_16x16x32_bf16 v[112:115], a[20:23], v[240:243], v[112:115]
ds_read_b64_tr_b16 a[66:67], v11 offset:8992
v_mfma_f32_16x16x32_bf16 v[116:119], a[20:23], v[244:247], v[116:119]
buffer_load_dwordx4 v9, s[8:11], s21 offen offset:1024 lds
v_mfma_f32_16x16x32_bf16 v[128:131], a[24:27], v[240:243], v[128:131]
ds_read_b64_tr_b16 a[68:69], v11 offset:21536
v_mfma_f32_16x16x32_bf16 v[132:135], a[24:27], v[244:247], v[132:135]
ds_read_b64_tr_b16 a[70:71], v11 offset:23328
v_mfma_f32_16x16x32_bf16 v[144:147], a[28:31], v[240:243], v[144:147]
v_mfma_f32_16x16x32_bf16 v[148:151], a[28:31], v[244:247], v[148:151]
ds_read_b64_tr_b16 a[72:73], v11 offset:7232
v_mfma_f32_16x16x32_bf16 v[160:163], a[32:35], v[240:243], v[160:163]
ds_read_b64_tr_b16 a[74:75], v11 offset:9024
v_mfma_f32_16x16x32_bf16 v[164:167], a[32:35], v[244:247], v[164:167]
buffer_load_dwordx4 v10, s[8:11], s21 offen offset:2048 lds
v_mfma_f32_16x16x32_bf16 a[112:115], a[36:39], v[240:243], a[112:115]
ds_read_b64_tr_b16 a[76:77], v11 offset:21568
s_add_u32 s22, s22, 1
v_mfma_f32_16x16x32_bf16 a[116:119], a[36:39], v[244:247], a[116:119]
ds_read_b64_tr_b16 a[78:79], v11 offset:23360
s_and_b32 s22, s22, 15
v_mfma_f32_16x16x32_bf16 a[128:131], a[40:43], v[240:243], a[128:131]
s_mul_i32 s21, s22, 458752
v_mfma_f32_16x16x32_bf16 a[132:135], a[40:43], v[244:247], a[132:135]
ds_read_b64_tr_b16 a[80:81], v11 offset:7264
v_mfma_f32_16x16x32_bf16 a[144:147], a[44:47], v[240:243], a[144:147]
ds_read_b64_tr_b16 a[82:83], v11 offset:9056
v_mfma_f32_16x16x32_bf16 a[148:151], a[44:47], v[244:247], a[148:151]
buffer_load_dwordx4 v[224:227], v2, s[4:7], s20 offen offset:0 sc1
v_mfma_f32_16x16x32_bf16 a[160:163], a[48:51], v[240:243], a[160:163]
ds_read_b64_tr_b16 a[84:85], v11 offset:21600
v_mfma_f32_16x16x32_bf16 a[164:167], a[48:51], v[244:247], a[164:167]
ds_read_b64_tr_b16 a[86:87], v11 offset:23392
v_mfma_f32_16x16x32_bf16 a[176:179], a[52:55], v[240:243], a[176:179]
v_mfma_f32_16x16x32_bf16 a[180:183], a[52:55], v[244:247], a[180:183]
ds_read_b64_tr_b16 a[88:89], v11 offset:7296
v_mfma_f32_16x16x32_bf16 v[40:43], a[0:3], v[248:251], v[40:43]
ds_read_b64_tr_b16 a[90:91], v11 offset:9088
v_mfma_f32_16x16x32_bf16 v[44:47], a[0:3], v[252:255], v[44:47]
buffer_load_dwordx4 v[228:231], v2, s[4:7], s20 offen offset:512 sc1
v_mfma_f32_16x16x32_bf16 v[56:59], a[4:7], v[248:251], v[56:59]
ds_read_b64_tr_b16 a[92:93], v11 offset:21632
v_mfma_f32_16x16x32_bf16 v[60:63], a[4:7], v[252:255], v[60:63]
ds_read_b64_tr_b16 a[94:95], v11 offset:23424
v_mfma_f32_16x16x32_bf16 v[72:75], a[8:11], v[248:251], v[72:75]
v_mfma_f32_16x16x32_bf16 v[76:79], a[8:11], v[252:255], v[76:79]
ds_read_b64_tr_b16 a[96:97], v11 offset:7328
v_mfma_f32_16x16x32_bf16 v[88:91], a[12:15], v[248:251], v[88:91]
ds_read_b64_tr_b16 a[98:99], v11 offset:9120
v_mfma_f32_16x16x32_bf16 v[92:95], a[12:15], v[252:255], v[92:95]
buffer_load_dwordx4 v[232:235], v3, s[4:7], s20 offen offset:0 sc1
v_mfma_f32_16x16x32_bf16 v[104:107], a[16:19], v[248:251], v[104:107]
ds_read_b64_tr_b16 a[100:101], v11 offset:21664
v_mfma_f32_16x16x32_bf16 v[108:111], a[16:19], v[252:255], v[108:111]
ds_read_b64_tr_b16 a[102:103], v11 offset:23456
v_mfma_f32_16x16x32_bf16 v[120:123], a[20:23], v[248:251], v[120:123]
v_mfma_f32_16x16x32_bf16 v[124:127], a[20:23], v[252:255], v[124:127]
ds_read_b64_tr_b16 a[104:105], v11 offset:7360
v_mfma_f32_16x16x32_bf16 v[136:139], a[24:27], v[248:251], v[136:139]
ds_read_b64_tr_b16 a[106:107], v11 offset:9152
v_mfma_f32_16x16x32_bf16 v[140:143], a[24:27], v[252:255], v[140:143]
buffer_load_dwordx4 v[236:239], v3, s[4:7], s20 offen offset:512 sc1
v_mfma_f32_16x16x32_bf16 v[152:155], a[28:31], v[248:251], v[152:155]
ds_read_b64_tr_b16 a[108:109], v11 offset:21696
v_mfma_f32_16x16x32_bf16 v[156:159], a[28:31], v[252:255], v[156:159]
ds_read_b64_tr_b16 a[110:111], v11 offset:23488
v_mfma_f32_16x16x32_bf16 v[168:171], a[32:35], v[248:251], v[168:171]
v_mfma_f32_16x16x32_bf16 v[172:175], a[32:35], v[252:255], v[172:175]
v_mfma_f32_16x16x32_bf16 a[120:123], a[36:39], v[248:251], a[120:123]
v_mfma_f32_16x16x32_bf16 a[124:127], a[36:39], v[252:255], a[124:127]
buffer_load_dword a192, v1, s[52:55], s58 offen
s_add_u32 s58, s58, 1024
v_mfma_f32_16x16x32_bf16 a[136:139], a[40:43], v[248:251], a[136:139]
v_mfma_f32_16x16x32_bf16 a[140:143], a[40:43], v[252:255], a[140:143]
v_mfma_f32_16x16x32_bf16 a[152:155], a[44:47], v[248:251], a[152:155]
s_waitcnt vmcnt(30)
v_swap_b32 v178, v180
v_mfma_f32_16x16x32_bf16 a[156:159], a[44:47], v[252:255], a[156:159]
v_swap_b32 v179, v181
v_mfma_f32_16x16x32_bf16 a[168:171], a[48:51], v[248:251], a[168:171]
v_swap_b32 v186, v188
v_mfma_f32_16x16x32_bf16 a[172:175], a[48:51], v[252:255], a[172:175]
v_swap_b32 v187, v189
v_mfma_f32_16x16x32_bf16 a[184:187], a[52:55], v[248:251], a[184:187]
v_mfma_f32_16x16x32_bf16 a[188:191], a[52:55], v[252:255], a[188:191]
s_waitcnt lgkmcnt(0)
v_mfma_f32_16x16x32_bf16 v[32:35], a[56:59], v[176:179], v[32:35]
v_mfma_f32_16x16x32_bf16 v[36:39], a[56:59], v[180:183], v[36:39]
v_mfma_f32_16x16x32_bf16 v[48:51], a[60:63], v[176:179], v[48:51]
s_waitcnt vmcnt(38) lgkmcnt(0)
s_barrier
v_mfma_f32_16x16x32_bf16 v[52:55], a[60:63], v[180:183], v[52:55]
ds_read_b64_tr_b16 a[0:1], v11 offset:28672
v_mfma_f32_16x16x32_bf16 v[64:67], a[64:67], v[176:179], v[64:67]
ds_read_b64_tr_b16 a[2:3], v11 offset:30464
v_mfma_f32_16x16x32_bf16 v[68:71], a[64:67], v[180:183], v[68:71]
buffer_load_dwordx4 v[240:243], v2, s[4:7], s20 offen offset:2048 sc1
v_mfma_f32_16x16x32_bf16 v[80:83], a[68:71], v[176:179], v[80:83]
ds_read_b64_tr_b16 a[4:5], v11 offset:43008
v_mfma_f32_16x16x32_bf16 v[84:87], a[68:71], v[180:183], v[84:87]
ds_read_b64_tr_b16 a[6:7], v11 offset:44800
v_mfma_f32_16x16x32_bf16 v[96:99], a[72:75], v[176:179], v[96:99]
s_waitcnt vmcnt(41)
s_mov_b32 s57, 0
L_g1_poll:
v_cmp_eq_u32 vcc, 1, v23
s_cmp_eq_u64 vcc, -1
s_cbranch_scc1 L_g1_polled
s_add_u32 s57, s57, 1
s_cmp_gt_u32 s57, 20000
s_cbranch_scc1 L_g1_polled
s_sleep 1
buffer_load_dword v23, v22, s[16:19], 0 offen sc1
s_waitcnt vmcnt(0)
s_branch L_g1_poll
L_g1_polled:
v_mfma_f32_16x16x32_bf16 v[100:103], a[72:75], v[180:183], v[100:103]
ds_read_b64_tr_b16 a[8:9], v11 offset:28704
v_mfma_f32_16x16x32_bf16 v[112:115], a[76:79], v[176:179], v[112:115]
ds_read_b64_tr_b16 a[10:11], v11 offset:30496
v_mfma_f32_16x16x32_bf16 v[116:119], a[76:79], v[180:183], v[116:119]
buffer_load_dwordx4 v[244:247], v2, s[4:7], s20 offen offset:2560 sc1
v_mfma_f32_16x16x32_bf16 v[128:131], a[80:83], v[176:179], v[128:131]
ds_read_b64_tr_b16 a[12:13], v11 offset:43040
v_mfma_f32_16x16x32_bf16 v[132:135], a[80:83], v[180:183], v[132:135]
ds_read_b64_tr_b16 a[14:15], v11 offset:44832
v_mfma_f32_16x16x32_bf16 v[144:147], a[84:87], v[176:179], v[144:147]
s_add_u32 m0, s26, 131072
s_nop 0
buffer_load_dwordx4 v28, s[16:19], 0 offen sc1 lds
v_mfma_f32_16x16x32_bf16 v[148:151], a[84:87], v[180:183], v[148:151]
ds_read_b64_tr_b16 a[16:17], v11 offset:28736
v_mfma_f32_16x16x32_bf16 v[160:163], a[88:91], v[176:179], v[160:163]
ds_read_b64_tr_b16 a[18:19], v11 offset:30528
v_mfma_f32_16x16x32_bf16 v[164:167], a[88:91], v[180:183], v[164:167]
buffer_load_dwordx4 v[248:251], v3, s[4:7], s20 offen offset:2048 sc1
v_mfma_f32_16x16x32_bf16 a[112:115], a[92:95], v[176:179], a[112:115]
ds_read_b64_tr_b16 a[20:21], v11 offset:43072
v_mfma_f32_16x16x32_bf16 a[116:119], a[92:95], v[180:183], a[116:119]
ds_read_b64_tr_b16 a[22:23], v11 offset:44864
v_mfma_f32_16x16x32_bf16 a[128:131], a[96:99], v[176:179], a[128:131]
v_mfma_f32_16x16x32_bf16 a[132:135], a[96:99], v[180:183], a[132:135]
ds_read_b64_tr_b16 a[24:25], v11 offset:28768
v_mfma_f32_16x16x32_bf16 a[144:147], a[100:103], v[176:179], a[144:147]
ds_read_b64_tr_b16 a[26:27], v11 offset:30560
v_mfma_f32_16x16x32_bf16 a[148:151], a[100:103], v[180:183], a[148:151]
buffer_load_dwordx4 v[252:255], v3, s[4:7], s20 offen offset:2560 sc1
v_mfma_f32_16x16x32_bf16 a[160:163], a[104:107], v[176:179], a[160:163]
ds_read_b64_tr_b16 a[28:29], v11 offset:43104
s_add_u32 s20, s20, 4096
v_mfma_f32_16x16x32_bf16 a[164:167], a[104:107], v[180:183], a[164:167]
ds_read_b64_tr_b16 a[30:31], v11 offset:44896
s_and_b32 s20, s20, 0xffff
v_mfma_f32_16x16x32_bf16 a[176:179], a[108:111], v[176:179], a[176:179]
buffer_load_dword v4, v13, s[16:19], s41 offen offset:0 sc1
v_mfma_f32_16x16x32_bf16 a[180:183], a[108:111], v[180:183], a[180:183]
ds_read_b64_tr_b16 a[32:33], v11 offset:28800
v_mfma_f32_16x16x32_bf16 v[40:43], a[56:59], v[184:187], v[40:43]
ds_read_b64_tr_b16 a[34:35], v11 offset:30592
v_mfma_f32_16x16x32_bf16 v[44:47], a[56:59], v[188:191], v[44:47]
v_mfma_f32_16x16x32_bf16 v[56:59], a[60:63], v[184:187], v[56:59]
ds_read_b64_tr_b16 a[36:37], v11 offset:43136
v_mfma_f32_16x16x32_bf16 v[60:63], a[60:63], v[188:191], v[60:63]
ds_read_b64_tr_b16 a[38:39], v11 offset:44928
v_mfma_f32_16x16x32_bf16 v[72:75], a[64:67], v[184:187], v[72:75]
buffer_load_dword v6, v13, s[16:19], s42 offen offset:0 sc1
v_mfma_f32_16x16x32_bf16 v[76:79], a[64:67], v[188:191], v[76:79]
ds_read_b64_tr_b16 a[40:41], v11 offset:28832
v_mfma_f32_16x16x32_bf16 v[88:91], a[68:71], v[184:187], v[88:91]
ds_read_b64_tr_b16 a[42:43], v11 offset:30624
v_mfma_f32_16x16x32_bf16 v[92:95], a[68:71], v[188:191], v[92:95]
v_mfma_f32_16x16x32_bf16 v[104:107], a[72:75], v[184:187], v[104:107]
ds_read_b64_tr_b16 a[44:45], v11 offset:43168
v_mfma_f32_16x16x32_bf16 v[108:111], a[72:75], v[188:191], v[108:111]
ds_read_b64_tr_b16 a[46:47], v11 offset:44960
v_mfma_f32_16x16x32_bf16 v[120:123], a[76:79], v[184:187], v[120:123]
buffer_load_dword v8, v13, s[16:19], s41 offen offset:64 sc1
v_mfma_f32_16x16x32_bf16 v[124:127], a[76:79], v[188:191], v[124:127]
ds_read_b64_tr_b16 a[48:49], v11 offset:28864
v_mfma_f32_16x16x32_bf16 v[136:139], a[80:83], v[184:187], v[136:139]
ds_read_b64_tr_b16 a[50:51], v11 offset:30656
v_mfma_f32_16x16x32_bf16 v[140:143], a[80:83], v[188:191], v[140:143]
v_mfma_f32_16x16x32_bf16 v[152:155], a[84:87], v[184:187], v[152:155]
ds_read_b64_tr_b16 a[52:53], v11 offset:43200
v_mfma_f32_16x16x32_bf16 v[156:159], a[84:87], v[188:191], v[156:159]
ds_read_b64_tr_b16 a[54:55], v11 offset:44992
v_mfma_f32_16x16x32_bf16 v[168:171], a[88:91], v[184:187], v[168:171]
buffer_load_dword v10, v13, s[16:19], s42 offen offset:64 sc1
v_mfma_f32_16x16x32_bf16 v[172:175], a[88:91], v[188:191], v[172:175]
v_mfma_f32_16x16x32_bf16 a[120:123], a[92:95], v[184:187], a[120:123]
buffer_load_dword v14, v13, s[16:19], s41 offen offset:128 sc1
v_mfma_f32_16x16x32_bf16 a[124:127], a[92:95], v[188:191], a[124:127]
buffer_load_dword a192, v1, s[52:55], s58 offen
s_add_u32 s58, s58, 1024
v_mfma_f32_16x16x32_bf16 a[136:139], a[96:99], v[184:187], a[136:139]
v_mfma_f32_16x16x32_bf16 a[140:143], a[96:99], v[188:191], a[140:143]
buffer_load_dword v16, v13, s[16:19], s42 offen offset:128 sc1
v_mfma_f32_16x16x32_bf16 a[152:155], a[100:103], v[184:187], a[152:155]
s_waitcnt vmcnt(30)
v_swap_b32 v194, v196
v_mfma_f32_16x16x32_bf16 a[156:159], a[100:103], v[188:191], a[156:159]
v_swap_b32 v195, v197
v_mfma_f32_16x16x32_bf16 a[168:171], a[104:107], v[184:187], a[168:171]
v_swap_b32 v202, v204
v_mfma_f32_16x16x32_bf16 a[172:175], a[104:107], v[188:191], a[172:175]
v_swap_b32 v203, v205
v_mfma_f32_16x16x32_bf16 a[184:187], a[108:111], v[184:187], a[184:187]
v_mfma_f32_16x16x32_bf16 a[188:191], a[108:111], v[188:191], a[188:191]
buffer_load_dword v18, v13, s[16:19], s41 offen offset:192 sc1
s_waitcnt lgkmcnt(0)
v_mfma_f32_16x16x32_bf16 v[32:35], a[0:3], v[192:195], v[32:35]
v_mfma_f32_16x16x32_bf16 v[36:39], a[0:3], v[196:199], v[36:39]
v_mfma_f32_16x16x32_bf16 v[48:51], a[4:7], v[192:195], v[48:51]
v_mfma_f32_16x16x32_bf16 v[52:55], a[4:7], v[196:199], v[52:55]
ds_read_b64_tr_b16 a[56:57], v11 offset:35840
v_mfma_f32_16x16x32_bf16 v[64:67], a[8:11], v[192:195], v[64:67]
ds_read_b64_tr_b16 a[58:59], v11 offset:37632
v_mfma_f32_16x16x32_bf16 v[68:71], a[8:11], v[196:199], v[68:71]
buffer_load_dwordx4 v[176:179], v2, s[4:7], s20 offen offset:0 sc1
v_mfma_f32_16x16x32_bf16 v[80:83], a[12:15], v[192:195], v[80:83]
ds_read_b64_tr_b16 a[60:61], v11 offset:50176
v_mfma_f32_16x16x32_bf16 v[84:87], a[12:15], v[196:199], v[84:87]
ds_read_b64_tr_b16 a[62:63], v11 offset:51968
v_mfma_f32_16x16x32_bf16 v[96:99], a[16:19], v[192:195], v[96:99]
v_mfma_f32_16x16x32_bf16 v[100:103], a[16:19], v[196:199], v[100:103]
ds_read_b64_tr_b16 a[64:65], v11 offset:35872
v_mfma_f32_16x16x32_bf16 v[112:115], a[20:23], v[192:195], v[112:115]
ds_read_b64_tr_b16 a[66:67], v11 offset:37664
v_mfma_f32_16x16x32_bf16 v[116:119], a[20:23], v[196:199], v[116:119]
buffer_load_dwordx4 v[180:183], v2, s[4:7], s20 offen offset:512 sc1
v_mfma_f32_16x16x32_bf16 v[128:131], a[24:27], v[192:195], v[128:131]
ds_read_b64_tr_b16 a[68:69], v11 offset:50208
v_mfma_f32_16x16x32_bf16 v[132:135], a[24:27], v[196:199], v[132:135]
ds_read_b64_tr_b16 a[70:71], v11 offset:52000
v_mfma_f32_16x16x32_bf16 v[144:147], a[28:31], v[192:195], v[144:147]
buffer_load_dword v20, v13, s[16:19], s42 offen offset:192 sc1
v_mfma_f32_16x16x32_bf16 v[148:151], a[28:31], v[196:199], v[148:151]
ds_read_b64_tr_b16 a[72:73], v11 offset:35904
v_mfma_f32_16x16x32_bf16 v[160:163], a[32:35], v[192:195], v[160:163]
ds_read_b64_tr_b16 a[74:75], v11 offset:37696
v_mfma_f32_16x16x32_bf16 v[164:167], a[32:35], v[196:199], v[164:167]
buffer_load_dwordx4 v[184:187], v3, s[4:7], s20 offen offset:0 sc1
v_mfma_f32_16x16x32_bf16 a[112:115], a[36:39], v[192:195], a[112:115]
ds_read_b64_tr_b16 a[76:77], v11 offset:50240
v_mfma_f32_16x16x32_bf16 a[116:119], a[36:39], v[196:199], a[116:119]
ds_read_b64_tr_b16 a[78:79], v11 offset:52032
v_mfma_f32_16x16x32_bf16 a[128:131], a[40:43], v[192:195], a[128:131]
v_mfma_f32_16x16x32_bf16 a[132:135], a[40:43], v[196:199], a[132:135]
ds_read_b64_tr_b16 a[80:81], v11 offset:35936
v_mfma_f32_16x16x32_bf16 a[144:147], a[44:47], v[192:195], a[144:147]
ds_read_b64_tr_b16 a[82:83], v11 offset:37728
v_mfma_f32_16x16x32_bf16 a[148:151], a[44:47], v[196:199], a[148:151]
buffer_load_dwordx4 v[188:191], v3, s[4:7], s20 offen offset:512 sc1
v_mfma_f32_16x16x32_bf16 a[160:163], a[48:51], v[192:195], a[160:163]
ds_read_b64_tr_b16 a[84:85], v11 offset:50272
v_mfma_f32_16x16x32_bf16 a[164:167], a[48:51], v[196:199], a[164:167]
ds_read_b64_tr_b16 a[86:87], v11 offset:52064
v_mfma_f32_16x16x32_bf16 a[176:179], a[52:55], v[192:195], a[176:179]
v_mfma_f32_16x16x32_bf16 a[180:183], a[52:55], v[196:199], a[180:183]
ds_read_b64_tr_b16 a[88:89], v11 offset:35968
v_mfma_f32_16x16x32_bf16 v[40:43], a[0:3], v[200:203], v[40:43]
ds_read_b64_tr_b16 a[90:91], v11 offset:37760
v_mfma_f32_16x16x32_bf16 v[44:47], a[0:3], v[204:207], v[44:47]
v_mfma_f32_16x16x32_bf16 v[56:59], a[4:7], v[200:203], v[56:59]
ds_read_b64_tr_b16 a[92:93], v11 offset:50304
v_mfma_f32_16x16x32_bf16 v[60:63], a[4:7], v[204:207], v[60:63]
ds_read_b64_tr_b16 a[94:95], v11 offset:52096
v_mfma_f32_16x16x32_bf16 v[72:75], a[8:11], v[200:203], v[72:75]
v_mfma_f32_16x16x32_bf16 v[76:79], a[8:11], v[204:207], v[76:79]
ds_read_b64_tr_b16 a[96:97], v11 offset:36000
v_mfma_f32_16x16x32_bf16 v[88:91], a[12:15], v[200:203], v[88:91]
ds_read_b64_tr_b16 a[98:99], v11 offset:37792
v_mfma_f32_16x16x32_bf16 v[92:95], a[12:15], v[204:207], v[92:95]
v_mfma_f32_16x16x32_bf16 v[104:107], a[16:19], v[200:203], v[104:107]
ds_read_b64_tr_b16 a[100:101], v11 offset:50336
v_mfma_f32_16x16x32_bf16 v[108:111], a[16:19], v[204:207], v[108:111]
ds_read_b64_tr_b16 a[102:103], v11 offset:52128
v_mfma_f32_16x16x32_bf16 v[120:123], a[20:23], v[200:203], v[120:123]
v_mfma_f32_16x16x32_bf16 v[124:127], a[20:23], v[204:207], v[124:127]
ds_read_b64_tr_b16 a[104:105], v11 offset:36032
v_mfma_f32_16x16x32_bf16 v[136:139], a[24:27], v[200:203], v[136:139]
ds_read_b64_tr_b16 a[106:107], v11 offset:37824
v_mfma_f32_16x16x32_bf16 v[140:143], a[24:27], v[204:207], v[140:143]
v_mfma_f32_16x16x32_bf16 v[152:155], a[28:31], v[200:203], v[152:155]
ds_read_b64_tr_b16 a[108:109], v11 offset:50368
v_mfma_f32_16x16x32_bf16 v[156:159], a[28:31], v[204:207], v[156:159]
ds_read_b64_tr_b16 a[110:111], v11 offset:52160
v_mfma_f32_16x16x32_bf16 v[168:171], a[32:35], v[200:203], v[168:171]
v_mfma_f32_16x16x32_bf16 v[172:175], a[32:35], v[204:207], v[172:175]
v_mfma_f32_16x16x32_bf16 a[120:123], a[36:39], v[200:203], a[120:123]
v_mfma_f32_16x16x32_bf16 a[124:127], a[36:39], v[204:207], a[124:127]
buffer_load_dword a192, v1, s[52:55], s58 offen
s_add_u32 s58, s58, 1024
v_mfma_f32_16x16x32_bf16 a[136:139], a[40:43], v[200:203], a[136:139]
v_mfma_f32_16x16x32_bf16 a[140:143], a[40:43], v[204:207], a[140:143]
v_mfma_f32_16x16x32_bf16 a[152:155], a[44:47], v[200:203], a[152:155]
s_waitcnt vmcnt(32)
v_swap_b32 v210, v212
v_mfma_f32_16x16x32_bf16 a[156:159], a[44:47], v[204:207], a[156:159]
v_swap_b32 v211, v213
v_mfma_f32_16x16x32_bf16 a[168:171], a[48:51], v[200:203], a[168:171]
v_swap_b32 v218, v220
v_mfma_f32_16x16x32_bf16 a[172:175], a[48:51], v[204:207], a[172:175]
v_swap_b32 v219, v221
v_mfma_f32_16x16x32_bf16 a[184:187], a[52:55], v[200:203], a[184:187]
v_mfma_f32_16x16x32_bf16 a[188:191], a[52:55], v[204:207], a[188:191]
s_waitcnt lgkmcnt(0)
v_mfma_f32_16x16x32_bf16 v[32:35], a[56:59], v[208:211], v[32:35]
v_mfma_f32_16x16x32_bf16 v[36:39], a[56:59], v[212:215], v[36:39]
v_mfma_f32_16x16x32_bf16 v[48:51], a[60:63], v[208:211], v[48:51]
s_waitcnt vmcnt(24) lgkmcnt(0)
s_barrier
v_mfma_f32_16x16x32_bf16 v[52:55], a[60:63], v[212:215], v[52:55]
ds_read_b64_tr_b16 a[0:1], v12 offset:0
v_mfma_f32_16x16x32_bf16 v[64:67], a[64:67], v[208:211], v[64:67]
ds_read_b64_tr_b16 a[2:3], v12 offset:1792
v_mfma_f32_16x16x32_bf16 v[68:71], a[64:67], v[212:215], v[68:71]
buffer_load_dwordx4 v[192:195], v2, s[4:7], s20 offen offset:2048 sc1
v_mfma_f32_16x16x32_bf16 v[80:83], a[68:71], v[208:211], v[80:83]
ds_read_b64_tr_b16 a[4:5], v12 offset:14336
v_mfma_f32_16x16x32_bf16 v[84:87], a[68:71], v[212:215], v[84:87]
ds_read_b64_tr_b16 a[6:7], v12 offset:16128
v_mfma_f32_16x16x32_bf16 v[96:99], a[72:75], v[208:211], v[96:99]
v_mfma_f32_16x16x32_bf16 v[100:103], a[72:75], v[212:215], v[100:103]
ds_read_b64_tr_b16 a[8:9], v12 offset:7168
v_mfma_f32_16x16x32_bf16 v[112:115], a[76:79], v[208:211], v[112:115]
ds_read_b64_tr_b16 a[10:11], v12 offset:8960
v_mfma_f32_16x16x32_bf16 v[116:119], a[76:79], v[212:215], v[116:119]
buffer_load_dwordx4 v[196:199], v2, s[4:7], s20 offen offset:2560 sc1
v_mfma_f32_16x16x32_bf16 v[128:131], a[80:83], v[208:211], v[128:131]
ds_read_b64_tr_b16 a[12:13], v12 offset:21504
v_mfma_f32_16x16x32_bf16 v[132:135], a[80:83], v[212:215], v[132:135]
ds_read_b64_tr_b16 a[14:15], v12 offset:23296
v_mfma_f32_16x16x32_bf16 v[144:147], a[84:87], v[208:211], v[144:147]
v_mfma_f32_16x16x32_bf16 v[148:151], a[84:87], v[212:215], v[148:151]
ds_read_b64_tr_b16 a[16:17], v12 offset:28672
v_mfma_f32_16x16x32_bf16 v[160:163], a[88:91], v[208:211], v[160:163]
ds_read_b64_tr_b16 a[18:19], v12 offset:30464
v_mfma_f32_16x16x32_bf16 v[164:167], a[88:91], v[212:215], v[164:167]
buffer_load_dwordx4 v[200:203], v3, s[4:7], s20 offen offset:2048 sc1
v_mfma_f32_16x16x32_bf16 a[112:115], a[92:95], v[208:211], a[112:115]
ds_read_b64_tr_b16 a[20:21], v12 offset:43008
v_mfma_f32_16x16x32_bf16 a[116:119], a[92:95], v[212:215], a[116:119]
ds_read_b64_tr_b16 a[22:23], v12 offset:44800
v_mfma_f32_16x16x32_bf16 a[128:131], a[96:99], v[208:211], a[128:131]
v_mfma_f32_16x16x32_bf16 a[132:135], a[96:99], v[212:215], a[132:135]
ds_read_b64_tr_b16 a[24:25], v12 offset:35840
v_mfma_f32_16x16x32_bf16 a[144:147], a[100:103], v[208:211], a[144:147]
ds_read_b64_tr_b16 a[26:27], v12 offset:37632
v_mfma_f32_16x16x32_bf16 a[148:151], a[100:103], v[212:215], a[148:151]
buffer_load_dwordx4 v[204:207], v3, s[4:7], s20 offen offset:2560 sc1
v_mfma_f32_16x16x32_bf16 a[160:163], a[104:107], v[208:211], a[160:163]
ds_read_b64_tr_b16 a[28:29], v12 offset:50176
s_add_u32 s20, s20, 4096
v_mfma_f32_16x16x32_bf16 a[164:167], a[104:107], v[212:215], a[164:167]
ds_read_b64_tr_b16 a[30:31], v12 offset:51968
s_and_b32 s20, s20, 0xffff
v_mfma_f32_16x16x32_bf16 a[176:179], a[108:111], v[208:211], a[176:179]
v_mfma_f32_16x16x32_bf16 a[180:183], a[108:111], v[212:215], a[180:183]
v_mfma_f32_16x16x32_bf16 v[40:43], a[56:59], v[216:219], v[40:43]
v_mfma_f32_16x16x32_bf16 v[44:47], a[56:59], v[220:223], v[44:47]
v_mfma_f32_16x16x32_bf16 v[56:59], a[60:63], v[216:219], v[56:59]
v_mfma_f32_16x16x32_bf16 v[60:63], a[60:63], v[220:223], v[60:63]
v_mfma_f32_16x16x32_bf16 v[72:75], a[64:67], v[216:219], v[72:75]
v_mfma_f32_16x16x32_bf16 v[76:79], a[64:67], v[220:223], v[76:79]
v_mfma_f32_16x16x32_bf16 v[88:91], a[68:71], v[216:219], v[88:91]
v_mfma_f32_16x16x32_bf16 v[92:95], a[68:71], v[220:223], v[92:95]
v_mfma_f32_16x16x32_bf16 v[104:107], a[72:75], v[216:219], v[104:107]
v_mfma_f32_16x16x32_bf16 v[108:111], a[72:75], v[220:223], v[108:111]
v_mfma_f32_16x16x32_bf16 v[120:123], a[76:79], v[216:219], v[120:123]
v_mfma_f32_16x16x32_bf16 v[124:127], a[76:79], v[220:223], v[124:127]
v_mfma_f32_16x16x32_bf16 v[136:139], a[80:83], v[216:219], v[136:139]
v_mfma_f32_16x16x32_bf16 v[140:143], a[80:83], v[220:223], v[140:143]
v_mfma_f32_16x16x32_bf16 v[152:155], a[84:87], v[216:219], v[152:155]
v_mfma_f32_16x16x32_bf16 v[156:159], a[84:87], v[220:223], v[156:159]
v_mfma_f32_16x16x32_bf16 v[168:171], a[88:91], v[216:219], v[168:171]
v_mfma_f32_16x16x32_bf16 v[172:175], a[88:91], v[220:223], v[172:175]
v_mfma_f32_16x16x32_bf16 a[120:123], a[92:95], v[216:219], a[120:123]
v_mfma_f32_16x16x32_bf16 a[124:127], a[92:95], v[220:223], a[124:127]
buffer_load_dword a192, v1, s[52:55], s58 offen
s_add_u32 s58, s58, 1024
v_mfma_f32_16x16x32_bf16 a[136:139], a[96:99], v[216:219], a[136:139]
v_mfma_f32_16x16x32_bf16 a[140:143], a[96:99], v[220:223], a[140:143]
v_mfma_f32_16x16x32_bf16 a[152:155], a[100:103], v[216:219], a[152:155]
s_waitcnt vmcnt(25)
v_swap_b32 v226, v228
v_mfma_f32_16x16x32_bf16 a[156:159], a[100:103], v[220:223], a[156:159]
v_swap_b32 v227, v229
v_mfma_f32_16x16x32_bf16 a[168:171], a[104:107], v[216:219], a[168:171]
v_swap_b32 v234, v236
v_mfma_f32_16x16x32_bf16 a[172:175], a[104:107], v[220:223], a[172:175]
v_swap_b32 v235, v237
v_mfma_f32_16x16x32_bf16 a[184:187], a[108:111], v[216:219], a[184:187]
v_mfma_f32_16x16x32_bf16 a[188:191], a[108:111], v[220:223], a[188:191]
s_waitcnt lgkmcnt(0)
v_mfma_f32_16x16x32_bf16 v[32:35], a[0:3], v[224:227], v[32:35]
ds_read_b64_tr_b16 a[56:57], v12 offset:32
s_waitcnt vmcnt(8)
v_lshrrev_b32 v11, 4, v0
v_mfma_f32_16x16x32_bf16 v[36:39], a[0:3], v[228:231], v[36:39]
ds_read_b64_tr_b16 a[58:59], v12 offset:1824
s_waitcnt vmcnt(19)
v_swap_b32 v242, v244
v_swap_b32 v243, v245
v_swap_b32 v250, v252
v_swap_b32 v251, v253
s_add_u32 m0, s26, 0
s_add_u32 s57, s26, 131072
v_lshl_add_u32 v13, v11, 4, s57
v_mfma_f32_16x16x32_bf16 v[40:43], a[0:3], v[232:235], v[40:43]
ds_read_b64_tr_b16 a[60:61], v12 offset:14368
v_mfma_f32_16x16x32_bf16 v[44:47], a[0:3], v[236:239], v[44:47]
ds_read_b64_tr_b16 a[62:63], v12 offset:16160
buffer_load_dwordx4 v30, s[52:55], s100 offen lds
v_mfma_f32_16x16x32_bf16 v[48:51], a[4:7], v[224:227], v[48:51]
ds_read_b64_tr_b16 a[64:65], v12 offset:7200
v_mfma_f32_16x16x32_bf16 v[52:55], a[4:7], v[228:231], v[52:55]
ds_read_b64_tr_b16 a[66:67], v12 offset:8992
buffer_load_dwordx4 v31, s[52:55], s100 offen offset:1024 lds
v_mfma_f32_16x16x32_bf16 v[56:59], a[4:7], v[232:235], v[56:59]
ds_read_b64_tr_b16 a[68:69], v12 offset:21536
v_mfma_f32_16x16x32_bf16 v[60:63], a[4:7], v[236:239], v[60:63]
ds_read_b64_tr_b16 a[70:71], v12 offset:23328
s_add_u32 s100, s100, 458752
v_mov_b32 v1, v13
v_mfma_f32_16x16x32_bf16 v[32:35], a[8:11], v[240:243], v[32:35]
ds_read_b64_tr_b16 a[72:73], v12 offset:28704
ds_read_b128 v[22:25], v1 offset:0
ds_read_b128 v[26:29], v1 offset:448
v_mfma_f32_16x16x32_bf16 v[36:39], a[8:11], v[244:247], v[36:39]
ds_read_b64_tr_b16 a[74:75], v12 offset:30496
s_waitcnt vmcnt(8)
v_swap_b32 v178, v180
v_swap_b32 v179, v181
v_swap_b32 v186, v188
v_swap_b32 v187, v189
s_add_u32 m0, s26, 8192
v_and_b32 v13, 1, v11
v_lshlrev_b32 v13, 9, v13
v_mfma_f32_16x16x32_bf16 v[40:43], a[8:11], v[248:251], v[40:43]
ds_read_b64_tr_b16 a[76:77], v12 offset:43040
v_lshrrev_b32 v11, 1, v11
v_lshlrev_b32 v11, 8, v11
v_mfma_f32_16x16x32_bf16 v[44:47], a[8:11], v[252:255], v[44:47]
ds_read_b64_tr_b16 a[78:79], v12 offset:44832
buffer_load_dwordx4 v30, s[52:55], s100 offen lds
v_and_b32 v7, 15, v0
v_lshlrev_b32 v7, 4, v7
v_mfma_f32_16x16x32_bf16 v[48:51], a[12:15], v[240:243], v[48:51]
ds_read_b64_tr_b16 a[80:81], v12 offset:35872
v_add3_u32 v2, v11, v13, v7
s_mul_i32 s41, s36, 229376
v_mfma_f32_16x16x32_bf16 v[52:55], a[12:15], v[244:247], v[52:55]
ds_read_b64_tr_b16 a[82:83], v12 offset:37664
buffer_load_dwordx4 v31, s[52:55], s100 offen offset:1024 lds
s_lshr_b32 s42, s35, 4
s_mul_i32 s42, s42, 114688
v_mfma_f32_16x16x32_bf16 v[56:59], a[12:15], v[248:251], v[56:59]
ds_read_b64_tr_b16 a[84:85], v12 offset:50208
s_and_b32 s57, s35, 15
s_lshl_b32 s57, s57, 10
v_mfma_f32_16x16x32_bf16 v[60:63], a[12:15], v[252:255], v[60:63]
ds_read_b64_tr_b16 a[86:87], v12 offset:52000
s_add_u32 s100, s100, 458752
s_add_u32 s42, s42, s57
s_add_u32 s41, s41, s42
v_add_u32 v2, s41, v2
v_mfma_f32_16x16x32_bf16 v[32:35], a[16:19], v[176:179], v[32:35]
s_add_u32 m0, s26, 16384
v_add_u32 v3, 229376, v2
s_mov_b32 s43, 0xbfb8aa3b
v_mfma_f32_16x16x32_bf16 v[36:39], a[16:19], v[180:183], v[36:39]
s_waitcnt vmcnt(5)
v_swap_b32 v194, v196
v_swap_b32 v195, v197
v_swap_b32 v202, v204
v_swap_b32 v203, v205
buffer_load_dwordx4 v30, s[52:55], s100 offen lds
s_mov_b32 s44, 0
v_mov_b32 v7, 0
v_mfma_f32_16x16x32_bf16 v[40:43], a[16:19], v[184:187], v[40:43]
buffer_load_dwordx4 v31, s[52:55], s100 offen offset:1024 lds
s_mov_b32 s45, 0xba800000
s_mov_b32 s46, 0x3a800000
v_mfma_f32_16x16x32_bf16 v[44:47], a[16:19], v[188:191], v[44:47]
s_add_u32 s100, s100, 458752
v_mul_f32 v4, s45, v4
v_mul_f32 v8, s45, v8
v_mfma_f32_16x16x32_bf16 v[48:51], a[20:23], v[176:179], v[48:51]
s_add_u32 m0, s26, 24576
v_mul_f32 v14, s45, v14
v_mul_f32 v18, s45, v18
v_mfma_f32_16x16x32_bf16 v[52:55], a[20:23], v[180:183], v[52:55]
buffer_load_dwordx4 v30, s[52:55], s100 offen lds
v_mul_f32 v6, s46, v6
v_mul_f32 v10, s46, v10
v_mfma_f32_16x16x32_bf16 v[56:59], a[20:23], v[184:187], v[56:59]
buffer_load_dwordx4 v31, s[52:55], s100 offen offset:1024 lds
v_mul_f32 v16, s46, v16
v_mul_f32 v20, s46, v20
v_mfma_f32_16x16x32_bf16 v[60:63], a[20:23], v[188:191], v[60:63]
v_fma_f32 v6, -v4, v4, v6
v_fma_f32 v10, -v8, v8, v10
v_fma_f32 v16, -v14, v14, v16
v_mfma_f32_16x16x32_bf16 v[32:35], a[24:27], v[192:195], v[32:35]
v_fma_f32 v20, -v18, v18, v20
v_max_f32 v6, 0, v6
v_mfma_f32_16x16x32_bf16 v[36:39], a[24:27], v[196:199], v[36:39]
v_max_f32 v10, 0, v10
v_max_f32 v16, 0, v16
v_mfma_f32_16x16x32_bf16 v[40:43], a[24:27], v[200:203], v[40:43]
v_max_f32 v20, 0, v20
v_add_f32 v6, 0x3727c5ac, v6
v_mfma_f32_16x16x32_bf16 v[44:47], a[24:27], v[204:207], v[44:47]
v_add_f32 v10, 0x3727c5ac, v10
v_add_f32 v16, 0x3727c5ac, v16
v_mfma_f32_16x16x32_bf16 v[48:51], a[28:31], v[192:195], v[48:51]
v_add_f32 v20, 0x3727c5ac, v20
v_rsq_f32 v5, v6
v_mfma_f32_16x16x32_bf16 v[52:55], a[28:31], v[196:199], v[52:55]
v_rsq_f32 v9, v10
v_rsq_f32 v15, v16
v_mfma_f32_16x16x32_bf16 v[56:59], a[28:31], v[200:203], v[56:59]
v_rsq_f32 v19, v20
v_mul_f32 v5, s43, v5
v_mfma_f32_16x16x32_bf16 v[60:63], a[28:31], v[204:207], v[60:63]
v_mul_f32 v9, s43, v9
v_mul_f32 v15, s43, v15
v_mul_f32 v19, s43, v19
s_waitcnt lgkmcnt(0)
v_mfma_f32_16x16x32_bf16 v[64:67], a[56:59], v[224:227], v[64:67]
ds_read_b64_tr_b16 a[0:1], v12 offset:64
v_mfma_f32_16x16x32_bf16 v[68:71], a[56:59], v[228:231], v[68:71]
ds_read_b64_tr_b16 a[2:3], v12 offset:1856
s_add_u32 s100, s100, 458752
v_mfma_f32_16x16x32_bf16 v[72:75], a[56:59], v[232:235], v[72:75]
ds_read_b64_tr_b16 a[4:5], v12 offset:14400
v_mfma_f32_16x16x32_bf16 v[76:79], a[56:59], v[236:239], v[76:79]
ds_read_b64_tr_b16 a[6:7], v12 offset:16192
s_add_u32 m0, s26, 32768
v_mfma_f32_16x16x32_bf16 v[80:83], a[60:63], v[224:227], v[80:83]
ds_read_b64_tr_b16 a[8:9], v12 offset:7232
v_mfma_f32_16x16x32_bf16 v[84:87], a[60:63], v[228:231], v[84:87]
ds_read_b64_tr_b16 a[10:11], v12 offset:9024
buffer_load_dwordx4 v30, s[52:55], s100 offen lds
v_mfma_f32_16x16x32_bf16 v[88:91], a[60:63], v[232:235], v[88:91]
ds_read_b64_tr_b16 a[12:13], v12 offset:21568
v_mfma_f32_16x16x32_bf16 v[92:95], a[60:63], v[236:239], v[92:95]
ds_read_b64_tr_b16 a[14:15], v12 offset:23360
buffer_load_dwordx4 v31, s[52:55], s100 offen offset:1024 lds
v_mfma_f32_16x16x32_bf16 v[64:67], a[64:67], v[240:243], v[64:67]
ds_read_b64_tr_b16 a[16:17], v12 offset:28736
v_mfma_f32_16x16x32_bf16 v[68:71], a[64:67], v[244:247], v[68:71]
ds_read_b64_tr_b16 a[18:19], v12 offset:30528
s_add_u32 s100, s100, 458752
v_mfma_f32_16x16x32_bf16 v[72:75], a[64:67], v[248:251], v[72:75]
ds_read_b64_tr_b16 a[20:21], v12 offset:43072
v_mfma_f32_16x16x32_bf16 v[76:79], a[64:67], v[252:255], v[76:79]
ds_read_b64_tr_b16 a[22:23], v12 offset:44864
s_add_u32 m0, s26, 40960
v_mfma_f32_16x16x32_bf16 v[80:83], a[68:71], v[240:243], v[80:83]
ds_read_b64_tr_b16 a[24:25], v12 offset:35904
v_mfma_f32_16x16x32_bf16 v[84:87], a[68:71], v[244:247], v[84:87]
ds_read_b64_tr_b16 a[26:27], v12 offset:37696
buffer_load_dwordx4 v30, s[52:55], s100 offen lds
v_mfma_f32_16x16x32_bf16 v[88:91], a[68:71], v[248:251], v[88:91]
ds_read_b64_tr_b16 a[28:29], v12 offset:50240
v_mfma_f32_16x16x32_bf16 v[92:95], a[68:71], v[252:255], v[92:95]
ds_read_b64_tr_b16 a[30:31], v12 offset:52032
buffer_load_dwordx4 v31, s[52:55], s100 offen offset:1024 lds
v_mfma_f32_16x16x32_bf16 v[64:67], a[72:75], v[176:179], v[64:67]
s_add_u32 s100, s100, 458752
v_mfma_f32_16x16x32_bf16 v[68:71], a[72:75], v[180:183], v[68:71]
s_add_u32 m0, s26, 49152
v_mfma_f32_16x16x32_bf16 v[72:75], a[72:75], v[184:187], v[72:75]
buffer_load_dwordx4 v30, s[52:55], s100 offen lds
v_mfma_f32_16x16x32_bf16 v[76:79], a[72:75], v[188:191], v[76:79]
buffer_load_dwordx4 v31, s[52:55], s100 offen offset:1024 lds
v_mfma_f32_16x16x32_bf16 v[80:83], a[76:79], v[176:179], v[80:83]
v_mfma_f32_16x16x32_bf16 v[84:87], a[76:79], v[180:183], v[84:87]
v_mfma_f32_16x16x32_bf16 v[88:91], a[76:79], v[184:187], v[88:91]
v_mfma_f32_16x16x32_bf16 v[92:95], a[76:79], v[188:191], v[92:95]
v_mfma_f32_16x16x32_bf16 v[64:67], a[80:83], v[192:195], v[64:67]
v_mfma_f32_16x16x32_bf16 v[68:71], a[80:83], v[196:199], v[68:71]
v_mfma_f32_16x16x32_bf16 v[72:75], a[80:83], v[200:203], v[72:75]
v_mfma_f32_16x16x32_bf16 v[76:79], a[80:83], v[204:207], v[76:79]
v_mfma_f32_16x16x32_bf16 v[80:83], a[84:87], v[192:195], v[80:83]
v_mfma_f32_16x16x32_bf16 v[84:87], a[84:87], v[196:199], v[84:87]
v_mfma_f32_16x16x32_bf16 v[88:91], a[84:87], v[200:203], v[88:91]
v_mfma_f32_16x16x32_bf16 v[92:95], a[84:87], v[204:207], v[92:95]
v_pk_fma_f32 v[32:33], v[4:5], v[22:23], v[32:33] op_sel_hi:[0,1,1]
v_pk_fma_f32 v[48:49], v[4:5], v[26:27], v[48:49] op_sel_hi:[0,1,1]
v_pk_fma_f32 v[34:35], v[4:5], v[24:25], v[34:35] op_sel_hi:[0,1,1]
v_pk_fma_f32 v[50:51], v[4:5], v[28:29], v[50:51] op_sel_hi:[0,1,1]
v_pk_fma_f32 v[36:37], v[8:9], v[22:23], v[36:37] op_sel_hi:[0,1,1]
v_pk_fma_f32 v[52:53], v[8:9], v[26:27], v[52:53] op_sel_hi:[0,1,1]
v_pk_fma_f32 v[38:39], v[8:9], v[24:25], v[38:39] op_sel_hi:[0,1,1]
v_pk_fma_f32 v[54:55], v[8:9], v[28:29], v[54:55] op_sel_hi:[0,1,1]
v_pk_fma_f32 v[40:41], v[14:15], v[22:23], v[40:41] op_sel_hi:[0,1,1]
v_pk_fma_f32 v[56:57], v[14:15], v[26:27], v[56:57] op_sel_hi:[0,1,1]
v_pk_fma_f32 v[42:43], v[14:15], v[24:25], v[42:43] op_sel_hi:[0,1,1]
v_pk_fma_f32 v[58:59], v[14:15], v[28:29], v[58:59] op_sel_hi:[0,1,1]
v_pk_fma_f32 v[44:45], v[18:19], v[22:23], v[44:45] op_sel_hi:[0,1,1]
v_pk_fma_f32 v[60:61], v[18:19], v[26:27], v[60:61] op_sel_hi:[0,1,1]
v_pk_fma_f32 v[46:47], v[18:19], v[24:25], v[46:47] op_sel_hi:[0,1,1]
v_pk_fma_f32 v[62:63], v[18:19], v[28:29], v[62:63] op_sel_hi:[0,1,1]
ds_read_b128 v[22:25], v1 offset:64
ds_read_b128 v[26:29], v1 offset:512
v_pk_mul_f32 v[48:49], v[32:33], v[48:49]
v_pk_mul_f32 v[32:33], v[32:33], v[4:5] op_sel:[0,1] op_sel_hi:[1,1]
v_pk_mul_f32 v[50:51], v[34:35], v[50:51]
v_pk_mul_f32 v[34:35], v[34:35], v[4:5] op_sel:[0,1] op_sel_hi:[1,1]
v_pk_mul_f32 v[52:53], v[36:37], v[52:53]
v_pk_mul_f32 v[36:37], v[36:37], v[8:9] op_sel:[0,1] op_sel_hi:[1,1]
v_pk_mul_f32 v[54:55], v[38:39], v[54:55]
v_pk_mul_f32 v[38:39], v[38:39], v[8:9] op_sel:[0,1] op_sel_hi:[1,1]
v_pk_mul_f32 v[56:57], v[40:41], v[56:57]
v_pk_mul_f32 v[40:41], v[40:41], v[14:15] op_sel:[0,1] op_sel_hi:[1,1]
v_pk_mul_f32 v[58:59], v[42:43], v[58:59]
v_pk_mul_f32 v[42:43], v[42:43], v[14:15] op_sel:[0,1] op_sel_hi:[1,1]
v_pk_mul_f32 v[60:61], v[44:45], v[60:61]
v_pk_mul_f32 v[44:45], v[44:45], v[18:19] op_sel:[0,1] op_sel_hi:[1,1]
v_pk_mul_f32 v[62:63], v[46:47], v[62:63]
v_pk_mul_f32 v[46:47], v[46:47], v[18:19] op_sel:[0,1] op_sel_hi:[1,1]
v_exp_f32 v32, v32
v_exp_f32 v33, v33
v_exp_f32 v34, v34
v_exp_f32 v35, v35
v_exp_f32 v36, v36
v_exp_f32 v37, v37
v_exp_f32 v38, v38
v_exp_f32 v39, v39
v_exp_f32 v40, v40
v_exp_f32 v41, v41
v_exp_f32 v42, v42
v_exp_f32 v43, v43
v_exp_f32 v44, v44
v_exp_f32 v45, v45
v_exp_f32 v46, v46
v_exp_f32 v47, v47
v_pk_fma_f32 v[32:33], v[32:33], v[6:7], v[6:7] op_sel_hi:[1,0,0]
v_pk_fma_f32 v[34:35], v[34:35], v[6:7], v[6:7] op_sel_hi:[1,0,0]
v_pk_fma_f32 v[36:37], v[36:37], v[10:11], v[10:11] op_sel_hi:[1,0,0]
v_pk_fma_f32 v[38:39], v[38:39], v[10:11], v[10:11] op_sel_hi:[1,0,0]
v_pk_fma_f32 v[40:41], v[40:41], v[16:17], v[16:17] op_sel_hi:[1,0,0]
v_pk_fma_f32 v[42:43], v[42:43], v[16:17], v[16:17] op_sel_hi:[1,0,0]
v_pk_fma_f32 v[44:45], v[44:45], v[20:21], v[20:21] op_sel_hi:[1,0,0]
v_pk_fma_f32 v[46:47], v[46:47], v[20:21], v[20:21] op_sel_hi:[1,0,0]
v_rcp_f32 v32, v32
v_rcp_f32 v33, v33
v_rcp_f32 v34, v34
v_rcp_f32 v35, v35
v_rcp_f32 v36, v36
v_rcp_f32 v37, v37
v_rcp_f32 v38, v38
v_rcp_f32 v39, v39
v_rcp_f32 v40, v40
v_rcp_f32 v41, v41
v_rcp_f32 v42, v42
v_rcp_f32 v43, v43
v_rcp_f32 v44, v44
v_rcp_f32 v45, v45
v_rcp_f32 v46, v46
v_rcp_f32 v47, v47
v_pk_mul_f32 v[48:49], v[32:33], v[48:49]
v_pk_mul_f32 v[50:51], v[34:35], v[50:51]
v_pk_mul_f32 v[52:53], v[36:37], v[52:53]
v_pk_mul_f32 v[54:55], v[38:39], v[54:55]
v_pk_mul_f32 v[56:57], v[40:41], v[56:57]
v_pk_mul_f32 v[58:59], v[42:43], v[58:59]
v_pk_mul_f32 v[60:61], v[44:45], v[60:61]
v_pk_mul_f32 v[62:63], v[46:47], v[62:63]
v_cvt_pk_bf16_f32 v32, v48, v49
v_cvt_pk_bf16_f32 v33, v50, v51
v_cvt_pk_bf16_f32 v34, v52, v53
v_cvt_pk_bf16_f32 v35, v54, v55
v_cvt_pk_bf16_f32 v40, v56, v57
v_cvt_pk_bf16_f32 v41, v58, v59
v_cvt_pk_bf16_f32 v42, v60, v61
v_cvt_pk_bf16_f32 v43, v62, v63
s_nop 0
v_permlane32_swap_b32 v32, v34
v_permlane32_swap_b32 v33, v35
v_permlane32_swap_b32 v40, v42
v_permlane32_swap_b32 v41, v43
buffer_store_dwordx4 v[32:35], v2, s[12:15], s44 offen sc1
buffer_store_dwordx4 v[40:43], v3, s[12:15], s44 offen sc1
s_add_u32 s44, s44, 16384
s_waitcnt lgkmcnt(0)
v_mfma_f32_16x16x32_bf16 v[96:99], a[0:3], v[224:227], v[96:99]
ds_read_b64_tr_b16 a[56:57], v12 offset:96
v_mfma_f32_16x16x32_bf16 v[100:103], a[0:3], v[228:231], v[100:103]
ds_read_b64_tr_b16 a[58:59], v12 offset:1888
v_mfma_f32_16x16x32_bf16 v[104:107], a[0:3], v[232:235], v[104:107]
ds_read_b64_tr_b16 a[60:61], v12 offset:14432
v_mfma_f32_16x16x32_bf16 v[108:111], a[0:3], v[236:239], v[108:111]
ds_read_b64_tr_b16 a[62:63], v12 offset:16224
v_mfma_f32_16x16x32_bf16 v[112:115], a[4:7], v[224:227], v[112:115]
ds_read_b64_tr_b16 a[64:65], v12 offset:7264
v_mfma_f32_16x16x32_bf16 v[116:119], a[4:7], v[228:231], v[116:119]
ds_read_b64_tr_b16 a[66:67], v12 offset:9056
v_mfma_f32_16x16x32_bf16 v[120:123], a[4:7], v[232:235], v[120:123]
ds_read_b64_tr_b16 a[68:69], v12 offset:21600
v_mfma_f32_16x16x32_bf16 v[124:127], a[4:7], v[236:239], v[124:127]
ds_read_b64_tr_b16 a[70:71], v12 offset:23392
v_mfma_f32_16x16x32_bf16 v[96:99], a[8:11], v[240:243], v[96:99]
ds_read_b64_tr_b16 a[72:73], v12 offset:28768
v_mfma_f32_16x16x32_bf16 v[100:103], a[8:11], v[244:247], v[100:103]
ds_read_b64_tr_b16 a[74:75], v12 offset:30560
v_mfma_f32_16x16x32_bf16 v[104:107], a[8:11], v[248:251], v[104:107]
ds_read_b64_tr_b16 a[76:77], v12 offset:43104
v_mfma_f32_16x16x32_bf16 v[108:111], a[8:11], v[252:255], v[108:111]
ds_read_b64_tr_b16 a[78:79], v12 offset:44896
v_mfma_f32_16x16x32_bf16 v[112:115], a[12:15], v[240:243], v[112:115]
ds_read_b64_tr_b16 a[80:81], v12 offset:35936
v_mfma_f32_16x16x32_bf16 v[116:119], a[12:15], v[244:247], v[116:119]
ds_read_b64_tr_b16 a[82:83], v12 offset:37728
v_mfma_f32_16x16x32_bf16 v[120:123], a[12:15], v[248:251], v[120:123]
ds_read_b64_tr_b16 a[84:85], v12 offset:50272
v_mfma_f32_16x16x32_bf16 v[124:127], a[12:15], v[252:255], v[124:127]
ds_read_b64_tr_b16 a[86:87], v12 offset:52064
v_mfma_f32_16x16x32_bf16 v[96:99], a[16:19], v[176:179], v[96:99]
v_mfma_f32_16x16x32_bf16 v[100:103], a[16:19], v[180:183], v[100:103]
v_mfma_f32_16x16x32_bf16 v[104:107], a[16:19], v[184:187], v[104:107]
v_mfma_f32_16x16x32_bf16 v[108:111], a[16:19], v[188:191], v[108:111]
v_mfma_f32_16x16x32_bf16 v[112:115], a[20:23], v[176:179], v[112:115]
v_mfma_f32_16x16x32_bf16 v[116:119], a[20:23], v[180:183], v[116:119]
v_mfma_f32_16x16x32_bf16 v[120:123], a[20:23], v[184:187], v[120:123]
v_mfma_f32_16x16x32_bf16 v[124:127], a[20:23], v[188:191], v[124:127]
v_mfma_f32_16x16x32_bf16 v[96:99], a[24:27], v[192:195], v[96:99]
v_mfma_f32_16x16x32_bf16 v[100:103], a[24:27], v[196:199], v[100:103]
v_mfma_f32_16x16x32_bf16 v[104:107], a[24:27], v[200:203], v[104:107]
v_mfma_f32_16x16x32_bf16 v[108:111], a[24:27], v[204:207], v[108:111]
v_mfma_f32_16x16x32_bf16 v[112:115], a[28:31], v[192:195], v[112:115]
v_mfma_f32_16x16x32_bf16 v[116:119], a[28:31], v[196:199], v[116:119]
v_mfma_f32_16x16x32_bf16 v[120:123], a[28:31], v[200:203], v[120:123]
v_mfma_f32_16x16x32_bf16 v[124:127], a[28:31], v[204:207], v[124:127]
v_pk_fma_f32 v[64:65], v[4:5], v[22:23], v[64:65] op_sel_hi:[0,1,1]
v_pk_fma_f32 v[80:81], v[4:5], v[26:27], v[80:81] op_sel_hi:[0,1,1]
v_pk_fma_f32 v[66:67], v[4:5], v[24:25], v[66:67] op_sel_hi:[0,1,1]
v_pk_fma_f32 v[82:83], v[4:5], v[28:29], v[82:83] op_sel_hi:[0,1,1]
v_pk_fma_f32 v[68:69], v[8:9], v[22:23], v[68:69] op_sel_hi:[0,1,1]
v_pk_fma_f32 v[84:85], v[8:9], v[26:27], v[84:85] op_sel_hi:[0,1,1]
v_pk_fma_f32 v[70:71], v[8:9], v[24:25], v[70:71] op_sel_hi:[0,1,1]
v_pk_fma_f32 v[86:87], v[8:9], v[28:29], v[86:87] op_sel_hi:[0,1,1]
v_pk_fma_f32 v[72:73], v[14:15], v[22:23], v[72:73] op_sel_hi:[0,1,1]
v_pk_fma_f32 v[88:89], v[14:15], v[26:27], v[88:89] op_sel_hi:[0,1,1]
v_pk_fma_f32 v[74:75], v[14:15], v[24:25], v[74:75] op_sel_hi:[0,1,1]
v_pk_fma_f32 v[90:91], v[14:15], v[28:29], v[90:91] op_sel_hi:[0,1,1]
v_pk_fma_f32 v[76:77], v[18:19], v[22:23], v[76:77] op_sel_hi:[0,1,1]
v_pk_fma_f32 v[92:93], v[18:19], v[26:27], v[92:93] op_sel_hi:[0,1,1]
v_pk_fma_f32 v[78:79], v[18:19], v[24:25], v[78:79] op_sel_hi:[0,1,1]
v_pk_fma_f32 v[94:95], v[18:19], v[28:29], v[94:95] op_sel_hi:[0,1,1]
ds_read_b128 v[22:25], v1 offset:128
ds_read_b128 v[26:29], v1 offset:576
v_pk_mul_f32 v[80:81], v[64:65], v[80:81]
v_pk_mul_f32 v[64:65], v[64:65], v[4:5] op_sel:[0,1] op_sel_hi:[1,1]
v_pk_mul_f32 v[82:83], v[66:67], v[82:83]
v_pk_mul_f32 v[66:67], v[66:67], v[4:5] op_sel:[0,1] op_sel_hi:[1,1]
v_pk_mul_f32 v[84:85], v[68:69], v[84:85]
v_pk_mul_f32 v[68:69], v[68:69], v[8:9] op_sel:[0,1] op_sel_hi:[1,1]
v_pk_mul_f32 v[86:87], v[70:71], v[86:87]
v_pk_mul_f32 v[70:71], v[70:71], v[8:9] op_sel:[0,1] op_sel_hi:[1,1]
v_pk_mul_f32 v[88:89], v[72:73], v[88:89]
v_pk_mul_f32 v[72:73], v[72:73], v[14:15] op_sel:[0,1] op_sel_hi:[1,1]
v_pk_mul_f32 v[90:91], v[74:75], v[90:91]
v_pk_mul_f32 v[74:75], v[74:75], v[14:15] op_sel:[0,1] op_sel_hi:[1,1]
v_pk_mul_f32 v[92:93], v[76:77], v[92:93]
v_pk_mul_f32 v[76:77], v[76:77], v[18:19] op_sel:[0,1] op_sel_hi:[1,1]
v_pk_mul_f32 v[94:95], v[78:79], v[94:95]
v_pk_mul_f32 v[78:79], v[78:79], v[18:19] op_sel:[0,1] op_sel_hi:[1,1]
v_exp_f32 v64, v64
v_exp_f32 v65, v65
v_exp_f32 v66, v66
v_exp_f32 v67, v67
v_exp_f32 v68, v68
v_exp_f32 v69, v69
v_exp_f32 v70, v70
v_exp_f32 v71, v71
v_exp_f32 v72, v72
v_exp_f32 v73, v73
v_exp_f32 v74, v74
v_exp_f32 v75, v75
v_exp_f32 v76, v76
v_exp_f32 v77, v77
v_exp_f32 v78, v78
v_exp_f32 v79, v79
v_pk_fma_f32 v[64:65], v[64:65], v[6:7], v[6:7] op_sel_hi:[1,0,0]
v_pk_fma_f32 v[66:67], v[66:67], v[6:7], v[6:7] op_sel_hi:[1,0,0]
v_pk_fma_f32 v[68:69], v[68:69], v[10:11], v[10:11] op_sel_hi:[1,0,0]
v_pk_fma_f32 v[70:71], v[70:71], v[10:11], v[10:11] op_sel_hi:[1,0,0]
v_pk_fma_f32 v[72:73], v[72:73], v[16:17], v[16:17] op_sel_hi:[1,0,0]
v_pk_fma_f32 v[74:75], v[74:75], v[16:17], v[16:17] op_sel_hi:[1,0,0]
v_pk_fma_f32 v[76:77], v[76:77], v[20:21], v[20:21] op_sel_hi:[1,0,0]
v_pk_fma_f32 v[78:79], v[78:79], v[20:21], v[20:21] op_sel_hi:[1,0,0]
v_rcp_f32 v64, v64
v_rcp_f32 v65, v65
v_rcp_f32 v66, v66
v_rcp_f32 v67, v67
v_rcp_f32 v68, v68
v_rcp_f32 v69, v69
v_rcp_f32 v70, v70
v_rcp_f32 v71, v71
v_rcp_f32 v72, v72
v_rcp_f32 v73, v73
v_rcp_f32 v74, v74
v_rcp_f32 v75, v75
v_rcp_f32 v76, v76
v_rcp_f32 v77, v77
v_rcp_f32 v78, v78
v_rcp_f32 v79, v79
v_pk_mul_f32 v[80:81], v[64:65], v[80:81]
v_pk_mul_f32 v[82:83], v[66:67], v[82:83]
v_pk_mul_f32 v[84:85], v[68:69], v[84:85]
v_pk_mul_f32 v[86:87], v[70:71], v[86:87]
v_pk_mul_f32 v[88:89], v[72:73], v[88:89]
v_pk_mul_f32 v[90:91], v[74:75], v[90:91]
v_pk_mul_f32 v[92:93], v[76:77], v[92:93]
v_pk_mul_f32 v[94:95], v[78:79], v[94:95]
v_cvt_pk_bf16_f32 v64, v80, v81
v_cvt_pk_bf16_f32 v65, v82, v83
v_cvt_pk_bf16_f32 v66, v84, v85
v_cvt_pk_bf16_f32 v67, v86, v87
v_cvt_pk_bf16_f32 v72, v88, v89
v_cvt_pk_bf16_f32 v73, v90, v91
v_cvt_pk_bf16_f32 v74, v92, v93
v_cvt_pk_bf16_f32 v75, v94, v95
s_nop 0
v_permlane32_swap_b32 v64, v66
v_permlane32_swap_b32 v65, v67
v_permlane32_swap_b32 v72, v74
v_permlane32_swap_b32 v73, v75
buffer_store_dwordx4 v[64:67], v2, s[12:15], s44 offen sc1
buffer_store_dwordx4 v[72:75], v3, s[12:15], s44 offen sc1
s_add_u32 s44, s44, 16384
s_waitcnt lgkmcnt(0)
v_mfma_f32_16x16x32_bf16 v[128:131], a[56:59], v[224:227], v[128:131]
ds_read_b64_tr_b16 a[0:1], v12 offset:128
v_mfma_f32_16x16x32_bf16 v[132:135], a[56:59], v[228:231], v[132:135]
ds_read_b64_tr_b16 a[2:3], v12 offset:1920
v_mfma_f32_16x16x32_bf16 v[136:139], a[56:59], v[232:235], v[136:139]
ds_read_b64_tr_b16 a[4:5], v12 offset:14464
v_mfma_f32_16x16x32_bf16 v[140:143], a[56:59], v[236:239], v[140:143]
ds_read_b64_tr_b16 a[6:7], v12 offset:16256
v_mfma_f32_16x16x32_bf16 v[144:147], a[60:63], v[224:227], v[144:147]
ds_read_b64_tr_b16 a[8:9], v12 offset:7296
v_mfma_f32_16x16x32_bf16 v[148:151], a[60:63], v[228:231], v[148:151]
ds_read_b64_tr_b16 a[10:11], v12 offset:9088
v_mfma_f32_16x16x32_bf16 v[152:155], a[60:63], v[232:235], v[152:155]
ds_read_b64_tr_b16 a[12:13], v12 offset:21632
v_mfma_f32_16x16x32_bf16 v[156:159], a[60:63], v[236:239], v[156:159]
ds_read_b64_tr_b16 a[14:15], v12 offset:23424
v_mfma_f32_16x16x32_bf16 v[128:131], a[64:67], v[240:243], v[128:131]
ds_read_b64_tr_b16 a[16:17], v12 offset:28800
v_mfma_f32_16x16x32_bf16 v[132:135], a[64:67], v[244:247], v[132:135]
ds_read_b64_tr_b16 a[18:19], v12 offset:30592
v_mfma_f32_16x16x32_bf16 v[136:139], a[64:67], v[248:251], v[136:139]
ds_read_b64_tr_b16 a[20:21], v12 offset:43136
v_mfma_f32_16x16x32_bf16 v[140:143], a[64:67], v[252:255], v[140:143]
ds_read_b64_tr_b16 a[22:23], v12 offset:44928
v_mfma_f32_16x16x32_bf16 v[144:147], a[68:71], v[240:243], v[144:147]
ds_read_b64_tr_b16 a[24:25], v12 offset:35968
v_mfma_f32_16x16x32_bf16 v[148:151], a[68:71], v[244:247], v[148:151]
ds_read_b64_tr_b16 a[26:27], v12 offset:37760
v_mfma_f32_16x16x32_bf16 v[152:155], a[68:71], v[248:251], v[152:155]
ds_read_b64_tr_b16 a[28:29], v12 offset:50304
v_mfma_f32_16x16x32_bf16 v[156:159], a[68:71], v[252:255], v[156:159]
ds_read_b64_tr_b16 a[30:31], v12 offset:52096
v_mfma_f32_16x16x32_bf16 v[128:131], a[72:75], v[176:179], v[128:131]
v_mfma_f32_16x16x32_bf16 v[132:135], a[72:75], v[180:183], v[132:135]
v_mfma_f32_16x16x32_bf16 v[136:139], a[72:75], v[184:187], v[136:139]
v_mfma_f32_16x16x32_bf16 v[140:143], a[72:75], v[188:191], v[140:143]
v_mfma_f32_16x16x32_bf16 v[144:147], a[76:79], v[176:179], v[144:147]
v_mfma_f32_16x16x32_bf16 v[148:151], a[76:79], v[180:183], v[148:151]
v_mfma_f32_16x16x32_bf16 v[152:155], a[76:79], v[184:187], v[152:155]
v_mfma_f32_16x16x32_bf16 v[156:159], a[76:79], v[188:191], v[156:159]
v_mfma_f32_16x16x32_bf16 v[128:131], a[80:83], v[192:195], v[128:131]
v_mfma_f32_16x16x32_bf16 v[132:135], a[80:83], v[196:199], v[132:135]
v_mfma_f32_16x16x32_bf16 v[136:139], a[80:83], v[200:203], v[136:139]
v_mfma_f32_16x16x32_bf16 v[140:143], a[80:83], v[204:207], v[140:143]
v_mfma_f32_16x16x32_bf16 v[144:147], a[84:87], v[192:195], v[144:147]
v_mfma_f32_16x16x32_bf16 v[148:151], a[84:87], v[196:199], v[148:151]
v_mfma_f32_16x16x32_bf16 v[152:155], a[84:87], v[200:203], v[152:155]
v_mfma_f32_16x16x32_bf16 v[156:159], a[84:87], v[204:207], v[156:159]
v_pk_fma_f32 v[96:97], v[4:5], v[22:23], v[96:97] op_sel_hi:[0,1,1]
v_pk_fma_f32 v[112:113], v[4:5], v[26:27], v[112:113] op_sel_hi:[0,1,1]
v_pk_fma_f32 v[98:99], v[4:5], v[24:25], v[98:99] op_sel_hi:[0,1,1]
v_pk_fma_f32 v[114:115], v[4:5], v[28:29], v[114:115] op_sel_hi:[0,1,1]
v_pk_fma_f32 v[100:101], v[8:9], v[22:23], v[100:101] op_sel_hi:[0,1,1]
v_pk_fma_f32 v[116:117], v[8:9], v[26:27], v[116:117] op_sel_hi:[0,1,1]
v_pk_fma_f32 v[102:103], v[8:9], v[24:25], v[102:103] op_sel_hi:[0,1,1]
v_pk_fma_f32 v[118:119], v[8:9], v[28:29], v[118:119] op_sel_hi:[0,1,1]
v_pk_fma_f32 v[104:105], v[14:15], v[22:23], v[104:105] op_sel_hi:[0,1,1]
v_pk_fma_f32 v[120:121], v[14:15], v[26:27], v[120:121] op_sel_hi:[0,1,1]
v_pk_fma_f32 v[106:107], v[14:15], v[24:25], v[106:107] op_sel_hi:[0,1,1]
v_pk_fma_f32 v[122:123], v[14:15], v[28:29], v[122:123] op_sel_hi:[0,1,1]
v_pk_fma_f32 v[108:109], v[18:19], v[22:23], v[108:109] op_sel_hi:[0,1,1]
v_pk_fma_f32 v[124:125], v[18:19], v[26:27], v[124:125] op_sel_hi:[0,1,1]
v_pk_fma_f32 v[110:111], v[18:19], v[24:25], v[110:111] op_sel_hi:[0,1,1]
v_pk_fma_f32 v[126:127], v[18:19], v[28:29], v[126:127] op_sel_hi:[0,1,1]
ds_read_b128 v[22:25], v1 offset:192
ds_read_b128 v[26:29], v1 offset:640
v_pk_mul_f32 v[112:113], v[96:97], v[112:113]
v_pk_mul_f32 v[96:97], v[96:97], v[4:5] op_sel:[0,1] op_sel_hi:[1,1]
v_pk_mul_f32 v[114:115], v[98:99], v[114:115]
v_pk_mul_f32 v[98:99], v[98:99], v[4:5] op_sel:[0,1] op_sel_hi:[1,1]
v_pk_mul_f32 v[116:117], v[100:101], v[116:117]
v_pk_mul_f32 v[100:101], v[100:101], v[8:9] op_sel:[0,1] op_sel_hi:[1,1]
v_pk_mul_f32 v[118:119], v[102:103], v[118:119]
v_pk_mul_f32 v[102:103], v[102:103], v[8:9] op_sel:[0,1] op_sel_hi:[1,1]
v_pk_mul_f32 v[120:121], v[104:105], v[120:121]
v_pk_mul_f32 v[104:105], v[104:105], v[14:15] op_sel:[0,1] op_sel_hi:[1,1]
v_pk_mul_f32 v[122:123], v[106:107], v[122:123]
v_pk_mul_f32 v[106:107], v[106:107], v[14:15] op_sel:[0,1] op_sel_hi:[1,1]
v_pk_mul_f32 v[124:125], v[108:109], v[124:125]
v_pk_mul_f32 v[108:109], v[108:109], v[18:19] op_sel:[0,1] op_sel_hi:[1,1]
v_pk_mul_f32 v[126:127], v[110:111], v[126:127]
v_pk_mul_f32 v[110:111], v[110:111], v[18:19] op_sel:[0,1] op_sel_hi:[1,1]
v_exp_f32 v96, v96
v_exp_f32 v97, v97
v_exp_f32 v98, v98
v_exp_f32 v99, v99
v_exp_f32 v100, v100
v_exp_f32 v101, v101
v_exp_f32 v102, v102
v_exp_f32 v103, v103
v_exp_f32 v104, v104
v_exp_f32 v105, v105
v_exp_f32 v106, v106
v_exp_f32 v107, v107
v_exp_f32 v108, v108
v_exp_f32 v109, v109
v_exp_f32 v110, v110
v_exp_f32 v111, v111
v_pk_fma_f32 v[96:97], v[96:97], v[6:7], v[6:7] op_sel_hi:[1,0,0]
v_pk_fma_f32 v[98:99], v[98:99], v[6:7], v[6:7] op_sel_hi:[1,0,0]
v_pk_fma_f32 v[100:101], v[100:101], v[10:11], v[10:11] op_sel_hi:[1,0,0]
v_pk_fma_f32 v[102:103], v[102:103], v[10:11], v[10:11] op_sel_hi:[1,0,0]
v_pk_fma_f32 v[104:105], v[104:105], v[16:17], v[16:17] op_sel_hi:[1,0,0]
v_pk_fma_f32 v[106:107], v[106:107], v[16:17], v[16:17] op_sel_hi:[1,0,0]
v_pk_fma_f32 v[108:109], v[108:109], v[20:21], v[20:21] op_sel_hi:[1,0,0]
v_pk_fma_f32 v[110:111], v[110:111], v[20:21], v[20:21] op_sel_hi:[1,0,0]
v_rcp_f32 v96, v96
v_rcp_f32 v97, v97
v_rcp_f32 v98, v98
v_rcp_f32 v99, v99
v_rcp_f32 v100, v100
v_rcp_f32 v101, v101
v_rcp_f32 v102, v102
v_rcp_f32 v103, v103
v_rcp_f32 v104, v104
v_rcp_f32 v105, v105
v_rcp_f32 v106, v106
v_rcp_f32 v107, v107
v_rcp_f32 v108, v108
v_rcp_f32 v109, v109
v_rcp_f32 v110, v110
v_rcp_f32 v111, v111
v_pk_mul_f32 v[112:113], v[96:97], v[112:113]
v_pk_mul_f32 v[114:115], v[98:99], v[114:115]
v_pk_mul_f32 v[116:117], v[100:101], v[116:117]
v_pk_mul_f32 v[118:119], v[102:103], v[118:119]
v_pk_mul_f32 v[120:121], v[104:105], v[120:121]
v_pk_mul_f32 v[122:123], v[106:107], v[122:123]
v_pk_mul_f32 v[124:125], v[108:109], v[124:125]
v_pk_mul_f32 v[126:127], v[110:111], v[126:127]
v_cvt_pk_bf16_f32 v96, v112, v113
v_cvt_pk_bf16_f32 v97, v114, v115
v_cvt_pk_bf16_f32 v98, v116, v117
v_cvt_pk_bf16_f32 v99, v118, v119
v_cvt_pk_bf16_f32 v104, v120, v121
v_cvt_pk_bf16_f32 v105, v122, v123
v_cvt_pk_bf16_f32 v106, v124, v125
v_cvt_pk_bf16_f32 v107, v126, v127
s_nop 0
v_permlane32_swap_b32 v96, v98
v_permlane32_swap_b32 v97, v99
v_permlane32_swap_b32 v104, v106
v_permlane32_swap_b32 v105, v107
buffer_store_dwordx4 v[96:99], v2, s[12:15], s44 offen sc1
buffer_store_dwordx4 v[104:107], v3, s[12:15], s44 offen sc1
s_add_u32 s44, s44, 16384
s_waitcnt vmcnt(4)
v_mov_b32 v11, 1
s_mov_b64 exec, 1
buffer_store_dword v11, v7, s[16:19], s39 offen sc1
s_mov_b64 exec, -1
s_waitcnt lgkmcnt(0)
v_mfma_f32_16x16x32_bf16 v[160:163], a[0:3], v[224:227], v[160:163]
ds_read_b64_tr_b16 a[56:57], v12 offset:160
v_mfma_f32_16x16x32_bf16 v[164:167], a[0:3], v[228:231], v[164:167]
ds_read_b64_tr_b16 a[58:59], v12 offset:1952
v_mfma_f32_16x16x32_bf16 v[168:171], a[0:3], v[232:235], v[168:171]
ds_read_b64_tr_b16 a[60:61], v12 offset:14496
v_mfma_f32_16x16x32_bf16 v[172:175], a[0:3], v[236:239], v[172:175]
ds_read_b64_tr_b16 a[62:63], v12 offset:16288
v_mfma_f32_16x16x32_bf16 a[112:115], a[4:7], v[224:227], a[112:115]
ds_read_b64_tr_b16 a[64:65], v12 offset:7328
v_mfma_f32_16x16x32_bf16 a[116:119], a[4:7], v[228:231], a[116:119]
ds_read_b64_tr_b16 a[66:67], v12 offset:9120
v_mfma_f32_16x16x32_bf16 a[120:123], a[4:7], v[232:235], a[120:123]
ds_read_b64_tr_b16 a[68:69], v12 offset:21664
v_mfma_f32_16x16x32_bf16 a[124:127], a[4:7], v[236:239], a[124:127]
ds_read_b64_tr_b16 a[70:71], v12 offset:23456
v_mfma_f32_16x16x32_bf16 v[160:163], a[8:11], v[240:243], v[160:163]
ds_read_b64_tr_b16 a[72:73], v12 offset:28832
v_mfma_f32_16x16x32_bf16 v[164:167], a[8:11], v[244:247], v[164:167]
ds_read_b64_tr_b16 a[74:75], v12 offset:30624
v_mfma_f32_16x16x32_bf16 v[168:171], a[8:11], v[248:251], v[168:171]
ds_read_b64_tr_b16 a[76:77], v12 offset:43168
v_mfma_f32_16x16x32_bf16 v[172:175], a[8:11], v[252:255], v[172:175]
ds_read_b64_tr_b16 a[78:79], v12 offset:44960
v_mfma_f32_16x16x32_bf16 a[112:115], a[12:15], v[240:243], a[112:115]
ds_read_b64_tr_b16 a[80:81], v12 offset:36000
v_mfma_f32_16x16x32_bf16 a[116:119], a[12:15], v[244:247], a[116:119]
ds_read_b64_tr_b16 a[82:83], v12 offset:37792
v_mfma_f32_16x16x32_bf16 a[120:123], a[12:15], v[248:251], a[120:123]
ds_read_b64_tr_b16 a[84:85], v12 offset:50336
v_mfma_f32_16x16x32_bf16 a[124:127], a[12:15], v[252:255], a[124:127]
ds_read_b64_tr_b16 a[86:87], v12 offset:52128
v_mfma_f32_16x16x32_bf16 v[160:163], a[16:19], v[176:179], v[160:163]
v_mfma_f32_16x16x32_bf16 v[164:167], a[16:19], v[180:183], v[164:167]
v_mfma_f32_16x16x32_bf16 v[168:171], a[16:19], v[184:187], v[168:171]
v_mfma_f32_16x16x32_bf16 v[172:175], a[16:19], v[188:191], v[172:175]
v_mfma_f32_16x16x32_bf16 a[112:115], a[20:23], v[176:179], a[112:115]
v_mfma_f32_16x16x32_bf16 a[116:119], a[20:23], v[180:183], a[116:119]
v_mfma_f32_16x16x32_bf16 a[120:123], a[20:23], v[184:187], a[120:123]
v_mfma_f32_16x16x32_bf16 a[124:127], a[20:23], v[188:191], a[124:127]
v_mfma_f32_16x16x32_bf16 v[160:163], a[24:27], v[192:195], v[160:163]
v_mfma_f32_16x16x32_bf16 v[164:167], a[24:27], v[196:199], v[164:167]
v_mfma_f32_16x16x32_bf16 v[168:171], a[24:27], v[200:203], v[168:171]
v_mfma_f32_16x16x32_bf16 v[172:175], a[24:27], v[204:207], v[172:175]
v_mfma_f32_16x16x32_bf16 a[112:115], a[28:31], v[192:195], a[112:115]
v_mfma_f32_16x16x32_bf16 a[116:119], a[28:31], v[196:199], a[116:119]
v_mfma_f32_16x16x32_bf16 a[120:123], a[28:31], v[200:203], a[120:123]
v_mfma_f32_16x16x32_bf16 a[124:127], a[28:31], v[204:207], a[124:127]
v_pk_fma_f32 v[128:129], v[4:5], v[22:23], v[128:129] op_sel_hi:[0,1,1]
v_pk_fma_f32 v[144:145], v[4:5], v[26:27], v[144:145] op_sel_hi:[0,1,1]
v_pk_fma_f32 v[130:131], v[4:5], v[24:25], v[130:131] op_sel_hi:[0,1,1]
v_pk_fma_f32 v[146:147], v[4:5], v[28:29], v[146:147] op_sel_hi:[0,1,1]
v_pk_fma_f32 v[132:133], v[8:9], v[22:23], v[132:133] op_sel_hi:[0,1,1]
v_pk_fma_f32 v[148:149], v[8:9], v[26:27], v[148:149] op_sel_hi:[0,1,1]
v_pk_fma_f32 v[134:135], v[8:9], v[24:25], v[134:135] op_sel_hi:[0,1,1]
v_pk_fma_f32 v[150:151], v[8:9], v[28:29], v[150:151] op_sel_hi:[0,1,1]
v_pk_fma_f32 v[136:137], v[14:15], v[22:23], v[136:137] op_sel_hi:[0,1,1]
v_pk_fma_f32 v[152:153], v[14:15], v[26:27], v[152:153] op_sel_hi:[0,1,1]
v_pk_fma_f32 v[138:139], v[14:15], v[24:25], v[138:139] op_sel_hi:[0,1,1]
v_pk_fma_f32 v[154:155], v[14:15], v[28:29], v[154:155] op_sel_hi:[0,1,1]
v_pk_fma_f32 v[140:141], v[18:19], v[22:23], v[140:141] op_sel_hi:[0,1,1]
v_pk_fma_f32 v[156:157], v[18:19], v[26:27], v[156:157] op_sel_hi:[0,1,1]
v_pk_fma_f32 v[142:143], v[18:19], v[24:25], v[142:143] op_sel_hi:[0,1,1]
v_pk_fma_f32 v[158:159], v[18:19], v[28:29], v[158:159] op_sel_hi:[0,1,1]
ds_read_b128 v[22:25], v1 offset:256
ds_read_b128 v[26:29], v1 offset:704
v_pk_mul_f32 v[144:145], v[128:129], v[144:145]
v_pk_mul_f32 v[128:129], v[128:129], v[4:5] op_sel:[0,1] op_sel_hi:[1,1]
v_pk_mul_f32 v[146:147], v[130:131], v[146:147]
v_pk_mul_f32 v[130:131], v[130:131], v[4:5] op_sel:[0,1] op_sel_hi:[1,1]
v_pk_mul_f32 v[148:149], v[132:133], v[148:149]
v_pk_mul_f32 v[132:133], v[132:133], v[8:9] op_sel:[0,1] op_sel_hi:[1,1]
v_pk_mul_f32 v[150:151], v[134:135], v[150:151]
v_pk_mul_f32 v[134:135], v[134:135], v[8:9] op_sel:[0,1] op_sel_hi:[1,1]
v_pk_mul_f32 v[152:153], v[136:137], v[152:153]
v_pk_mul_f32 v[136:137], v[136:137], v[14:15] op_sel:[0,1] op_sel_hi:[1,1]
v_pk_mul_f32 v[154:155], v[138:139], v[154:155]
v_pk_mul_f32 v[138:139], v[138:139], v[14:15] op_sel:[0,1] op_sel_hi:[1,1]
v_pk_mul_f32 v[156:157], v[140:141], v[156:157]
v_pk_mul_f32 v[140:141], v[140:141], v[18:19] op_sel:[0,1] op_sel_hi:[1,1]
v_pk_mul_f32 v[158:159], v[142:143], v[158:159]
v_pk_mul_f32 v[142:143], v[142:143], v[18:19] op_sel:[0,1] op_sel_hi:[1,1]
v_exp_f32 v128, v128
v_exp_f32 v129, v129
v_exp_f32 v130, v130
v_exp_f32 v131, v131
v_exp_f32 v132, v132
v_exp_f32 v133, v133
v_exp_f32 v134, v134
v_exp_f32 v135, v135
v_exp_f32 v136, v136
v_exp_f32 v137, v137
v_exp_f32 v138, v138
v_exp_f32 v139, v139
v_exp_f32 v140, v140
v_exp_f32 v141, v141
v_exp_f32 v142, v142
v_exp_f32 v143, v143
v_pk_fma_f32 v[128:129], v[128:129], v[6:7], v[6:7] op_sel_hi:[1,0,0]
v_pk_fma_f32 v[130:131], v[130:131], v[6:7], v[6:7] op_sel_hi:[1,0,0]
v_pk_fma_f32 v[132:133], v[132:133], v[10:11], v[10:11] op_sel_hi:[1,0,0]
v_pk_fma_f32 v[134:135], v[134:135], v[10:11], v[10:11] op_sel_hi:[1,0,0]
v_pk_fma_f32 v[136:137], v[136:137], v[16:17], v[16:17] op_sel_hi:[1,0,0]
v_pk_fma_f32 v[138:139], v[138:139], v[16:17], v[16:17] op_sel_hi:[1,0,0]
v_pk_fma_f32 v[140:141], v[140:141], v[20:21], v[20:21] op_sel_hi:[1,0,0]
v_pk_fma_f32 v[142:143], v[142:143], v[20:21], v[20:21] op_sel_hi:[1,0,0]
v_rcp_f32 v128, v128
v_rcp_f32 v129, v129
v_rcp_f32 v130, v130
v_rcp_f32 v131, v131
v_rcp_f32 v132, v132
v_rcp_f32 v133, v133
v_rcp_f32 v134, v134
v_rcp_f32 v135, v135
v_rcp_f32 v136, v136
v_rcp_f32 v137, v137
v_rcp_f32 v138, v138
v_rcp_f32 v139, v139
v_rcp_f32 v140, v140
v_rcp_f32 v141, v141
v_rcp_f32 v142, v142
v_rcp_f32 v143, v143
v_pk_mul_f32 v[144:145], v[128:129], v[144:145]
v_pk_mul_f32 v[146:147], v[130:131], v[146:147]
v_pk_mul_f32 v[148:149], v[132:133], v[148:149]
v_pk_mul_f32 v[150:151], v[134:135], v[150:151]
v_pk_mul_f32 v[152:153], v[136:137], v[152:153]
v_pk_mul_f32 v[154:155], v[138:139], v[154:155]
v_pk_mul_f32 v[156:157], v[140:141], v[156:157]
v_pk_mul_f32 v[158:159], v[142:143], v[158:159]
v_cvt_pk_bf16_f32 v128, v144, v145
v_cvt_pk_bf16_f32 v129, v146, v147
v_cvt_pk_bf16_f32 v130, v148, v149
v_cvt_pk_bf16_f32 v131, v150, v151
v_cvt_pk_bf16_f32 v136, v152, v153
v_cvt_pk_bf16_f32 v137, v154, v155
v_cvt_pk_bf16_f32 v138, v156, v157
v_cvt_pk_bf16_f32 v139, v158, v159
s_nop 0
v_permlane32_swap_b32 v128, v130
v_permlane32_swap_b32 v129, v131
v_permlane32_swap_b32 v136, v138
v_permlane32_swap_b32 v137, v139
buffer_store_dwordx4 v[128:131], v2, s[12:15], s44 offen sc1
buffer_store_dwordx4 v[136:139], v3, s[12:15], s44 offen sc1
s_add_u32 s44, s44, 16384
s_waitcnt lgkmcnt(0)
v_mfma_f32_16x16x32_bf16 a[128:131], a[56:59], v[224:227], a[128:131]
ds_read_b64_tr_b16 a[0:1], v12 offset:192
v_mfma_f32_16x16x32_bf16 a[132:135], a[56:59], v[228:231], a[132:135]
ds_read_b64_tr_b16 a[2:3], v12 offset:1984
v_mfma_f32_16x16x32_bf16 a[136:139], a[56:59], v[232:235], a[136:139]
ds_read_b64_tr_b16 a[4:5], v12 offset:14528
v_mfma_f32_16x16x32_bf16 a[140:143], a[56:59], v[236:239], a[140:143]
ds_read_b64_tr_b16 a[6:7], v12 offset:16320
v_mfma_f32_16x16x32_bf16 a[144:147], a[60:63], v[224:227], a[144:147]
ds_read_b64_tr_b16 a[8:9], v12 offset:7360
v_mfma_f32_16x16x32_bf16 a[148:151], a[60:63], v[228:231], a[148:151]
ds_read_b64_tr_b16 a[10:11], v12 offset:9152
v_mfma_f32_16x16x32_bf16 a[152:155], a[60:63], v[232:235], a[152:155]
ds_read_b64_tr_b16 a[12:13], v12 offset:21696
v_mfma_f32_16x16x32_bf16 a[156:159], a[60:63], v[236:239], a[156:159]
ds_read_b64_tr_b16 a[14:15], v12 offset:23488
v_mfma_f32_16x16x32_bf16 a[128:131], a[64:67], v[240:243], a[128:131]
ds_read_b64_tr_b16 a[16:17], v12 offset:28864
v_mfma_f32_16x16x32_bf16 a[132:135], a[64:67], v[244:247], a[132:135]
ds_read_b64_tr_b16 a[18:19], v12 offset:30656
v_mfma_f32_16x16x32_bf16 a[136:139], a[64:67], v[248:251], a[136:139]
ds_read_b64_tr_b16 a[20:21], v12 offset:43200
v_mfma_f32_16x16x32_bf16 a[140:143], a[64:67], v[252:255], a[140:143]
ds_read_b64_tr_b16 a[22:23], v12 offset:44992
v_mfma_f32_16x16x32_bf16 a[144:147], a[68:71], v[240:243], a[144:147]
ds_read_b64_tr_b16 a[24:25], v12 offset:36032
v_mfma_f32_16x16x32_bf16 a[148:151], a[68:71], v[244:247], a[148:151]
ds_read_b64_tr_b16 a[26:27], v12 offset:37824
v_mfma_f32_16x16x32_bf16 a[152:155], a[68:71], v[248:251], a[152:155]
ds_read_b64_tr_b16 a[28:29], v12 offset:50368
v_mfma_f32_16x16x32_bf16 a[156:159], a[68:71], v[252:255], a[156:159]
ds_read_b64_tr_b16 a[30:31], v12 offset:52160
v_mfma_f32_16x16x32_bf16 a[128:131], a[72:75], v[176:179], a[128:131]
v_mfma_f32_16x16x32_bf16 a[132:135], a[72:75], v[180:183], a[132:135]
v_mfma_f32_16x16x32_bf16 a[136:139], a[72:75], v[184:187], a[136:139]
v_mfma_f32_16x16x32_bf16 a[140:143], a[72:75], v[188:191], a[140:143]
v_mfma_f32_16x16x32_bf16 a[144:147], a[76:79], v[176:179], a[144:147]
v_mfma_f32_16x16x32_bf16 a[148:151], a[76:79], v[180:183], a[148:151]
v_mfma_f32_16x16x32_bf16 a[152:155], a[76:79], v[184:187], a[152:155]
v_mfma_f32_16x16x32_bf16 a[156:159], a[76:79], v[188:191], a[156:159]
v_mfma_f32_16x16x32_bf16 a[128:131], a[80:83], v[192:195], a[128:131]
v_mfma_f32_16x16x32_bf16 a[132:135], a[80:83], v[196:199], a[132:135]
v_mfma_f32_16x16x32_bf16 a[136:139], a[80:83], v[200:203], a[136:139]
v_mfma_f32_16x16x32_bf16 a[140:143], a[80:83], v[204:207], a[140:143]
v_mfma_f32_16x16x32_bf16 a[144:147], a[84:87], v[192:195], a[144:147]
v_mfma_f32_16x16x32_bf16 a[148:151], a[84:87], v[196:199], a[148:151]
v_mfma_f32_16x16x32_bf16 a[152:155], a[84:87], v[200:203], a[152:155]
v_mfma_f32_16x16x32_bf16 a[156:159], a[84:87], v[204:207], a[156:159]
v_accvgpr_read_b32 v128, a112
v_accvgpr_read_b32 v129, a113
v_accvgpr_read_b32 v130, a114
v_accvgpr_read_b32 v131, a115
v_accvgpr_read_b32 v132, a116
v_accvgpr_read_b32 v133, a117
v_accvgpr_read_b32 v134, a118
v_accvgpr_read_b32 v135, a119
v_accvgpr_read_b32 v136, a120
v_accvgpr_read_b32 v137, a121
v_accvgpr_read_b32 v138, a122
v_accvgpr_read_b32 v139, a123
v_accvgpr_read_b32 v140, a124
v_accvgpr_read_b32 v141, a125
v_accvgpr_read_b32 v142, a126
v_accvgpr_read_b32 v143, a127
v_pk_fma_f32 v[160:161], v[4:5], v[22:23], v[160:161] op_sel_hi:[0,1,1]
v_pk_fma_f32 v[128:129], v[4:5], v[26:27], v[128:129] op_sel_hi:[0,1,1]
v_pk_fma_f32 v[162:163], v[4:5], v[24:25], v[162:163] op_sel_hi:[0,1,1]
v_pk_fma_f32 v[130:131], v[4:5], v[28:29], v[130:131] op_sel_hi:[0,1,1]
v_pk_fma_f32 v[164:165], v[8:9], v[22:23], v[164:165] op_sel_hi:[0,1,1]
v_pk_fma_f32 v[132:133], v[8:9], v[26:27], v[132:133] op_sel_hi:[0,1,1]
v_pk_fma_f32 v[166:167], v[8:9], v[24:25], v[166:167] op_sel_hi:[0,1,1]
v_pk_fma_f32 v[134:135], v[8:9], v[28:29], v[134:135] op_sel_hi:[0,1,1]
v_pk_fma_f32 v[168:169], v[14:15], v[22:23], v[168:169] op_sel_hi:[0,1,1]
v_pk_fma_f32 v[136:137], v[14:15], v[26:27], v[136:137] op_sel_hi:[0,1,1]
v_pk_fma_f32 v[170:171], v[14:15], v[24:25], v[170:171] op_sel_hi:[0,1,1]
v_pk_fma_f32 v[138:139], v[14:15], v[28:29], v[138:139] op_sel_hi:[0,1,1]
v_pk_fma_f32 v[172:173], v[18:19], v[22:23], v[172:173] op_sel_hi:[0,1,1]
v_pk_fma_f32 v[140:141], v[18:19], v[26:27], v[140:141] op_sel_hi:[0,1,1]
v_pk_fma_f32 v[174:175], v[18:19], v[24:25], v[174:175] op_sel_hi:[0,1,1]
v_pk_fma_f32 v[142:143], v[18:19], v[28:29], v[142:143] op_sel_hi:[0,1,1]
ds_read_b128 v[22:25], v1 offset:320
ds_read_b128 v[26:29], v1 offset:768
v_pk_mul_f32 v[128:129], v[160:161], v[128:129]
v_pk_mul_f32 v[160:161], v[160:161], v[4:5] op_sel:[0,1] op_sel_hi:[1,1]
v_pk_mul_f32 v[130:131], v[162:163], v[130:131]
v_pk_mul_f32 v[162:163], v[162:163], v[4:5] op_sel:[0,1] op_sel_hi:[1,1]
v_pk_mul_f32 v[132:133], v[164:165], v[132:133]
v_pk_mul_f32 v[164:165], v[164:165], v[8:9] op_sel:[0,1] op_sel_hi:[1,1]
v_pk_mul_f32 v[134:135], v[166:167], v[134:135]
v_pk_mul_f32 v[166:167], v[166:167], v[8:9] op_sel:[0,1] op_sel_hi:[1,1]
v_pk_mul_f32 v[136:137], v[168:169], v[136:137]
v_pk_mul_f32 v[168:169], v[168:169], v[14:15] op_sel:[0,1] op_sel_hi:[1,1]
v_pk_mul_f32 v[138:139], v[170:171], v[138:139]
v_pk_mul_f32 v[170:171], v[170:171], v[14:15] op_sel:[0,1] op_sel_hi:[1,1]
v_pk_mul_f32 v[140:141], v[172:173], v[140:141]
v_pk_mul_f32 v[172:173], v[172:173], v[18:19] op_sel:[0,1] op_sel_hi:[1,1]
v_pk_mul_f32 v[142:143], v[174:175], v[142:143]
v_pk_mul_f32 v[174:175], v[174:175], v[18:19] op_sel:[0,1] op_sel_hi:[1,1]
v_exp_f32 v160, v160
v_exp_f32 v161, v161
v_exp_f32 v162, v162
v_exp_f32 v163, v163
v_exp_f32 v164, v164
v_exp_f32 v165, v165
v_exp_f32 v166, v166
v_exp_f32 v167, v167
v_exp_f32 v168, v168
v_exp_f32 v169, v169
v_exp_f32 v170, v170
v_exp_f32 v171, v171
v_exp_f32 v172, v172
v_exp_f32 v173, v173
v_exp_f32 v174, v174
v_exp_f32 v175, v175
v_pk_fma_f32 v[160:161], v[160:161], v[6:7], v[6:7] op_sel_hi:[1,0,0]
v_pk_fma_f32 v[162:163], v[162:163], v[6:7], v[6:7] op_sel_hi:[1,0,0]
v_pk_fma_f32 v[164:165], v[164:165], v[10:11], v[10:11] op_sel_hi:[1,0,0]
v_pk_fma_f32 v[166:167], v[166:167], v[10:11], v[10:11] op_sel_hi:[1,0,0]
v_pk_fma_f32 v[168:169], v[168:169], v[16:17], v[16:17] op_sel_hi:[1,0,0]
v_pk_fma_f32 v[170:171], v[170:171], v[16:17], v[16:17] op_sel_hi:[1,0,0]
v_pk_fma_f32 v[172:173], v[172:173], v[20:21], v[20:21] op_sel_hi:[1,0,0]
v_pk_fma_f32 v[174:175], v[174:175], v[20:21], v[20:21] op_sel_hi:[1,0,0]
v_rcp_f32 v160, v160
v_rcp_f32 v161, v161
v_rcp_f32 v162, v162
v_rcp_f32 v163, v163
v_rcp_f32 v164, v164
v_rcp_f32 v165, v165
v_rcp_f32 v166, v166
v_rcp_f32 v167, v167
v_rcp_f32 v168, v168
v_rcp_f32 v169, v169
v_rcp_f32 v170, v170
v_rcp_f32 v171, v171
v_rcp_f32 v172, v172
v_rcp_f32 v173, v173
v_rcp_f32 v174, v174
v_rcp_f32 v175, v175
v_pk_mul_f32 v[128:129], v[160:161], v[128:129]
v_pk_mul_f32 v[130:131], v[162:163], v[130:131]
v_pk_mul_f32 v[132:133], v[164:165], v[132:133]
v_pk_mul_f32 v[134:135], v[166:167], v[134:135]
v_pk_mul_f32 v[136:137], v[168:169], v[136:137]
v_pk_mul_f32 v[138:139], v[170:171], v[138:139]
v_pk_mul_f32 v[140:141], v[172:173], v[140:141]
v_pk_mul_f32 v[142:143], v[174:175], v[142:143]
v_cvt_pk_bf16_f32 v160, v128, v129
v_cvt_pk_bf16_f32 v161, v130, v131
v_cvt_pk_bf16_f32 v162, v132, v133
v_cvt_pk_bf16_f32 v163, v134, v135
v_cvt_pk_bf16_f32 v168, v136, v137
v_cvt_pk_bf16_f32 v169, v138, v139
v_cvt_pk_bf16_f32 v170, v140, v141
v_cvt_pk_bf16_f32 v171, v142, v143
s_nop 0
v_permlane32_swap_b32 v160, v162
v_permlane32_swap_b32 v161, v163
v_permlane32_swap_b32 v168, v170
v_permlane32_swap_b32 v169, v171
buffer_store_dwordx4 v[160:163], v2, s[12:15], s44 offen sc1
buffer_store_dwordx4 v[168:171], v3, s[12:15], s44 offen sc1
s_add_u32 s44, s44, 16384
s_lshr_b32 s56, s99, 1
s_lshl_b32 s56, s56, 5
s_lshl_b32 s57, s96, 4
s_add_u32 s56, s56, s57
s_lshl_b32 s56, s56, 7
s_add_u32 s56, s56, 28049408
v_and_b32 v151, 15, v0
v_lshlrev_b32 v144, 7, v151
v_add_u32 v144, s56, v144
s_mul_i32 s37, s99, 229376
s_mul_i32 s38, s96, 114688
s_add_u32 s37, s37, s38
v_bfe_u32 v150, v0, 4, 1
v_lshlrev_b32 v150, 9, v150
v_lshl_add_u32 v150, v151, 4, v150
v_lshrrev_b32 v149, 5, v0
v_mul_u32_u24 v146, 1024, v149
v_add3_u32 v146, v146, v150, s37
v_lshlrev_b32 v147, 4, v0
s_lshl_b32 s56, s99, 16
s_lshl_b32 s57, s98, 13
s_add_u32 s56, s56, s57
s_lshl_b32 s57, s96, 12
s_add_u32 s56, s56, s57
buffer_load_dwordx4 v[112:115], v147, s[4:7], s56 offen offset:0 sc1
buffer_load_dwordx4 v[116:119], v147, s[4:7], s56 offen offset:1024 sc1
buffer_load_dwordx4 v[120:123], v147, s[4:7], s56 offen offset:2048 sc1
buffer_load_dwordx4 v[124:127], v147, s[4:7], s56 offen offset:3072 sc1
v_lshlrev_b32 v149, 4, v149
v_bfe_u32 v150, v0, 2, 3
v_add_u32 v149, v149, v150
v_lshlrev_b32 v149, 8, v149
v_and_b32 v151, 3, v0
v_lshl_add_u32 v149, v151, 3, v149
s_lshl_b32 s40, s96, 2
v_xor_b32 v150, s40, v150
v_lshl_add_u32 v149, v150, 5, v149
v_lshlrev_b32 v148, 4, v0
v_xor_b32 v96, 0, v149
v_add_u32 v104, 65536, v96
v_xor_b32 v97, 32, v149
v_add_u32 v105, 65536, v97
v_xor_b32 v98, 64, v149
v_add_u32 v106, 65536, v98
v_xor_b32 v99, 96, v149
v_add_u32 v107, 65536, v99
v_xor_b32 v100, 128, v149
v_add_u32 v108, 65536, v100
v_xor_b32 v101, 160, v149
v_add_u32 v109, 65536, v101
v_xor_b32 v102, 192, v149
v_add_u32 v110, 65536, v102
v_xor_b32 v103, 224, v149
v_add_u32 v111, 65536, v103
s_waitcnt vmcnt(9)
v_mov_b32 v11, 3
s_mov_b64 exec, 1
buffer_store_dword v11, v7, s[16:19], s39 offen sc1
s_mov_b64 exec, -1
buffer_load_dword v145, v144, s[16:19], 0 offen sc1
s_waitcnt lgkmcnt(0)
s_barrier
v_mfma_f32_16x16x32_bf16 a[160:163], a[0:3], v[224:227], a[160:163]
v_mfma_f32_16x16x32_bf16 a[164:167], a[0:3], v[228:231], a[164:167]
s_add_u32 s100, s100, 458752
v_mfma_f32_16x16x32_bf16 a[168:171], a[0:3], v[232:235], a[168:171]
v_mfma_f32_16x16x32_bf16 a[172:175], a[0:3], v[236:239], a[172:175]
s_add_u32 m0, s26, 57344
v_mfma_f32_16x16x32_bf16 a[176:179], a[4:7], v[224:227], a[176:179]
v_mfma_f32_16x16x32_bf16 a[180:183], a[4:7], v[228:231], a[180:183]
buffer_load_dwordx4 v30, s[52:55], s100 offen lds
v_mfma_f32_16x16x32_bf16 a[184:187], a[4:7], v[232:235], a[184:187]
v_mfma_f32_16x16x32_bf16 a[188:191], a[4:7], v[236:239], a[188:191]
buffer_load_dwordx4 v31, s[52:55], s100 offen offset:1024 lds
v_mfma_f32_16x16x32_bf16 a[160:163], a[8:11], v[240:243], a[160:163]
v_mfma_f32_16x16x32_bf16 a[164:167], a[8:11], v[244:247], a[164:167]
s_sub_u32 s100, s100, 3178496
v_mfma_f32_16x16x32_bf16 a[168:171], a[8:11], v[248:251], a[168:171]
v_mfma_f32_16x16x32_bf16 a[172:175], a[8:11], v[252:255], a[172:175]
s_add_u32 m0, s26, 65536
v_mfma_f32_16x16x32_bf16 a[176:179], a[12:15], v[240:243], a[176:179]
v_mfma_f32_16x16x32_bf16 a[180:183], a[12:15], v[244:247], a[180:183]
buffer_load_dwordx4 v30, s[52:55], s100 offen lds
v_mfma_f32_16x16x32_bf16 a[184:187], a[12:15], v[248:251], a[184:187]
v_mfma_f32_16x16x32_bf16 a[188:191], a[12:15], v[252:255], a[188:191]
buffer_load_dwordx4 v31, s[52:55], s100 offen offset:1024 lds
v_mfma_f32_16x16x32_bf16 a[160:163], a[16:19], v[176:179], a[160:163]
s_add_u32 s100, s100, 458752
v_mfma_f32_16x16x32_bf16 a[164:167], a[16:19], v[180:183], a[164:167]
s_add_u32 m0, s26, 73728
v_mfma_f32_16x16x32_bf16 a[168:171], a[16:19], v[184:187], a[168:171]
buffer_load_dwordx4 v30, s[52:55], s100 offen lds
v_mfma_f32_16x16x32_bf16 a[172:175], a[16:19], v[188:191], a[172:175]
buffer_load_dwordx4 v31, s[52:55], s100 offen offset:1024 lds
v_mfma_f32_16x16x32_bf16 a[176:179], a[20:23], v[176:179], a[176:179]
s_add_u32 s100, s100, 458752
v_mfma_f32_16x16x32_bf16 a[180:183], a[20:23], v[180:183], a[180:183]
s_add_u32 m0, s26, 81920
v_mfma_f32_16x16x32_bf16 a[184:187], a[20:23], v[184:187], a[184:187]
buffer_load_dwordx4 v30, s[52:55], s100 offen lds
v_mfma_f32_16x16x32_bf16 a[188:191], a[20:23], v[188:191], a[188:191]
buffer_load_dwordx4 v31, s[52:55], s100 offen offset:1024 lds
v_mfma_f32_16x16x32_bf16 a[160:163], a[24:27], v[192:195], a[160:163]
s_add_u32 s100, s100, 458752
v_mfma_f32_16x16x32_bf16 a[164:167], a[24:27], v[196:199], a[164:167]
s_add_u32 m0, s26, 90112
v_mfma_f32_16x16x32_bf16 a[168:171], a[24:27], v[200:203], a[168:171]
buffer_load_dwordx4 v30, s[52:55], s100 offen lds
v_mfma_f32_16x16x32_bf16 a[172:175], a[24:27], v[204:207], a[172:175]
buffer_load_dwordx4 v31, s[52:55], s100 offen offset:1024 lds
v_mfma_f32_16x16x32_bf16 a[176:179], a[28:31], v[192:195], a[176:179]
v_mfma_f32_16x16x32_bf16 a[180:183], a[28:31], v[196:199], a[180:183]
v_mfma_f32_16x16x32_bf16 a[184:187], a[28:31], v[200:203], a[184:187]
v_mfma_f32_16x16x32_bf16 a[188:191], a[28:31], v[204:207], a[188:191]
v_accvgpr_read_b32 v152, a128
v_accvgpr_read_b32 v153, a129
v_accvgpr_read_b32 v154, a130
v_accvgpr_read_b32 v155, a131
v_accvgpr_read_b32 v156, a132
v_accvgpr_read_b32 v157, a133
v_accvgpr_read_b32 v158, a134
v_accvgpr_read_b32 v159, a135
v_accvgpr_read_b32 v160, a136
v_accvgpr_read_b32 v161, a137
v_accvgpr_read_b32 v162, a138
v_accvgpr_read_b32 v163, a139
v_accvgpr_read_b32 v164, a140
v_accvgpr_read_b32 v165, a141
v_accvgpr_read_b32 v166, a142
v_accvgpr_read_b32 v167, a143
v_accvgpr_read_b32 v128, a144
v_accvgpr_read_b32 v129, a145
v_accvgpr_read_b32 v130, a146
v_accvgpr_read_b32 v131, a147
v_accvgpr_read_b32 v132, a148
v_accvgpr_read_b32 v133, a149
v_accvgpr_read_b32 v134, a150
v_accvgpr_read_b32 v135, a151
v_accvgpr_read_b32 v136, a152
v_accvgpr_read_b32 v137, a153
v_accvgpr_read_b32 v138, a154
v_accvgpr_read_b32 v139, a155
v_accvgpr_read_b32 v140, a156
v_accvgpr_read_b32 v141, a157
v_accvgpr_read_b32 v142, a158
v_accvgpr_read_b32 v143, a159
v_pk_fma_f32 v[152:153], v[4:5], v[22:23], v[152:153] op_sel_hi:[0,1,1]
v_pk_fma_f32 v[128:129], v[4:5], v[26:27], v[128:129] op_sel_hi:[0,1,1]
v_pk_fma_f32 v[154:155], v[4:5], v[24:25], v[154:155] op_sel_hi:[0,1,1]
v_pk_fma_f32 v[130:131], v[4:5], v[28:29], v[130:131] op_sel_hi:[0,1,1]
v_pk_fma_f32 v[156:157], v[8:9], v[22:23], v[156:157] op_sel_hi:[0,1,1]
v_pk_fma_f32 v[132:133], v[8:9], v[26:27], v[132:133] op_sel_hi:[0,1,1]
v_pk_fma_f32 v[158:159], v[8:9], v[24:25], v[158:159] op_sel_hi:[0,1,1]
v_pk_fma_f32 v[134:135], v[8:9], v[28:29], v[134:135] op_sel_hi:[0,1,1]
v_pk_fma_f32 v[160:161], v[14:15], v[22:23], v[160:161] op_sel_hi:[0,1,1]
v_pk_fma_f32 v[136:137], v[14:15], v[26:27], v[136:137] op_sel_hi:[0,1,1]
v_pk_fma_f32 v[162:163], v[14:15], v[24:25], v[162:163] op_sel_hi:[0,1,1]
v_pk_fma_f32 v[138:139], v[14:15], v[28:29], v[138:139] op_sel_hi:[0,1,1]
v_pk_fma_f32 v[164:165], v[18:19], v[22:23], v[164:165] op_sel_hi:[0,1,1]
v_pk_fma_f32 v[140:141], v[18:19], v[26:27], v[140:141] op_sel_hi:[0,1,1]
v_pk_fma_f32 v[166:167], v[18:19], v[24:25], v[166:167] op_sel_hi:[0,1,1]
v_pk_fma_f32 v[142:143], v[18:19], v[28:29], v[142:143] op_sel_hi:[0,1,1]
ds_read_b128 v[22:25], v1 offset:384
ds_read_b128 v[26:29], v1 offset:832
v_pk_mul_f32 v[128:129], v[152:153], v[128:129]
v_pk_mul_f32 v[152:153], v[152:153], v[4:5] op_sel:[0,1] op_sel_hi:[1,1]
v_pk_mul_f32 v[130:131], v[154:155], v[130:131]
v_pk_mul_f32 v[154:155], v[154:155], v[4:5] op_sel:[0,1] op_sel_hi:[1,1]
v_pk_mul_f32 v[132:133], v[156:157], v[132:133]
v_pk_mul_f32 v[156:157], v[156:157], v[8:9] op_sel:[0,1] op_sel_hi:[1,1]
v_pk_mul_f32 v[134:135], v[158:159], v[134:135]
v_pk_mul_f32 v[158:159], v[158:159], v[8:9] op_sel:[0,1] op_sel_hi:[1,1]
v_pk_mul_f32 v[136:137], v[160:161], v[136:137]
v_pk_mul_f32 v[160:161], v[160:161], v[14:15] op_sel:[0,1] op_sel_hi:[1,1]
v_pk_mul_f32 v[138:139], v[162:163], v[138:139]
v_pk_mul_f32 v[162:163], v[162:163], v[14:15] op_sel:[0,1] op_sel_hi:[1,1]
v_pk_mul_f32 v[140:141], v[164:165], v[140:141]
v_pk_mul_f32 v[164:165], v[164:165], v[18:19] op_sel:[0,1] op_sel_hi:[1,1]
v_pk_mul_f32 v[142:143], v[166:167], v[142:143]
v_pk_mul_f32 v[166:167], v[166:167], v[18:19] op_sel:[0,1] op_sel_hi:[1,1]
v_exp_f32 v152, v152
v_exp_f32 v153, v153
v_exp_f32 v154, v154
v_exp_f32 v155, v155
v_exp_f32 v156, v156
v_exp_f32 v157, v157
v_exp_f32 v158, v158
v_exp_f32 v159, v159
v_exp_f32 v160, v160
v_exp_f32 v161, v161
v_exp_f32 v162, v162
v_exp_f32 v163, v163
v_exp_f32 v164, v164
v_exp_f32 v165, v165
v_exp_f32 v166, v166
v_exp_f32 v167, v167
v_pk_fma_f32 v[152:153], v[152:153], v[6:7], v[6:7] op_sel_hi:[1,0,0]
v_pk_fma_f32 v[154:155], v[154:155], v[6:7], v[6:7] op_sel_hi:[1,0,0]
v_pk_fma_f32 v[156:157], v[156:157], v[10:11], v[10:11] op_sel_hi:[1,0,0]
v_pk_fma_f32 v[158:159], v[158:159], v[10:11], v[10:11] op_sel_hi:[1,0,0]
v_pk_fma_f32 v[160:161], v[160:161], v[16:17], v[16:17] op_sel_hi:[1,0,0]
v_pk_fma_f32 v[162:163], v[162:163], v[16:17], v[16:17] op_sel_hi:[1,0,0]
v_pk_fma_f32 v[164:165], v[164:165], v[20:21], v[20:21] op_sel_hi:[1,0,0]
v_pk_fma_f32 v[166:167], v[166:167], v[20:21], v[20:21] op_sel_hi:[1,0,0]
v_rcp_f32 v152, v152
v_rcp_f32 v153, v153
v_rcp_f32 v154, v154
v_rcp_f32 v155, v155
v_rcp_f32 v156, v156
v_rcp_f32 v157, v157
v_rcp_f32 v158, v158
v_rcp_f32 v159, v159
v_rcp_f32 v160, v160
v_rcp_f32 v161, v161
v_rcp_f32 v162, v162
v_rcp_f32 v163, v163
v_rcp_f32 v164, v164
v_rcp_f32 v165, v165
v_rcp_f32 v166, v166
v_rcp_f32 v167, v167
v_pk_mul_f32 v[128:129], v[152:153], v[128:129]
v_pk_mul_f32 v[130:131], v[154:155], v[130:131]
v_pk_mul_f32 v[132:133], v[156:157], v[132:133]
v_pk_mul_f32 v[134:135], v[158:159], v[134:135]
v_pk_mul_f32 v[136:137], v[160:161], v[136:137]
v_pk_mul_f32 v[138:139], v[162:163], v[138:139]
v_pk_mul_f32 v[140:141], v[164:165], v[140:141]
v_pk_mul_f32 v[142:143], v[166:167], v[142:143]
v_cvt_pk_bf16_f32 v152, v128, v129
v_cvt_pk_bf16_f32 v153, v130, v131
v_cvt_pk_bf16_f32 v154, v132, v133
v_cvt_pk_bf16_f32 v155, v134, v135
v_cvt_pk_bf16_f32 v160, v136, v137
v_cvt_pk_bf16_f32 v161, v138, v139
v_cvt_pk_bf16_f32 v162, v140, v141
v_cvt_pk_bf16_f32 v163, v142, v143
s_nop 0
v_permlane32_swap_b32 v152, v154
v_permlane32_swap_b32 v153, v155
v_permlane32_swap_b32 v160, v162
v_permlane32_swap_b32 v161, v163
buffer_store_dwordx4 v[152:155], v2, s[12:15], s44 offen sc1
buffer_store_dwordx4 v[160:163], v3, s[12:15], s44 offen sc1
s_add_u32 s44, s44, 16384
s_waitcnt vmcnt(14)
v_lshlrev_b32 v32, 16, v112
v_and_b32 v33, 0xffff0000, v112
v_lshlrev_b32 v34, 16, v113
v_and_b32 v35, 0xffff0000, v113
v_lshlrev_b32 v36, 16, v116
v_and_b32 v37, 0xffff0000, v116
v_lshlrev_b32 v38, 16, v117
v_and_b32 v39, 0xffff0000, v117
v_lshlrev_b32 v40, 16, v120
v_and_b32 v41, 0xffff0000, v120
v_lshlrev_b32 v42, 16, v121
v_and_b32 v43, 0xffff0000, v121
v_lshlrev_b32 v44, 16, v124
v_and_b32 v45, 0xffff0000, v124
v_lshlrev_b32 v46, 16, v125
v_and_b32 v47, 0xffff0000, v125
v_lshlrev_b32 v64, 16, v114
v_and_b32 v65, 0xffff0000, v114
v_lshlrev_b32 v66, 16, v115
v_and_b32 v67, 0xffff0000, v115
v_lshlrev_b32 v68, 16, v118
v_and_b32 v69, 0xffff0000, v118
v_lshlrev_b32 v70, 16, v119
v_and_b32 v71, 0xffff0000, v119
v_lshlrev_b32 v72, 16, v122
v_and_b32 v73, 0xffff0000, v122
v_lshlrev_b32 v74, 16, v123
v_and_b32 v75, 0xffff0000, v123
v_lshlrev_b32 v76, 16, v126
v_and_b32 v77, 0xffff0000, v126
v_lshlrev_b32 v78, 16, v127
v_and_b32 v79, 0xffff0000, v127
s_waitcnt vmcnt(12)
v_cmp_le_u32 vcc, 1, v145
s_cmp_eq_u64 vcc, -1
s_cselect_b32 s23, 1, 0
s_cbranch_scc0 L_g2_late0
s_mov_b32 s20, 0
buffer_load_dwordx4 a[192:195], v146, s[12:15], s20 offen offset:0 sc1
buffer_load_dwordx4 a[196:199], v146, s[12:15], s20 offen offset:256 sc1
buffer_load_dwordx4 a[200:203], v146, s[12:15], s20 offen offset:2048 sc1
buffer_load_dwordx4 a[204:207], v146, s[12:15], s20 offen offset:2304 sc1
s_add_u32 s20, s20, 4096
buffer_load_dwordx4 a[208:211], v146, s[12:15], s20 offen offset:0 sc1
buffer_load_dwordx4 a[212:215], v146, s[12:15], s20 offen offset:256 sc1
buffer_load_dwordx4 a[216:219], v146, s[12:15], s20 offen offset:2048 sc1
buffer_load_dwordx4 a[220:223], v146, s[12:15], s20 offen offset:2304 sc1
s_add_u32 s20, s20, 4096
buffer_load_dwordx4 a[224:227], v146, s[12:15], s20 offen offset:0 sc1
buffer_load_dwordx4 a[228:231], v146, s[12:15], s20 offen offset:256 sc1
buffer_load_dwordx4 a[232:235], v146, s[12:15], s20 offen offset:2048 sc1
buffer_load_dwordx4 a[236:239], v146, s[12:15], s20 offen offset:2304 sc1
s_add_u32 s20, s20, 4096
buffer_load_dwordx4 a[240:243], v146, s[12:15], s20 offen offset:0 sc1
buffer_load_dwordx4 a[244:247], v146, s[12:15], s20 offen offset:256 sc1
L_g2_late0:
s_waitcnt lgkmcnt(0)
s_waitcnt vmcnt(35)
s_barrier
ds_read_b64_tr_b16 a[0:1], v96 offset:0
ds_read_b64_tr_b16 a[2:3], v96 offset:2048
ds_read_b64_tr_b16 a[4:5], v97 offset:0
ds_read_b64_tr_b16 a[6:7], v97 offset:2048
ds_read_b64_tr_b16 a[8:9], v98 offset:0
ds_read_b64_tr_b16 a[10:11], v98 offset:2048
ds_read_b64_tr_b16 a[12:13], v99 offset:0
ds_read_b64_tr_b16 a[14:15], v99 offset:2048
ds_read_b64_tr_b16 a[16:17], v100 offset:0
ds_read_b64_tr_b16 a[18:19], v100 offset:2048
ds_read_b64_tr_b16 a[20:21], v101 offset:0
ds_read_b64_tr_b16 a[22:23], v101 offset:2048
ds_read_b64_tr_b16 a[24:25], v102 offset:0
ds_read_b64_tr_b16 a[26:27], v102 offset:2048
ds_read_b64_tr_b16 a[28:29], v103 offset:0
ds_read_b64_tr_b16 a[30:31], v103 offset:2048
v_accvgpr_read_b32 v176, a160
v_accvgpr_read_b32 v177, a161
v_accvgpr_read_b32 v178, a162
v_accvgpr_read_b32 v179, a163
s_add_u32 s100, s100, 458752
v_accvgpr_read_b32 v180, a164
v_accvgpr_read_b32 v181, a165
v_accvgpr_read_b32 v182, a166
v_accvgpr_read_b32 v183, a167
s_add_u32 m0, s26, 98304
v_accvgpr_read_b32 v184, a168
v_accvgpr_read_b32 v185, a169
v_accvgpr_read_b32 v186, a170
v_accvgpr_read_b32 v187, a171
buffer_load_dwordx4 v30, s[52:55], s100 offen lds
v_accvgpr_read_b32 v188, a172
v_accvgpr_read_b32 v189, a173
v_accvgpr_read_b32 v190, a174
v_accvgpr_read_b32 v191, a175
buffer_load_dwordx4 v31, s[52:55], s100 offen offset:1024 lds
v_accvgpr_read_b32 v192, a176
v_accvgpr_read_b32 v193, a177
v_accvgpr_read_b32 v194, a178
v_accvgpr_read_b32 v195, a179
s_add_u32 s100, s100, 458752
v_accvgpr_read_b32 v196, a180
v_accvgpr_read_b32 v197, a181
v_accvgpr_read_b32 v198, a182
v_accvgpr_read_b32 v199, a183
s_add_u32 m0, s26, 106496
v_accvgpr_read_b32 v200, a184
v_accvgpr_read_b32 v201, a185
v_accvgpr_read_b32 v202, a186
v_accvgpr_read_b32 v203, a187
buffer_load_dwordx4 v30, s[52:55], s100 offen lds
v_accvgpr_read_b32 v204, a188
v_accvgpr_read_b32 v205, a189
v_accvgpr_read_b32 v206, a190
v_accvgpr_read_b32 v207, a191
buffer_load_dwordx4 v31, s[52:55], s100 offen offset:1024 lds
v_pk_fma_f32 v[176:177], v[4:5], v[22:23], v[176:177] op_sel_hi:[0,1,1]
v_pk_fma_f32 v[192:193], v[4:5], v[26:27], v[192:193] op_sel_hi:[0,1,1]
v_pk_fma_f32 v[178:179], v[4:5], v[24:25], v[178:179] op_sel_hi:[0,1,1]
v_pk_fma_f32 v[194:195], v[4:5], v[28:29], v[194:195] op_sel_hi:[0,1,1]
s_add_u32 s100, s100, 458752
v_pk_fma_f32 v[180:181], v[8:9], v[22:23], v[180:181] op_sel_hi:[0,1,1]
v_pk_fma_f32 v[196:197], v[8:9], v[26:27], v[196:197] op_sel_hi:[0,1,1]
v_pk_fma_f32 v[182:183], v[8:9], v[24:25], v[182:183] op_sel_hi:[0,1,1]
v_pk_fma_f32 v[198:199], v[8:9], v[28:29], v[198:199] op_sel_hi:[0,1,1]
s_add_u32 m0, s26, 114688
v_pk_fma_f32 v[184:185], v[14:15], v[22:23], v[184:185] op_sel_hi:[0,1,1]
v_pk_fma_f32 v[200:201], v[14:15], v[26:27], v[200:201] op_sel_hi:[0,1,1]
v_pk_fma_f32 v[186:187], v[14:15], v[24:25], v[186:187] op_sel_hi:[0,1,1]
v_pk_fma_f32 v[202:203], v[14:15], v[28:29], v[202:203] op_sel_hi:[0,1,1]
buffer_load_dwordx4 v30, s[52:55], s100 offen lds
v_pk_fma_f32 v[188:189], v[18:19], v[22:23], v[188:189] op_sel_hi:[0,1,1]
v_pk_fma_f32 v[204:205], v[18:19], v[26:27], v[204:205] op_sel_hi:[0,1,1]
v_pk_fma_f32 v[190:191], v[18:19], v[24:25], v[190:191] op_sel_hi:[0,1,1]
v_pk_fma_f32 v[206:207], v[18:19], v[28:29], v[206:207] op_sel_hi:[0,1,1]
buffer_load_dwordx4 v31, s[52:55], s100 offen offset:1024 lds
v_pk_mul_f32 v[192:193], v[176:177], v[192:193]
v_pk_mul_f32 v[176:177], v[176:177], v[4:5] op_sel:[0,1] op_sel_hi:[1,1]
v_pk_mul_f32 v[194:195], v[178:179], v[194:195]
v_pk_mul_f32 v[178:179], v[178:179], v[4:5] op_sel:[0,1] op_sel_hi:[1,1]
s_add_u32 s100, s100, 458752
v_pk_mul_f32 v[196:197], v[180:181], v[196:197]
v_pk_mul_f32 v[180:181], v[180:181], v[8:9] op_sel:[0,1] op_sel_hi:[1,1]
v_pk_mul_f32 v[198:199], v[182:183], v[198:199]
v_pk_mul_f32 v[182:183], v[182:183], v[8:9] op_sel:[0,1] op_sel_hi:[1,1]
s_add_u32 m0, s26, 122880
v_pk_mul_f32 v[200:201], v[184:185], v[200:201]
v_pk_mul_f32 v[184:185], v[184:185], v[14:15] op_sel:[0,1] op_sel_hi:[1,1]
v_pk_mul_f32 v[202:203], v[186:187], v[202:203]
v_pk_mul_f32 v[186:187], v[186:187], v[14:15] op_sel:[0,1] op_sel_hi:[1,1]
buffer_load_dwordx4 v30, s[52:55], s100 offen lds
v_pk_mul_f32 v[204:205], v[188:189], v[204:205]
v_pk_mul_f32 v[188:189], v[188:189], v[18:19] op_sel:[0,1] op_sel_hi:[1,1]
v_pk_mul_f32 v[206:207], v[190:191], v[206:207]
v_pk_mul_f32 v[190:191], v[190:191], v[18:19] op_sel:[0,1] op_sel_hi:[1,1]
buffer_load_dwordx4 v31, s[52:55], s100 offen offset:1024 lds
v_exp_f32 v176, v176
v_exp_f32 v177, v177
v_exp_f32 v178, v178
v_exp_f32 v179, v179
v_exp_f32 v180, v180
v_exp_f32 v181, v181
v_exp_f32 v182, v182
v_exp_f32 v183, v183
v_exp_f32 v184, v184
v_exp_f32 v185, v185
v_exp_f32 v186, v186
v_exp_f32 v187, v187
v_exp_f32 v188, v188
v_exp_f32 v189, v189
v_exp_f32 v190, v190
v_exp_f32 v191, v191
v_pk_fma_f32 v[176:177], v[176:177], v[6:7], v[6:7] op_sel_hi:[1,0,0]
v_pk_fma_f32 v[178:179], v[178:179], v[6:7], v[6:7] op_sel_hi:[1,0,0]
v_pk_fma_f32 v[180:181], v[180:181], v[10:11], v[10:11] op_sel_hi:[1,0,0]
v_pk_fma_f32 v[182:183], v[182:183], v[10:11], v[10:11] op_sel_hi:[1,0,0]
v_pk_fma_f32 v[184:185], v[184:185], v[16:17], v[16:17] op_sel_hi:[1,0,0]
v_pk_fma_f32 v[186:187], v[186:187], v[16:17], v[16:17] op_sel_hi:[1,0,0]
v_pk_fma_f32 v[188:189], v[188:189], v[20:21], v[20:21] op_sel_hi:[1,0,0]
v_pk_fma_f32 v[190:191], v[190:191], v[20:21], v[20:21] op_sel_hi:[1,0,0]
v_rcp_f32 v176, v176
v_rcp_f32 v177, v177
v_rcp_f32 v178, v178
v_rcp_f32 v179, v179
v_rcp_f32 v180, v180
v_rcp_f32 v181, v181
v_rcp_f32 v182, v182
v_rcp_f32 v183, v183
v_rcp_f32 v184, v184
v_rcp_f32 v185, v185
v_rcp_f32 v186, v186
v_rcp_f32 v187, v187
v_rcp_f32 v188, v188
v_rcp_f32 v189, v189
v_rcp_f32 v190, v190
v_rcp_f32 v191, v191
v_pk_mul_f32 v[192:193], v[176:177], v[192:193]
v_pk_mul_f32 v[194:195], v[178:179], v[194:195]
v_pk_mul_f32 v[196:197], v[180:181], v[196:197]
v_pk_mul_f32 v[198:199], v[182:183], v[198:199]
v_pk_mul_f32 v[200:201], v[184:185], v[200:201]
v_pk_mul_f32 v[202:203], v[186:187], v[202:203]
v_pk_mul_f32 v[204:205], v[188:189], v[204:205]
v_pk_mul_f32 v[206:207], v[190:191], v[206:207]
v_cvt_pk_bf16_f32 v176, v192, v193
v_cvt_pk_bf16_f32 v177, v194, v195
v_cvt_pk_bf16_f32 v178, v196, v197
v_cvt_pk_bf16_f32 v179, v198, v199
v_cvt_pk_bf16_f32 v184, v200, v201
v_cvt_pk_bf16_f32 v185, v202, v203
v_cvt_pk_bf16_f32 v186, v204, v205
v_cvt_pk_bf16_f32 v187, v206, v207
s_nop 0
v_permlane32_swap_b32 v176, v178
v_permlane32_swap_b32 v177, v179
v_permlane32_swap_b32 v184, v186
v_permlane32_swap_b32 v185, v187
buffer_store_dwordx4 v[176:179], v2, s[12:15], s44 offen sc1
buffer_store_dwordx4 v[184:187], v3, s[12:15], s44 offen sc1
s_add_u32 s44, s44, 16384
s_cmp_eq_u32 s23, 1
s_cbranch_scc1 L_g2_go
s_mov_b32 s57, 0
L_g2_pl:
buffer_load_dword v145, v144, s[16:19], 0 offen sc1
s_waitcnt vmcnt(0)
v_cmp_le_u32 vcc, 1, v145
s_cmp_eq_u64 vcc, -1
s_cbranch_scc1 L_g2_pl2
s_add_u32 s57, s57, 1
s_cmp_gt_u32 s57, 20000
s_cbranch_scc0 L_g2_pl
L_g2_pl2:
s_mov_b32 s20, 0
buffer_load_dwordx4 a[192:195], v146, s[12:15], s20 offen offset:0 sc1
buffer_load_dwordx4 a[196:199], v146, s[12:15], s20 offen offset:256 sc1
buffer_load_dwordx4 a[200:203], v146, s[12:15], s20 offen offset:2048 sc1
buffer_load_dwordx4 a[204:207], v146, s[12:15], s20 offen offset:2304 sc1
s_add_u32 s20, s20, 4096
buffer_load_dwordx4 a[208:211], v146, s[12:15], s20 offen offset:0 sc1
buffer_load_dwordx4 a[212:215], v146, s[12:15], s20 offen offset:256 sc1
buffer_load_dwordx4 a[216:219], v146, s[12:15], s20 offen offset:2048 sc1
buffer_load_dwordx4 a[220:223], v146, s[12:15], s20 offen offset:2304 sc1
s_add_u32 s20, s20, 4096
buffer_load_dwordx4 a[224:227], v146, s[12:15], s20 offen offset:0 sc1
buffer_load_dwordx4 a[228:231], v146, s[12:15], s20 offen offset:256 sc1
buffer_load_dwordx4 a[232:235], v146, s[12:15], s20 offen offset:2048 sc1
buffer_load_dwordx4 a[236:239], v146, s[12:15], s20 offen offset:2304 sc1
s_add_u32 s20, s20, 4096
buffer_load_dwordx4 a[240:243], v146, s[12:15], s20 offen offset:0 sc1
buffer_load_dwordx4 a[244:247], v146, s[12:15], s20 offen offset:256 sc1
s_waitcnt vmcnt(0)
L_g2_go:
s_waitcnt vmcnt(42)
v_mov_b32 v11, 5
s_mov_b64 exec, 1
buffer_store_dword v11, v7, s[16:19], s39 offen sc1
s_mov_b64 exec, -1
buffer_load_dword v145, v144, s[16:19], 0 offen sc1
s_lshl_b32 s43, s2, 2
s_add_u32 s43, s43, s3
s_xor_b32 s44, s43, 16
s_lshl_b32 s43, s43, 12
s_lshl_b32 s44, s44, 12
s_add_u32 s43, s43, 29360128
s_add_u32 s44, s44, 29360128
s_mov_b32 s45, 5
s_waitcnt vmcnt(24)
s_waitcnt lgkmcnt(8)
v_mfma_f32_16x16x32_bf16 v[32:35], a[0:3], a[192:195], v[32:35]
ds_read_b64_tr_b16 a[32:33], v96 offset:8192
v_mfma_f32_16x16x32_bf16 v[64:67], a[0:3], a[196:199], v[64:67]
ds_read_b64_tr_b16 a[34:35], v96 offset:10240
buffer_load_dwordx4 a[248:251], v146, s[12:15], s20 offen offset:2048 sc1
v_mfma_f32_16x16x32_bf16 v[36:39], a[4:7], a[192:195], v[36:39]
ds_read_b64_tr_b16 a[36:37], v97 offset:8192
v_mfma_f32_16x16x32_bf16 v[68:71], a[4:7], a[196:199], v[68:71]
ds_read_b64_tr_b16 a[38:39], v97 offset:10240
buffer_load_dwordx4 a[252:255], v146, s[12:15], s20 offen offset:2304 sc1
v_mfma_f32_16x16x32_bf16 v[40:43], a[8:11], a[192:195], v[40:43]
ds_read_b64_tr_b16 a[40:41], v98 offset:8192
v_mfma_f32_16x16x32_bf16 v[72:75], a[8:11], a[196:199], v[72:75]
ds_read_b64_tr_b16 a[42:43], v98 offset:10240
v_mfma_f32_16x16x32_bf16 v[44:47], a[12:15], a[192:195], v[44:47]
ds_read_b64_tr_b16 a[44:45], v99 offset:8192
v_mfma_f32_16x16x32_bf16 v[76:79], a[12:15], a[196:199], v[76:79]
ds_read_b64_tr_b16 a[46:47], v99 offset:10240
s_waitcnt lgkmcnt(8)
v_mfma_f32_16x16x32_bf16 v[48:51], a[16:19], a[192:195], 0
ds_read_b64_tr_b16 a[48:49], v100 offset:8192
v_mfma_f32_16x16x32_bf16 v[80:83], a[16:19], a[196:199], 0
ds_read_b64_tr_b16 a[50:51], v100 offset:10240
v_mfma_f32_16x16x32_bf16 v[52:55], a[20:23], a[192:195], 0
ds_read_b64_tr_b16 a[52:53], v101 offset:8192
v_mfma_f32_16x16x32_bf16 v[84:87], a[20:23], a[196:199], 0
ds_read_b64_tr_b16 a[54:55], v101 offset:10240
v_mfma_f32_16x16x32_bf16 v[56:59], a[24:27], a[192:195], 0
ds_read_b64_tr_b16 a[56:57], v102 offset:8192
v_mfma_f32_16x16x32_bf16 v[88:91], a[24:27], a[196:199], 0
ds_read_b64_tr_b16 a[58:59], v102 offset:10240
v_mfma_f32_16x16x32_bf16 v[60:63], a[28:31], a[192:195], 0
ds_read_b64_tr_b16 a[60:61], v103 offset:8192
v_mfma_f32_16x16x32_bf16 v[92:95], a[28:31], a[196:199], 0
ds_read_b64_tr_b16 a[62:63], v103 offset:10240
s_waitcnt vmcnt(24)
s_waitcnt lgkmcnt(8)
v_mfma_f32_16x16x32_bf16 v[32:35], a[32:35], a[200:203], v[32:35]
ds_read_b64_tr_b16 a[0:1], v96 offset:16384
v_mfma_f32_16x16x32_bf16 v[64:67], a[32:35], a[204:207], v[64:67]
ds_read_b64_tr_b16 a[2:3], v96 offset:18432
s_waitcnt vmcnt(2)
s_mov_b32 s57, 0
L_g2_pollA0:
v_cmp_le_u32 vcc, 3, v145
s_cmp_eq_u64 vcc, -1
s_cbranch_scc1 L_g2_polledA0
s_add_u32 s57, s57, 1
s_cmp_gt_u32 s57, 20000
s_cbranch_scc1 L_g2_polledA0
buffer_load_dword v145, v144, s[16:19], 0 offen sc1
s_waitcnt vmcnt(0)
s_branch L_g2_pollA0
L_g2_polledA0:
v_mfma_f32_16x16x32_bf16 v[36:39], a[36:39], a[200:203], v[36:39]
ds_read_b64_tr_b16 a[4:5], v97 offset:16384
v_mfma_f32_16x16x32_bf16 v[68:71], a[36:39], a[204:207], v[68:71]
ds_read_b64_tr_b16 a[6:7], v97 offset:18432
s_add_u32 s20, s20, 4096
v_mfma_f32_16x16x32_bf16 v[40:43], a[40:43], a[200:203], v[40:43]
ds_read_b64_tr_b16 a[8:9], v98 offset:16384
v_mfma_f32_16x16x32_bf16 v[72:75], a[40:43], a[204:207], v[72:75]
ds_read_b64_tr_b16 a[10:11], v98 offset:18432
buffer_load_dwordx4 a[128:131], v146, s[12:15], s20 offen offset:0 sc1
v_mfma_f32_16x16x32_bf16 v[44:47], a[44:47], a[200:203], v[44:47]
ds_read_b64_tr_b16 a[12:13], v99 offset:16384
v_mfma_f32_16x16x32_bf16 v[76:79], a[44:47], a[204:207], v[76:79]
ds_read_b64_tr_b16 a[14:15], v99 offset:18432
buffer_load_dwordx4 a[132:135], v146, s[12:15], s20 offen offset:256 sc1
s_waitcnt lgkmcnt(8)
v_mfma_f32_16x16x32_bf16 v[48:51], a[48:51], a[200:203], v[48:51]
ds_read_b64_tr_b16 a[16:17], v100 offset:16384
v_mfma_f32_16x16x32_bf16 v[80:83], a[48:51], a[204:207], v[80:83]
ds_read_b64_tr_b16 a[18:19], v100 offset:18432
v_mfma_f32_16x16x32_bf16 v[52:55], a[52:55], a[200:203], v[52:55]
ds_read_b64_tr_b16 a[20:21], v101 offset:16384
v_mfma_f32_16x16x32_bf16 v[84:87], a[52:55], a[204:207], v[84:87]
ds_read_b64_tr_b16 a[22:23], v101 offset:18432
v_mfma_f32_16x16x32_bf16 v[56:59], a[56:59], a[200:203], v[56:59]
ds_read_b64_tr_b16 a[24:25], v102 offset:16384
v_mfma_f32_16x16x32_bf16 v[88:91], a[56:59], a[204:207], v[88:91]
ds_read_b64_tr_b16 a[26:27], v102 offset:18432
v_mfma_f32_16x16x32_bf16 v[60:63], a[60:63], a[200:203], v[60:63]
ds_read_b64_tr_b16 a[28:29], v103 offset:16384
v_mfma_f32_16x16x32_bf16 v[92:95], a[60:63], a[204:207], v[92:95]
ds_read_b64_tr_b16 a[30:31], v103 offset:18432
s_waitcnt vmcnt(24)
s_waitcnt lgkmcnt(8)
v_mfma_f32_16x16x32_bf16 v[32:35], a[0:3], a[208:211], v[32:35]
ds_read_b64_tr_b16 a[32:33], v96 offset:24576
v_mfma_f32_16x16x32_bf16 v[64:67], a[0:3], a[212:215], v[64:67]
ds_read_b64_tr_b16 a[34:35], v96 offset:26624
buffer_load_dwordx4 a[136:139], v146, s[12:15], s20 offen offset:2048 sc1
v_mfma_f32_16x16x32_bf16 v[36:39], a[4:7], a[208:211], v[36:39]
ds_read_b64_tr_b16 a[36:37], v97 offset:24576
v_mfma_f32_16x16x32_bf16 v[68:71], a[4:7], a[212:215], v[68:71]
ds_read_b64_tr_b16 a[38:39], v97 offset:26624
buffer_load_dwordx4 a[140:143], v146, s[12:15], s20 offen offset:2304 sc1
v_mfma_f32_16x16x32_bf16 v[40:43], a[8:11], a[208:211], v[40:43]
ds_read_b64_tr_b16 a[40:41], v98 offset:24576
v_mfma_f32_16x16x32_bf16 v[72:75], a[8:11], a[212:215], v[72:75]
ds_read_b64_tr_b16 a[42:43], v98 offset:26624
v_mfma_f32_16x16x32_bf16 v[44:47], a[12:15], a[208:211], v[44:47]
ds_read_b64_tr_b16 a[44:45], v99 offset:24576
v_mfma_f32_16x16x32_bf16 v[76:79], a[12:15], a[212:215], v[76:79]
ds_read_b64_tr_b16 a[46:47], v99 offset:26624
s_waitcnt lgkmcnt(8)
v_mfma_f32_16x16x32_bf16 v[48:51], a[16:19], a[208:211], v[48:51]
ds_read_b64_tr_b16 a[48:49], v100 offset:24576
v_mfma_f32_16x16x32_bf16 v[80:83], a[16:19], a[212:215], v[80:83]
ds_read_b64_tr_b16 a[50:51], v100 offset:26624
v_mfma_f32_16x16x32_bf16 v[52:55], a[20:23], a[208:211], v[52:55]
ds_read_b64_tr_b16 a[52:53], v101 offset:24576
v_mfma_f32_16x16x32_bf16 v[84:87], a[20:23], a[212:215], v[84:87]
ds_read_b64_tr_b16 a[54:55], v101 offset:26624
v_mfma_f32_16x16x32_bf16 v[56:59], a[24:27], a[208:211], v[56:59]
ds_read_b64_tr_b16 a[56:57], v102 offset:24576
v_mfma_f32_16x16x32_bf16 v[88:91], a[24:27], a[212:215], v[88:91]
ds_read_b64_tr_b16 a[58:59], v102 offset:26624
v_mfma_f32_16x16x32_bf16 v[60:63], a[28:31], a[208:211], v[60:63]
ds_read_b64_tr_b16 a[60:61], v103 offset:24576
v_mfma_f32_16x16x32_bf16 v[92:95], a[28:31], a[212:215], v[92:95]
ds_read_b64_tr_b16 a[62:63], v103 offset:26624
s_waitcnt vmcnt(24)
s_waitcnt lgkmcnt(8)
v_mfma_f32_16x16x32_bf16 v[32:35], a[32:35], a[216:219], v[32:35]
s_waitcnt vmcnt(8)
v_mov_b32 v11, 7
s_mov_b64 exec, 1
buffer_store_dword v11, v7, s[16:19], s39 offen sc1
s_mov_b64 exec, -1
v_mfma_f32_16x16x32_bf16 v[64:67], a[32:35], a[220:223], v[64:67]
s_add_u32 s20, s20, 4096
v_mfma_f32_16x16x32_bf16 v[36:39], a[36:39], a[216:219], v[36:39]
buffer_load_dwordx4 a[144:147], v146, s[12:15], s20 offen offset:0 sc1
v_mfma_f32_16x16x32_bf16 v[68:71], a[36:39], a[220:223], v[68:71]
buffer_load_dwordx4 a[148:151], v146, s[12:15], s20 offen offset:256 sc1
v_mfma_f32_16x16x32_bf16 v[40:43], a[40:43], a[216:219], v[40:43]
v_mfma_f32_16x16x32_bf16 v[72:75], a[40:43], a[220:223], v[72:75]
v_mfma_f32_16x16x32_bf16 v[44:47], a[44:47], a[216:219], v[44:47]
v_mfma_f32_16x16x32_bf16 v[76:79], a[44:47], a[220:223], v[76:79]
s_waitcnt vmcnt(45) lgkmcnt(0)
s_barrier
v_mfma_f32_16x16x32_bf16 v[48:51], a[48:51], a[216:219], v[48:51]
ds_read_b64_tr_b16 a[0:1], v96 offset:32768
ds_read_b64_tr_b16 a[2:3], v96 offset:34816
v_mfma_f32_16x16x32_bf16 v[80:83], a[48:51], a[220:223], v[80:83]
ds_read_b64_tr_b16 a[4:5], v97 offset:32768
ds_read_b64_tr_b16 a[6:7], v97 offset:34816
v_mfma_f32_16x16x32_bf16 v[52:55], a[52:55], a[216:219], v[52:55]
ds_read_b64_tr_b16 a[8:9], v98 offset:32768
ds_read_b64_tr_b16 a[10:11], v98 offset:34816
v_mfma_f32_16x16x32_bf16 v[84:87], a[52:55], a[220:223], v[84:87]
ds_read_b64_tr_b16 a[12:13], v99 offset:32768
ds_read_b64_tr_b16 a[14:15], v99 offset:34816
v_mfma_f32_16x16x32_bf16 v[56:59], a[56:59], a[216:219], v[56:59]
ds_read_b64_tr_b16 a[16:17], v100 offset:32768
ds_read_b64_tr_b16 a[18:19], v100 offset:34816
v_mfma_f32_16x16x32_bf16 v[88:91], a[56:59], a[220:223], v[88:91]
ds_read_b64_tr_b16 a[20:21], v101 offset:32768
ds_read_b64_tr_b16 a[22:23], v101 offset:34816
v_mfma_f32_16x16x32_bf16 v[60:63], a[60:63], a[216:219], v[60:63]
ds_read_b64_tr_b16 a[24:25], v102 offset:32768
ds_read_b64_tr_b16 a[26:27], v102 offset:34816
v_mfma_f32_16x16x32_bf16 v[92:95], a[60:63], a[220:223], v[92:95]
ds_read_b64_tr_b16 a[28:29], v103 offset:32768
ds_read_b64_tr_b16 a[30:31], v103 offset:34816
s_waitcnt vmcnt(25)
s_waitcnt lgkmcnt(8)
v_mfma_f32_16x16x32_bf16 v[32:35], a[0:3], a[224:227], v[32:35]
ds_read_b64_tr_b16 a[32:33], v96 offset:40960
v_mfma_f32_16x16x32_bf16 v[64:67], a[0:3], a[228:231], v[64:67]
ds_read_b64_tr_b16 a[34:35], v96 offset:43008
buffer_load_dwordx4 a[152:155], v146, s[12:15], s20 offen offset:2048 sc1
v_mfma_f32_16x16x32_bf16 v[36:39], a[4:7], a[224:227], v[36:39]
ds_read_b64_tr_b16 a[36:37], v97 offset:40960
v_mfma_f32_16x16x32_bf16 v[68:71], a[4:7], a[228:231], v[68:71]
ds_read_b64_tr_b16 a[38:39], v97 offset:43008
buffer_load_dwordx4 a[156:159], v146, s[12:15], s20 offen offset:2304 sc1
v_mfma_f32_16x16x32_bf16 v[40:43], a[8:11], a[224:227], v[40:43]
ds_read_b64_tr_b16 a[40:41], v98 offset:40960
v_mfma_f32_16x16x32_bf16 v[72:75], a[8:11], a[228:231], v[72:75]
ds_read_b64_tr_b16 a[42:43], v98 offset:43008
s_sub_u32 s100, s100, 3178496
v_mfma_f32_16x16x32_bf16 v[44:47], a[12:15], a[224:227], v[44:47]
ds_read_b64_tr_b16 a[44:45], v99 offset:40960
v_mfma_f32_16x16x32_bf16 v[76:79], a[12:15], a[228:231], v[76:79]
ds_read_b64_tr_b16 a[46:47], v99 offset:43008
s_add_u32 m0, s26, 0
s_waitcnt lgkmcnt(8)
v_mfma_f32_16x16x32_bf16 v[48:51], a[16:19], a[224:227], v[48:51]
ds_read_b64_tr_b16 a[48:49], v100 offset:40960
v_mfma_f32_16x16x32_bf16 v[80:83], a[16:19], a[228:231], v[80:83]
ds_read_b64_tr_b16 a[50:51], v100 offset:43008
buffer_load_dwordx4 v30, s[52:55], s100 offen lds
v_mfma_f32_16x16x32_bf16 v[52:55], a[20:23], a[224:227], v[52:55]
ds_read_b64_tr_b16 a[52:53], v101 offset:40960
v_mfma_f32_16x16x32_bf16 v[84:87], a[20:23], a[228:231], v[84:87]
ds_read_b64_tr_b16 a[54:55], v101 offset:43008
buffer_load_dwordx4 v31, s[52:55], s100 offen offset:1024 lds
v_mfma_f32_16x16x32_bf16 v[56:59], a[24:27], a[224:227], v[56:59]
ds_read_b64_tr_b16 a[56:57], v102 offset:40960
v_mfma_f32_16x16x32_bf16 v[88:91], a[24:27], a[228:231], v[88:91]
ds_read_b64_tr_b16 a[58:59], v102 offset:43008
v_mfma_f32_16x16x32_bf16 v[60:63], a[28:31], a[224:227], v[60:63]
ds_read_b64_tr_b16 a[60:61], v103 offset:40960
v_mfma_f32_16x16x32_bf16 v[92:95], a[28:31], a[228:231], v[92:95]
ds_read_b64_tr_b16 a[62:63], v103 offset:43008
s_waitcnt vmcnt(27)
s_waitcnt lgkmcnt(8)
v_mfma_f32_16x16x32_bf16 v[32:35], a[32:35], a[232:235], v[32:35]
ds_read_b64_tr_b16 a[0:1], v96 offset:49152
v_mfma_f32_16x16x32_bf16 v[64:67], a[32:35], a[236:239], v[64:67]
ds_read_b64_tr_b16 a[2:3], v96 offset:51200
s_add_u32 s20, s20, 4096
v_mfma_f32_16x16x32_bf16 v[36:39], a[36:39], a[232:235], v[36:39]
ds_read_b64_tr_b16 a[4:5], v97 offset:49152
v_mfma_f32_16x16x32_bf16 v[68:71], a[36:39], a[236:239], v[68:71]
ds_read_b64_tr_b16 a[6:7], v97 offset:51200
buffer_load_dwordx4 a[160:163], v146, s[12:15], s20 offen offset:0 sc1
v_mfma_f32_16x16x32_bf16 v[40:43], a[40:43], a[232:235], v[40:43]
ds_read_b64_tr_b16 a[8:9], v98 offset:49152
v_mfma_f32_16x16x32_bf16 v[72:75], a[40:43], a[236:239], v[72:75]
ds_read_b64_tr_b16 a[10:11], v98 offset:51200
buffer_load_dwordx4 a[164:167], v146, s[12:15], s20 offen offset:256 sc1
v_mfma_f32_16x16x32_bf16 v[44:47], a[44:47], a[232:235], v[44:47]
ds_read_b64_tr_b16 a[12:13], v99 offset:49152
v_mfma_f32_16x16x32_bf16 v[76:79], a[44:47], a[236:239], v[76:79]
ds_read_b64_tr_b16 a[14:15], v99 offset:51200
s_add_u32 s100, s100, 458752
s_waitcnt lgkmcnt(8)
v_mfma_f32_16x16x32_bf16 v[48:51], a[48:51], a[232:235], v[48:51]
ds_read_b64_tr_b16 a[16:17], v100 offset:49152
v_mfma_f32_16x16x32_bf16 v[80:83], a[48:51], a[236:239], v[80:83]
ds_read_b64_tr_b16 a[18:19], v100 offset:51200
s_add_u32 m0, s26, 8192
v_mfma_f32_16x16x32_bf16 v[52:55], a[52:55], a[232:235], v[52:55]
ds_read_b64_tr_b16 a[20:21], v101 offset:49152
v_mfma_f32_16x16x32_bf16 v[84:87], a[52:55], a[236:239], v[84:87]
ds_read_b64_tr_b16 a[22:23], v101 offset:51200
buffer_load_dwordx4 v30, s[52:55], s100 offen lds
v_mfma_f32_16x16x32_bf16 v[56:59], a[56:59], a[232:235], v[56:59]
ds_read_b64_tr_b16 a[24:25], v102 offset:49152
v_mfma_f32_16x16x32_bf16 v[88:91], a[56:59], a[236:239], v[88:91]
ds_read_b64_tr_b16 a[26:27], v102 offset:51200
buffer_load_dwordx4 v31, s[52:55], s100 offen offset:1024 lds
v_mfma_f32_16x16x32_bf16 v[60:63], a[60:63], a[232:235], v[60:63]
ds_read_b64_tr_b16 a[28:29], v103 offset:49152
v_mfma_f32_16x16x32_bf16 v[92:95], a[60:63], a[236:239], v[92:95]
ds_read_b64_tr_b16 a[30:31], v103 offset:51200
s_waitcnt vmcnt(29)
s_waitcnt lgkmcnt(8)
v_mfma_f32_16x16x32_bf16 v[32:35], a[0:3], a[240:243], v[32:35]
ds_read_b64_tr_b16 a[32:33], v96 offset:57344
v_mfma_f32_16x16x32_bf16 v[64:67], a[0:3], a[244:247], v[64:67]
ds_read_b64_tr_b16 a[34:35], v96 offset:59392
buffer_load_dwordx4 a[168:171], v146, s[12:15], s20 offen offset:2048 sc1
v_mfma_f32_16x16x32_bf16 v[36:39], a[4:7], a[240:243], v[36:39]
ds_read_b64_tr_b16 a[36:37], v97 offset:57344
v_mfma_f32_16x16x32_bf16 v[68:71], a[4:7], a[244:247], v[68:71]
ds_read_b64_tr_b16 a[38:39], v97 offset:59392
buffer_load_dwordx4 a[172:175], v146, s[12:15], s20 offen offset:2304 sc1
v_mfma_f32_16x16x32_bf16 v[40:43], a[8:11], a[240:243], v[40:43]
ds_read_b64_tr_b16 a[40:41], v98 offset:57344
v_mfma_f32_16x16x32_bf16 v[72:75], a[8:11], a[244:247], v[72:75]
ds_read_b64_tr_b16 a[42:43], v98 offset:59392
s_add_u32 s100, s100, 458752
v_mfma_f32_16x16x32_bf16 v[44:47], a[12:15], a[240:243], v[44:47]
ds_read_b64_tr_b16 a[44:45], v99 offset:57344
v_mfma_f32_16x16x32_bf16 v[76:79], a[12:15], a[244:247], v[76:79]
ds_read_b64_tr_b16 a[46:47], v99 offset:59392
s_add_u32 m0, s26, 16384
s_waitcnt lgkmcnt(8)
v_mfma_f32_16x16x32_bf16 v[48:51], a[16:19], a[240:243], v[48:51]
ds_read_b64_tr_b16 a[48:49], v100 offset:57344
v_mfma_f32_16x16x32_bf16 v[80:83], a[16:19], a[244:247], v[80:83]
ds_read_b64_tr_b16 a[50:51], v100 offset:59392
buffer_load_dwordx4 v30, s[52:55], s100 offen lds
v_mfma_f32_16x16x32_bf16 v[52:55], a[20:23], a[240:243], v[52:55]
ds_read_b64_tr_b16 a[52:53], v101 offset:57344
v_mfma_f32_16x16x32_bf16 v[84:87], a[20:23], a[244:247], v[84:87]
ds_read_b64_tr_b16 a[54:55], v101 offset:59392
buffer_load_dwordx4 v31, s[52:55], s100 offen offset:1024 lds
v_mfma_f32_16x16x32_bf16 v[56:59], a[24:27], a[240:243], v[56:59]
ds_read_b64_tr_b16 a[56:57], v102 offset:57344
v_mfma_f32_16x16x32_bf16 v[88:91], a[24:27], a[244:247], v[88:91]
ds_read_b64_tr_b16 a[58:59], v102 offset:59392
v_mfma_f32_16x16x32_bf16 v[60:63], a[28:31], a[240:243], v[60:63]
ds_read_b64_tr_b16 a[60:61], v103 offset:57344
v_mfma_f32_16x16x32_bf16 v[92:95], a[28:31], a[244:247], v[92:95]
ds_read_b64_tr_b16 a[62:63], v103 offset:59392
s_waitcnt vmcnt(19)
s_waitcnt lgkmcnt(8)
v_mfma_f32_16x16x32_bf16 v[32:35], a[32:35], a[248:251], v[32:35]
s_add_u32 s20, s20, 4096
v_mfma_f32_16x16x32_bf16 v[64:67], a[32:35], a[252:255], v[64:67]
buffer_load_dwordx4 a[176:179], v146, s[12:15], s20 offen offset:0 sc1
v_mfma_f32_16x16x32_bf16 v[36:39], a[36:39], a[248:251], v[36:39]
buffer_load_dwordx4 a[180:183], v146, s[12:15], s20 offen offset:256 sc1
v_mfma_f32_16x16x32_bf16 v[68:71], a[36:39], a[252:255], v[68:71]
s_add_u32 s100, s100, 458752
v_mfma_f32_16x16x32_bf16 v[40:43], a[40:43], a[248:251], v[40:43]
s_add_u32 m0, s26, 24576
v_mfma_f32_16x16x32_bf16 v[72:75], a[40:43], a[252:255], v[72:75]
buffer_load_dwordx4 v30, s[52:55], s100 offen lds
v_mfma_f32_16x16x32_bf16 v[44:47], a[44:47], a[248:251], v[44:47]
buffer_load_dwordx4 v31, s[52:55], s100 offen offset:1024 lds
v_mfma_f32_16x16x32_bf16 v[76:79], a[44:47], a[252:255], v[76:79]
s_waitcnt vmcnt(53) lgkmcnt(0)
s_barrier
v_mfma_f32_16x16x32_bf16 v[48:51], a[48:51], a[248:251], v[48:51]
ds_read_b64_tr_b16 a[0:1], v104 offset:0
ds_read_b64_tr_b16 a[2:3], v104 offset:2048
v_mfma_f32_16x16x32_bf16 v[80:83], a[48:51], a[252:255], v[80:83]
ds_read_b64_tr_b16 a[4:5], v105 offset:0
ds_read_b64_tr_b16 a[6:7], v105 offset:2048
v_mfma_f32_16x16x32_bf16 v[52:55], a[52:55], a[248:251], v[52:55]
ds_read_b64_tr_b16 a[8:9], v106 offset:0
ds_read_b64_tr_b16 a[10:11], v106 offset:2048
v_mfma_f32_16x16x32_bf16 v[84:87], a[52:55], a[252:255], v[84:87]
ds_read_b64_tr_b16 a[12:13], v107 offset:0
ds_read_b64_tr_b16 a[14:15], v107 offset:2048
v_mfma_f32_16x16x32_bf16 v[56:59], a[56:59], a[248:251], v[56:59]
ds_read_b64_tr_b16 a[16:17], v108 offset:0
ds_read_b64_tr_b16 a[18:19], v108 offset:2048
v_mfma_f32_16x16x32_bf16 v[88:91], a[56:59], a[252:255], v[88:91]
ds_read_b64_tr_b16 a[20:21], v109 offset:0
ds_read_b64_tr_b16 a[22:23], v109 offset:2048
v_mfma_f32_16x16x32_bf16 v[60:63], a[60:63], a[248:251], v[60:63]
ds_read_b64_tr_b16 a[24:25], v110 offset:0
ds_read_b64_tr_b16 a[26:27], v110 offset:2048
v_mfma_f32_16x16x32_bf16 v[92:95], a[60:63], a[252:255], v[92:95]
ds_read_b64_tr_b16 a[28:29], v111 offset:0
ds_read_b64_tr_b16 a[30:31], v111 offset:2048
s_waitcnt vmcnt(21)
s_waitcnt lgkmcnt(8)
v_mfma_f32_16x16x32_bf16 v[32:35], a[0:3], a[128:131], v[32:35]
ds_read_b64_tr_b16 a[32:33], v104 offset:8192
v_mfma_f32_16x16x32_bf16 v[64:67], a[0:3], a[132:135], v[64:67]
ds_read_b64_tr_b16 a[34:35], v104 offset:10240
buffer_load_dwordx4 a[184:187], v146, s[12:15], s20 offen offset:2048 sc1
v_mfma_f32_16x16x32_bf16 v[36:39], a[4:7], a[128:131], v[36:39]
ds_read_b64_tr_b16 a[36:37], v105 offset:8192
v_mfma_f32_16x16x32_bf16 v[68:71], a[4:7], a[132:135], v[68:71]
ds_read_b64_tr_b16 a[38:39], v105 offset:10240
buffer_load_dwordx4 a[188:191], v146, s[12:15], s20 offen offset:2304 sc1
v_mfma_f32_16x16x32_bf16 v[40:43], a[8:11], a[128:131], v[40:43]
ds_read_b64_tr_b16 a[40:41], v106 offset:8192
v_mfma_f32_16x16x32_bf16 v[72:75], a[8:11], a[132:135], v[72:75]
ds_read_b64_tr_b16 a[42:43], v106 offset:10240
s_add_u32 s100, s100, 458752
v_mfma_f32_16x16x32_bf16 v[44:47], a[12:15], a[128:131], v[44:47]
ds_read_b64_tr_b16 a[44:45], v107 offset:8192
v_mfma_f32_16x16x32_bf16 v[76:79], a[12:15], a[132:135], v[76:79]
ds_read_b64_tr_b16 a[46:47], v107 offset:10240
s_add_u32 m0, s26, 32768
s_waitcnt lgkmcnt(8)
v_mfma_f32_16x16x32_bf16 v[48:51], a[16:19], a[128:131], v[48:51]
ds_read_b64_tr_b16 a[48:49], v108 offset:8192
v_mfma_f32_16x16x32_bf16 v[80:83], a[16:19], a[132:135], v[80:83]
ds_read_b64_tr_b16 a[50:51], v108 offset:10240
buffer_load_dwordx4 v30, s[52:55], s100 offen lds
v_mfma_f32_16x16x32_bf16 v[52:55], a[20:23], a[128:131], v[52:55]
ds_read_b64_tr_b16 a[52:53], v109 offset:8192
v_mfma_f32_16x16x32_bf16 v[84:87], a[20:23], a[132:135], v[84:87]
ds_read_b64_tr_b16 a[54:55], v109 offset:10240
buffer_load_dwordx4 v31, s[52:55], s100 offen offset:1024 lds
v_mfma_f32_16x16x32_bf16 v[56:59], a[24:27], a[128:131], v[56:59]
ds_read_b64_tr_b16 a[56:57], v110 offset:8192
v_mfma_f32_16x16x32_bf16 v[88:91], a[24:27], a[132:135], v[88:91]
ds_read_b64_tr_b16 a[58:59], v110 offset:10240
v_mfma_f32_16x16x32_bf16 v[60:63], a[28:31], a[128:131], v[60:63]
ds_read_b64_tr_b16 a[60:61], v111 offset:8192
v_mfma_f32_16x16x32_bf16 v[92:95], a[28:31], a[132:135], v[92:95]
ds_read_b64_tr_b16 a[62:63], v111 offset:10240
s_waitcnt vmcnt(23)
s_waitcnt lgkmcnt(8)
v_mfma_f32_16x16x32_bf16 v[32:35], a[32:35], a[136:139], v[32:35]
ds_read_b64_tr_b16 a[0:1], v104 offset:16384
v_mfma_f32_16x16x32_bf16 v[64:67], a[32:35], a[140:143], v[64:67]
ds_read_b64_tr_b16 a[2:3], v104 offset:18432
s_add_u32 s20, s20, 4096
v_mfma_f32_16x16x32_bf16 v[36:39], a[36:39], a[136:139], v[36:39]
ds_read_b64_tr_b16 a[4:5], v105 offset:16384
v_mfma_f32_16x16x32_bf16 v[68:71], a[36:39], a[140:143], v[68:71]
ds_read_b64_tr_b16 a[6:7], v105 offset:18432
buffer_load_dwordx4 a[192:195], v146, s[12:15], s20 offen offset:0 sc1
v_mfma_f32_16x16x32_bf16 v[40:43], a[40:43], a[136:139], v[40:43]
ds_read_b64_tr_b16 a[8:9], v106 offset:16384
v_mfma_f32_16x16x32_bf16 v[72:75], a[40:43], a[140:143], v[72:75]
ds_read_b64_tr_b16 a[10:11], v106 offset:18432
buffer_load_dwordx4 a[196:199], v146, s[12:15], s20 offen offset:256 sc1
v_mfma_f32_16x16x32_bf16 v[44:47], a[44:47], a[136:139], v[44:47]
ds_read_b64_tr_b16 a[12:13], v107 offset:16384
v_mfma_f32_16x16x32_bf16 v[76:79], a[44:47], a[140:143], v[76:79]
ds_read_b64_tr_b16 a[14:15], v107 offset:18432
s_add_u32 s100, s100, 458752
s_waitcnt lgkmcnt(8)
v_mfma_f32_16x16x32_bf16 v[48:51], a[48:51], a[136:139], v[48:51]
ds_read_b64_tr_b16 a[16:17], v108 offset:16384
v_mfma_f32_16x16x32_bf16 v[80:83], a[48:51], a[140:143], v[80:83]
ds_read_b64_tr_b16 a[18:19], v108 offset:18432
s_add_u32 m0, s26, 40960
v_mfma_f32_16x16x32_bf16 v[52:55], a[52:55], a[136:139], v[52:55]
ds_read_b64_tr_b16 a[20:21], v109 offset:16384
v_mfma_f32_16x16x32_bf16 v[84:87], a[52:55], a[140:143], v[84:87]
ds_read_b64_tr_b16 a[22:23], v109 offset:18432
buffer_load_dwordx4 v30, s[52:55], s100 offen lds
v_mfma_f32_16x16x32_bf16 v[56:59], a[56:59], a[136:139], v[56:59]
ds_read_b64_tr_b16 a[24:25], v110 offset:16384
v_mfma_f32_16x16x32_bf16 v[88:91], a[56:59], a[140:143], v[88:91]
ds_read_b64_tr_b16 a[26:27], v110 offset:18432
buffer_load_dwordx4 v31, s[52:55], s100 offen offset:1024 lds
v_mfma_f32_16x16x32_bf16 v[60:63], a[60:63], a[136:139], v[60:63]
ds_read_b64_tr_b16 a[28:29], v111 offset:16384
v_mfma_f32_16x16x32_bf16 v[92:95], a[60:63], a[140:143], v[92:95]
ds_read_b64_tr_b16 a[30:31], v111 offset:18432
s_waitcnt vmcnt(24)
s_waitcnt lgkmcnt(8)
v_mfma_f32_16x16x32_bf16 v[32:35], a[0:3], a[144:147], v[32:35]
ds_read_b64_tr_b16 a[32:33], v104 offset:24576
v_mfma_f32_16x16x32_bf16 v[64:67], a[0:3], a[148:151], v[64:67]
ds_read_b64_tr_b16 a[34:35], v104 offset:26624
buffer_load_dwordx4 a[200:203], v146, s[12:15], s20 offen offset:2048 sc1
v_mfma_f32_16x16x32_bf16 v[36:39], a[4:7], a[144:147], v[36:39]
ds_read_b64_tr_b16 a[36:37], v105 offset:24576
v_mfma_f32_16x16x32_bf16 v[68:71], a[4:7], a[148:151], v[68:71]
ds_read_b64_tr_b16 a[38:39], v105 offset:26624
buffer_load_dwordx4 a[204:207], v146, s[12:15], s20 offen offset:2304 sc1
v_mfma_f32_16x16x32_bf16 v[40:43], a[8:11], a[144:147], v[40:43]
ds_read_b64_tr_b16 a[40:41], v106 offset:24576
v_mfma_f32_16x16x32_bf16 v[72:75], a[8:11], a[148:151], v[72:75]
ds_read_b64_tr_b16 a[42:43], v106 offset:26624
s_add_u32 s100, s100, 458752
v_mfma_f32_16x16x32_bf16 v[44:47], a[12:15], a[144:147], v[44:47]
ds_read_b64_tr_b16 a[44:45], v107 offset:24576
v_mfma_f32_16x16x32_bf16 v[76:79], a[12:15], a[148:151], v[76:79]
ds_read_b64_tr_b16 a[46:47], v107 offset:26624
s_add_u32 m0, s26, 49152
s_waitcnt lgkmcnt(8)
v_mfma_f32_16x16x32_bf16 v[48:51], a[16:19], a[144:147], v[48:51]
ds_read_b64_tr_b16 a[48:49], v108 offset:24576
v_mfma_f32_16x16x32_bf16 v[80:83], a[16:19], a[148:151], v[80:83]
ds_read_b64_tr_b16 a[50:51], v108 offset:26624
buffer_load_dwordx4 v30, s[52:55], s100 offen lds
v_mfma_f32_16x16x32_bf16 v[52:55], a[20:23], a[144:147], v[52:55]
ds_read_b64_tr_b16 a[52:53], v109 offset:24576
v_mfma_f32_16x16x32_bf16 v[84:87], a[20:23], a[148:151], v[84:87]
ds_read_b64_tr_b16 a[54:55], v109 offset:26624
buffer_load_dwordx4 v31, s[52:55], s100 offen offset:1024 lds
v_mfma_f32_16x16x32_bf16 v[56:59], a[24:27], a[144:147], v[56:59]
ds_read_b64_tr_b16 a[56:57], v110 offset:24576
v_mfma_f32_16x16x32_bf16 v[88:91], a[24:27], a[148:151], v[88:91]
ds_read_b64_tr_b16 a[58:59], v110 offset:26624
v_mfma_f32_16x16x32_bf16 v[60:63], a[28:31], a[144:147], v[60:63]
ds_read_b64_tr_b16 a[60:61], v111 offset:24576
v_mfma_f32_16x16x32_bf16 v[92:95], a[28:31], a[148:151], v[92:95]
ds_read_b64_tr_b16 a[62:63], v111 offset:26624
s_waitcnt vmcnt(26)
s_waitcnt lgkmcnt(8)
v_mfma_f32_16x16x32_bf16 v[32:35], a[32:35], a[152:155], v[32:35]
s_add_u32 s20, s20, 4096
v_mfma_f32_16x16x32_bf16 v[64:67], a[32:35], a[156:159], v[64:67]
buffer_load_dwordx4 a[208:211], v146, s[12:15], s20 offen offset:0 sc1
v_mfma_f32_16x16x32_bf16 v[36:39], a[36:39], a[152:155], v[36:39]
buffer_load_dwordx4 a[212:215], v146, s[12:15], s20 offen offset:256 sc1
v_mfma_f32_16x16x32_bf16 v[68:71], a[36:39], a[156:159], v[68:71]
s_add_u32 s100, s100, 458752
v_mfma_f32_16x16x32_bf16 v[40:43], a[40:43], a[152:155], v[40:43]
s_add_u32 m0, s26, 57344
v_mfma_f32_16x16x32_bf16 v[72:75], a[40:43], a[156:159], v[72:75]
buffer_load_dwordx4 v30, s[52:55], s100 offen lds
v_mfma_f32_16x16x32_bf16 v[44:47], a[44:47], a[152:155], v[44:47]
buffer_load_dwordx4 v31, s[52:55], s100 offen offset:1024 lds
v_mfma_f32_16x16x32_bf16 v[76:79], a[44:47], a[156:159], v[76:79]
s_waitcnt vmcnt(45) lgkmcnt(0)
s_barrier
v_mfma_f32_16x16x32_bf16 v[48:51], a[48:51], a[152:155], v[48:51]
ds_read_b64_tr_b16 a[0:1], v104 offset:32768
ds_read_b64_tr_b16 a[2:3], v104 offset:34816
v_mfma_f32_16x16x32_bf16 v[80:83], a[48:51], a[156:159], v[80:83]
ds_read_b64_tr_b16 a[4:5], v105 offset:32768
ds_read_b64_tr_b16 a[6:7], v105 offset:34816
v_mfma_f32_16x16x32_bf16 v[52:55], a[52:55], a[152:155], v[52:55]
ds_read_b64_tr_b16 a[8:9], v106 offset:32768
ds_read_b64_tr_b16 a[10:11], v106 offset:34816
v_mfma_f32_16x16x32_bf16 v[84:87], a[52:55], a[156:159], v[84:87]
ds_read_b64_tr_b16 a[12:13], v107 offset:32768
ds_read_b64_tr_b16 a[14:15], v107 offset:34816
v_mfma_f32_16x16x32_bf16 v[56:59], a[56:59], a[152:155], v[56:59]
ds_read_b64_tr_b16 a[16:17], v108 offset:32768
ds_read_b64_tr_b16 a[18:19], v108 offset:34816
v_mfma_f32_16x16x32_bf16 v[88:91], a[56:59], a[156:159], v[88:91]
ds_read_b64_tr_b16 a[20:21], v109 offset:32768
ds_read_b64_tr_b16 a[22:23], v109 offset:34816
v_mfma_f32_16x16x32_bf16 v[60:63], a[60:63], a[152:155], v[60:63]
ds_read_b64_tr_b16 a[24:25], v110 offset:32768
ds_read_b64_tr_b16 a[26:27], v110 offset:34816
v_mfma_f32_16x16x32_bf16 v[92:95], a[60:63], a[156:159], v[92:95]
ds_read_b64_tr_b16 a[28:29], v111 offset:32768
ds_read_b64_tr_b16 a[30:31], v111 offset:34816
s_waitcnt vmcnt(26)
s_waitcnt lgkmcnt(8)
v_mfma_f32_16x16x32_bf16 v[32:35], a[0:3], a[160:163], v[32:35]
ds_read_b64_tr_b16 a[32:33], v104 offset:40960
v_mfma_f32_16x16x32_bf16 v[64:67], a[0:3], a[164:167], v[64:67]
ds_read_b64_tr_b16 a[34:35], v104 offset:43008
buffer_load_dword v145, v144, s[16:19], 0 offen sc1
v_mfma_f32_16x16x32_bf16 v[36:39], a[4:7], a[160:163], v[36:39]
ds_read_b64_tr_b16 a[36:37], v105 offset:40960
v_mfma_f32_16x16x32_bf16 v[68:71], a[4:7], a[164:167], v[68:71]
ds_read_b64_tr_b16 a[38:39], v105 offset:43008
buffer_load_dwordx4 a[216:219], v146, s[12:15], s20 offen offset:2048 sc1
v_mfma_f32_16x16x32_bf16 v[40:43], a[8:11], a[160:163], v[40:43]
ds_read_b64_tr_b16 a[40:41], v106 offset:40960
v_mfma_f32_16x16x32_bf16 v[72:75], a[8:11], a[164:167], v[72:75]
ds_read_b64_tr_b16 a[42:43], v106 offset:43008
buffer_load_dwordx4 a[220:223], v146, s[12:15], s20 offen offset:2304 sc1
v_mfma_f32_16x16x32_bf16 v[44:47], a[12:15], a[160:163], v[44:47]
ds_read_b64_tr_b16 a[44:45], v107 offset:40960
v_mfma_f32_16x16x32_bf16 v[76:79], a[12:15], a[164:167], v[76:79]
ds_read_b64_tr_b16 a[46:47], v107 offset:43008
s_sub_u32 s100, s100, 3178496
s_waitcnt lgkmcnt(8)
v_mfma_f32_16x16x32_bf16 v[48:51], a[16:19], a[160:163], v[48:51]
ds_read_b64_tr_b16 a[48:49], v108 offset:40960
v_mfma_f32_16x16x32_bf16 v[80:83], a[16:19], a[164:167], v[80:83]
ds_read_b64_tr_b16 a[50:51], v108 offset:43008
s_add_u32 m0, s26, 65536
v_mfma_f32_16x16x32_bf16 v[52:55], a[20:23], a[160:163], v[52:55]
ds_read_b64_tr_b16 a[52:53], v109 offset:40960
v_mfma_f32_16x16x32_bf16 v[84:87], a[20:23], a[164:167], v[84:87]
ds_read_b64_tr_b16 a[54:55], v109 offset:43008
buffer_load_dwordx4 v30, s[52:55], s100 offen lds
v_mfma_f32_16x16x32_bf16 v[56:59], a[24:27], a[160:163], v[56:59]
ds_read_b64_tr_b16 a[56:57], v110 offset:40960
v_mfma_f32_16x16x32_bf16 v[88:91], a[24:27], a[164:167], v[88:91]
ds_read_b64_tr_b16 a[58:59], v110 offset:43008
buffer_load_dwordx4 v31, s[52:55], s100 offen offset:1024 lds
v_mfma_f32_16x16x32_bf16 v[60:63], a[28:31], a[160:163], v[60:63]
ds_read_b64_tr_b16 a[60:61], v111 offset:40960
v_mfma_f32_16x16x32_bf16 v[92:95], a[28:31], a[164:167], v[92:95]
ds_read_b64_tr_b16 a[62:63], v111 offset:43008
s_waitcnt vmcnt(27)
s_waitcnt lgkmcnt(8)
v_mfma_f32_16x16x32_bf16 v[32:35], a[32:35], a[168:171], v[32:35]
ds_read_b64_tr_b16 a[0:1], v104 offset:49152
v_mfma_f32_16x16x32_bf16 v[64:67], a[32:35], a[172:175], v[64:67]
ds_read_b64_tr_b16 a[2:3], v104 offset:51200
s_add_u32 s20, s20, 4096
v_mfma_f32_16x16x32_bf16 v[36:39], a[36:39], a[168:171], v[36:39]
ds_read_b64_tr_b16 a[4:5], v105 offset:49152
v_mfma_f32_16x16x32_bf16 v[68:71], a[36:39], a[172:175], v[68:71]
ds_read_b64_tr_b16 a[6:7], v105 offset:51200
buffer_load_dwordx4 a[224:227], v146, s[12:15], s20 offen offset:0 sc1
v_mfma_f32_16x16x32_bf16 v[40:43], a[40:43], a[168:171], v[40:43]
ds_read_b64_tr_b16 a[8:9], v106 offset:49152
v_mfma_f32_16x16x32_bf16 v[72:75], a[40:43], a[172:175], v[72:75]
ds_read_b64_tr_b16 a[10:11], v106 offset:51200
buffer_load_dwordx4 a[228:231], v146, s[12:15], s20 offen offset:256 sc1
v_mfma_f32_16x16x32_bf16 v[44:47], a[44:47], a[168:171], v[44:47]
ds_read_b64_tr_b16 a[12:13], v107 offset:49152
v_mfma_f32_16x16x32_bf16 v[76:79], a[44:47], a[172:175], v[76:79]
ds_read_b64_tr_b16 a[14:15], v107 offset:51200
s_add_u32 s100, s100, 458752
s_waitcnt lgkmcnt(8)
v_mfma_f32_16x16x32_bf16 v[48:51], a[48:51], a[168:171], v[48:51]
ds_read_b64_tr_b16 a[16:17], v108 offset:49152
v_mfma_f32_16x16x32_bf16 v[80:83], a[48:51], a[172:175], v[80:83]
ds_read_b64_tr_b16 a[18:19], v108 offset:51200
s_add_u32 m0, s26, 73728
v_mfma_f32_16x16x32_bf16 v[52:55], a[52:55], a[168:171], v[52:55]
ds_read_b64_tr_b16 a[20:21], v109 offset:49152
v_mfma_f32_16x16x32_bf16 v[84:87], a[52:55], a[172:175], v[84:87]
ds_read_b64_tr_b16 a[22:23], v109 offset:51200
buffer_load_dwordx4 v30, s[52:55], s100 offen lds
v_mfma_f32_16x16x32_bf16 v[56:59], a[56:59], a[168:171], v[56:59]
ds_read_b64_tr_b16 a[24:25], v110 offset:49152
v_mfma_f32_16x16x32_bf16 v[88:91], a[56:59], a[172:175], v[88:91]
ds_read_b64_tr_b16 a[26:27], v110 offset:51200
buffer_load_dwordx4 v31, s[52:55], s100 offen offset:1024 lds
v_mfma_f32_16x16x32_bf16 v[60:63], a[60:63], a[168:171], v[60:63]
ds_read_b64_tr_b16 a[28:29], v111 offset:49152
v_mfma_f32_16x16x32_bf16 v[92:95], a[60:63], a[172:175], v[92:95]
ds_read_b64_tr_b16 a[30:31], v111 offset:51200
s_waitcnt vmcnt(27)
s_waitcnt lgkmcnt(8)
v_mfma_f32_16x16x32_bf16 v[32:35], a[0:3], a[176:179], v[32:35]
ds_read_b64_tr_b16 a[32:33], v104 offset:57344
v_mfma_f32_16x16x32_bf16 v[64:67], a[0:3], a[180:183], v[64:67]
ds_read_b64_tr_b16 a[34:35], v104 offset:59392
buffer_load_dwordx4 a[232:235], v146, s[12:15], s20 offen offset:2048 sc1
v_mfma_f32_16x16x32_bf16 v[36:39], a[4:7], a[176:179], v[36:39]
ds_read_b64_tr_b16 a[36:37], v105 offset:57344
v_mfma_f32_16x16x32_bf16 v[68:71], a[4:7], a[180:183], v[68:71]
ds_read_b64_tr_b16 a[38:39], v105 offset:59392
buffer_load_dwordx4 a[236:239], v146, s[12:15], s20 offen offset:2304 sc1
v_mfma_f32_16x16x32_bf16 v[40:43], a[8:11], a[176:179], v[40:43]
ds_read_b64_tr_b16 a[40:41], v106 offset:57344
v_mfma_f32_16x16x32_bf16 v[72:75], a[8:11], a[180:183], v[72:75]
ds_read_b64_tr_b16 a[42:43], v106 offset:59392
s_add_u32 s100, s100, 458752
v_mfma_f32_16x16x32_bf16 v[44:47], a[12:15], a[176:179], v[44:47]
ds_read_b64_tr_b16 a[44:45], v107 offset:57344
v_mfma_f32_16x16x32_bf16 v[76:79], a[12:15], a[180:183], v[76:79]
ds_read_b64_tr_b16 a[46:47], v107 offset:59392
s_add_u32 m0, s26, 81920
s_waitcnt lgkmcnt(8)
v_mfma_f32_16x16x32_bf16 v[48:51], a[16:19], a[176:179], v[48:51]
ds_read_b64_tr_b16 a[48:49], v108 offset:57344
v_mfma_f32_16x16x32_bf16 v[80:83], a[16:19], a[180:183], v[80:83]
ds_read_b64_tr_b16 a[50:51], v108 offset:59392
buffer_load_dwordx4 v30, s[52:55], s100 offen lds
v_mfma_f32_16x16x32_bf16 v[52:55], a[20:23], a[176:179], v[52:55]
ds_read_b64_tr_b16 a[52:53], v109 offset:57344
v_mfma_f32_16x16x32_bf16 v[84:87], a[20:23], a[180:183], v[84:87]
ds_read_b64_tr_b16 a[54:55], v109 offset:59392
buffer_load_dwordx4 v31, s[52:55], s100 offen offset:1024 lds
v_mfma_f32_16x16x32_bf16 v[56:59], a[24:27], a[176:179], v[56:59]
ds_read_b64_tr_b16 a[56:57], v110 offset:57344
v_mfma_f32_16x16x32_bf16 v[88:91], a[24:27], a[180:183], v[88:91]
ds_read_b64_tr_b16 a[58:59], v110 offset:59392
v_mfma_f32_16x16x32_bf16 v[60:63], a[28:31], a[176:179], v[60:63]
ds_read_b64_tr_b16 a[60:61], v111 offset:57344
v_mfma_f32_16x16x32_bf16 v[92:95], a[28:31], a[180:183], v[92:95]
ds_read_b64_tr_b16 a[62:63], v111 offset:59392
s_waitcnt vmcnt(27)
s_waitcnt lgkmcnt(8)
v_mfma_f32_16x16x32_bf16 v[32:35], a[32:35], a[184:187], v[32:35]
s_add_u32 s20, s20, 4096
v_mfma_f32_16x16x32_bf16 v[64:67], a[32:35], a[188:191], v[64:67]
buffer_load_dwordx4 a[240:243], v146, s[12:15], s20 offen offset:0 sc1
v_mfma_f32_16x16x32_bf16 v[36:39], a[36:39], a[184:187], v[36:39]
buffer_load_dwordx4 a[244:247], v146, s[12:15], s20 offen offset:256 sc1
v_mfma_f32_16x16x32_bf16 v[68:71], a[36:39], a[188:191], v[68:71]
s_add_u32 s100, s100, 458752
v_mfma_f32_16x16x32_bf16 v[40:43], a[40:43], a[184:187], v[40:43]
s_add_u32 m0, s26, 90112
v_mfma_f32_16x16x32_bf16 v[72:75], a[40:43], a[188:191], v[72:75]
buffer_load_dwordx4 v30, s[52:55], s100 offen lds
v_mfma_f32_16x16x32_bf16 v[44:47], a[44:47], a[184:187], v[44:47]
buffer_load_dwordx4 v31, s[52:55], s100 offen offset:1024 lds
v_mfma_f32_16x16x32_bf16 v[76:79], a[44:47], a[188:191], v[76:79]
s_waitcnt vmcnt(33) lgkmcnt(0)
s_barrier
v_mfma_f32_16x16x32_bf16 v[48:51], a[48:51], a[184:187], v[48:51]
ds_read_b64_tr_b16 a[0:1], v96 offset:0
ds_read_b64_tr_b16 a[2:3], v96 offset:2048
v_mfma_f32_16x16x32_bf16 v[80:83], a[48:51], a[188:191], v[80:83]
ds_read_b64_tr_b16 a[4:5], v97 offset:0
ds_read_b64_tr_b16 a[6:7], v97 offset:2048
v_mfma_f32_16x16x32_bf16 v[52:55], a[52:55], a[184:187], v[52:55]
ds_read_b64_tr_b16 a[8:9], v98 offset:0
ds_read_b64_tr_b16 a[10:11], v98 offset:2048
v_mfma_f32_16x16x32_bf16 v[84:87], a[52:55], a[188:191], v[84:87]
ds_read_b64_tr_b16 a[12:13], v99 offset:0
ds_read_b64_tr_b16 a[14:15], v99 offset:2048
v_mfma_f32_16x16x32_bf16 v[56:59], a[56:59], a[184:187], v[56:59]
ds_read_b64_tr_b16 a[16:17], v100 offset:0
ds_read_b64_tr_b16 a[18:19], v100 offset:2048
v_mfma_f32_16x16x32_bf16 v[88:91], a[56:59], a[188:191], v[88:91]
ds_read_b64_tr_b16 a[20:21], v101 offset:0
ds_read_b64_tr_b16 a[22:23], v101 offset:2048
v_mfma_f32_16x16x32_bf16 v[60:63], a[60:63], a[184:187], v[60:63]
ds_read_b64_tr_b16 a[24:25], v102 offset:0
ds_read_b64_tr_b16 a[26:27], v102 offset:2048
v_mfma_f32_16x16x32_bf16 v[92:95], a[60:63], a[188:191], v[92:95]
ds_read_b64_tr_b16 a[28:29], v103 offset:0
ds_read_b64_tr_b16 a[30:31], v103 offset:2048
s_waitcnt vmcnt(27)
s_waitcnt lgkmcnt(8)
v_mfma_f32_16x16x32_bf16 v[32:35], a[0:3], a[192:195], v[32:35]
ds_read_b64_tr_b16 a[32:33], v96 offset:8192
v_mfma_f32_16x16x32_bf16 v[64:67], a[0:3], a[196:199], v[64:67]
ds_read_b64_tr_b16 a[34:35], v96 offset:10240
buffer_load_dwordx4 a[248:251], v146, s[12:15], s20 offen offset:2048 sc1
v_mfma_f32_16x16x32_bf16 v[36:39], a[4:7], a[192:195], v[36:39]
ds_read_b64_tr_b16 a[36:37], v97 offset:8192
v_mfma_f32_16x16x32_bf16 v[68:71], a[4:7], a[196:199], v[68:71]
ds_read_b64_tr_b16 a[38:39], v97 offset:10240
buffer_load_dwordx4 a[252:255], v146, s[12:15], s20 offen offset:2304 sc1
v_mfma_f32_16x16x32_bf16 v[40:43], a[8:11], a[192:195], v[40:43]
ds_read_b64_tr_b16 a[40:41], v98 offset:8192
v_mfma_f32_16x16x32_bf16 v[72:75], a[8:11], a[196:199], v[72:75]
ds_read_b64_tr_b16 a[42:43], v98 offset:10240
s_add_u32 s100, s100, 458752
v_mfma_f32_16x16x32_bf16 v[44:47], a[12:15], a[192:195], v[44:47]
ds_read_b64_tr_b16 a[44:45], v99 offset:8192
v_mfma_f32_16x16x32_bf16 v[76:79], a[12:15], a[196:199], v[76:79]
ds_read_b64_tr_b16 a[46:47], v99 offset:10240
s_add_u32 m0, s26, 98304
s_waitcnt lgkmcnt(8)
v_mfma_f32_16x16x32_bf16 v[48:51], a[16:19], a[192:195], v[48:51]
ds_read_b64_tr_b16 a[48:49], v100 offset:8192
v_mfma_f32_16x16x32_bf16 v[80:83], a[16:19], a[196:199], v[80:83]
ds_read_b64_tr_b16 a[50:51], v100 offset:10240
buffer_load_dwordx4 v30, s[52:55], s100 offen lds
v_mfma_f32_16x16x32_bf16 v[52:55], a[20:23], a[192:195], v[52:55]
ds_read_b64_tr_b16 a[52:53], v101 offset:8192
v_mfma_f32_16x16x32_bf16 v[84:87], a[20:23], a[196:199], v[84:87]
ds_read_b64_tr_b16 a[54:55], v101 offset:10240
buffer_load_dwordx4 v31, s[52:55], s100 offen offset:1024 lds
v_mfma_f32_16x16x32_bf16 v[56:59], a[24:27], a[192:195], v[56:59]
ds_read_b64_tr_b16 a[56:57], v102 offset:8192
v_mfma_f32_16x16x32_bf16 v[88:91], a[24:27], a[196:199], v[88:91]
ds_read_b64_tr_b16 a[58:59], v102 offset:10240
v_mfma_f32_16x16x32_bf16 v[60:63], a[28:31], a[192:195], v[60:63]
ds_read_b64_tr_b16 a[60:61], v103 offset:8192
v_mfma_f32_16x16x32_bf16 v[92:95], a[28:31], a[196:199], v[92:95]
ds_read_b64_tr_b16 a[62:63], v103 offset:10240
s_waitcnt vmcnt(27)
s_waitcnt lgkmcnt(8)
v_mfma_f32_16x16x32_bf16 v[32:35], a[32:35], a[200:203], v[32:35]
ds_read_b64_tr_b16 a[0:1], v96 offset:16384
v_mfma_f32_16x16x32_bf16 v[64:67], a[32:35], a[204:207], v[64:67]
ds_read_b64_tr_b16 a[2:3], v96 offset:18432
s_waitcnt vmcnt(20)
s_mov_b32 s57, 0
L_g2_pollA1:
v_cmp_le_u32 vcc, 5, v145
s_cmp_eq_u64 vcc, -1
s_cbranch_scc1 L_g2_polledA1
s_add_u32 s57, s57, 1
s_cmp_gt_u32 s57, 20000
s_cbranch_scc1 L_g2_polledA1
buffer_load_dword v145, v144, s[16:19], 0 offen sc1
s_waitcnt vmcnt(0)
s_branch L_g2_pollA1
L_g2_polledA1:
v_mfma_f32_16x16x32_bf16 v[36:39], a[36:39], a[200:203], v[36:39]
ds_read_b64_tr_b16 a[4:5], v97 offset:16384
v_mfma_f32_16x16x32_bf16 v[68:71], a[36:39], a[204:207], v[68:71]
ds_read_b64_tr_b16 a[6:7], v97 offset:18432
s_add_u32 s20, s20, 4096
v_mfma_f32_16x16x32_bf16 v[40:43], a[40:43], a[200:203], v[40:43]
ds_read_b64_tr_b16 a[8:9], v98 offset:16384
v_mfma_f32_16x16x32_bf16 v[72:75], a[40:43], a[204:207], v[72:75]
ds_read_b64_tr_b16 a[10:11], v98 offset:18432
buffer_load_dwordx4 a[128:131], v146, s[12:15], s20 offen offset:0 sc1
v_mfma_f32_16x16x32_bf16 v[44:47], a[44:47], a[200:203], v[44:47]
ds_read_b64_tr_b16 a[12:13], v99 offset:16384
v_mfma_f32_16x16x32_bf16 v[76:79], a[44:47], a[204:207], v[76:79]
ds_read_b64_tr_b16 a[14:15], v99 offset:18432
buffer_load_dwordx4 a[132:135], v146, s[12:15], s20 offen offset:256 sc1
s_waitcnt lgkmcnt(8)
v_mfma_f32_16x16x32_bf16 v[48:51], a[48:51], a[200:203], v[48:51]
ds_read_b64_tr_b16 a[16:17], v100 offset:16384
v_mfma_f32_16x16x32_bf16 v[80:83], a[48:51], a[204:207], v[80:83]
ds_read_b64_tr_b16 a[18:19], v100 offset:18432
s_add_u32 s100, s100, 458752
v_mfma_f32_16x16x32_bf16 v[52:55], a[52:55], a[200:203], v[52:55]
ds_read_b64_tr_b16 a[20:21], v101 offset:16384
v_mfma_f32_16x16x32_bf16 v[84:87], a[52:55], a[204:207], v[84:87]
ds_read_b64_tr_b16 a[22:23], v101 offset:18432
s_add_u32 m0, s26, 106496
v_mfma_f32_16x16x32_bf16 v[56:59], a[56:59], a[200:203], v[56:59]
ds_read_b64_tr_b16 a[24:25], v102 offset:16384
v_mfma_f32_16x16x32_bf16 v[88:91], a[56:59], a[204:207], v[88:91]
ds_read_b64_tr_b16 a[26:27], v102 offset:18432
buffer_load_dwordx4 v30, s[52:55], s100 offen lds
v_mfma_f32_16x16x32_bf16 v[60:63], a[60:63], a[200:203], v[60:63]
ds_read_b64_tr_b16 a[28:29], v103 offset:16384
v_mfma_f32_16x16x32_bf16 v[92:95], a[60:63], a[204:207], v[92:95]
ds_read_b64_tr_b16 a[30:31], v103 offset:18432
buffer_load_dwordx4 v31, s[52:55], s100 offen offset:1024 lds
s_waitcnt vmcnt(27)
s_waitcnt lgkmcnt(8)
v_mfma_f32_16x16x32_bf16 v[32:35], a[0:3], a[208:211], v[32:35]
ds_read_b64_tr_b16 a[32:33], v96 offset:24576
v_mfma_f32_16x16x32_bf16 v[64:67], a[0:3], a[212:215], v[64:67]
ds_read_b64_tr_b16 a[34:35], v96 offset:26624
buffer_load_dwordx4 a[136:139], v146, s[12:15], s20 offen offset:2048 sc1
v_mfma_f32_16x16x32_bf16 v[36:39], a[4:7], a[208:211], v[36:39]
ds_read_b64_tr_b16 a[36:37], v97 offset:24576
v_mfma_f32_16x16x32_bf16 v[68:71], a[4:7], a[212:215], v[68:71]
ds_read_b64_tr_b16 a[38:39], v97 offset:26624
buffer_load_dwordx4 a[140:143], v146, s[12:15], s20 offen offset:2304 sc1
v_mfma_f32_16x16x32_bf16 v[40:43], a[8:11], a[208:211], v[40:43]
ds_read_b64_tr_b16 a[40:41], v98 offset:24576
v_mfma_f32_16x16x32_bf16 v[72:75], a[8:11], a[212:215], v[72:75]
ds_read_b64_tr_b16 a[42:43], v98 offset:26624
s_add_u32 s100, s100, 458752
v_mfma_f32_16x16x32_bf16 v[44:47], a[12:15], a[208:211], v[44:47]
ds_read_b64_tr_b16 a[44:45], v99 offset:24576
v_mfma_f32_16x16x32_bf16 v[76:79], a[12:15], a[212:215], v[76:79]
ds_read_b64_tr_b16 a[46:47], v99 offset:26624
s_add_u32 m0, s26, 114688
s_waitcnt lgkmcnt(8)
v_mfma_f32_16x16x32_bf16 v[48:51], a[16:19], a[208:211], v[48:51]
ds_read_b64_tr_b16 a[48:49], v100 offset:24576
v_mfma_f32_16x16x32_bf16 v[80:83], a[16:19], a[212:215], v[80:83]
ds_read_b64_tr_b16 a[50:51], v100 offset:26624
buffer_load_dwordx4 v30, s[52:55], s100 offen lds
v_mfma_f32_16x16x32_bf16 v[52:55], a[20:23], a[208:211], v[52:55]
ds_read_b64_tr_b16 a[52:53], v101 offset:24576
v_mfma_f32_16x16x32_bf16 v[84:87], a[20:23], a[212:215], v[84:87]
ds_read_b64_tr_b16 a[54:55], v101 offset:26624
buffer_load_dwordx4 v31, s[52:55], s100 offen offset:1024 lds
v_mfma_f32_16x16x32_bf16 v[56:59], a[24:27], a[208:211], v[56:59]
ds_read_b64_tr_b16 a[56:57], v102 offset:24576
v_mfma_f32_16x16x32_bf16 v[88:91], a[24:27], a[212:215], v[88:91]
ds_read_b64_tr_b16 a[58:59], v102 offset:26624
v_mfma_f32_16x16x32_bf16 v[60:63], a[28:31], a[208:211], v[60:63]
ds_read_b64_tr_b16 a[60:61], v103 offset:24576
v_mfma_f32_16x16x32_bf16 v[92:95], a[28:31], a[212:215], v[92:95]
ds_read_b64_tr_b16 a[62:63], v103 offset:26624
s_waitcnt vmcnt(26)
s_waitcnt lgkmcnt(8)
v_mfma_f32_16x16x32_bf16 v[32:35], a[32:35], a[216:219], v[32:35]
s_add_u32 s20, s20, 4096
v_mfma_f32_16x16x32_bf16 v[64:67], a[32:35], a[220:223], v[64:67]
buffer_load_dwordx4 a[144:147], v146, s[12:15], s20 offen offset:0 sc1
v_mfma_f32_16x16x32_bf16 v[36:39], a[36:39], a[216:219], v[36:39]
buffer_load_dwordx4 a[148:151], v146, s[12:15], s20 offen offset:256 sc1
v_mfma_f32_16x16x32_bf16 v[68:71], a[36:39], a[220:223], v[68:71]
s_add_u32 s100, s100, 458752
v_mfma_f32_16x16x32_bf16 v[40:43], a[40:43], a[216:219], v[40:43]
s_add_u32 m0, s26, 122880
v_mfma_f32_16x16x32_bf16 v[72:75], a[40:43], a[220:223], v[72:75]
buffer_load_dwordx4 v30, s[52:55], s100 offen lds
v_mfma_f32_16x16x32_bf16 v[44:47], a[44:47], a[216:219], v[44:47]
buffer_load_dwordx4 v31, s[52:55], s100 offen offset:1024 lds
v_mfma_f32_16x16x32_bf16 v[76:79], a[44:47], a[220:223], v[76:79]
s_waitcnt vmcnt(33) lgkmcnt(0)
s_barrier
v_mfma_f32_16x16x32_bf16 v[48:51], a[48:51], a[216:219], v[48:51]
ds_read_b64_tr_b16 a[0:1], v96 offset:32768
ds_read_b64_tr_b16 a[2:3], v96 offset:34816
v_mfma_f32_16x16x32_bf16 v[80:83], a[48:51], a[220:223], v[80:83]
ds_read_b64_tr_b16 a[4:5], v97 offset:32768
ds_read_b64_tr_b16 a[6:7], v97 offset:34816
v_mfma_f32_16x16x32_bf16 v[52:55], a[52:55], a[216:219], v[52:55]
ds_read_b64_tr_b16 a[8:9], v98 offset:32768
ds_read_b64_tr_b16 a[10:11], v98 offset:34816
v_mfma_f32_16x16x32_bf16 v[84:87], a[52:55], a[220:223], v[84:87]
ds_read_b64_tr_b16 a[12:13], v99 offset:32768
ds_read_b64_tr_b16 a[14:15], v99 offset:34816
v_mfma_f32_16x16x32_bf16 v[56:59], a[56:59], a[216:219], v[56:59]
ds_read_b64_tr_b16 a[16:17], v100 offset:32768
ds_read_b64_tr_b16 a[18:19], v100 offset:34816
v_mfma_f32_16x16x32_bf16 v[88:91], a[56:59], a[220:223], v[88:91]
ds_read_b64_tr_b16 a[20:21], v101 offset:32768
ds_read_b64_tr_b16 a[22:23], v101 offset:34816
v_mfma_f32_16x16x32_bf16 v[60:63], a[60:63], a[216:219], v[60:63]
ds_read_b64_tr_b16 a[24:25], v102 offset:32768
ds_read_b64_tr_b16 a[26:27], v102 offset:34816
v_mfma_f32_16x16x32_bf16 v[92:95], a[60:63], a[220:223], v[92:95]
ds_read_b64_tr_b16 a[28:29], v103 offset:32768
ds_read_b64_tr_b16 a[30:31], v103 offset:34816
s_waitcnt vmcnt(26)
s_waitcnt lgkmcnt(8)
v_mfma_f32_16x16x32_bf16 v[32:35], a[0:3], a[224:227], v[32:35]
ds_read_b64_tr_b16 a[32:33], v96 offset:40960
v_mfma_f32_16x16x32_bf16 v[64:67], a[0:3], a[228:231], v[64:67]
ds_read_b64_tr_b16 a[34:35], v96 offset:43008
buffer_load_dwordx4 a[152:155], v146, s[12:15], s20 offen offset:2048 sc1
v_mfma_f32_16x16x32_bf16 v[36:39], a[4:7], a[224:227], v[36:39]
ds_read_b64_tr_b16 a[36:37], v97 offset:40960
v_mfma_f32_16x16x32_bf16 v[68:71], a[4:7], a[228:231], v[68:71]
ds_read_b64_tr_b16 a[38:39], v97 offset:43008
buffer_load_dwordx4 a[156:159], v146, s[12:15], s20 offen offset:2304 sc1
v_mfma_f32_16x16x32_bf16 v[40:43], a[8:11], a[224:227], v[40:43]
ds_read_b64_tr_b16 a[40:41], v98 offset:40960
v_mfma_f32_16x16x32_bf16 v[72:75], a[8:11], a[228:231], v[72:75]
ds_read_b64_tr_b16 a[42:43], v98 offset:43008
s_sub_u32 s100, s100, 3178496
v_mfma_f32_16x16x32_bf16 v[44:47], a[12:15], a[224:227], v[44:47]
ds_read_b64_tr_b16 a[44:45], v99 offset:40960
v_mfma_f32_16x16x32_bf16 v[76:79], a[12:15], a[228:231], v[76:79]
ds_read_b64_tr_b16 a[46:47], v99 offset:43008
s_add_u32 m0, s26, 0
s_waitcnt lgkmcnt(8)
v_mfma_f32_16x16x32_bf16 v[48:51], a[16:19], a[224:227], v[48:51]
ds_read_b64_tr_b16 a[48:49], v100 offset:40960
v_mfma_f32_16x16x32_bf16 v[80:83], a[16:19], a[228:231], v[80:83]
ds_read_b64_tr_b16 a[50:51], v100 offset:43008
buffer_load_dwordx4 v30, s[52:55], s100 offen lds
v_mfma_f32_16x16x32_bf16 v[52:55], a[20:23], a[224:227], v[52:55]
ds_read_b64_tr_b16 a[52:53], v101 offset:40960
v_mfma_f32_16x16x32_bf16 v[84:87], a[20:23], a[228:231], v[84:87]
ds_read_b64_tr_b16 a[54:55], v101 offset:43008
buffer_load_dwordx4 v31, s[52:55], s100 offen offset:1024 lds
v_mfma_f32_16x16x32_bf16 v[56:59], a[24:27], a[224:227], v[56:59]
ds_read_b64_tr_b16 a[56:57], v102 offset:40960
v_mfma_f32_16x16x32_bf16 v[88:91], a[24:27], a[228:231], v[88:91]
ds_read_b64_tr_b16 a[58:59], v102 offset:43008
v_mfma_f32_16x16x32_bf16 v[60:63], a[28:31], a[224:227], v[60:63]
ds_read_b64_tr_b16 a[60:61], v103 offset:40960
v_mfma_f32_16x16x32_bf16 v[92:95], a[28:31], a[228:231], v[92:95]
ds_read_b64_tr_b16 a[62:63], v103 offset:43008
s_waitcnt vmcnt(26)
s_waitcnt lgkmcnt(8)
v_mfma_f32_16x16x32_bf16 v[32:35], a[32:35], a[232:235], v[32:35]
ds_read_b64_tr_b16 a[0:1], v96 offset:49152
v_mfma_f32_16x16x32_bf16 v[64:67], a[32:35], a[236:239], v[64:67]
ds_read_b64_tr_b16 a[2:3], v96 offset:51200
s_add_u32 s20, s20, 4096
v_mfma_f32_16x16x32_bf16 v[36:39], a[36:39], a[232:235], v[36:39]
ds_read_b64_tr_b16 a[4:5], v97 offset:49152
v_mfma_f32_16x16x32_bf16 v[68:71], a[36:39], a[236:239], v[68:71]
ds_read_b64_tr_b16 a[6:7], v97 offset:51200
buffer_load_dwordx4 a[160:163], v146, s[12:15], s20 offen offset:0 sc1
v_mfma_f32_16x16x32_bf16 v[40:43], a[40:43], a[232:235], v[40:43]
ds_read_b64_tr_b16 a[8:9], v98 offset:49152
v_mfma_f32_16x16x32_bf16 v[72:75], a[40:43], a[236:239], v[72:75]
ds_read_b64_tr_b16 a[10:11], v98 offset:51200
buffer_load_dwordx4 a[164:167], v146, s[12:15], s20 offen offset:256 sc1
v_mfma_f32_16x16x32_bf16 v[44:47], a[44:47], a[232:235], v[44:47]
ds_read_b64_tr_b16 a[12:13], v99 offset:49152
v_mfma_f32_16x16x32_bf16 v[76:79], a[44:47], a[236:239], v[76:79]
ds_read_b64_tr_b16 a[14:15], v99 offset:51200
s_add_u32 s100, s100, 458752
s_waitcnt lgkmcnt(8)
v_mfma_f32_16x16x32_bf16 v[48:51], a[48:51], a[232:235], v[48:51]
ds_read_b64_tr_b16 a[16:17], v100 offset:49152
v_mfma_f32_16x16x32_bf16 v[80:83], a[48:51], a[236:239], v[80:83]
ds_read_b64_tr_b16 a[18:19], v100 offset:51200
s_add_u32 m0, s26, 8192
v_mfma_f32_16x16x32_bf16 v[52:55], a[52:55], a[232:235], v[52:55]
ds_read_b64_tr_b16 a[20:21], v101 offset:49152
v_mfma_f32_16x16x32_bf16 v[84:87], a[52:55], a[236:239], v[84:87]
ds_read_b64_tr_b16 a[22:23], v101 offset:51200
buffer_load_dwordx4 v30, s[52:55], s100 offen lds
v_mfma_f32_16x16x32_bf16 v[56:59], a[56:59], a[232:235], v[56:59]
ds_read_b64_tr_b16 a[24:25], v102 offset:49152
v_mfma_f32_16x16x32_bf16 v[88:91], a[56:59], a[236:239], v[88:91]
ds_read_b64_tr_b16 a[26:27], v102 offset:51200
buffer_load_dwordx4 v31, s[52:55], s100 offen offset:1024 lds
v_mfma_f32_16x16x32_bf16 v[60:63], a[60:63], a[232:235], v[60:63]
ds_read_b64_tr_b16 a[28:29], v103 offset:49152
v_mfma_f32_16x16x32_bf16 v[92:95], a[60:63], a[236:239], v[92:95]
ds_read_b64_tr_b16 a[30:31], v103 offset:51200
s_waitcnt vmcnt(26)
s_waitcnt lgkmcnt(8)
v_mfma_f32_16x16x32_bf16 v[32:35], a[0:3], a[240:243], v[32:35]
ds_read_b64_tr_b16 a[32:33], v96 offset:57344
v_mfma_f32_16x16x32_bf16 v[64:67], a[0:3], a[244:247], v[64:67]
ds_read_b64_tr_b16 a[34:35], v96 offset:59392
buffer_load_dwordx4 a[168:171], v146, s[12:15], s20 offen offset:2048 sc1
v_mfma_f32_16x16x32_bf16 v[36:39], a[4:7], a[240:243], v[36:39]
ds_read_b64_tr_b16 a[36:37], v97 offset:57344
v_mfma_f32_16x16x32_bf16 v[68:71], a[4:7], a[244:247], v[68:71]
ds_read_b64_tr_b16 a[38:39], v97 offset:59392
buffer_load_dwordx4 a[172:175], v146, s[12:15], s20 offen offset:2304 sc1
v_mfma_f32_16x16x32_bf16 v[40:43], a[8:11], a[240:243], v[40:43]
ds_read_b64_tr_b16 a[40:41], v98 offset:57344
v_mfma_f32_16x16x32_bf16 v[72:75], a[8:11], a[244:247], v[72:75]
ds_read_b64_tr_b16 a[42:43], v98 offset:59392
s_add_u32 s100, s100, 458752
v_mfma_f32_16x16x32_bf16 v[44:47], a[12:15], a[240:243], v[44:47]
ds_read_b64_tr_b16 a[44:45], v99 offset:57344
v_mfma_f32_16x16x32_bf16 v[76:79], a[12:15], a[244:247], v[76:79]
ds_read_b64_tr_b16 a[46:47], v99 offset:59392
s_add_u32 m0, s26, 16384
s_waitcnt lgkmcnt(8)
v_mfma_f32_16x16x32_bf16 v[48:51], a[16:19], a[240:243], v[48:51]
ds_read_b64_tr_b16 a[48:49], v100 offset:57344
v_mfma_f32_16x16x32_bf16 v[80:83], a[16:19], a[244:247], v[80:83]
ds_read_b64_tr_b16 a[50:51], v100 offset:59392
buffer_load_dwordx4 v30, s[52:55], s100 offen lds
v_mfma_f32_16x16x32_bf16 v[52:55], a[20:23], a[240:243], v[52:55]
ds_read_b64_tr_b16 a[52:53], v101 offset:57344
v_mfma_f32_16x16x32_bf16 v[84:87], a[20:23], a[244:247], v[84:87]
ds_read_b64_tr_b16 a[54:55], v101 offset:59392
buffer_load_dwordx4 v31, s[52:55], s100 offen offset:1024 lds
v_mfma_f32_16x16x32_bf16 v[56:59], a[24:27], a[240:243], v[56:59]
ds_read_b64_tr_b16 a[56:57], v102 offset:57344
v_mfma_f32_16x16x32_bf16 v[88:91], a[24:27], a[244:247], v[88:91]
ds_read_b64_tr_b16 a[58:59], v102 offset:59392
v_mfma_f32_16x16x32_bf16 v[60:63], a[28:31], a[240:243], v[60:63]
ds_read_b64_tr_b16 a[60:61], v103 offset:57344
v_mfma_f32_16x16x32_bf16 v[92:95], a[28:31], a[244:247], v[92:95]
ds_read_b64_tr_b16 a[62:63], v103 offset:59392
s_waitcnt vmcnt(26)
s_waitcnt lgkmcnt(8)
v_mfma_f32_16x16x32_bf16 v[32:35], a[32:35], a[248:251], v[32:35]
s_add_u32 s20, s20, 4096
v_mfma_f32_16x16x32_bf16 v[64:67], a[32:35], a[252:255], v[64:67]
buffer_load_dwordx4 a[176:179], v146, s[12:15], s20 offen offset:0 sc1
v_mfma_f32_16x16x32_bf16 v[36:39], a[36:39], a[248:251], v[36:39]
buffer_load_dwordx4 a[180:183], v146, s[12:15], s20 offen offset:256 sc1
v_mfma_f32_16x16x32_bf16 v[68:71], a[36:39], a[252:255], v[68:71]
s_add_u32 s100, s100, 458752
v_mfma_f32_16x16x32_bf16 v[40:43], a[40:43], a[248:251], v[40:43]
s_add_u32 m0, s26, 24576
v_mfma_f32_16x16x32_bf16 v[72:75], a[40:43], a[252:255], v[72:75]
buffer_load_dwordx4 v30, s[52:55], s100 offen lds
v_mfma_f32_16x16x32_bf16 v[44:47], a[44:47], a[248:251], v[44:47]
buffer_load_dwordx4 v31, s[52:55], s100 offen offset:1024 lds
v_mfma_f32_16x16x32_bf16 v[76:79], a[44:47], a[252:255], v[76:79]
s_waitcnt vmcnt(32) lgkmcnt(0)
s_barrier
v_mfma_f32_16x16x32_bf16 v[48:51], a[48:51], a[248:251], v[48:51]
ds_read_b64_tr_b16 a[0:1], v104 offset:0
ds_read_b64_tr_b16 a[2:3], v104 offset:2048
v_mfma_f32_16x16x32_bf16 v[80:83], a[48:51], a[252:255], v[80:83]
ds_read_b64_tr_b16 a[4:5], v105 offset:0
ds_read_b64_tr_b16 a[6:7], v105 offset:2048
v_mfma_f32_16x16x32_bf16 v[52:55], a[52:55], a[248:251], v[52:55]
ds_read_b64_tr_b16 a[8:9], v106 offset:0
ds_read_b64_tr_b16 a[10:11], v106 offset:2048
v_mfma_f32_16x16x32_bf16 v[84:87], a[52:55], a[252:255], v[84:87]
ds_read_b64_tr_b16 a[12:13], v107 offset:0
ds_read_b64_tr_b16 a[14:15], v107 offset:2048
v_mfma_f32_16x16x32_bf16 v[56:59], a[56:59], a[248:251], v[56:59]
ds_read_b64_tr_b16 a[16:17], v108 offset:0
ds_read_b64_tr_b16 a[18:19], v108 offset:2048
v_mfma_f32_16x16x32_bf16 v[88:91], a[56:59], a[252:255], v[88:91]
ds_read_b64_tr_b16 a[20:21], v109 offset:0
ds_read_b64_tr_b16 a[22:23], v109 offset:2048
v_mfma_f32_16x16x32_bf16 v[60:63], a[60:63], a[248:251], v[60:63]
ds_read_b64_tr_b16 a[24:25], v110 offset:0
ds_read_b64_tr_b16 a[26:27], v110 offset:2048
v_mfma_f32_16x16x32_bf16 v[92:95], a[60:63], a[252:255], v[92:95]
ds_read_b64_tr_b16 a[28:29], v111 offset:0
ds_read_b64_tr_b16 a[30:31], v111 offset:2048
s_waitcnt vmcnt(26)
s_waitcnt lgkmcnt(8)
v_mfma_f32_16x16x32_bf16 v[32:35], a[0:3], a[128:131], v[32:35]
ds_read_b64_tr_b16 a[32:33], v104 offset:8192
v_mfma_f32_16x16x32_bf16 v[64:67], a[0:3], a[132:135], v[64:67]
ds_read_b64_tr_b16 a[34:35], v104 offset:10240
buffer_load_dwordx4 a[184:187], v146, s[12:15], s20 offen offset:2048 sc1
v_mfma_f32_16x16x32_bf16 v[36:39], a[4:7], a[128:131], v[36:39]
ds_read_b64_tr_b16 a[36:37], v105 offset:8192
v_mfma_f32_16x16x32_bf16 v[68:71], a[4:7], a[132:135], v[68:71]
ds_read_b64_tr_b16 a[38:39], v105 offset:10240
buffer_load_dwordx4 a[188:191], v146, s[12:15], s20 offen offset:2304 sc1
v_mfma_f32_16x16x32_bf16 v[40:43], a[8:11], a[128:131], v[40:43]
ds_read_b64_tr_b16 a[40:41], v106 offset:8192
v_mfma_f32_16x16x32_bf16 v[72:75], a[8:11], a[132:135], v[72:75]
ds_read_b64_tr_b16 a[42:43], v106 offset:10240
s_add_u32 s100, s100, 458752
v_mfma_f32_16x16x32_bf16 v[44:47], a[12:15], a[128:131], v[44:47]
ds_read_b64_tr_b16 a[44:45], v107 offset:8192
v_mfma_f32_16x16x32_bf16 v[76:79], a[12:15], a[132:135], v[76:79]
ds_read_b64_tr_b16 a[46:47], v107 offset:10240
s_add_u32 m0, s26, 32768
s_waitcnt lgkmcnt(8)
v_mfma_f32_16x16x32_bf16 v[48:51], a[16:19], a[128:131], v[48:51]
ds_read_b64_tr_b16 a[48:49], v108 offset:8192
v_mfma_f32_16x16x32_bf16 v[80:83], a[16:19], a[132:135], v[80:83]
ds_read_b64_tr_b16 a[50:51], v108 offset:10240
buffer_load_dwordx4 v30, s[52:55], s100 offen lds
v_mfma_f32_16x16x32_bf16 v[52:55], a[20:23], a[128:131], v[52:55]
ds_read_b64_tr_b16 a[52:53], v109 offset:8192
v_mfma_f32_16x16x32_bf16 v[84:87], a[20:23], a[132:135], v[84:87]
ds_read_b64_tr_b16 a[54:55], v109 offset:10240
buffer_load_dwordx4 v31, s[52:55], s100 offen offset:1024 lds
v_mfma_f32_16x16x32_bf16 v[56:59], a[24:27], a[128:131], v[56:59]
ds_read_b64_tr_b16 a[56:57], v110 offset:8192
v_mfma_f32_16x16x32_bf16 v[88:91], a[24:27], a[132:135], v[88:91]
ds_read_b64_tr_b16 a[58:59], v110 offset:10240
v_mfma_f32_16x16x32_bf16 v[60:63], a[28:31], a[128:131], v[60:63]
ds_read_b64_tr_b16 a[60:61], v111 offset:8192
v_mfma_f32_16x16x32_bf16 v[92:95], a[28:31], a[132:135], v[92:95]
ds_read_b64_tr_b16 a[62:63], v111 offset:10240
s_waitcnt vmcnt(26)
s_waitcnt lgkmcnt(8)
v_mfma_f32_16x16x32_bf16 v[32:35], a[32:35], a[136:139], v[32:35]
ds_read_b64_tr_b16 a[0:1], v104 offset:16384
v_mfma_f32_16x16x32_bf16 v[64:67], a[32:35], a[140:143], v[64:67]
ds_read_b64_tr_b16 a[2:3], v104 offset:18432
s_add_u32 s20, s20, 4096
v_mfma_f32_16x16x32_bf16 v[36:39], a[36:39], a[136:139], v[36:39]
ds_read_b64_tr_b16 a[4:5], v105 offset:16384
v_mfma_f32_16x16x32_bf16 v[68:71], a[36:39], a[140:143], v[68:71]
ds_read_b64_tr_b16 a[6:7], v105 offset:18432
buffer_load_dwordx4 a[192:195], v146, s[12:15], s20 offen offset:0 sc1
v_mfma_f32_16x16x32_bf16 v[40:43], a[40:43], a[136:139], v[40:43]
ds_read_b64_tr_b16 a[8:9], v106 offset:16384
v_mfma_f32_16x16x32_bf16 v[72:75], a[40:43], a[140:143], v[72:75]
ds_read_b64_tr_b16 a[10:11], v106 offset:18432
buffer_load_dwordx4 a[196:199], v146, s[12:15], s20 offen offset:256 sc1
v_mfma_f32_16x16x32_bf16 v[44:47], a[44:47], a[136:139], v[44:47]
ds_read_b64_tr_b16 a[12:13], v107 offset:16384
v_mfma_f32_16x16x32_bf16 v[76:79], a[44:47], a[140:143], v[76:79]
ds_read_b64_tr_b16 a[14:15], v107 offset:18432
s_add_u32 s100, s100, 458752
s_waitcnt lgkmcnt(8)
v_mfma_f32_16x16x32_bf16 v[48:51], a[48:51], a[136:139], v[48:51]
ds_read_b64_tr_b16 a[16:17], v108 offset:16384
v_mfma_f32_16x16x32_bf16 v[80:83], a[48:51], a[140:143], v[80:83]
ds_read_b64_tr_b16 a[18:19], v108 offset:18432
s_add_u32 m0, s26, 40960
v_mfma_f32_16x16x32_bf16 v[52:55], a[52:55], a[136:139], v[52:55]
ds_read_b64_tr_b16 a[20:21], v109 offset:16384
v_mfma_f32_16x16x32_bf16 v[84:87], a[52:55], a[140:143], v[84:87]
ds_read_b64_tr_b16 a[22:23], v109 offset:18432
buffer_load_dwordx4 v30, s[52:55], s100 offen lds
v_mfma_f32_16x16x32_bf16 v[56:59], a[56:59], a[136:139], v[56:59]
ds_read_b64_tr_b16 a[24:25], v110 offset:16384
v_mfma_f32_16x16x32_bf16 v[88:91], a[56:59], a[140:143], v[88:91]
ds_read_b64_tr_b16 a[26:27], v110 offset:18432
buffer_load_dwordx4 v31, s[52:55], s100 offen offset:1024 lds
v_mfma_f32_16x16x32_bf16 v[60:63], a[60:63], a[136:139], v[60:63]
ds_read_b64_tr_b16 a[28:29], v111 offset:16384
v_mfma_f32_16x16x32_bf16 v[92:95], a[60:63], a[140:143], v[92:95]
ds_read_b64_tr_b16 a[30:31], v111 offset:18432
s_waitcnt vmcnt(26)
s_waitcnt lgkmcnt(8)
v_mfma_f32_16x16x32_bf16 v[32:35], a[0:3], a[144:147], v[32:35]
ds_read_b64_tr_b16 a[32:33], v104 offset:24576
v_mfma_f32_16x16x32_bf16 v[64:67], a[0:3], a[148:151], v[64:67]
ds_read_b64_tr_b16 a[34:35], v104 offset:26624
buffer_load_dwordx4 a[200:203], v146, s[12:15], s20 offen offset:2048 sc1
v_mfma_f32_16x16x32_bf16 v[36:39], a[4:7], a[144:147], v[36:39]
ds_read_b64_tr_b16 a[36:37], v105 offset:24576
v_mfma_f32_16x16x32_bf16 v[68:71], a[4:7], a[148:151], v[68:71]
ds_read_b64_tr_b16 a[38:39], v105 offset:26624
buffer_load_dwordx4 a[204:207], v146, s[12:15], s20 offen offset:2304 sc1
v_mfma_f32_16x16x32_bf16 v[40:43], a[8:11], a[144:147], v[40:43]
ds_read_b64_tr_b16 a[40:41], v106 offset:24576
v_mfma_f32_16x16x32_bf16 v[72:75], a[8:11], a[148:151], v[72:75]
ds_read_b64_tr_b16 a[42:43], v106 offset:26624
s_add_u32 s100, s100, 458752
v_mfma_f32_16x16x32_bf16 v[44:47], a[12:15], a[144:147], v[44:47]
ds_read_b64_tr_b16 a[44:45], v107 offset:24576
v_mfma_f32_16x16x32_bf16 v[76:79], a[12:15], a[148:151], v[76:79]
ds_read_b64_tr_b16 a[46:47], v107 offset:26624
s_add_u32 m0, s26, 49152
s_waitcnt lgkmcnt(8)
v_mfma_f32_16x16x32_bf16 v[48:51], a[16:19], a[144:147], v[48:51]
ds_read_b64_tr_b16 a[48:49], v108 offset:24576
v_mfma_f32_16x16x32_bf16 v[80:83], a[16:19], a[148:151], v[80:83]
ds_read_b64_tr_b16 a[50:51], v108 offset:26624
buffer_load_dwordx4 v30, s[52:55], s100 offen lds
v_mfma_f32_16x16x32_bf16 v[52:55], a[20:23], a[144:147], v[52:55]
ds_read_b64_tr_b16 a[52:53], v109 offset:24576
v_mfma_f32_16x16x32_bf16 v[84:87], a[20:23], a[148:151], v[84:87]
ds_read_b64_tr_b16 a[54:55], v109 offset:26624
buffer_load_dwordx4 v31, s[52:55], s100 offen offset:1024 lds
v_mfma_f32_16x16x32_bf16 v[56:59], a[24:27], a[144:147], v[56:59]
ds_read_b64_tr_b16 a[56:57], v110 offset:24576
v_mfma_f32_16x16x32_bf16 v[88:91], a[24:27], a[148:151], v[88:91]
ds_read_b64_tr_b16 a[58:59], v110 offset:26624
v_mfma_f32_16x16x32_bf16 v[60:63], a[28:31], a[144:147], v[60:63]
ds_read_b64_tr_b16 a[60:61], v111 offset:24576
v_mfma_f32_16x16x32_bf16 v[92:95], a[28:31], a[148:151], v[92:95]
ds_read_b64_tr_b16 a[62:63], v111 offset:26624
s_waitcnt vmcnt(26)
s_waitcnt lgkmcnt(8)
v_mfma_f32_16x16x32_bf16 v[32:35], a[32:35], a[152:155], v[32:35]
s_add_u32 s20, s20, 4096
v_mfma_f32_16x16x32_bf16 v[64:67], a[32:35], a[156:159], v[64:67]
buffer_load_dwordx4 a[208:211], v146, s[12:15], s20 offen offset:0 sc1
v_mfma_f32_16x16x32_bf16 v[36:39], a[36:39], a[152:155], v[36:39]
buffer_load_dwordx4 a[212:215], v146, s[12:15], s20 offen offset:256 sc1
v_mfma_f32_16x16x32_bf16 v[68:71], a[36:39], a[156:159], v[68:71]
s_add_u32 s100, s100, 458752
v_mfma_f32_16x16x32_bf16 v[40:43], a[40:43], a[152:155], v[40:43]
s_add_u32 m0, s26, 57344
v_mfma_f32_16x16x32_bf16 v[72:75], a[40:43], a[156:159], v[72:75]
buffer_load_dwordx4 v30, s[52:55], s100 offen lds
v_mfma_f32_16x16x32_bf16 v[44:47], a[44:47], a[152:155], v[44:47]
buffer_load_dwordx4 v31, s[52:55], s100 offen offset:1024 lds
v_mfma_f32_16x16x32_bf16 v[76:79], a[44:47], a[156:159], v[76:79]
s_waitcnt vmcnt(32) lgkmcnt(0)
s_barrier
v_mfma_f32_16x16x32_bf16 v[48:51], a[48:51], a[152:155], v[48:51]
ds_read_b64_tr_b16 a[0:1], v104 offset:32768
ds_read_b64_tr_b16 a[2:3], v104 offset:34816
v_mfma_f32_16x16x32_bf16 v[80:83], a[48:51], a[156:159], v[80:83]
ds_read_b64_tr_b16 a[4:5], v105 offset:32768
ds_read_b64_tr_b16 a[6:7], v105 offset:34816
v_mfma_f32_16x16x32_bf16 v[52:55], a[52:55], a[152:155], v[52:55]
ds_read_b64_tr_b16 a[8:9], v106 offset:32768
ds_read_b64_tr_b16 a[10:11], v106 offset:34816
v_mfma_f32_16x16x32_bf16 v[84:87], a[52:55], a[156:159], v[84:87]
ds_read_b64_tr_b16 a[12:13], v107 offset:32768
ds_read_b64_tr_b16 a[14:15], v107 offset:34816
v_mfma_f32_16x16x32_bf16 v[56:59], a[56:59], a[152:155], v[56:59]
ds_read_b64_tr_b16 a[16:17], v108 offset:32768
ds_read_b64_tr_b16 a[18:19], v108 offset:34816
v_mfma_f32_16x16x32_bf16 v[88:91], a[56:59], a[156:159], v[88:91]
ds_read_b64_tr_b16 a[20:21], v109 offset:32768
ds_read_b64_tr_b16 a[22:23], v109 offset:34816
v_mfma_f32_16x16x32_bf16 v[60:63], a[60:63], a[152:155], v[60:63]
ds_read_b64_tr_b16 a[24:25], v110 offset:32768
ds_read_b64_tr_b16 a[26:27], v110 offset:34816
v_mfma_f32_16x16x32_bf16 v[92:95], a[60:63], a[156:159], v[92:95]
ds_read_b64_tr_b16 a[28:29], v111 offset:32768
ds_read_b64_tr_b16 a[30:31], v111 offset:34816
s_waitcnt vmcnt(26)
s_waitcnt lgkmcnt(8)
v_mfma_f32_16x16x32_bf16 v[32:35], a[0:3], a[160:163], v[32:35]
ds_read_b64_tr_b16 a[32:33], v104 offset:40960
v_mfma_f32_16x16x32_bf16 v[64:67], a[0:3], a[164:167], v[64:67]
ds_read_b64_tr_b16 a[34:35], v104 offset:43008
buffer_load_dword v145, v144, s[16:19], 0 offen sc1
v_mfma_f32_16x16x32_bf16 v[36:39], a[4:7], a[160:163], v[36:39]
ds_read_b64_tr_b16 a[36:37], v105 offset:40960
v_mfma_f32_16x16x32_bf16 v[68:71], a[4:7], a[164:167], v[68:71]
ds_read_b64_tr_b16 a[38:39], v105 offset:43008
buffer_load_dwordx4 a[216:219], v146, s[12:15], s20 offen offset:2048 sc1
v_mfma_f32_16x16x32_bf16 v[40:43], a[8:11], a[160:163], v[40:43]
ds_read_b64_tr_b16 a[40:41], v106 offset:40960
v_mfma_f32_16x16x32_bf16 v[72:75], a[8:11], a[164:167], v[72:75]
ds_read_b64_tr_b16 a[42:43], v106 offset:43008
buffer_load_dwordx4 a[220:223], v146, s[12:15], s20 offen offset:2304 sc1
v_mfma_f32_16x16x32_bf16 v[44:47], a[12:15], a[160:163], v[44:47]
ds_read_b64_tr_b16 a[44:45], v107 offset:40960
v_mfma_f32_16x16x32_bf16 v[76:79], a[12:15], a[164:167], v[76:79]
ds_read_b64_tr_b16 a[46:47], v107 offset:43008
s_sub_u32 s100, s100, 3178496
s_waitcnt lgkmcnt(8)
v_mfma_f32_16x16x32_bf16 v[48:51], a[16:19], a[160:163], v[48:51]
ds_read_b64_tr_b16 a[48:49], v108 offset:40960
v_mfma_f32_16x16x32_bf16 v[80:83], a[16:19], a[164:167], v[80:83]
ds_read_b64_tr_b16 a[50:51], v108 offset:43008
s_add_u32 m0, s26, 65536
v_mfma_f32_16x16x32_bf16 v[52:55], a[20:23], a[160:163], v[52:55]
ds_read_b64_tr_b16 a[52:53], v109 offset:40960
v_mfma_f32_16x16x32_bf16 v[84:87], a[20:23], a[164:167], v[84:87]
ds_read_b64_tr_b16 a[54:55], v109 offset:43008
buffer_load_dwordx4 v30, s[52:55], s100 offen lds
v_mfma_f32_16x16x32_bf16 v[56:59], a[24:27], a[160:163], v[56:59]
ds_read_b64_tr_b16 a[56:57], v110 offset:40960
v_mfma_f32_16x16x32_bf16 v[88:91], a[24:27], a[164:167], v[88:91]
ds_read_b64_tr_b16 a[58:59], v110 offset:43008
buffer_load_dwordx4 v31, s[52:55], s100 offen offset:1024 lds
v_mfma_f32_16x16x32_bf16 v[60:63], a[28:31], a[160:163], v[60:63]
ds_read_b64_tr_b16 a[60:61], v111 offset:40960
v_mfma_f32_16x16x32_bf16 v[92:95], a[28:31], a[164:167], v[92:95]
ds_read_b64_tr_b16 a[62:63], v111 offset:43008
s_waitcnt vmcnt(27)
s_waitcnt lgkmcnt(8)
v_mfma_f32_16x16x32_bf16 v[32:35], a[32:35], a[168:171], v[32:35]
ds_read_b64_tr_b16 a[0:1], v104 offset:49152
v_mfma_f32_16x16x32_bf16 v[64:67], a[32:35], a[172:175], v[64:67]
ds_read_b64_tr_b16 a[2:3], v104 offset:51200
s_add_u32 s20, s20, 4096
v_mfma_f32_16x16x32_bf16 v[36:39], a[36:39], a[168:171], v[36:39]
ds_read_b64_tr_b16 a[4:5], v105 offset:49152
v_mfma_f32_16x16x32_bf16 v[68:71], a[36:39], a[172:175], v[68:71]
ds_read_b64_tr_b16 a[6:7], v105 offset:51200
buffer_load_dwordx4 a[224:227], v146, s[12:15], s20 offen offset:0 sc1
v_mfma_f32_16x16x32_bf16 v[40:43], a[40:43], a[168:171], v[40:43]
ds_read_b64_tr_b16 a[8:9], v106 offset:49152
v_mfma_f32_16x16x32_bf16 v[72:75], a[40:43], a[172:175], v[72:75]
ds_read_b64_tr_b16 a[10:11], v106 offset:51200
buffer_load_dwordx4 a[228:231], v146, s[12:15], s20 offen offset:256 sc1
v_mfma_f32_16x16x32_bf16 v[44:47], a[44:47], a[168:171], v[44:47]
ds_read_b64_tr_b16 a[12:13], v107 offset:49152
v_mfma_f32_16x16x32_bf16 v[76:79], a[44:47], a[172:175], v[76:79]
ds_read_b64_tr_b16 a[14:15], v107 offset:51200
s_add_u32 s100, s100, 458752
s_waitcnt lgkmcnt(8)
v_mfma_f32_16x16x32_bf16 v[48:51], a[48:51], a[168:171], v[48:51]
ds_read_b64_tr_b16 a[16:17], v108 offset:49152
v_mfma_f32_16x16x32_bf16 v[80:83], a[48:51], a[172:175], v[80:83]
ds_read_b64_tr_b16 a[18:19], v108 offset:51200
s_add_u32 m0, s26, 73728
v_mfma_f32_16x16x32_bf16 v[52:55], a[52:55], a[168:171], v[52:55]
ds_read_b64_tr_b16 a[20:21], v109 offset:49152
v_mfma_f32_16x16x32_bf16 v[84:87], a[52:55], a[172:175], v[84:87]
ds_read_b64_tr_b16 a[22:23], v109 offset:51200
buffer_load_dwordx4 v30, s[52:55], s100 offen lds
v_mfma_f32_16x16x32_bf16 v[56:59], a[56:59], a[168:171], v[56:59]
ds_read_b64_tr_b16 a[24:25], v110 offset:49152
v_mfma_f32_16x16x32_bf16 v[88:91], a[56:59], a[172:175], v[88:91]
ds_read_b64_tr_b16 a[26:27], v110 offset:51200
buffer_load_dwordx4 v31, s[52:55], s100 offen offset:1024 lds
v_mfma_f32_16x16x32_bf16 v[60:63], a[60:63], a[168:171], v[60:63]
ds_read_b64_tr_b16 a[28:29], v111 offset:49152
v_mfma_f32_16x16x32_bf16 v[92:95], a[60:63], a[172:175], v[92:95]
ds_read_b64_tr_b16 a[30:31], v111 offset:51200
s_waitcnt vmcnt(27)
s_waitcnt lgkmcnt(8)
v_mfma_f32_16x16x32_bf16 v[32:35], a[0:3], a[176:179], v[32:35]
ds_read_b64_tr_b16 a[32:33], v104 offset:57344
v_mfma_f32_16x16x32_bf16 v[64:67], a[0:3], a[180:183], v[64:67]
ds_read_b64_tr_b16 a[34:35], v104 offset:59392
buffer_load_dwordx4 a[232:235], v146, s[12:15], s20 offen offset:2048 sc1
v_mfma_f32_16x16x32_bf16 v[36:39], a[4:7], a[176:179], v[36:39]
ds_read_b64_tr_b16 a[36:37], v105 offset:57344
v_mfma_f32_16x16x32_bf16 v[68:71], a[4:7], a[180:183], v[68:71]
ds_read_b64_tr_b16 a[38:39], v105 offset:59392
buffer_load_dwordx4 a[236:239], v146, s[12:15], s20 offen offset:2304 sc1
v_mfma_f32_16x16x32_bf16 v[40:43], a[8:11], a[176:179], v[40:43]
ds_read_b64_tr_b16 a[40:41], v106 offset:57344
v_mfma_f32_16x16x32_bf16 v[72:75], a[8:11], a[180:183], v[72:75]
ds_read_b64_tr_b16 a[42:43], v106 offset:59392
s_add_u32 s100, s100, 458752
v_mfma_f32_16x16x32_bf16 v[44:47], a[12:15], a[176:179], v[44:47]
ds_read_b64_tr_b16 a[44:45], v107 offset:57344
v_mfma_f32_16x16x32_bf16 v[76:79], a[12:15], a[180:183], v[76:79]
ds_read_b64_tr_b16 a[46:47], v107 offset:59392
s_add_u32 m0, s26, 81920
s_waitcnt lgkmcnt(8)
v_mfma_f32_16x16x32_bf16 v[48:51], a[16:19], a[176:179], v[48:51]
ds_read_b64_tr_b16 a[48:49], v108 offset:57344
v_mfma_f32_16x16x32_bf16 v[80:83], a[16:19], a[180:183], v[80:83]
ds_read_b64_tr_b16 a[50:51], v108 offset:59392
buffer_load_dwordx4 v30, s[52:55], s100 offen lds
v_mfma_f32_16x16x32_bf16 v[52:55], a[20:23], a[176:179], v[52:55]
ds_read_b64_tr_b16 a[52:53], v109 offset:57344
v_mfma_f32_16x16x32_bf16 v[84:87], a[20:23], a[180:183], v[84:87]
ds_read_b64_tr_b16 a[54:55], v109 offset:59392
buffer_load_dwordx4 v31, s[52:55], s100 offen offset:1024 lds
v_mfma_f32_16x16x32_bf16 v[56:59], a[24:27], a[176:179], v[56:59]
ds_read_b64_tr_b16 a[56:57], v110 offset:57344
v_mfma_f32_16x16x32_bf16 v[88:91], a[24:27], a[180:183], v[88:91]
ds_read_b64_tr_b16 a[58:59], v110 offset:59392
v_mfma_f32_16x16x32_bf16 v[60:63], a[28:31], a[176:179], v[60:63]
ds_read_b64_tr_b16 a[60:61], v111 offset:57344
v_mfma_f32_16x16x32_bf16 v[92:95], a[28:31], a[180:183], v[92:95]
ds_read_b64_tr_b16 a[62:63], v111 offset:59392
s_waitcnt vmcnt(27)
s_waitcnt lgkmcnt(8)
v_mfma_f32_16x16x32_bf16 v[32:35], a[32:35], a[184:187], v[32:35]
s_add_u32 s20, s20, 4096
v_mfma_f32_16x16x32_bf16 v[64:67], a[32:35], a[188:191], v[64:67]
buffer_load_dwordx4 a[240:243], v146, s[12:15], s20 offen offset:0 sc1
v_mfma_f32_16x16x32_bf16 v[36:39], a[36:39], a[184:187], v[36:39]
buffer_load_dwordx4 a[244:247], v146, s[12:15], s20 offen offset:256 sc1
v_mfma_f32_16x16x32_bf16 v[68:71], a[36:39], a[188:191], v[68:71]
s_add_u32 s100, s100, 458752
v_mfma_f32_16x16x32_bf16 v[40:43], a[40:43], a[184:187], v[40:43]
s_add_u32 m0, s26, 90112
v_mfma_f32_16x16x32_bf16 v[72:75], a[40:43], a[188:191], v[72:75]
buffer_load_dwordx4 v30, s[52:55], s100 offen lds
v_mfma_f32_16x16x32_bf16 v[44:47], a[44:47], a[184:187], v[44:47]
buffer_load_dwordx4 v31, s[52:55], s100 offen offset:1024 lds
v_mfma_f32_16x16x32_bf16 v[76:79], a[44:47], a[188:191], v[76:79]
s_waitcnt vmcnt(33) lgkmcnt(0)
s_barrier
v_mfma_f32_16x16x32_bf16 v[48:51], a[48:51], a[184:187], v[48:51]
ds_read_b64_tr_b16 a[0:1], v96 offset:0
ds_read_b64_tr_b16 a[2:3], v96 offset:2048
v_mfma_f32_16x16x32_bf16 v[80:83], a[48:51], a[188:191], v[80:83]
ds_read_b64_tr_b16 a[4:5], v97 offset:0
ds_read_b64_tr_b16 a[6:7], v97 offset:2048
v_mfma_f32_16x16x32_bf16 v[52:55], a[52:55], a[184:187], v[52:55]
ds_read_b64_tr_b16 a[8:9], v98 offset:0
ds_read_b64_tr_b16 a[10:11], v98 offset:2048
v_mfma_f32_16x16x32_bf16 v[84:87], a[52:55], a[188:191], v[84:87]
ds_read_b64_tr_b16 a[12:13], v99 offset:0
ds_read_b64_tr_b16 a[14:15], v99 offset:2048
v_mfma_f32_16x16x32_bf16 v[56:59], a[56:59], a[184:187], v[56:59]
ds_read_b64_tr_b16 a[16:17], v100 offset:0
ds_read_b64_tr_b16 a[18:19], v100 offset:2048
v_mfma_f32_16x16x32_bf16 v[88:91], a[56:59], a[188:191], v[88:91]
ds_read_b64_tr_b16 a[20:21], v101 offset:0
ds_read_b64_tr_b16 a[22:23], v101 offset:2048
v_mfma_f32_16x16x32_bf16 v[60:63], a[60:63], a[184:187], v[60:63]
ds_read_b64_tr_b16 a[24:25], v102 offset:0
ds_read_b64_tr_b16 a[26:27], v102 offset:2048
v_mfma_f32_16x16x32_bf16 v[92:95], a[60:63], a[188:191], v[92:95]
ds_read_b64_tr_b16 a[28:29], v103 offset:0
ds_read_b64_tr_b16 a[30:31], v103 offset:2048
s_waitcnt vmcnt(27)
s_waitcnt lgkmcnt(8)
v_mfma_f32_16x16x32_bf16 v[32:35], a[0:3], a[192:195], v[32:35]
ds_read_b64_tr_b16 a[32:33], v96 offset:8192
v_mfma_f32_16x16x32_bf16 v[64:67], a[0:3], a[196:199], v[64:67]
ds_read_b64_tr_b16 a[34:35], v96 offset:10240
buffer_load_dwordx4 a[248:251], v146, s[12:15], s20 offen offset:2048 sc1
v_mfma_f32_16x16x32_bf16 v[36:39], a[4:7], a[192:195], v[36:39]
ds_read_b64_tr_b16 a[36:37], v97 offset:8192
v_mfma_f32_16x16x32_bf16 v[68:71], a[4:7], a[196:199], v[68:71]
ds_read_b64_tr_b16 a[38:39], v97 offset:10240
buffer_load_dwordx4 a[252:255], v146, s[12:15], s20 offen offset:2304 sc1
v_mfma_f32_16x16x32_bf16 v[40:43], a[8:11], a[192:195], v[40:43]
ds_read_b64_tr_b16 a[40:41], v98 offset:8192
v_mfma_f32_16x16x32_bf16 v[72:75], a[8:11], a[196:199], v[72:75]
ds_read_b64_tr_b16 a[42:43], v98 offset:10240
s_add_u32 s100, s100, 458752
v_mfma_f32_16x16x32_bf16 v[44:47], a[12:15], a[192:195], v[44:47]
ds_read_b64_tr_b16 a[44:45], v99 offset:8192
v_mfma_f32_16x16x32_bf16 v[76:79], a[12:15], a[196:199], v[76:79]
ds_read_b64_tr_b16 a[46:47], v99 offset:10240
s_add_u32 m0, s26, 98304
s_waitcnt lgkmcnt(8)
v_mfma_f32_16x16x32_bf16 v[48:51], a[16:19], a[192:195], v[48:51]
ds_read_b64_tr_b16 a[48:49], v100 offset:8192
v_mfma_f32_16x16x32_bf16 v[80:83], a[16:19], a[196:199], v[80:83]
ds_read_b64_tr_b16 a[50:51], v100 offset:10240
buffer_load_dwordx4 v30, s[52:55], s100 offen lds
v_mfma_f32_16x16x32_bf16 v[52:55], a[20:23], a[192:195], v[52:55]
ds_read_b64_tr_b16 a[52:53], v101 offset:8192
v_mfma_f32_16x16x32_bf16 v[84:87], a[20:23], a[196:199], v[84:87]
ds_read_b64_tr_b16 a[54:55], v101 offset:10240
buffer_load_dwordx4 v31, s[52:55], s100 offen offset:1024 lds
v_mfma_f32_16x16x32_bf16 v[56:59], a[24:27], a[192:195], v[56:59]
ds_read_b64_tr_b16 a[56:57], v102 offset:8192
v_mfma_f32_16x16x32_bf16 v[88:91], a[24:27], a[196:199], v[88:91]
ds_read_b64_tr_b16 a[58:59], v102 offset:10240
v_mfma_f32_16x16x32_bf16 v[60:63], a[28:31], a[192:195], v[60:63]
ds_read_b64_tr_b16 a[60:61], v103 offset:8192
v_mfma_f32_16x16x32_bf16 v[92:95], a[28:31], a[196:199], v[92:95]
ds_read_b64_tr_b16 a[62:63], v103 offset:10240
s_waitcnt vmcnt(27)
s_waitcnt lgkmcnt(8)
v_mfma_f32_16x16x32_bf16 v[32:35], a[32:35], a[200:203], v[32:35]
ds_read_b64_tr_b16 a[0:1], v96 offset:16384
v_mfma_f32_16x16x32_bf16 v[64:67], a[32:35], a[204:207], v[64:67]
ds_read_b64_tr_b16 a[2:3], v96 offset:18432
s_waitcnt vmcnt(20)
s_mov_b32 s57, 0
L_g2_pollA2:
v_cmp_le_u32 vcc, 7, v145
s_cmp_eq_u64 vcc, -1
s_cbranch_scc1 L_g2_polledA2
s_add_u32 s57, s57, 1
s_cmp_gt_u32 s57, 20000
s_cbranch_scc1 L_g2_polledA2
buffer_load_dword v145, v144, s[16:19], 0 offen sc1
s_waitcnt vmcnt(0)
s_branch L_g2_pollA2
L_g2_polledA2:
v_mfma_f32_16x16x32_bf16 v[36:39], a[36:39], a[200:203], v[36:39]
ds_read_b64_tr_b16 a[4:5], v97 offset:16384
v_mfma_f32_16x16x32_bf16 v[68:71], a[36:39], a[204:207], v[68:71]
ds_read_b64_tr_b16 a[6:7], v97 offset:18432
s_add_u32 s20, s20, 4096
v_mfma_f32_16x16x32_bf16 v[40:43], a[40:43], a[200:203], v[40:43]
ds_read_b64_tr_b16 a[8:9], v98 offset:16384
v_mfma_f32_16x16x32_bf16 v[72:75], a[40:43], a[204:207], v[72:75]
ds_read_b64_tr_b16 a[10:11], v98 offset:18432
buffer_load_dwordx4 a[128:131], v146, s[12:15], s20 offen offset:0 sc1
v_mfma_f32_16x16x32_bf16 v[44:47], a[44:47], a[200:203], v[44:47]
ds_read_b64_tr_b16 a[12:13], v99 offset:16384
v_mfma_f32_16x16x32_bf16 v[76:79], a[44:47], a[204:207], v[76:79]
ds_read_b64_tr_b16 a[14:15], v99 offset:18432
buffer_load_dwordx4 a[132:135], v146, s[12:15], s20 offen offset:256 sc1
s_waitcnt lgkmcnt(8)
v_mfma_f32_16x16x32_bf16 v[48:51], a[48:51], a[200:203], v[48:51]
ds_read_b64_tr_b16 a[16:17], v100 offset:16384
v_mfma_f32_16x16x32_bf16 v[80:83], a[48:51], a[204:207], v[80:83]
ds_read_b64_tr_b16 a[18:19], v100 offset:18432
s_add_u32 s100, s100, 458752
v_mfma_f32_16x16x32_bf16 v[52:55], a[52:55], a[200:203], v[52:55]
ds_read_b64_tr_b16 a[20:21], v101 offset:16384
v_mfma_f32_16x16x32_bf16 v[84:87], a[52:55], a[204:207], v[84:87]
ds_read_b64_tr_b16 a[22:23], v101 offset:18432
s_add_u32 m0, s26, 106496
v_mfma_f32_16x16x32_bf16 v[56:59], a[56:59], a[200:203], v[56:59]
ds_read_b64_tr_b16 a[24:25], v102 offset:16384
v_mfma_f32_16x16x32_bf16 v[88:91], a[56:59], a[204:207], v[88:91]
ds_read_b64_tr_b16 a[26:27], v102 offset:18432
buffer_load_dwordx4 v30, s[52:55], s100 offen lds
v_mfma_f32_16x16x32_bf16 v[60:63], a[60:63], a[200:203], v[60:63]
ds_read_b64_tr_b16 a[28:29], v103 offset:16384
v_mfma_f32_16x16x32_bf16 v[92:95], a[60:63], a[204:207], v[92:95]
ds_read_b64_tr_b16 a[30:31], v103 offset:18432
buffer_load_dwordx4 v31, s[52:55], s100 offen offset:1024 lds
s_waitcnt vmcnt(27)
s_waitcnt lgkmcnt(8)
v_mfma_f32_16x16x32_bf16 v[32:35], a[0:3], a[208:211], v[32:35]
ds_read_b64_tr_b16 a[32:33], v96 offset:24576
v_mfma_f32_16x16x32_bf16 v[64:67], a[0:3], a[212:215], v[64:67]
ds_read_b64_tr_b16 a[34:35], v96 offset:26624
buffer_load_dwordx4 a[136:139], v146, s[12:15], s20 offen offset:2048 sc1
v_mfma_f32_16x16x32_bf16 v[36:39], a[4:7], a[208:211], v[36:39]
ds_read_b64_tr_b16 a[36:37], v97 offset:24576
v_mfma_f32_16x16x32_bf16 v[68:71], a[4:7], a[212:215], v[68:71]
ds_read_b64_tr_b16 a[38:39], v97 offset:26624
buffer_load_dwordx4 a[140:143], v146, s[12:15], s20 offen offset:2304 sc1
v_mfma_f32_16x16x32_bf16 v[40:43], a[8:11], a[208:211], v[40:43]
ds_read_b64_tr_b16 a[40:41], v98 offset:24576
v_mfma_f32_16x16x32_bf16 v[72:75], a[8:11], a[212:215], v[72:75]
ds_read_b64_tr_b16 a[42:43], v98 offset:26624
s_add_u32 s100, s100, 458752
v_mfma_f32_16x16x32_bf16 v[44:47], a[12:15], a[208:211], v[44:47]
ds_read_b64_tr_b16 a[44:45], v99 offset:24576
v_mfma_f32_16x16x32_bf16 v[76:79], a[12:15], a[212:215], v[76:79]
ds_read_b64_tr_b16 a[46:47], v99 offset:26624
s_add_u32 m0, s26, 114688
s_waitcnt lgkmcnt(8)
v_mfma_f32_16x16x32_bf16 v[48:51], a[16:19], a[208:211], v[48:51]
ds_read_b64_tr_b16 a[48:49], v100 offset:24576
v_mfma_f32_16x16x32_bf16 v[80:83], a[16:19], a[212:215], v[80:83]
ds_read_b64_tr_b16 a[50:51], v100 offset:26624
buffer_load_dwordx4 v30, s[52:55], s100 offen lds
v_mfma_f32_16x16x32_bf16 v[52:55], a[20:23], a[208:211], v[52:55]
ds_read_b64_tr_b16 a[52:53], v101 offset:24576
v_mfma_f32_16x16x32_bf16 v[84:87], a[20:23], a[212:215], v[84:87]
ds_read_b64_tr_b16 a[54:55], v101 offset:26624
buffer_load_dwordx4 v31, s[52:55], s100 offen offset:1024 lds
v_mfma_f32_16x16x32_bf16 v[56:59], a[24:27], a[208:211], v[56:59]
ds_read_b64_tr_b16 a[56:57], v102 offset:24576
v_mfma_f32_16x16x32_bf16 v[88:91], a[24:27], a[212:215], v[88:91]
ds_read_b64_tr_b16 a[58:59], v102 offset:26624
v_mfma_f32_16x16x32_bf16 v[60:63], a[28:31], a[208:211], v[60:63]
ds_read_b64_tr_b16 a[60:61], v103 offset:24576
v_mfma_f32_16x16x32_bf16 v[92:95], a[28:31], a[212:215], v[92:95]
ds_read_b64_tr_b16 a[62:63], v103 offset:26624
s_waitcnt vmcnt(26)
s_waitcnt lgkmcnt(8)
v_mfma_f32_16x16x32_bf16 v[32:35], a[32:35], a[216:219], v[32:35]
s_add_u32 s20, s20, 4096
v_mfma_f32_16x16x32_bf16 v[64:67], a[32:35], a[220:223], v[64:67]
buffer_load_dwordx4 a[144:147], v146, s[12:15], s20 offen offset:0 sc1
v_mfma_f32_16x16x32_bf16 v[36:39], a[36:39], a[216:219], v[36:39]
buffer_load_dwordx4 a[148:151], v146, s[12:15], s20 offen offset:256 sc1
v_mfma_f32_16x16x32_bf16 v[68:71], a[36:39], a[220:223], v[68:71]
s_add_u32 s100, s100, 458752
v_mfma_f32_16x16x32_bf16 v[40:43], a[40:43], a[216:219], v[40:43]
s_add_u32 m0, s26, 122880
v_mfma_f32_16x16x32_bf16 v[72:75], a[40:43], a[220:223], v[72:75]
buffer_load_dwordx4 v30, s[52:55], s100 offen lds
v_mfma_f32_16x16x32_bf16 v[44:47], a[44:47], a[216:219], v[44:47]
buffer_load_dwordx4 v31, s[52:55], s100 offen offset:1024 lds
v_mfma_f32_16x16x32_bf16 v[76:79], a[44:47], a[220:223], v[76:79]
s_waitcnt vmcnt(33) lgkmcnt(0)
s_barrier
v_mfma_f32_16x16x32_bf16 v[48:51], a[48:51], a[216:219], v[48:51]
ds_read_b64_tr_b16 a[0:1], v96 offset:32768
ds_read_b64_tr_b16 a[2:3], v96 offset:34816
v_mfma_f32_16x16x32_bf16 v[80:83], a[48:51], a[220:223], v[80:83]
ds_read_b64_tr_b16 a[4:5], v97 offset:32768
ds_read_b64_tr_b16 a[6:7], v97 offset:34816
v_mfma_f32_16x16x32_bf16 v[52:55], a[52:55], a[216:219], v[52:55]
ds_read_b64_tr_b16 a[8:9], v98 offset:32768
ds_read_b64_tr_b16 a[10:11], v98 offset:34816
v_mfma_f32_16x16x32_bf16 v[84:87], a[52:55], a[220:223], v[84:87]
ds_read_b64_tr_b16 a[12:13], v99 offset:32768
ds_read_b64_tr_b16 a[14:15], v99 offset:34816
v_mfma_f32_16x16x32_bf16 v[56:59], a[56:59], a[216:219], v[56:59]
ds_read_b64_tr_b16 a[16:17], v100 offset:32768
ds_read_b64_tr_b16 a[18:19], v100 offset:34816
v_mfma_f32_16x16x32_bf16 v[88:91], a[56:59], a[220:223], v[88:91]
ds_read_b64_tr_b16 a[20:21], v101 offset:32768
ds_read_b64_tr_b16 a[22:23], v101 offset:34816
v_mfma_f32_16x16x32_bf16 v[60:63], a[60:63], a[216:219], v[60:63]
ds_read_b64_tr_b16 a[24:25], v102 offset:32768
ds_read_b64_tr_b16 a[26:27], v102 offset:34816
v_mfma_f32_16x16x32_bf16 v[92:95], a[60:63], a[220:223], v[92:95]
ds_read_b64_tr_b16 a[28:29], v103 offset:32768
ds_read_b64_tr_b16 a[30:31], v103 offset:34816
s_waitcnt vmcnt(26)
s_waitcnt lgkmcnt(8)
v_mfma_f32_16x16x32_bf16 v[32:35], a[0:3], a[224:227], v[32:35]
ds_read_b64_tr_b16 a[32:33], v96 offset:40960
v_mfma_f32_16x16x32_bf16 v[64:67], a[0:3], a[228:231], v[64:67]
ds_read_b64_tr_b16 a[34:35], v96 offset:43008
buffer_load_dwordx4 a[152:155], v146, s[12:15], s20 offen offset:2048 sc1
v_mfma_f32_16x16x32_bf16 v[36:39], a[4:7], a[224:227], v[36:39]
ds_read_b64_tr_b16 a[36:37], v97 offset:40960
v_mfma_f32_16x16x32_bf16 v[68:71], a[4:7], a[228:231], v[68:71]
ds_read_b64_tr_b16 a[38:39], v97 offset:43008
buffer_load_dwordx4 a[156:159], v146, s[12:15], s20 offen offset:2304 sc1
v_mfma_f32_16x16x32_bf16 v[40:43], a[8:11], a[224:227], v[40:43]
ds_read_b64_tr_b16 a[40:41], v98 offset:40960
v_mfma_f32_16x16x32_bf16 v[72:75], a[8:11], a[228:231], v[72:75]
ds_read_b64_tr_b16 a[42:43], v98 offset:43008
s_sub_u32 s100, s100, 3178496
v_mfma_f32_16x16x32_bf16 v[44:47], a[12:15], a[224:227], v[44:47]
ds_read_b64_tr_b16 a[44:45], v99 offset:40960
v_mfma_f32_16x16x32_bf16 v[76:79], a[12:15], a[228:231], v[76:79]
ds_read_b64_tr_b16 a[46:47], v99 offset:43008
s_add_u32 m0, s26, 0
s_waitcnt lgkmcnt(8)
v_mfma_f32_16x16x32_bf16 v[48:51], a[16:19], a[224:227], v[48:51]
ds_read_b64_tr_b16 a[48:49], v100 offset:40960
v_mfma_f32_16x16x32_bf16 v[80:83], a[16:19], a[228:231], v[80:83]
ds_read_b64_tr_b16 a[50:51], v100 offset:43008
buffer_load_dwordx4 v30, s[52:55], s100 offen lds
v_mfma_f32_16x16x32_bf16 v[52:55], a[20:23], a[224:227], v[52:55]
ds_read_b64_tr_b16 a[52:53], v101 offset:40960
v_mfma_f32_16x16x32_bf16 v[84:87], a[20:23], a[228:231], v[84:87]
ds_read_b64_tr_b16 a[54:55], v101 offset:43008
buffer_load_dwordx4 v31, s[52:55], s100 offen offset:1024 lds
v_mfma_f32_16x16x32_bf16 v[56:59], a[24:27], a[224:227], v[56:59]
ds_read_b64_tr_b16 a[56:57], v102 offset:40960
v_mfma_f32_16x16x32_bf16 v[88:91], a[24:27], a[228:231], v[88:91]
ds_read_b64_tr_b16 a[58:59], v102 offset:43008
v_mfma_f32_16x16x32_bf16 v[60:63], a[28:31], a[224:227], v[60:63]
ds_read_b64_tr_b16 a[60:61], v103 offset:40960
v_mfma_f32_16x16x32_bf16 v[92:95], a[28:31], a[228:231], v[92:95]
ds_read_b64_tr_b16 a[62:63], v103 offset:43008
s_waitcnt vmcnt(26)
s_waitcnt lgkmcnt(8)
v_mfma_f32_16x16x32_bf16 v[32:35], a[32:35], a[232:235], v[32:35]
ds_read_b64_tr_b16 a[0:1], v96 offset:49152
v_mfma_f32_16x16x32_bf16 v[64:67], a[32:35], a[236:239], v[64:67]
ds_read_b64_tr_b16 a[2:3], v96 offset:51200
s_add_u32 s20, s20, 4096
v_mfma_f32_16x16x32_bf16 v[36:39], a[36:39], a[232:235], v[36:39]
ds_read_b64_tr_b16 a[4:5], v97 offset:49152
v_mfma_f32_16x16x32_bf16 v[68:71], a[36:39], a[236:239], v[68:71]
ds_read_b64_tr_b16 a[6:7], v97 offset:51200
buffer_load_dwordx4 a[160:163], v146, s[12:15], s20 offen offset:0 sc1
v_mfma_f32_16x16x32_bf16 v[40:43], a[40:43], a[232:235], v[40:43]
ds_read_b64_tr_b16 a[8:9], v98 offset:49152
v_mfma_f32_16x16x32_bf16 v[72:75], a[40:43], a[236:239], v[72:75]
ds_read_b64_tr_b16 a[10:11], v98 offset:51200
buffer_load_dwordx4 a[164:167], v146, s[12:15], s20 offen offset:256 sc1
v_mfma_f32_16x16x32_bf16 v[44:47], a[44:47], a[232:235], v[44:47]
ds_read_b64_tr_b16 a[12:13], v99 offset:49152
v_mfma_f32_16x16x32_bf16 v[76:79], a[44:47], a[236:239], v[76:79]
ds_read_b64_tr_b16 a[14:15], v99 offset:51200
s_add_u32 s100, s100, 458752
s_waitcnt lgkmcnt(8)
v_mfma_f32_16x16x32_bf16 v[48:51], a[48:51], a[232:235], v[48:51]
ds_read_b64_tr_b16 a[16:17], v100 offset:49152
v_mfma_f32_16x16x32_bf16 v[80:83], a[48:51], a[236:239], v[80:83]
ds_read_b64_tr_b16 a[18:19], v100 offset:51200
s_add_u32 m0, s26, 8192
v_mfma_f32_16x16x32_bf16 v[52:55], a[52:55], a[232:235], v[52:55]
ds_read_b64_tr_b16 a[20:21], v101 offset:49152
v_mfma_f32_16x16x32_bf16 v[84:87], a[52:55], a[236:239], v[84:87]
ds_read_b64_tr_b16 a[22:23], v101 offset:51200
buffer_load_dwordx4 v30, s[52:55], s100 offen lds
v_mfma_f32_16x16x32_bf16 v[56:59], a[56:59], a[232:235], v[56:59]
ds_read_b64_tr_b16 a[24:25], v102 offset:49152
v_mfma_f32_16x16x32_bf16 v[88:91], a[56:59], a[236:239], v[88:91]
ds_read_b64_tr_b16 a[26:27], v102 offset:51200
buffer_load_dwordx4 v31, s[52:55], s100 offen offset:1024 lds
v_mfma_f32_16x16x32_bf16 v[60:63], a[60:63], a[232:235], v[60:63]
ds_read_b64_tr_b16 a[28:29], v103 offset:49152
v_mfma_f32_16x16x32_bf16 v[92:95], a[60:63], a[236:239], v[92:95]
ds_read_b64_tr_b16 a[30:31], v103 offset:51200
s_waitcnt vmcnt(26)
s_waitcnt lgkmcnt(8)
v_mfma_f32_16x16x32_bf16 v[32:35], a[0:3], a[240:243], v[32:35]
ds_read_b64_tr_b16 a[32:33], v96 offset:57344
v_mfma_f32_16x16x32_bf16 v[64:67], a[0:3], a[244:247], v[64:67]
ds_read_b64_tr_b16 a[34:35], v96 offset:59392
buffer_load_dwordx4 a[168:171], v146, s[12:15], s20 offen offset:2048 sc1
v_mfma_f32_16x16x32_bf16 v[36:39], a[4:7], a[240:243], v[36:39]
ds_read_b64_tr_b16 a[36:37], v97 offset:57344
v_mfma_f32_16x16x32_bf16 v[68:71], a[4:7], a[244:247], v[68:71]
ds_read_b64_tr_b16 a[38:39], v97 offset:59392
buffer_load_dwordx4 a[172:175], v146, s[12:15], s20 offen offset:2304 sc1
v_mfma_f32_16x16x32_bf16 v[40:43], a[8:11], a[240:243], v[40:43]
ds_read_b64_tr_b16 a[40:41], v98 offset:57344
v_mfma_f32_16x16x32_bf16 v[72:75], a[8:11], a[244:247], v[72:75]
ds_read_b64_tr_b16 a[42:43], v98 offset:59392
s_add_u32 s100, s100, 458752
v_mfma_f32_16x16x32_bf16 v[44:47], a[12:15], a[240:243], v[44:47]
ds_read_b64_tr_b16 a[44:45], v99 offset:57344
v_mfma_f32_16x16x32_bf16 v[76:79], a[12:15], a[244:247], v[76:79]
ds_read_b64_tr_b16 a[46:47], v99 offset:59392
s_add_u32 m0, s26, 16384
s_waitcnt lgkmcnt(8)
v_mfma_f32_16x16x32_bf16 v[48:51], a[16:19], a[240:243], v[48:51]
ds_read_b64_tr_b16 a[48:49], v100 offset:57344
v_mfma_f32_16x16x32_bf16 v[80:83], a[16:19], a[244:247], v[80:83]
ds_read_b64_tr_b16 a[50:51], v100 offset:59392
buffer_load_dwordx4 v30, s[52:55], s100 offen lds
v_mfma_f32_16x16x32_bf16 v[52:55], a[20:23], a[240:243], v[52:55]
ds_read_b64_tr_b16 a[52:53], v101 offset:57344
v_mfma_f32_16x16x32_bf16 v[84:87], a[20:23], a[244:247], v[84:87]
ds_read_b64_tr_b16 a[54:55], v101 offset:59392
buffer_load_dwordx4 v31, s[52:55], s100 offen offset:1024 lds
v_mfma_f32_16x16x32_bf16 v[56:59], a[24:27], a[240:243], v[56:59]
ds_read_b64_tr_b16 a[56:57], v102 offset:57344
v_mfma_f32_16x16x32_bf16 v[88:91], a[24:27], a[244:247], v[88:91]
ds_read_b64_tr_b16 a[58:59], v102 offset:59392
v_mfma_f32_16x16x32_bf16 v[60:63], a[28:31], a[240:243], v[60:63]
ds_read_b64_tr_b16 a[60:61], v103 offset:57344
v_mfma_f32_16x16x32_bf16 v[92:95], a[28:31], a[244:247], v[92:95]
ds_read_b64_tr_b16 a[62:63], v103 offset:59392
s_waitcnt vmcnt(26)
s_waitcnt lgkmcnt(8)
v_mfma_f32_16x16x32_bf16 v[32:35], a[32:35], a[248:251], v[32:35]
s_add_u32 s20, s20, 4096
v_mfma_f32_16x16x32_bf16 v[64:67], a[32:35], a[252:255], v[64:67]
buffer_load_dwordx4 a[176:179], v146, s[12:15], s20 offen offset:0 sc1
v_mfma_f32_16x16x32_bf16 v[36:39], a[36:39], a[248:251], v[36:39]
buffer_load_dwordx4 a[180:183], v146, s[12:15], s20 offen offset:256 sc1
v_mfma_f32_16x16x32_bf16 v[68:71], a[36:39], a[252:255], v[68:71]
s_add_u32 s100, s100, 458752
v_mfma_f32_16x16x32_bf16 v[40:43], a[40:43], a[248:251], v[40:43]
s_add_u32 m0, s26, 24576
v_mfma_f32_16x16x32_bf16 v[72:75], a[40:43], a[252:255], v[72:75]
buffer_load_dwordx4 v30, s[52:55], s100 offen lds
v_mfma_f32_16x16x32_bf16 v[44:47], a[44:47], a[248:251], v[44:47]
buffer_load_dwordx4 v31, s[52:55], s100 offen offset:1024 lds
v_mfma_f32_16x16x32_bf16 v[76:79], a[44:47], a[252:255], v[76:79]
s_waitcnt vmcnt(32) lgkmcnt(0)
s_barrier
v_mfma_f32_16x16x32_bf16 v[48:51], a[48:51], a[248:251], v[48:51]
ds_read_b64_tr_b16 a[0:1], v104 offset:0
ds_read_b64_tr_b16 a[2:3], v104 offset:2048
v_mfma_f32_16x16x32_bf16 v[80:83], a[48:51], a[252:255], v[80:83]
ds_read_b64_tr_b16 a[4:5], v105 offset:0
ds_read_b64_tr_b16 a[6:7], v105 offset:2048
v_mfma_f32_16x16x32_bf16 v[52:55], a[52:55], a[248:251], v[52:55]
ds_read_b64_tr_b16 a[8:9], v106 offset:0
ds_read_b64_tr_b16 a[10:11], v106 offset:2048
v_mfma_f32_16x16x32_bf16 v[84:87], a[52:55], a[252:255], v[84:87]
ds_read_b64_tr_b16 a[12:13], v107 offset:0
ds_read_b64_tr_b16 a[14:15], v107 offset:2048
v_mfma_f32_16x16x32_bf16 v[56:59], a[56:59], a[248:251], v[56:59]
ds_read_b64_tr_b16 a[16:17], v108 offset:0
ds_read_b64_tr_b16 a[18:19], v108 offset:2048
v_mfma_f32_16x16x32_bf16 v[88:91], a[56:59], a[252:255], v[88:91]
ds_read_b64_tr_b16 a[20:21], v109 offset:0
ds_read_b64_tr_b16 a[22:23], v109 offset:2048
v_mfma_f32_16x16x32_bf16 v[60:63], a[60:63], a[248:251], v[60:63]
ds_read_b64_tr_b16 a[24:25], v110 offset:0
ds_read_b64_tr_b16 a[26:27], v110 offset:2048
v_mfma_f32_16x16x32_bf16 v[92:95], a[60:63], a[252:255], v[92:95]
ds_read_b64_tr_b16 a[28:29], v111 offset:0
ds_read_b64_tr_b16 a[30:31], v111 offset:2048
s_waitcnt vmcnt(26)
s_waitcnt lgkmcnt(8)
v_mfma_f32_16x16x32_bf16 v[32:35], a[0:3], a[128:131], v[32:35]
ds_read_b64_tr_b16 a[32:33], v104 offset:8192
v_mfma_f32_16x16x32_bf16 v[64:67], a[0:3], a[132:135], v[64:67]
ds_read_b64_tr_b16 a[34:35], v104 offset:10240
buffer_load_dwordx4 a[184:187], v146, s[12:15], s20 offen offset:2048 sc1
v_mfma_f32_16x16x32_bf16 v[36:39], a[4:7], a[128:131], v[36:39]
ds_read_b64_tr_b16 a[36:37], v105 offset:8192
v_mfma_f32_16x16x32_bf16 v[68:71], a[4:7], a[132:135], v[68:71]
ds_read_b64_tr_b16 a[38:39], v105 offset:10240
buffer_load_dwordx4 a[188:191], v146, s[12:15], s20 offen offset:2304 sc1
v_mfma_f32_16x16x32_bf16 v[40:43], a[8:11], a[128:131], v[40:43]
ds_read_b64_tr_b16 a[40:41], v106 offset:8192
v_mfma_f32_16x16x32_bf16 v[72:75], a[8:11], a[132:135], v[72:75]
ds_read_b64_tr_b16 a[42:43], v106 offset:10240
s_add_u32 s100, s100, 458752
v_mfma_f32_16x16x32_bf16 v[44:47], a[12:15], a[128:131], v[44:47]
ds_read_b64_tr_b16 a[44:45], v107 offset:8192
v_mfma_f32_16x16x32_bf16 v[76:79], a[12:15], a[132:135], v[76:79]
ds_read_b64_tr_b16 a[46:47], v107 offset:10240
s_add_u32 m0, s26, 32768
s_waitcnt lgkmcnt(8)
v_mfma_f32_16x16x32_bf16 v[48:51], a[16:19], a[128:131], v[48:51]
ds_read_b64_tr_b16 a[48:49], v108 offset:8192
v_mfma_f32_16x16x32_bf16 v[80:83], a[16:19], a[132:135], v[80:83]
ds_read_b64_tr_b16 a[50:51], v108 offset:10240
buffer_load_dwordx4 v30, s[52:55], s100 offen lds
v_mfma_f32_16x16x32_bf16 v[52:55], a[20:23], a[128:131], v[52:55]
ds_read_b64_tr_b16 a[52:53], v109 offset:8192
v_mfma_f32_16x16x32_bf16 v[84:87], a[20:23], a[132:135], v[84:87]
ds_read_b64_tr_b16 a[54:55], v109 offset:10240
buffer_load_dwordx4 v31, s[52:55], s100 offen offset:1024 lds
v_mfma_f32_16x16x32_bf16 v[56:59], a[24:27], a[128:131], v[56:59]
ds_read_b64_tr_b16 a[56:57], v110 offset:8192
v_mfma_f32_16x16x32_bf16 v[88:91], a[24:27], a[132:135], v[88:91]
ds_read_b64_tr_b16 a[58:59], v110 offset:10240
v_mfma_f32_16x16x32_bf16 v[60:63], a[28:31], a[128:131], v[60:63]
ds_read_b64_tr_b16 a[60:61], v111 offset:8192
v_mfma_f32_16x16x32_bf16 v[92:95], a[28:31], a[132:135], v[92:95]
ds_read_b64_tr_b16 a[62:63], v111 offset:10240
s_waitcnt vmcnt(26)
s_waitcnt lgkmcnt(8)
v_mfma_f32_16x16x32_bf16 v[32:35], a[32:35], a[136:139], v[32:35]
ds_read_b64_tr_b16 a[0:1], v104 offset:16384
v_mfma_f32_16x16x32_bf16 v[64:67], a[32:35], a[140:143], v[64:67]
ds_read_b64_tr_b16 a[2:3], v104 offset:18432
s_add_u32 s20, s20, 4096
v_mfma_f32_16x16x32_bf16 v[36:39], a[36:39], a[136:139], v[36:39]
ds_read_b64_tr_b16 a[4:5], v105 offset:16384
v_mfma_f32_16x16x32_bf16 v[68:71], a[36:39], a[140:143], v[68:71]
ds_read_b64_tr_b16 a[6:7], v105 offset:18432
buffer_load_dwordx4 a[192:195], v146, s[12:15], s20 offen offset:0 sc1
v_mfma_f32_16x16x32_bf16 v[40:43], a[40:43], a[136:139], v[40:43]
ds_read_b64_tr_b16 a[8:9], v106 offset:16384
v_mfma_f32_16x16x32_bf16 v[72:75], a[40:43], a[140:143], v[72:75]
ds_read_b64_tr_b16 a[10:11], v106 offset:18432
buffer_load_dwordx4 a[196:199], v146, s[12:15], s20 offen offset:256 sc1
v_mfma_f32_16x16x32_bf16 v[44:47], a[44:47], a[136:139], v[44:47]
ds_read_b64_tr_b16 a[12:13], v107 offset:16384
v_mfma_f32_16x16x32_bf16 v[76:79], a[44:47], a[140:143], v[76:79]
ds_read_b64_tr_b16 a[14:15], v107 offset:18432
s_add_u32 s100, s100, 458752
s_waitcnt lgkmcnt(8)
v_mfma_f32_16x16x32_bf16 v[48:51], a[48:51], a[136:139], v[48:51]
ds_read_b64_tr_b16 a[16:17], v108 offset:16384
v_mfma_f32_16x16x32_bf16 v[80:83], a[48:51], a[140:143], v[80:83]
ds_read_b64_tr_b16 a[18:19], v108 offset:18432
s_add_u32 m0, s26, 40960
v_mfma_f32_16x16x32_bf16 v[52:55], a[52:55], a[136:139], v[52:55]
ds_read_b64_tr_b16 a[20:21], v109 offset:16384
v_mfma_f32_16x16x32_bf16 v[84:87], a[52:55], a[140:143], v[84:87]
ds_read_b64_tr_b16 a[22:23], v109 offset:18432
buffer_load_dwordx4 v30, s[52:55], s100 offen lds
v_mfma_f32_16x16x32_bf16 v[56:59], a[56:59], a[136:139], v[56:59]
ds_read_b64_tr_b16 a[24:25], v110 offset:16384
v_mfma_f32_16x16x32_bf16 v[88:91], a[56:59], a[140:143], v[88:91]
ds_read_b64_tr_b16 a[26:27], v110 offset:18432
buffer_load_dwordx4 v31, s[52:55], s100 offen offset:1024 lds
v_mfma_f32_16x16x32_bf16 v[60:63], a[60:63], a[136:139], v[60:63]
ds_read_b64_tr_b16 a[28:29], v111 offset:16384
v_mfma_f32_16x16x32_bf16 v[92:95], a[60:63], a[140:143], v[92:95]
ds_read_b64_tr_b16 a[30:31], v111 offset:18432
s_waitcnt vmcnt(26)
s_waitcnt lgkmcnt(8)
v_mfma_f32_16x16x32_bf16 v[32:35], a[0:3], a[144:147], v[32:35]
ds_read_b64_tr_b16 a[32:33], v104 offset:24576
v_mfma_f32_16x16x32_bf16 v[64:67], a[0:3], a[148:151], v[64:67]
ds_read_b64_tr_b16 a[34:35], v104 offset:26624
buffer_load_dwordx4 a[200:203], v146, s[12:15], s20 offen offset:2048 sc1
v_mfma_f32_16x16x32_bf16 v[36:39], a[4:7], a[144:147], v[36:39]
ds_read_b64_tr_b16 a[36:37], v105 offset:24576
v_mfma_f32_16x16x32_bf16 v[68:71], a[4:7], a[148:151], v[68:71]
ds_read_b64_tr_b16 a[38:39], v105 offset:26624
buffer_load_dwordx4 a[204:207], v146, s[12:15], s20 offen offset:2304 sc1
v_mfma_f32_16x16x32_bf16 v[40:43], a[8:11], a[144:147], v[40:43]
ds_read_b64_tr_b16 a[40:41], v106 offset:24576
v_mfma_f32_16x16x32_bf16 v[72:75], a[8:11], a[148:151], v[72:75]
ds_read_b64_tr_b16 a[42:43], v106 offset:26624
s_add_u32 s100, s100, 458752
v_mfma_f32_16x16x32_bf16 v[44:47], a[12:15], a[144:147], v[44:47]
ds_read_b64_tr_b16 a[44:45], v107 offset:24576
v_mfma_f32_16x16x32_bf16 v[76:79], a[12:15], a[148:151], v[76:79]
ds_read_b64_tr_b16 a[46:47], v107 offset:26624
s_add_u32 m0, s26, 49152
s_waitcnt lgkmcnt(8)
v_mfma_f32_16x16x32_bf16 v[48:51], a[16:19], a[144:147], v[48:51]
ds_read_b64_tr_b16 a[48:49], v108 offset:24576
v_mfma_f32_16x16x32_bf16 v[80:83], a[16:19], a[148:151], v[80:83]
ds_read_b64_tr_b16 a[50:51], v108 offset:26624
buffer_load_dwordx4 v30, s[52:55], s100 offen lds
v_mfma_f32_16x16x32_bf16 v[52:55], a[20:23], a[144:147], v[52:55]
ds_read_b64_tr_b16 a[52:53], v109 offset:24576
v_mfma_f32_16x16x32_bf16 v[84:87], a[20:23], a[148:151], v[84:87]
ds_read_b64_tr_b16 a[54:55], v109 offset:26624
buffer_load_dwordx4 v31, s[52:55], s100 offen offset:1024 lds
v_mfma_f32_16x16x32_bf16 v[56:59], a[24:27], a[144:147], v[56:59]
ds_read_b64_tr_b16 a[56:57], v110 offset:24576
v_mfma_f32_16x16x32_bf16 v[88:91], a[24:27], a[148:151], v[88:91]
ds_read_b64_tr_b16 a[58:59], v110 offset:26624
v_mfma_f32_16x16x32_bf16 v[60:63], a[28:31], a[144:147], v[60:63]
ds_read_b64_tr_b16 a[60:61], v111 offset:24576
v_mfma_f32_16x16x32_bf16 v[92:95], a[28:31], a[148:151], v[92:95]
ds_read_b64_tr_b16 a[62:63], v111 offset:26624
s_waitcnt vmcnt(26)
s_waitcnt lgkmcnt(8)
v_mfma_f32_16x16x32_bf16 v[32:35], a[32:35], a[152:155], v[32:35]
s_add_u32 s20, s20, 4096
v_mfma_f32_16x16x32_bf16 v[64:67], a[32:35], a[156:159], v[64:67]
buffer_load_dwordx4 a[208:211], v146, s[12:15], s20 offen offset:0 sc1
v_mfma_f32_16x16x32_bf16 v[36:39], a[36:39], a[152:155], v[36:39]
buffer_load_dwordx4 a[212:215], v146, s[12:15], s20 offen offset:256 sc1
v_mfma_f32_16x16x32_bf16 v[68:71], a[36:39], a[156:159], v[68:71]
s_add_u32 s100, s100, 458752
v_mfma_f32_16x16x32_bf16 v[40:43], a[40:43], a[152:155], v[40:43]
s_add_u32 m0, s26, 57344
v_mfma_f32_16x16x32_bf16 v[72:75], a[40:43], a[156:159], v[72:75]
buffer_load_dwordx4 v30, s[52:55], s100 offen lds
v_mfma_f32_16x16x32_bf16 v[44:47], a[44:47], a[152:155], v[44:47]
buffer_load_dwordx4 v31, s[52:55], s100 offen offset:1024 lds
v_mfma_f32_16x16x32_bf16 v[76:79], a[44:47], a[156:159], v[76:79]
s_waitcnt vmcnt(32) lgkmcnt(0)
s_barrier
v_mfma_f32_16x16x32_bf16 v[48:51], a[48:51], a[152:155], v[48:51]
ds_read_b64_tr_b16 a[0:1], v104 offset:32768
ds_read_b64_tr_b16 a[2:3], v104 offset:34816
v_mfma_f32_16x16x32_bf16 v[80:83], a[48:51], a[156:159], v[80:83]
ds_read_b64_tr_b16 a[4:5], v105 offset:32768
ds_read_b64_tr_b16 a[6:7], v105 offset:34816
v_mfma_f32_16x16x32_bf16 v[52:55], a[52:55], a[152:155], v[52:55]
ds_read_b64_tr_b16 a[8:9], v106 offset:32768
ds_read_b64_tr_b16 a[10:11], v106 offset:34816
v_mfma_f32_16x16x32_bf16 v[84:87], a[52:55], a[156:159], v[84:87]
ds_read_b64_tr_b16 a[12:13], v107 offset:32768
ds_read_b64_tr_b16 a[14:15], v107 offset:34816
v_mfma_f32_16x16x32_bf16 v[56:59], a[56:59], a[152:155], v[56:59]
ds_read_b64_tr_b16 a[16:17], v108 offset:32768
ds_read_b64_tr_b16 a[18:19], v108 offset:34816
v_mfma_f32_16x16x32_bf16 v[88:91], a[56:59], a[156:159], v[88:91]
ds_read_b64_tr_b16 a[20:21], v109 offset:32768
ds_read_b64_tr_b16 a[22:23], v109 offset:34816
v_mfma_f32_16x16x32_bf16 v[60:63], a[60:63], a[152:155], v[60:63]
ds_read_b64_tr_b16 a[24:25], v110 offset:32768
ds_read_b64_tr_b16 a[26:27], v110 offset:34816
v_mfma_f32_16x16x32_bf16 v[92:95], a[60:63], a[156:159], v[92:95]
ds_read_b64_tr_b16 a[28:29], v111 offset:32768
ds_read_b64_tr_b16 a[30:31], v111 offset:34816
s_waitcnt vmcnt(26)
s_waitcnt lgkmcnt(8)
v_mfma_f32_16x16x32_bf16 v[32:35], a[0:3], a[160:163], v[32:35]
ds_read_b64_tr_b16 a[32:33], v104 offset:40960
v_mfma_f32_16x16x32_bf16 v[64:67], a[0:3], a[164:167], v[64:67]
ds_read_b64_tr_b16 a[34:35], v104 offset:43008
buffer_load_dwordx4 a[216:219], v146, s[12:15], s20 offen offset:2048 sc1
v_mfma_f32_16x16x32_bf16 v[36:39], a[4:7], a[160:163], v[36:39]
ds_read_b64_tr_b16 a[36:37], v105 offset:40960
v_mfma_f32_16x16x32_bf16 v[68:71], a[4:7], a[164:167], v[68:71]
ds_read_b64_tr_b16 a[38:39], v105 offset:43008
buffer_load_dwordx4 a[220:223], v146, s[12:15], s20 offen offset:2304 sc1
v_mfma_f32_16x16x32_bf16 v[40:43], a[8:11], a[160:163], v[40:43]
ds_read_b64_tr_b16 a[40:41], v106 offset:40960
v_mfma_f32_16x16x32_bf16 v[72:75], a[8:11], a[164:167], v[72:75]
ds_read_b64_tr_b16 a[42:43], v106 offset:43008
v_mfma_f32_16x16x32_bf16 v[44:47], a[12:15], a[160:163], v[44:47]
ds_read_b64_tr_b16 a[44:45], v107 offset:40960
v_mfma_f32_16x16x32_bf16 v[76:79], a[12:15], a[164:167], v[76:79]
ds_read_b64_tr_b16 a[46:47], v107 offset:43008
s_waitcnt lgkmcnt(8)
v_mfma_f32_16x16x32_bf16 v[48:51], a[16:19], a[160:163], v[48:51]
ds_read_b64_tr_b16 a[48:49], v108 offset:40960
v_mfma_f32_16x16x32_bf16 v[80:83], a[16:19], a[164:167], v[80:83]
ds_read_b64_tr_b16 a[50:51], v108 offset:43008
v_mfma_f32_16x16x32_bf16 v[52:55], a[20:23], a[160:163], v[52:55]
ds_read_b64_tr_b16 a[52:53], v109 offset:40960
v_mfma_f32_16x16x32_bf16 v[84:87], a[20:23], a[164:167], v[84:87]
ds_read_b64_tr_b16 a[54:55], v109 offset:43008
v_mfma_f32_16x16x32_bf16 v[56:59], a[24:27], a[160:163], v[56:59]
ds_read_b64_tr_b16 a[56:57], v110 offset:40960
v_mfma_f32_16x16x32_bf16 v[88:91], a[24:27], a[164:167], v[88:91]
ds_read_b64_tr_b16 a[58:59], v110 offset:43008
v_mfma_f32_16x16x32_bf16 v[60:63], a[28:31], a[160:163], v[60:63]
ds_read_b64_tr_b16 a[60:61], v111 offset:40960
v_mfma_f32_16x16x32_bf16 v[92:95], a[28:31], a[164:167], v[92:95]
ds_read_b64_tr_b16 a[62:63], v111 offset:43008
s_waitcnt vmcnt(24)
s_waitcnt lgkmcnt(8)
v_mfma_f32_16x16x32_bf16 v[32:35], a[32:35], a[168:171], v[32:35]
ds_read_b64_tr_b16 a[0:1], v104 offset:49152
v_mfma_f32_16x16x32_bf16 v[64:67], a[32:35], a[172:175], v[64:67]
ds_read_b64_tr_b16 a[2:3], v104 offset:51200
s_add_u32 s20, s20, 4096
v_mfma_f32_16x16x32_bf16 v[36:39], a[36:39], a[168:171], v[36:39]
ds_read_b64_tr_b16 a[4:5], v105 offset:49152
v_mfma_f32_16x16x32_bf16 v[68:71], a[36:39], a[172:175], v[68:71]
ds_read_b64_tr_b16 a[6:7], v105 offset:51200
buffer_load_dwordx4 a[224:227], v146, s[12:15], s20 offen offset:0 sc1
v_mfma_f32_16x16x32_bf16 v[40:43], a[40:43], a[168:171], v[40:43]
ds_read_b64_tr_b16 a[8:9], v106 offset:49152
v_mfma_f32_16x16x32_bf16 v[72:75], a[40:43], a[172:175], v[72:75]
ds_read_b64_tr_b16 a[10:11], v106 offset:51200
buffer_load_dwordx4 a[228:231], v146, s[12:15], s20 offen offset:256 sc1
v_mfma_f32_16x16x32_bf16 v[44:47], a[44:47], a[168:171], v[44:47]
ds_read_b64_tr_b16 a[12:13], v107 offset:49152
v_mfma_f32_16x16x32_bf16 v[76:79], a[44:47], a[172:175], v[76:79]
ds_read_b64_tr_b16 a[14:15], v107 offset:51200
s_waitcnt lgkmcnt(8)
v_mfma_f32_16x16x32_bf16 v[48:51], a[48:51], a[168:171], v[48:51]
ds_read_b64_tr_b16 a[16:17], v108 offset:49152
v_mfma_f32_16x16x32_bf16 v[80:83], a[48:51], a[172:175], v[80:83]
ds_read_b64_tr_b16 a[18:19], v108 offset:51200
v_mfma_f32_16x16x32_bf16 v[52:55], a[52:55], a[168:171], v[52:55]
ds_read_b64_tr_b16 a[20:21], v109 offset:49152
v_mfma_f32_16x16x32_bf16 v[84:87], a[52:55], a[172:175], v[84:87]
ds_read_b64_tr_b16 a[22:23], v109 offset:51200
v_mfma_f32_16x16x32_bf16 v[56:59], a[56:59], a[168:171], v[56:59]
ds_read_b64_tr_b16 a[24:25], v110 offset:49152
v_mfma_f32_16x16x32_bf16 v[88:91], a[56:59], a[172:175], v[88:91]
ds_read_b64_tr_b16 a[26:27], v110 offset:51200
v_mfma_f32_16x16x32_bf16 v[60:63], a[60:63], a[168:171], v[60:63]
ds_read_b64_tr_b16 a[28:29], v111 offset:49152
v_mfma_f32_16x16x32_bf16 v[92:95], a[60:63], a[172:175], v[92:95]
ds_read_b64_tr_b16 a[30:31], v111 offset:51200
s_waitcnt vmcnt(22)
s_waitcnt lgkmcnt(8)
v_mfma_f32_16x16x32_bf16 v[32:35], a[0:3], a[176:179], v[32:35]
ds_read_b64_tr_b16 a[48:49], v108 offset:57344
v_mfma_f32_16x16x32_bf16 v[64:67], a[0:3], a[180:183], v[64:67]
buffer_load_dwordx4 a[232:235], v146, s[12:15], s20 offen offset:2048 sc1
v_mfma_f32_16x16x32_bf16 v[36:39], a[4:7], a[176:179], v[36:39]
ds_read_b64_tr_b16 a[50:51], v108 offset:59392
v_mfma_f32_16x16x32_bf16 v[68:71], a[4:7], a[180:183], v[68:71]
buffer_load_dwordx4 a[236:239], v146, s[12:15], s20 offen offset:2304 sc1
v_mfma_f32_16x16x32_bf16 v[40:43], a[8:11], a[176:179], v[40:43]
ds_read_b64_tr_b16 a[52:53], v109 offset:57344
v_mfma_f32_16x16x32_bf16 v[72:75], a[8:11], a[180:183], v[72:75]
v_mfma_f32_16x16x32_bf16 v[44:47], a[12:15], a[176:179], v[44:47]
ds_read_b64_tr_b16 a[54:55], v109 offset:59392
v_mfma_f32_16x16x32_bf16 v[76:79], a[12:15], a[180:183], v[76:79]
s_waitcnt lgkmcnt(4)
v_mfma_f32_16x16x32_bf16 v[48:51], a[16:19], a[176:179], v[48:51]
ds_read_b64_tr_b16 a[56:57], v110 offset:57344
v_mfma_f32_16x16x32_bf16 v[80:83], a[16:19], a[180:183], v[80:83]
v_mfma_f32_16x16x32_bf16 v[52:55], a[20:23], a[176:179], v[52:55]
ds_read_b64_tr_b16 a[58:59], v110 offset:59392
v_mfma_f32_16x16x32_bf16 v[84:87], a[20:23], a[180:183], v[84:87]
v_mfma_f32_16x16x32_bf16 v[56:59], a[24:27], a[176:179], v[56:59]
ds_read_b64_tr_b16 a[60:61], v111 offset:57344
v_mfma_f32_16x16x32_bf16 v[88:91], a[24:27], a[180:183], v[88:91]
v_mfma_f32_16x16x32_bf16 v[60:63], a[28:31], a[176:179], v[60:63]
ds_read_b64_tr_b16 a[62:63], v111 offset:59392
v_mfma_f32_16x16x32_bf16 v[92:95], a[28:31], a[180:183], v[92:95]
s_waitcnt vmcnt(20)
s_waitcnt lgkmcnt(0)
v_mfma_f32_16x16x32_bf16 v[48:51], a[48:51], a[184:187], v[48:51]
s_add_u32 s20, s20, 4096
v_mfma_f32_16x16x32_bf16 v[80:83], a[48:51], a[188:191], v[80:83]
buffer_load_dwordx4 a[240:243], v146, s[12:15], s20 offen offset:0 sc1
v_mfma_f32_16x16x32_bf16 v[52:55], a[52:55], a[184:187], v[52:55]
buffer_load_dwordx4 a[244:247], v146, s[12:15], s20 offen offset:256 sc1
s_waitcnt vmcnt(24) lgkmcnt(0)
s_barrier
v_mfma_f32_16x16x32_bf16 v[84:87], a[52:55], a[188:191], v[84:87]
ds_read_b64_tr_b16 a[16:17], v100 offset:0
ds_read_b64_tr_b16 a[18:19], v100 offset:2048
v_mfma_f32_16x16x32_bf16 v[56:59], a[56:59], a[184:187], v[56:59]
ds_read_b64_tr_b16 a[20:21], v101 offset:0
ds_read_b64_tr_b16 a[22:23], v101 offset:2048
v_mfma_f32_16x16x32_bf16 v[88:91], a[56:59], a[188:191], v[88:91]
ds_read_b64_tr_b16 a[24:25], v102 offset:0
v_mfma_f32_16x16x32_bf16 v[60:63], a[60:63], a[184:187], v[60:63]
ds_read_b64_tr_b16 a[26:27], v102 offset:2048
ds_read_b64_tr_b16 a[28:29], v103 offset:0
v_mfma_f32_16x16x32_bf16 v[92:95], a[60:63], a[188:191], v[92:95]
ds_read_b64_tr_b16 a[30:31], v103 offset:2048
s_waitcnt vmcnt(18)
s_waitcnt lgkmcnt(0)
v_mfma_f32_16x16x32_bf16 v[48:51], a[16:19], a[192:195], v[48:51]
ds_read_b64_tr_b16 a[48:49], v100 offset:8192
buffer_load_dwordx4 a[248:251], v146, s[12:15], s20 offen offset:2048 sc1
v_mfma_f32_16x16x32_bf16 v[80:83], a[16:19], a[196:199], v[80:83]
ds_read_b64_tr_b16 a[50:51], v100 offset:10240
buffer_load_dwordx4 a[252:255], v146, s[12:15], s20 offen offset:2304 sc1
v_mfma_f32_16x16x32_bf16 v[52:55], a[20:23], a[192:195], v[52:55]
ds_read_b64_tr_b16 a[52:53], v101 offset:8192
v_mfma_f32_16x16x32_bf16 v[84:87], a[20:23], a[196:199], v[84:87]
ds_read_b64_tr_b16 a[54:55], v101 offset:10240
v_mfma_f32_16x16x32_bf16 v[56:59], a[24:27], a[192:195], v[56:59]
ds_read_b64_tr_b16 a[56:57], v102 offset:8192
v_mfma_f32_16x16x32_bf16 v[88:91], a[24:27], a[196:199], v[88:91]
ds_read_b64_tr_b16 a[58:59], v102 offset:10240
v_mfma_f32_16x16x32_bf16 v[60:63], a[28:31], a[192:195], v[60:63]
ds_read_b64_tr_b16 a[60:61], v103 offset:8192
v_mfma_f32_16x16x32_bf16 v[92:95], a[28:31], a[196:199], v[92:95]
ds_read_b64_tr_b16 a[62:63], v103 offset:10240
s_waitcnt vmcnt(16)
s_waitcnt lgkmcnt(0)
v_mfma_f32_16x16x32_bf16 v[48:51], a[48:51], a[200:203], v[48:51]
ds_read_b64_tr_b16 a[16:17], v100 offset:16384
v_mfma_f32_16x16x32_bf16 v[80:83], a[48:51], a[204:207], v[80:83]
ds_read_b64_tr_b16 a[18:19], v100 offset:18432
v_mfma_f32_16x16x32_bf16 v[52:55], a[52:55], a[200:203], v[52:55]
ds_read_b64_tr_b16 a[20:21], v101 offset:16384
v_mfma_f32_16x16x32_bf16 v[84:87], a[52:55], a[204:207], v[84:87]
ds_read_b64_tr_b16 a[22:23], v101 offset:18432
v_mfma_f32_16x16x32_bf16 v[56:59], a[56:59], a[200:203], v[56:59]
ds_read_b64_tr_b16 a[24:25], v102 offset:16384
v_mfma_f32_16x16x32_bf16 v[88:91], a[56:59], a[204:207], v[88:91]
ds_read_b64_tr_b16 a[26:27], v102 offset:18432
v_mfma_f32_16x16x32_bf16 v[60:63], a[60:63], a[200:203], v[60:63]
ds_read_b64_tr_b16 a[28:29], v103 offset:16384
v_mfma_f32_16x16x32_bf16 v[92:95], a[60:63], a[204:207], v[92:95]
ds_read_b64_tr_b16 a[30:31], v103 offset:18432
s_waitcnt vmcnt(12)
s_waitcnt lgkmcnt(0)
v_mfma_f32_16x16x32_bf16 v[48:51], a[16:19], a[208:211], v[48:51]
ds_read_b64_tr_b16 a[48:49], v100 offset:24576
v_mfma_f32_16x16x32_bf16 v[80:83], a[16:19], a[212:215], v[80:83]
ds_read_b64_tr_b16 a[50:51], v100 offset:26624
v_mfma_f32_16x16x32_bf16 v[52:55], a[20:23], a[208:211], v[52:55]
ds_read_b64_tr_b16 a[52:53], v101 offset:24576
v_mfma_f32_16x16x32_bf16 v[84:87], a[20:23], a[212:215], v[84:87]
ds_read_b64_tr_b16 a[54:55], v101 offset:26624
v_mfma_f32_16x16x32_bf16 v[56:59], a[24:27], a[208:211], v[56:59]
ds_read_b64_tr_b16 a[56:57], v102 offset:24576
v_mfma_f32_16x16x32_bf16 v[88:91], a[24:27], a[212:215], v[88:91]
ds_read_b64_tr_b16 a[58:59], v102 offset:26624
v_mfma_f32_16x16x32_bf16 v[60:63], a[28:31], a[208:211], v[60:63]
ds_read_b64_tr_b16 a[60:61], v103 offset:24576
v_mfma_f32_16x16x32_bf16 v[92:95], a[28:31], a[212:215], v[92:95]
ds_read_b64_tr_b16 a[62:63], v103 offset:26624
s_waitcnt vmcnt(8)
s_waitcnt lgkmcnt(0)
v_mfma_f32_16x16x32_bf16 v[48:51], a[48:51], a[216:219], v[48:51]
v_mfma_f32_16x16x32_bf16 v[80:83], a[48:51], a[220:223], v[80:83]
v_mfma_f32_16x16x32_bf16 v[52:55], a[52:55], a[216:219], v[52:55]
s_waitcnt vmcnt(10) lgkmcnt(0)
s_barrier
v_mfma_f32_16x16x32_bf16 v[84:87], a[52:55], a[220:223], v[84:87]
ds_read_b64_tr_b16 a[16:17], v100 offset:32768
ds_read_b64_tr_b16 a[18:19], v100 offset:34816
v_mfma_f32_16x16x32_bf16 v[56:59], a[56:59], a[216:219], v[56:59]
ds_read_b64_tr_b16 a[20:21], v101 offset:32768
ds_read_b64_tr_b16 a[22:23], v101 offset:34816
v_mfma_f32_16x16x32_bf16 v[88:91], a[56:59], a[220:223], v[88:91]
ds_read_b64_tr_b16 a[24:25], v102 offset:32768
v_mfma_f32_16x16x32_bf16 v[60:63], a[60:63], a[216:219], v[60:63]
ds_read_b64_tr_b16 a[26:27], v102 offset:34816
ds_read_b64_tr_b16 a[28:29], v103 offset:32768
v_mfma_f32_16x16x32_bf16 v[92:95], a[60:63], a[220:223], v[92:95]
ds_read_b64_tr_b16 a[30:31], v103 offset:34816
s_waitcnt vmcnt(6)
s_waitcnt lgkmcnt(0)
v_mfma_f32_16x16x32_bf16 v[48:51], a[16:19], a[224:227], v[48:51]
ds_read_b64_tr_b16 a[48:49], v100 offset:40960
v_mfma_f32_16x16x32_bf16 v[80:83], a[16:19], a[228:231], v[80:83]
ds_read_b64_tr_b16 a[50:51], v100 offset:43008
v_mfma_f32_16x16x32_bf16 v[52:55], a[20:23], a[224:227], v[52:55]
ds_read_b64_tr_b16 a[52:53], v101 offset:40960
v_mfma_f32_16x16x32_bf16 v[84:87], a[20:23], a[228:231], v[84:87]
ds_read_b64_tr_b16 a[54:55], v101 offset:43008
v_mfma_f32_16x16x32_bf16 v[56:59], a[24:27], a[224:227], v[56:59]
ds_read_b64_tr_b16 a[56:57], v102 offset:40960
v_mfma_f32_16x16x32_bf16 v[88:91], a[24:27], a[228:231], v[88:91]
ds_read_b64_tr_b16 a[58:59], v102 offset:43008
v_mfma_f32_16x16x32_bf16 v[60:63], a[28:31], a[224:227], v[60:63]
ds_read_b64_tr_b16 a[60:61], v103 offset:40960
v_mfma_f32_16x16x32_bf16 v[92:95], a[28:31], a[228:231], v[92:95]
ds_read_b64_tr_b16 a[62:63], v103 offset:43008
s_waitcnt vmcnt(4)
s_waitcnt lgkmcnt(0)
v_mfma_f32_16x16x32_bf16 v[48:51], a[48:51], a[232:235], v[48:51]
ds_read_b64_tr_b16 a[16:17], v100 offset:49152
v_mfma_f32_16x16x32_bf16 v[80:83], a[48:51], a[236:239], v[80:83]
ds_read_b64_tr_b16 a[18:19], v100 offset:51200
v_mfma_f32_16x16x32_bf16 v[52:55], a[52:55], a[232:235], v[52:55]
ds_read_b64_tr_b16 a[20:21], v101 offset:49152
v_mfma_f32_16x16x32_bf16 v[84:87], a[52:55], a[236:239], v[84:87]
ds_read_b64_tr_b16 a[22:23], v101 offset:51200
v_mfma_f32_16x16x32_bf16 v[56:59], a[56:59], a[232:235], v[56:59]
ds_read_b64_tr_b16 a[24:25], v102 offset:49152
v_mfma_f32_16x16x32_bf16 v[88:91], a[56:59], a[236:239], v[88:91]
ds_read_b64_tr_b16 a[26:27], v102 offset:51200
v_mfma_f32_16x16x32_bf16 v[60:63], a[60:63], a[232:235], v[60:63]
ds_read_b64_tr_b16 a[28:29], v103 offset:49152
v_mfma_f32_16x16x32_bf16 v[92:95], a[60:63], a[236:239], v[92:95]
ds_read_b64_tr_b16 a[30:31], v103 offset:51200
s_waitcnt vmcnt(2)
s_waitcnt lgkmcnt(0)
v_mfma_f32_16x16x32_bf16 v[48:51], a[16:19], a[240:243], v[48:51]
ds_read_b64_tr_b16 a[48:49], v100 offset:57344
v_mfma_f32_16x16x32_bf16 v[80:83], a[16:19], a[244:247], v[80:83]
ds_read_b64_tr_b16 a[50:51], v100 offset:59392
v_mfma_f32_16x16x32_bf16 v[52:55], a[20:23], a[240:243], v[52:55]
ds_read_b64_tr_b16 a[52:53], v101 offset:57344
v_mfma_f32_16x16x32_bf16 v[84:87], a[20:23], a[244:247], v[84:87]
ds_read_b64_tr_b16 a[54:55], v101 offset:59392
v_mfma_f32_16x16x32_bf16 v[56:59], a[24:27], a[240:243], v[56:59]
ds_read_b64_tr_b16 a[56:57], v102 offset:57344
v_mfma_f32_16x16x32_bf16 v[88:91], a[24:27], a[244:247], v[88:91]
ds_read_b64_tr_b16 a[58:59], v102 offset:59392
v_mfma_f32_16x16x32_bf16 v[60:63], a[28:31], a[240:243], v[60:63]
ds_read_b64_tr_b16 a[60:61], v103 offset:57344
v_mfma_f32_16x16x32_bf16 v[92:95], a[28:31], a[244:247], v[92:95]
ds_read_b64_tr_b16 a[62:63], v103 offset:59392
s_waitcnt vmcnt(0)
s_waitcnt lgkmcnt(0)
v_mfma_f32_16x16x32_bf16 v[48:51], a[48:51], a[248:251], v[48:51]
ds_read_b64_tr_b16 a[64:65], v104 offset:57344
v_mfma_f32_16x16x32_bf16 v[80:83], a[48:51], a[252:255], v[80:83]
ds_read_b64_tr_b16 a[66:67], v104 offset:59392
v_mfma_f32_16x16x32_bf16 v[52:55], a[52:55], a[248:251], v[52:55]
ds_read_b64_tr_b16 a[68:69], v105 offset:57344
v_mfma_f32_16x16x32_bf16 v[84:87], a[52:55], a[252:255], v[84:87]
ds_read_b64_tr_b16 a[70:71], v105 offset:59392
v_mfma_f32_16x16x32_bf16 v[56:59], a[56:59], a[248:251], v[56:59]
ds_read_b64_tr_b16 a[72:73], v106 offset:57344
v_mfma_f32_16x16x32_bf16 v[88:91], a[56:59], a[252:255], v[88:91]
ds_read_b64_tr_b16 a[74:75], v106 offset:59392
v_mfma_f32_16x16x32_bf16 v[60:63], a[60:63], a[248:251], v[60:63]
ds_read_b64_tr_b16 a[76:77], v107 offset:57344
v_mfma_f32_16x16x32_bf16 v[92:95], a[60:63], a[252:255], v[92:95]
ds_read_b64_tr_b16 a[78:79], v107 offset:59392
v_and_b32 v15, 15, v0
v_lshlrev_b32 v15, 11, v15
v_bfe_u32 v14, v0, 4, 1
v_lshlrev_b32 v14, 5, v14
v_lshrrev_b32 v13, 5, v0
v_lshlrev_b32 v13, 4, v13
v_add3_u32 v3, v13, v14, v15
s_lshl_b32 s41, s99, 16
s_lshl_b32 s42, s98, 8
s_add_u32 s41, s41, s42
s_lshl_b32 s42, s96, 7
s_add_u32 s41, s41, s42
s_add_u32 s42, s41, 32768
v_cvt_pk_bf16_f32 v48, v48, v49
v_cvt_pk_bf16_f32 v49, v50, v51
v_cvt_pk_bf16_f32 v50, v52, v53
v_cvt_pk_bf16_f32 v51, v54, v55
buffer_store_dwordx4 v[48:51], v148, s[16:19], s43 offen offset:0 sc1
v_cvt_pk_bf16_f32 v56, v56, v57
v_cvt_pk_bf16_f32 v57, v58, v59
v_cvt_pk_bf16_f32 v58, v60, v61
v_cvt_pk_bf16_f32 v59, v62, v63
buffer_store_dwordx4 v[56:59], v148, s[16:19], s43 offen offset:1024 sc1
v_cvt_pk_bf16_f32 v80, v80, v81
v_cvt_pk_bf16_f32 v81, v82, v83
v_cvt_pk_bf16_f32 v82, v84, v85
v_cvt_pk_bf16_f32 v83, v86, v87
buffer_store_dwordx4 v[80:83], v148, s[16:19], s43 offen offset:2048 sc1
v_cvt_pk_bf16_f32 v88, v88, v89
v_cvt_pk_bf16_f32 v89, v90, v91
v_cvt_pk_bf16_f32 v90, v92, v93
v_cvt_pk_bf16_f32 v91, v94, v95
buffer_store_dwordx4 v[88:91], v148, s[16:19], s43 offen offset:3072 sc1
s_waitcnt lgkmcnt(4)
v_mfma_f32_16x16x32_bf16 v[32:35], a[64:67], a[184:187], v[32:35]
ds_read_b64_tr_b16 a[80:81], v96 offset:0
v_mfma_f32_16x16x32_bf16 v[64:67], a[64:67], a[188:191], v[64:67]
ds_read_b64_tr_b16 a[82:83], v96 offset:2048
v_mfma_f32_16x16x32_bf16 v[36:39], a[68:71], a[184:187], v[36:39]
ds_read_b64_tr_b16 a[84:85], v97 offset:0
v_mfma_f32_16x16x32_bf16 v[68:71], a[68:71], a[188:191], v[68:71]
ds_read_b64_tr_b16 a[86:87], v97 offset:2048
s_waitcnt lgkmcnt(4)
v_mfma_f32_16x16x32_bf16 v[40:43], a[72:75], a[184:187], v[40:43]
ds_read_b64_tr_b16 a[88:89], v98 offset:0
v_mfma_f32_16x16x32_bf16 v[72:75], a[72:75], a[188:191], v[72:75]
ds_read_b64_tr_b16 a[90:91], v98 offset:2048
v_mfma_f32_16x16x32_bf16 v[44:47], a[76:79], a[184:187], v[44:47]
ds_read_b64_tr_b16 a[92:93], v99 offset:0
v_mfma_f32_16x16x32_bf16 v[76:79], a[76:79], a[188:191], v[76:79]
ds_read_b64_tr_b16 a[94:95], v99 offset:2048
s_waitcnt lgkmcnt(4)
v_mfma_f32_16x16x32_bf16 v[32:35], a[80:83], a[192:195], v[32:35]
ds_read_b64_tr_b16 a[64:65], v96 offset:8192
v_mfma_f32_16x16x32_bf16 v[64:67], a[80:83], a[196:199], v[64:67]
ds_read_b64_tr_b16 a[66:67], v96 offset:10240
v_mfma_f32_16x16x32_bf16 v[36:39], a[84:87], a[192:195], v[36:39]
ds_read_b64_tr_b16 a[68:69], v97 offset:8192
v_mfma_f32_16x16x32_bf16 v[68:71], a[84:87], a[196:199], v[68:71]
ds_read_b64_tr_b16 a[70:71], v97 offset:10240
s_waitcnt lgkmcnt(4)
v_mfma_f32_16x16x32_bf16 v[40:43], a[88:91], a[192:195], v[40:43]
ds_read_b64_tr_b16 a[72:73], v98 offset:8192
v_mfma_f32_16x16x32_bf16 v[72:75], a[88:91], a[196:199], v[72:75]
ds_read_b64_tr_b16 a[74:75], v98 offset:10240
v_mfma_f32_16x16x32_bf16 v[44:47], a[92:95], a[192:195], v[44:47]
ds_read_b64_tr_b16 a[76:77], v99 offset:8192
v_mfma_f32_16x16x32_bf16 v[76:79], a[92:95], a[196:199], v[76:79]
ds_read_b64_tr_b16 a[78:79], v99 offset:10240
s_waitcnt lgkmcnt(4)
v_mfma_f32_16x16x32_bf16 v[32:35], a[64:67], a[200:203], v[32:35]
ds_read_b64_tr_b16 a[80:81], v96 offset:16384
v_mfma_f32_16x16x32_bf16 v[64:67], a[64:67], a[204:207], v[64:67]
ds_read_b64_tr_b16 a[82:83], v96 offset:18432
v_mfma_f32_16x16x32_bf16 v[36:39], a[68:71], a[200:203], v[36:39]
ds_read_b64_tr_b16 a[84:85], v97 offset:16384
v_mfma_f32_16x16x32_bf16 v[68:71], a[68:71], a[204:207], v[68:71]
ds_read_b64_tr_b16 a[86:87], v97 offset:18432
s_waitcnt lgkmcnt(4)
v_mfma_f32_16x16x32_bf16 v[40:43], a[72:75], a[200:203], v[40:43]
ds_read_b64_tr_b16 a[88:89], v98 offset:16384
v_mfma_f32_16x16x32_bf16 v[72:75], a[72:75], a[204:207], v[72:75]
ds_read_b64_tr_b16 a[90:91], v98 offset:18432
v_mfma_f32_16x16x32_bf16 v[44:47], a[76:79], a[200:203], v[44:47]
ds_read_b64_tr_b16 a[92:93], v99 offset:16384
v_mfma_f32_16x16x32_bf16 v[76:79], a[76:79], a[204:207], v[76:79]
ds_read_b64_tr_b16 a[94:95], v99 offset:18432
s_waitcnt lgkmcnt(4)
v_mfma_f32_16x16x32_bf16 v[32:35], a[80:83], a[208:211], v[32:35]
ds_read_b64_tr_b16 a[64:65], v96 offset:24576
v_mfma_f32_16x16x32_bf16 v[64:67], a[80:83], a[212:215], v[64:67]
ds_read_b64_tr_b16 a[66:67], v96 offset:26624
v_mfma_f32_16x16x32_bf16 v[36:39], a[84:87], a[208:211], v[36:39]
ds_read_b64_tr_b16 a[68:69], v97 offset:24576
v_mfma_f32_16x16x32_bf16 v[68:71], a[84:87], a[212:215], v[68:71]
ds_read_b64_tr_b16 a[70:71], v97 offset:26624
s_waitcnt lgkmcnt(4)
v_mfma_f32_16x16x32_bf16 v[40:43], a[88:91], a[208:211], v[40:43]
ds_read_b64_tr_b16 a[72:73], v98 offset:24576
v_mfma_f32_16x16x32_bf16 v[72:75], a[88:91], a[212:215], v[72:75]
ds_read_b64_tr_b16 a[74:75], v98 offset:26624
v_mfma_f32_16x16x32_bf16 v[44:47], a[92:95], a[208:211], v[44:47]
ds_read_b64_tr_b16 a[76:77], v99 offset:24576
v_mfma_f32_16x16x32_bf16 v[76:79], a[92:95], a[212:215], v[76:79]
ds_read_b64_tr_b16 a[78:79], v99 offset:26624
s_waitcnt lgkmcnt(4)
v_mfma_f32_16x16x32_bf16 v[32:35], a[64:67], a[216:219], v[32:35]
ds_read_b64_tr_b16 a[80:81], v96 offset:32768
v_mfma_f32_16x16x32_bf16 v[64:67], a[64:67], a[220:223], v[64:67]
ds_read_b64_tr_b16 a[82:83], v96 offset:34816
v_mfma_f32_16x16x32_bf16 v[36:39], a[68:71], a[216:219], v[36:39]
ds_read_b64_tr_b16 a[84:85], v97 offset:32768
v_mfma_f32_16x16x32_bf16 v[68:71], a[68:71], a[220:223], v[68:71]
ds_read_b64_tr_b16 a[86:87], v97 offset:34816
s_waitcnt lgkmcnt(4)
v_mfma_f32_16x16x32_bf16 v[40:43], a[72:75], a[216:219], v[40:43]
ds_read_b64_tr_b16 a[88:89], v98 offset:32768
v_mfma_f32_16x16x32_bf16 v[72:75], a[72:75], a[220:223], v[72:75]
ds_read_b64_tr_b16 a[90:91], v98 offset:34816
v_mfma_f32_16x16x32_bf16 v[44:47], a[76:79], a[216:219], v[44:47]
ds_read_b64_tr_b16 a[92:93], v99 offset:32768
v_mfma_f32_16x16x32_bf16 v[76:79], a[76:79], a[220:223], v[76:79]
ds_read_b64_tr_b16 a[94:95], v99 offset:34816
s_waitcnt lgkmcnt(4)
v_mfma_f32_16x16x32_bf16 v[32:35], a[80:83], a[224:227], v[32:35]
ds_read_b64_tr_b16 a[64:65], v96 offset:40960
v_mfma_f32_16x16x32_bf16 v[64:67], a[80:83], a[228:231], v[64:67]
ds_read_b64_tr_b16 a[66:67], v96 offset:43008
v_mfma_f32_16x16x32_bf16 v[36:39], a[84:87], a[224:227], v[36:39]
ds_read_b64_tr_b16 a[68:69], v97 offset:40960
v_mfma_f32_16x16x32_bf16 v[68:71], a[84:87], a[228:231], v[68:71]
ds_read_b64_tr_b16 a[70:71], v97 offset:43008
s_waitcnt lgkmcnt(4)
v_mfma_f32_16x16x32_bf16 v[40:43], a[88:91], a[224:227], v[40:43]
ds_read_b64_tr_b16 a[72:73], v98 offset:40960
v_mfma_f32_16x16x32_bf16 v[72:75], a[88:91], a[228:231], v[72:75]
ds_read_b64_tr_b16 a[74:75], v98 offset:43008
v_mfma_f32_16x16x32_bf16 v[44:47], a[92:95], a[224:227], v[44:47]
ds_read_b64_tr_b16 a[76:77], v99 offset:40960
v_mfma_f32_16x16x32_bf16 v[76:79], a[92:95], a[228:231], v[76:79]
ds_read_b64_tr_b16 a[78:79], v99 offset:43008
s_waitcnt lgkmcnt(4)
v_mfma_f32_16x16x32_bf16 v[32:35], a[64:67], a[232:235], v[32:35]
ds_read_b64_tr_b16 a[80:81], v96 offset:49152
v_mfma_f32_16x16x32_bf16 v[64:67], a[64:67], a[236:239], v[64:67]
ds_read_b64_tr_b16 a[82:83], v96 offset:51200
v_mfma_f32_16x16x32_bf16 v[36:39], a[68:71], a[232:235], v[36:39]
ds_read_b64_tr_b16 a[84:85], v97 offset:49152
v_mfma_f32_16x16x32_bf16 v[68:71], a[68:71], a[236:239], v[68:71]
ds_read_b64_tr_b16 a[86:87], v97 offset:51200
s_waitcnt lgkmcnt(4)
v_mfma_f32_16x16x32_bf16 v[40:43], a[72:75], a[232:235], v[40:43]
ds_read_b64_tr_b16 a[88:89], v98 offset:49152
v_mfma_f32_16x16x32_bf16 v[72:75], a[72:75], a[236:239], v[72:75]
ds_read_b64_tr_b16 a[90:91], v98 offset:51200
v_mfma_f32_16x16x32_bf16 v[44:47], a[76:79], a[232:235], v[44:47]
ds_read_b64_tr_b16 a[92:93], v99 offset:49152
v_mfma_f32_16x16x32_bf16 v[76:79], a[76:79], a[236:239], v[76:79]
ds_read_b64_tr_b16 a[94:95], v99 offset:51200
s_waitcnt lgkmcnt(4)
v_mfma_f32_16x16x32_bf16 v[32:35], a[80:83], a[240:243], v[32:35]
ds_read_b64_tr_b16 a[64:65], v96 offset:57344
v_mfma_f32_16x16x32_bf16 v[64:67], a[80:83], a[244:247], v[64:67]
ds_read_b64_tr_b16 a[66:67], v96 offset:59392
v_mfma_f32_16x16x32_bf16 v[36:39], a[84:87], a[240:243], v[36:39]
ds_read_b64_tr_b16 a[68:69], v97 offset:57344
v_mfma_f32_16x16x32_bf16 v[68:71], a[84:87], a[244:247], v[68:71]
ds_read_b64_tr_b16 a[70:71], v97 offset:59392
s_waitcnt lgkmcnt(4)
v_mfma_f32_16x16x32_bf16 v[40:43], a[88:91], a[240:243], v[40:43]
ds_read_b64_tr_b16 a[72:73], v98 offset:57344
v_mfma_f32_16x16x32_bf16 v[72:75], a[88:91], a[244:247], v[72:75]
ds_read_b64_tr_b16 a[74:75], v98 offset:59392
v_mfma_f32_16x16x32_bf16 v[44:47], a[92:95], a[240:243], v[44:47]
ds_read_b64_tr_b16 a[76:77], v99 offset:57344
v_mfma_f32_16x16x32_bf16 v[76:79], a[92:95], a[244:247], v[76:79]
ds_read_b64_tr_b16 a[78:79], v99 offset:59392
s_waitcnt lgkmcnt(4)
v_mfma_f32_16x16x32_bf16 v[32:35], a[64:67], a[248:251], v[32:35]
v_mfma_f32_16x16x32_bf16 v[64:67], a[64:67], a[252:255], v[64:67]
v_mfma_f32_16x16x32_bf16 v[36:39], a[68:71], a[248:251], v[36:39]
v_mfma_f32_16x16x32_bf16 v[68:71], a[68:71], a[252:255], v[68:71]
s_waitcnt lgkmcnt(0)
v_mfma_f32_16x16x32_bf16 v[40:43], a[72:75], a[248:251], v[40:43]
v_mfma_f32_16x16x32_bf16 v[72:75], a[72:75], a[252:255], v[72:75]
v_mfma_f32_16x16x32_bf16 v[44:47], a[76:79], a[248:251], v[44:47]
v_mfma_f32_16x16x32_bf16 v[76:79], a[76:79], a[252:255], v[76:79]
s_mov_b32 s57, 0
L_g2_poll:
buffer_load_dwordx4 v[112:115], v148, s[16:19], s44 offen offset:0 sc1
buffer_load_dwordx4 v[116:119], v148, s[16:19], s44 offen offset:1024 sc1
buffer_load_dwordx4 v[120:123], v148, s[16:19], s44 offen offset:2048 sc1
buffer_load_dwordx4 v[124:127], v148, s[16:19], s44 offen offset:3072 sc1
s_waitcnt vmcnt(0)
v_max3_u32 v9, v112, v113, v114
v_max3_u32 v10, v115, v116, v117
v_max3_u32 v9, v9, v118, v119
v_max3_u32 v10, v10, v120, v121
v_max3_u32 v9, v9, v122, v123
v_max3_u32 v10, v10, v124, v125
v_max3_u32 v9, v9, v126, v127
v_max_u32 v9, v9, v10
v_cmp_eq_u32 vcc, -1, v9
s_cbranch_vccz L_g2_polled
s_add_u32 s57, s57, 1
s_cmp_gt_u32 s57, 20000
s_cbranch_scc0 L_g2_poll
L_g2_polled:
v_lshlrev_b32 v128, 16, v112
v_and_b32 v129, 0xffff0000, v112
v_pk_add_f32 v[32:33], v[32:33], v[128:129]
v_lshlrev_b32 v130, 16, v113
v_and_b32 v131, 0xffff0000, v113
v_pk_add_f32 v[34:35], v[34:35], v[130:131]
v_lshlrev_b32 v132, 16, v114
v_and_b32 v133, 0xffff0000, v114
v_pk_add_f32 v[36:37], v[36:37], v[132:133]
v_lshlrev_b32 v134, 16, v115
v_and_b32 v135, 0xffff0000, v115
v_pk_add_f32 v[38:39], v[38:39], v[134:135]
v_cvt_pk_bf16_f32 v16, v32, v33
v_cvt_pk_bf16_f32 v17, v34, v35
v_cvt_pk_bf16_f32 v18, v36, v37
v_cvt_pk_bf16_f32 v19, v38, v39
s_nop 1
v_permlane16_swap_b32 v16, v18
v_permlane16_swap_b32 v17, v19
buffer_store_dwordx4 v[16:19], v3, s[88:91], s41 offen offset:0
v_lshlrev_b32 v128, 16, v116
v_and_b32 v129, 0xffff0000, v116
v_pk_add_f32 v[40:41], v[40:41], v[128:129]
v_lshlrev_b32 v130, 16, v117
v_and_b32 v131, 0xffff0000, v117
v_pk_add_f32 v[42:43], v[42:43], v[130:131]
v_lshlrev_b32 v132, 16, v118
v_and_b32 v133, 0xffff0000, v118
v_pk_add_f32 v[44:45], v[44:45], v[132:133]
v_lshlrev_b32 v134, 16, v119
v_and_b32 v135, 0xffff0000, v119
v_pk_add_f32 v[46:47], v[46:47], v[134:135]
v_cvt_pk_bf16_f32 v20, v40, v41
v_cvt_pk_bf16_f32 v21, v42, v43
v_cvt_pk_bf16_f32 v22, v44, v45
v_cvt_pk_bf16_f32 v23, v46, v47
s_nop 1
v_permlane16_swap_b32 v20, v22
v_permlane16_swap_b32 v21, v23
buffer_store_dwordx4 v[20:23], v3, s[88:91], s41 offen offset:64
v_lshlrev_b32 v128, 16, v120
v_and_b32 v129, 0xffff0000, v120
v_pk_add_f32 v[64:65], v[64:65], v[128:129]
v_lshlrev_b32 v130, 16, v121
v_and_b32 v131, 0xffff0000, v121
v_pk_add_f32 v[66:67], v[66:67], v[130:131]
v_lshlrev_b32 v132, 16, v122
v_and_b32 v133, 0xffff0000, v122
v_pk_add_f32 v[68:69], v[68:69], v[132:133]
v_lshlrev_b32 v134, 16, v123
v_and_b32 v135, 0xffff0000, v123
v_pk_add_f32 v[70:71], v[70:71], v[134:135]
v_cvt_pk_bf16_f32 v24, v64, v65
v_cvt_pk_bf16_f32 v25, v66, v67
v_cvt_pk_bf16_f32 v26, v68, v69
v_cvt_pk_bf16_f32 v27, v70, v71
s_nop 1
v_permlane16_swap_b32 v24, v26
v_permlane16_swap_b32 v25, v27
buffer_store_dwordx4 v[24:27], v3, s[88:91], s42 offen offset:0
v_lshlrev_b32 v128, 16, v124
v_and_b32 v129, 0xffff0000, v124
v_pk_add_f32 v[72:73], v[72:73], v[128:129]
v_lshlrev_b32 v130, 16, v125
v_and_b32 v131, 0xffff0000, v125
v_pk_add_f32 v[74:75], v[74:75], v[130:131]
v_lshlrev_b32 v132, 16, v126
v_and_b32 v133, 0xffff0000, v126
v_pk_add_f32 v[76:77], v[76:77], v[132:133]
v_lshlrev_b32 v134, 16, v127
v_and_b32 v135, 0xffff0000, v127
v_pk_add_f32 v[78:79], v[78:79], v[134:135]
v_cvt_pk_bf16_f32 v28, v72, v73
v_cvt_pk_bf16_f32 v29, v74, v75
v_cvt_pk_bf16_f32 v30, v76, v77
v_cvt_pk_bf16_f32 v31, v78, v79
s_nop 1
v_permlane16_swap_b32 v28, v30
v_permlane16_swap_b32 v29, v31
buffer_store_dwordx4 v[28:31], v3, s[88:91], s42 offen offset:64
L_g12_end:
s_endpgm
.section .rodata,"a"
.p2align 6
.amdhsa_kernel sequential_preLN__ssm_conv_h3__glu_gated_swiglu__prompt_kernel
  .amdhsa_next_free_vgpr 512
  .amdhsa_next_free_sgpr 102
  .amdhsa_accum_offset 256
  .amdhsa_group_segment_fixed_size 0
  .amdhsa_kernarg_size 104
  .amdhsa_user_sgpr_count 2
  .amdhsa_user_sgpr_kernarg_segment_ptr 1
  .amdhsa_system_sgpr_workgroup_id_x 1
  .amdhsa_float_denorm_mode_32 3
  .amdhsa_float_denorm_mode_16_64 3
.end_amdhsa_kernel
```
